```python
import torch

def _softmax(x, axis=-1):
    return torch.softmax(x, dim=axis)
def _gelu(x):
    return torch.nn.functional.gelu(x, approximate="tanh")
def _silu(x):
    return torch.nn.functional.silu(x)
def _sigmoid(x):
    return torch.sigmoid(x)
def _layernorm(x, axis=-1, eps=1e-5):
    m = x.mean(dim=axis, keepdim=True)
    v = x.var(dim=axis, keepdim=True, unbiased=False)
    return (x - m) / torch.sqrt(v + eps)
def _scatter_add(tgt, idx, src, axis=0):
    return tgt.clone().index_add_(axis, idx, src)
def _segment_sum(src, seg, n):
    out = torch.zeros((n,) + src.shape[1:], dtype=src.dtype)
    return out.index_add_(0, seg, src)
def _pad(x, pw):
    flat = tuple(v for pair in reversed(pw) for v in pair)
    return torch.nn.functional.pad(x, flat)

kernel_name = 'parallel_sum__mha_block__mixer_s_mlp__prompt'

def setup_inputs():

    _w = (lambda a: (lambda t: t.to(torch.bfloat16) if t.is_floating_point() else t)(torch.as_tensor(a)))
    def _A_setup():
        B, S, D, H = 1, 2048, 640, 32
        return {
            "x": _w((lambda *s: torch.randn(*s, dtype=torch.bfloat16) * 0.05)(B, S, D)),
            "wqkv": _w((lambda *s: torch.randn(*s, dtype=torch.bfloat16) * 0.05)(D, 3 * D)),
            "wo": _w((lambda *s: torch.randn(*s, dtype=torch.bfloat16) * 0.05)(D, D)),
        }
    _A_in = _A_setup()

    def _B_setup():
        B, S, D, F = 1, 2048, 640, 1536
        return {
            "x":  _w((lambda *s: torch.randn(*s, dtype=torch.bfloat16) * 0.05)(B, S, D)),
            "w1": _w((lambda *s: torch.randn(*s, dtype=torch.bfloat16) * 0.8)(D, D) * (D ** -0.5)),
            "w2": _w((lambda *s: torch.randn(*s, dtype=torch.bfloat16) * 0.8)(D, D) * (D ** -0.5)),
            "w3": _w((lambda *s: torch.randn(*s, dtype=torch.bfloat16) * 0.8)(D, F) * (D ** -0.5)),
            "w4": _w((lambda *s: torch.randn(*s, dtype=torch.bfloat16) * 0.8)(F, D) * (F ** -0.5)),
        }
    _B_in = _B_setup()

    return {
        "A_x": _A_in["x"],
        "A_wqkv": _A_in["wqkv"],
        "A_wo": _A_in["wo"],
        "B_x": _B_in["x"],
        "B_w1": _B_in["w1"],
        "B_w2": _B_in["w2"],
        "B_w3": _B_in["w3"],
        "B_w4": _B_in["w4"],
    }

def reference(A_x, A_wqkv, A_wo, B_x, B_w1, B_w2, B_w3, B_w4):
    def _A_ref(x, wqkv, wo):
        B, S, D = x.shape
        H = 32
        Dh = D // H
        qkv = (lambda x, *d: x.permute(*d))((x @ wqkv).reshape(B, S, 3, H, Dh), 2, 0, 3, 1, 4)
        q, k, v = qkv[0], qkv[1], qkv[2]
        scores = torch.einsum("bhqd,bhkd->bhqk", q, k) * (Dh ** -0.5)
        p = _softmax(scores, axis=-1)
        o = torch.einsum("bhqk,bhkd->bhqd", p, v)
        return (lambda x, *d: x.permute(*d))(o, 0, 2, 1, 3).reshape(B, S, D) @ wo

    def _B_ref(x, w1, w2, w3, w4):
        B, S, D = x.shape
        h = _gelu(_layernorm(x, axis=-1) @ w1)
        c = D // 4
        g0 = _pad(h[:, :, 0*c:1*c], ((0, 0), (1, 0), (0, 0)))[:, :S, :]
        g1 = _pad(h[:, :, 1*c:2*c], ((0, 0), (0, 1), (0, 0)))[:, 1:, :]
        g2 = _pad(h[:, :, 2*c:3*c], ((0, 0), (2, 0), (0, 0)))[:, :S, :]
        g3 = _pad(h[:, :, 3*c:   ], ((0, 0), (0, 2), (0, 0)))[:, 2:, :]
        hs = torch.concatenate([g0, g1, g2, g3], axis=-1) @ w2
        x1 = x + hs
        h2 = _gelu(_layernorm(x1, axis=-1) @ w3) @ w4
        return x1 + h2

    x = A_x
    xn = _layernorm(x, axis=-1)
    return x + _A_ref(xn, A_wqkv, A_wo) + _B_ref(xn, B_w1, B_w2, B_w3, B_w4)
```

```asm
; @launch kernel=g1_kernel grid=(256,1,1) block=(512,1,1) lds=155648
; @launch kernel=l2_kernel grid=(512,1,1) block=(256,1,1) lds=73728
.amdgcn_target "amdgcn-amd-amdhsa--gfx950"
.text
.globl g1_kernel
.p2align 8
.type g1_kernel,@function
g1_kernel:
  s_cmp_ge_u32 s2, 256
  s_cbranch_scc1 g1_kernel_end1
  s_load_dwordx16 s[40:55], s[0:1], 0
  s_load_dwordx2 s[56:57], s[0:1], 80
  v_lshrrev_b32 v8, 6, v0
  s_and_b32 s36, s2, 7
  s_lshr_b32 s37, s2, 3
  v_readfirstlane_b32 s20, v8
  s_and_b32 s38, s36, 1
  s_lshl_b32 s38, s38, 3
  s_and_b32 s39, s37, 7
  s_add_u32 s21, s38, s39
  s_lshr_b32 s23, s36, 1
  s_lshr_b32 s24, s37, 3
  v_and_b32 v1, 63, v0
  v_and_b32 v2, 31, v1
  v_lshrrev_b32 v3, 5, v1
  s_and_b32 s29, s20, 3
  s_lshl_b32 s32, s23, 2
  s_add_u32 s32, s32, s24
  s_lshl_b32 s33, s21, 2
  s_add_u32 s33, s33, s29
  s_lshl_b32 s27, s29, 12
  s_movk_i32 s34, 1280
  s_cmp_eq_u32 s23, 3
  s_cselect_b32 s25, s34, 3840
  s_lshl_b32 s26, s25, 6
  v_mov_b32 v4, 0x3f803f80
  v_mov_b32 v5, 0x3f803f80
  s_cmp_ge_u32 s20, 4
  s_cbranch_scc1 g1_kernel_loader2
  s_waitcnt lgkmcnt(0)
  s_mov_b32 s16, s56
  s_and_b32 s17, s57, 0xffff
  s_mov_b32 s18, 37748736
  s_mov_b32 s19, 0x20000
  v_lshrrev_b32 v8, 1, v2
  v_and_b32 v8, 7, v8
  v_lshlrev_b32 v9, 7, v2
  v_add_u32 v9, s27, v9
  v_add_u32 v10, 0, v3
  v_xor_b32 v10, v10, v8
  v_lshlrev_b32 v10, 4, v10
  v_add_u32 v58, v9, v10
  v_add_u32 v10, 2, v3
  v_xor_b32 v10, v10, v8
  v_lshlrev_b32 v10, 4, v10
  v_add_u32 v59, v9, v10
  v_add_u32 v10, 4, v3
  v_xor_b32 v10, v10, v8
  v_lshlrev_b32 v10, 4, v10
  v_add_u32 v60, v9, v10
  v_add_u32 v10, 6, v3
  v_xor_b32 v10, v10, v8
  v_lshlrev_b32 v10, 4, v10
  v_add_u32 v61, v9, v10
  v_lshrrev_b32 v8, 4, v1
  v_and_b32 v9, 15, v1
  v_lshrrev_b32 v10, 2, v9
  v_and_b32 v9, 3, v9
  v_lshrrev_b32 v11, 1, v8
  v_lshlrev_b32 v11, 3, v11
  v_add_u32 v10, v10, v11
  v_mul_u32_u24 v10, 320, v10
  v_and_b32 v8, 1, v8
  v_lshlrev_b32 v8, 5, v8
  v_lshlrev_b32 v9, 3, v9
  v_add3_u32 v62, v10, v8, v9
  v_add_u32 v62, 65536, v62
  v_mov_b32 v63, v62
  s_mov_b32 s39, 0
  v_mov_b32 v64, 0
  v_mov_b32 v65, 0
  v_mov_b32 v66, 0
  v_mov_b32 v67, 0
  v_mov_b32 v68, 0
  v_mov_b32 v69, 0
  v_mov_b32 v70, 0
  v_mov_b32 v71, 0
  v_mov_b32 v72, 0
  v_mov_b32 v73, 0
  v_mov_b32 v74, 0
  v_mov_b32 v75, 0
  v_mov_b32 v76, 0
  v_mov_b32 v77, 0
  v_mov_b32 v78, 0
  v_mov_b32 v79, 0
  v_mov_b32 v80, 0
  v_mov_b32 v81, 0
  v_mov_b32 v82, 0
  v_mov_b32 v83, 0
  v_mov_b32 v84, 0
  v_mov_b32 v85, 0
  v_mov_b32 v86, 0
  v_mov_b32 v87, 0
  v_mov_b32 v88, 0
  v_mov_b32 v89, 0
  v_mov_b32 v90, 0
  v_mov_b32 v91, 0
  v_mov_b32 v92, 0
  v_mov_b32 v93, 0
  v_mov_b32 v94, 0
  v_mov_b32 v95, 0
  v_mov_b32 v96, 0
  v_mov_b32 v97, 0
  v_mov_b32 v98, 0
  v_mov_b32 v99, 0
  v_mov_b32 v100, 0
  v_mov_b32 v101, 0
  v_mov_b32 v102, 0
  v_mov_b32 v103, 0
  v_mov_b32 v104, 0
  v_mov_b32 v105, 0
  v_mov_b32 v106, 0
  v_mov_b32 v107, 0
  v_mov_b32 v108, 0
  v_mov_b32 v109, 0
  v_mov_b32 v110, 0
  v_mov_b32 v111, 0
  v_mov_b32 v112, 0
  v_mov_b32 v113, 0
  v_mov_b32 v114, 0
  v_mov_b32 v115, 0
  v_mov_b32 v116, 0
  v_mov_b32 v117, 0
  v_mov_b32 v118, 0
  v_mov_b32 v119, 0
  v_mov_b32 v120, 0
  v_mov_b32 v121, 0
  v_mov_b32 v122, 0
  v_mov_b32 v123, 0
  v_mov_b32 v124, 0
  v_mov_b32 v125, 0
  v_mov_b32 v126, 0
  v_mov_b32 v127, 0
  v_mov_b32 v128, 0
  v_mov_b32 v129, 0
  v_mov_b32 v130, 0
  v_mov_b32 v131, 0
  v_mov_b32 v132, 0
  v_mov_b32 v133, 0
  v_mov_b32 v134, 0
  v_mov_b32 v135, 0
  v_mov_b32 v136, 0
  v_mov_b32 v137, 0
  v_mov_b32 v138, 0
  v_mov_b32 v139, 0
  v_mov_b32 v140, 0
  v_mov_b32 v141, 0
  v_mov_b32 v142, 0
  v_mov_b32 v143, 0
  s_getpc_b64 s[72:73]
g1_kernel_pc3:
  s_sub_u32 s72, s72, g1_kernel_pc3-g1_kernel
  s_subb_u32 s73, s73, 0
  s_and_b32 s73, s73, 0xffff
  s_mov_b32 s74, TEXT_END-g1_kernel
  s_mov_b32 s75, 0x20000
  s_lshr_b32 s34, s2, 3
  s_lshl_b32 s34, s34, 2
  s_add_u32 s34, s34, s29
  s_lshl_b32 s34, s34, 10
  v_lshlrev_b32 v56, 4, v1
  buffer_load_dwordx4 v[52:55], v56, s[72:75], s34 offen
  s_waitcnt lgkmcnt(0)
  s_cmp_lg_u32 s29, 0
  s_cbranch_scc1 g1_kernel_nf4
  s_mul_i32 s34, s2, 1536
  s_add_u32 s34, s34, 31457280
  v_lshlrev_b32 v20, 4, v1
  v_mov_b32 v16, 0
  v_mov_b32 v17, 0
  v_mov_b32 v18, 0
  v_mov_b32 v19, 0
  buffer_store_dwordx4 v[16:19], v20, s[16:19], s34 offen sc1
  s_mov_b32 exec_hi, 0
  buffer_store_dwordx4 v[16:19], v20, s[16:19], s34 offen offset:1024 sc1
  s_mov_b64 exec, -1
g1_kernel_nf4:
  s_mul_i32 s34, s21, 163840
  s_add_u32 s4, s40, s34
  s_addc_u32 s5, s41, 0
  s_mov_b32 s8, s4
  s_and_b32 s9, s5, 0xffff
  s_mov_b32 s10, 163840
  s_mov_b32 s11, 0x20000
  s_mul_i32 s35, s24, 320
  s_cmp_eq_u32 s23, 3
  s_cbranch_scc1 g1_kernel_w15
  s_mul_i32 s36, s23, 1280
  s_add_u32 s35, s35, s36
  s_add_u32 s6, s42, s35
  s_addc_u32 s7, s43, 0
  s_sub_u32 s36, 2457600, s35
  s_branch g1_kernel_wd6
g1_kernel_w15:
  s_add_u32 s6, s48, s35
  s_addc_u32 s7, s49, 0
  s_sub_u32 s36, 819200, s35
g1_kernel_wd6:
  s_mov_b32 s12, s6
  s_and_b32 s13, s7, 0xffff
  s_mov_b32 s14, s36
  s_mov_b32 s15, 0x20000
  v_mov_b32 v216, 0
  v_mov_b32 v217, 0
  v_mov_b32 v218, 0
  v_mov_b32 v219, 0
  v_mov_b32 v220, 0
  v_mov_b32 v221, 0
  v_mov_b32 v222, 0
  v_mov_b32 v223, 0
  v_mov_b32 v224, 0
  v_mov_b32 v225, 0
  v_mov_b32 v226, 0
  v_mov_b32 v227, 0
  v_mov_b32 v228, 0
  v_mov_b32 v229, 0
  v_mov_b32 v230, 0
  v_mov_b32 v231, 0
  v_mov_b32 v232, 0
  v_mov_b32 v233, 0
  v_mov_b32 v234, 0
  v_mov_b32 v235, 0
  v_mov_b32 v240, 0
  v_mov_b32 v241, 0
  v_mov_b32 v242, 0
  v_mov_b32 v243, 0
  v_mov_b32 v244, 0
  v_mov_b32 v245, 0
  v_mov_b32 v246, 0
  v_mov_b32 v247, 0
  s_cmp_eq_u32 s23, 2
  s_cbranch_scc1 g1_kernel_V7
  s_barrier
  v_add_u32 v237, 61440, v62
  ds_read_b128 v[144:147], v58 offset:0
  ds_read_b64_tr_b16 v[156:157], v62 offset:0
  ds_read_b64_tr_b16 v[158:159], v62 offset:1280
  ds_read_b64_tr_b16 v[160:161], v62 offset:64
  ds_read_b64_tr_b16 v[162:163], v62 offset:1344
  ds_read_b64_tr_b16 v[164:165], v62 offset:128
  ds_read_b64_tr_b16 v[166:167], v62 offset:1408
  ds_read_b64_tr_b16 v[168:169], v62 offset:192
  ds_read_b64_tr_b16 v[170:171], v62 offset:1472
  ds_read_b64_tr_b16 v[172:173], v62 offset:256
  ds_read_b64_tr_b16 v[174:175], v62 offset:1536
  ds_read_b128 v[148:151], v59 offset:0
  ds_read_b64_tr_b16 v[176:177], v62 offset:5120
  ds_read_b64_tr_b16 v[178:179], v62 offset:6400
  ds_read_b64_tr_b16 v[180:181], v62 offset:5184
  ds_read_b64_tr_b16 v[182:183], v62 offset:6464
  ds_read_b64_tr_b16 v[184:185], v62 offset:5248
  ds_read_b64_tr_b16 v[186:187], v62 offset:6528
  ds_read_b64_tr_b16 v[188:189], v62 offset:5312
  ds_read_b64_tr_b16 v[190:191], v62 offset:6592
  ds_read_b64_tr_b16 v[192:193], v62 offset:5376
  ds_read_b64_tr_b16 v[194:195], v62 offset:6656
  s_waitcnt lgkmcnt(11)
  v_mfma_f32_32x32x16_bf16 v[64:79], v[156:159], v[144:147], 0
  ds_read_b128 v[152:155], v60 offset:0
  ds_read_b64_tr_b16 v[196:197], v62 offset:10240
  ds_read_b64_tr_b16 v[198:199], v62 offset:11520
  v_lshlrev_b32 v248, 16, v144
  v_and_b32 v249, 0xffff0000, v144
  v_add_f32 v240, v240, v248
  v_fmac_f32 v244, v248, v248
  v_add_f32 v242, v242, v249
  v_mfma_f32_32x32x16_bf16 v[80:95], v[160:163], v[144:147], 0
  ds_read_b64_tr_b16 v[200:201], v62 offset:10304
  ds_read_b64_tr_b16 v[202:203], v62 offset:11584
  v_fmac_f32 v246, v249, v249
  v_lshlrev_b32 v250, 16, v145
  v_and_b32 v251, 0xffff0000, v145
  v_add_f32 v241, v241, v250
  v_fmac_f32 v245, v250, v250
  v_mfma_f32_32x32x16_bf16 v[96:111], v[164:167], v[144:147], 0
  ds_read_b64_tr_b16 v[204:205], v62 offset:10368
  ds_read_b64_tr_b16 v[206:207], v62 offset:11648
  v_add_f32 v243, v243, v251
  v_fmac_f32 v247, v251, v251
  v_lshlrev_b32 v248, 16, v146
  v_and_b32 v249, 0xffff0000, v146
  v_add_f32 v240, v240, v248
  v_mfma_f32_32x32x16_bf16 v[112:127], v[168:171], v[144:147], 0
  ds_read_b64_tr_b16 v[208:209], v62 offset:10432
  ds_read_b64_tr_b16 v[210:211], v62 offset:11712
  v_fmac_f32 v244, v248, v248
  v_add_f32 v242, v242, v249
  v_fmac_f32 v246, v249, v249
  v_lshlrev_b32 v250, 16, v147
  v_and_b32 v251, 0xffff0000, v147
  v_mfma_f32_32x32x16_bf16 v[128:143], v[172:175], v[144:147], 0
  ds_read_b64_tr_b16 v[212:213], v62 offset:10496
  ds_read_b64_tr_b16 v[214:215], v62 offset:11776
  v_add_f32 v241, v241, v250
  v_fmac_f32 v245, v250, v250
  v_add_f32 v243, v243, v251
  v_fmac_f32 v247, v251, v251
  s_cmp_lg_u32 s29, 0
  s_cbranch_scc1 g1_kernel_cs9
  v_mfma_f32_4x4x4_16b_bf16 v[216:219], v[4:5], v[156:157], v[216:219]
  v_mfma_f32_4x4x4_16b_bf16 v[220:223], v[4:5], v[160:161], v[220:223]
  v_mfma_f32_4x4x4_16b_bf16 v[224:227], v[4:5], v[164:165], v[224:227]
  v_mfma_f32_4x4x4_16b_bf16 v[228:231], v[4:5], v[168:169], v[228:231]
  v_mfma_f32_4x4x4_16b_bf16 v[232:235], v[4:5], v[172:173], v[232:235]
  v_mfma_f32_4x4x4_16b_bf16 v[216:219], v[4:5], v[158:159], v[216:219]
  v_mfma_f32_4x4x4_16b_bf16 v[220:223], v[4:5], v[162:163], v[220:223]
  v_mfma_f32_4x4x4_16b_bf16 v[224:227], v[4:5], v[166:167], v[224:227]
  v_mfma_f32_4x4x4_16b_bf16 v[228:231], v[4:5], v[170:171], v[228:231]
  v_mfma_f32_4x4x4_16b_bf16 v[232:235], v[4:5], v[174:175], v[232:235]
g1_kernel_cs9:
  s_waitcnt lgkmcnt(11)
  v_mfma_f32_32x32x16_bf16 v[64:79], v[176:179], v[148:151], v[64:79]
  ds_read_b128 v[144:147], v61 offset:0
  ds_read_b64_tr_b16 v[156:157], v62 offset:15360
  ds_read_b64_tr_b16 v[158:159], v62 offset:16640
  v_lshlrev_b32 v248, 16, v148
  v_and_b32 v249, 0xffff0000, v148
  v_add_f32 v240, v240, v248
  v_fmac_f32 v244, v248, v248
  v_add_f32 v242, v242, v249
  v_mfma_f32_32x32x16_bf16 v[80:95], v[180:183], v[148:151], v[80:95]
  ds_read_b64_tr_b16 v[160:161], v62 offset:15424
  ds_read_b64_tr_b16 v[162:163], v62 offset:16704
  v_fmac_f32 v246, v249, v249
  v_lshlrev_b32 v250, 16, v149
  v_and_b32 v251, 0xffff0000, v149
  v_add_f32 v241, v241, v250
  v_fmac_f32 v245, v250, v250
  v_mfma_f32_32x32x16_bf16 v[96:111], v[184:187], v[148:151], v[96:111]
  ds_read_b64_tr_b16 v[164:165], v62 offset:15488
  ds_read_b64_tr_b16 v[166:167], v62 offset:16768
  v_add_f32 v243, v243, v251
  v_fmac_f32 v247, v251, v251
  v_lshlrev_b32 v248, 16, v150
  v_and_b32 v249, 0xffff0000, v150
  v_add_f32 v240, v240, v248
  v_mfma_f32_32x32x16_bf16 v[112:127], v[188:191], v[148:151], v[112:127]
  ds_read_b64_tr_b16 v[168:169], v62 offset:15552
  ds_read_b64_tr_b16 v[170:171], v62 offset:16832
  v_fmac_f32 v244, v248, v248
  v_add_f32 v242, v242, v249
  v_fmac_f32 v246, v249, v249
  v_lshlrev_b32 v250, 16, v151
  v_and_b32 v251, 0xffff0000, v151
  v_mfma_f32_32x32x16_bf16 v[128:143], v[192:195], v[148:151], v[128:143]
  ds_read_b64_tr_b16 v[172:173], v62 offset:15616
  ds_read_b64_tr_b16 v[174:175], v62 offset:16896
  v_add_f32 v241, v241, v250
  v_fmac_f32 v245, v250, v250
  v_add_f32 v243, v243, v251
  v_fmac_f32 v247, v251, v251
  s_cmp_lg_u32 s29, 1
  s_cbranch_scc1 g1_kernel_cs10
  v_mfma_f32_4x4x4_16b_bf16 v[216:219], v[4:5], v[176:177], v[216:219]
  v_mfma_f32_4x4x4_16b_bf16 v[220:223], v[4:5], v[180:181], v[220:223]
  v_mfma_f32_4x4x4_16b_bf16 v[224:227], v[4:5], v[184:185], v[224:227]
  v_mfma_f32_4x4x4_16b_bf16 v[228:231], v[4:5], v[188:189], v[228:231]
  v_mfma_f32_4x4x4_16b_bf16 v[232:235], v[4:5], v[192:193], v[232:235]
  v_mfma_f32_4x4x4_16b_bf16 v[216:219], v[4:5], v[178:179], v[216:219]
  v_mfma_f32_4x4x4_16b_bf16 v[220:223], v[4:5], v[182:183], v[220:223]
  v_mfma_f32_4x4x4_16b_bf16 v[224:227], v[4:5], v[186:187], v[224:227]
  v_mfma_f32_4x4x4_16b_bf16 v[228:231], v[4:5], v[190:191], v[228:231]
  v_mfma_f32_4x4x4_16b_bf16 v[232:235], v[4:5], v[194:195], v[232:235]
g1_kernel_cs10:
  s_barrier
  s_waitcnt lgkmcnt(11)
  v_mfma_f32_32x32x16_bf16 v[64:79], v[196:199], v[152:155], v[64:79]
  ds_read_b128 v[148:151], v58 offset:16384
  ds_read_b64_tr_b16 v[176:177], v62 offset:20480
  ds_read_b64_tr_b16 v[178:179], v62 offset:21760
  v_lshlrev_b32 v248, 16, v152
  v_and_b32 v249, 0xffff0000, v152
  v_add_f32 v240, v240, v248
  v_fmac_f32 v244, v248, v248
  v_add_f32 v242, v242, v249
  v_mfma_f32_32x32x16_bf16 v[80:95], v[200:203], v[152:155], v[80:95]
  ds_read_b64_tr_b16 v[180:181], v62 offset:20544
  ds_read_b64_tr_b16 v[182:183], v62 offset:21824
  v_fmac_f32 v246, v249, v249
  v_lshlrev_b32 v250, 16, v153
  v_and_b32 v251, 0xffff0000, v153
  v_add_f32 v241, v241, v250
  v_fmac_f32 v245, v250, v250
  v_mfma_f32_32x32x16_bf16 v[96:111], v[204:207], v[152:155], v[96:111]
  ds_read_b64_tr_b16 v[184:185], v62 offset:20608
  ds_read_b64_tr_b16 v[186:187], v62 offset:21888
  v_add_f32 v243, v243, v251
  v_fmac_f32 v247, v251, v251
  v_lshlrev_b32 v248, 16, v154
  v_and_b32 v249, 0xffff0000, v154
  v_add_f32 v240, v240, v248
  v_mfma_f32_32x32x16_bf16 v[112:127], v[208:211], v[152:155], v[112:127]
  ds_read_b64_tr_b16 v[188:189], v62 offset:20672
  ds_read_b64_tr_b16 v[190:191], v62 offset:21952
  v_fmac_f32 v244, v248, v248
  v_add_f32 v242, v242, v249
  v_fmac_f32 v246, v249, v249
  v_lshlrev_b32 v250, 16, v155
  v_and_b32 v251, 0xffff0000, v155
  v_mfma_f32_32x32x16_bf16 v[128:143], v[212:215], v[152:155], v[128:143]
  ds_read_b64_tr_b16 v[192:193], v62 offset:20736
  ds_read_b64_tr_b16 v[194:195], v62 offset:22016
  v_add_f32 v241, v241, v250
  v_fmac_f32 v245, v250, v250
  v_add_f32 v243, v243, v251
  v_fmac_f32 v247, v251, v251
  s_cmp_lg_u32 s29, 2
  s_cbranch_scc1 g1_kernel_cs11
  v_mfma_f32_4x4x4_16b_bf16 v[216:219], v[4:5], v[196:197], v[216:219]
  v_mfma_f32_4x4x4_16b_bf16 v[220:223], v[4:5], v[200:201], v[220:223]
  v_mfma_f32_4x4x4_16b_bf16 v[224:227], v[4:5], v[204:205], v[224:227]
  v_mfma_f32_4x4x4_16b_bf16 v[228:231], v[4:5], v[208:209], v[228:231]
  v_mfma_f32_4x4x4_16b_bf16 v[232:235], v[4:5], v[212:213], v[232:235]
  v_mfma_f32_4x4x4_16b_bf16 v[216:219], v[4:5], v[198:199], v[216:219]
  v_mfma_f32_4x4x4_16b_bf16 v[220:223], v[4:5], v[202:203], v[220:223]
  v_mfma_f32_4x4x4_16b_bf16 v[224:227], v[4:5], v[206:207], v[224:227]
  v_mfma_f32_4x4x4_16b_bf16 v[228:231], v[4:5], v[210:211], v[228:231]
  v_mfma_f32_4x4x4_16b_bf16 v[232:235], v[4:5], v[214:215], v[232:235]
g1_kernel_cs11:
  s_waitcnt lgkmcnt(11)
  v_mfma_f32_32x32x16_bf16 v[64:79], v[156:159], v[144:147], v[64:79]
  ds_read_b128 v[152:155], v59 offset:16384
  ds_read_b64_tr_b16 v[196:197], v62 offset:25600
  ds_read_b64_tr_b16 v[198:199], v62 offset:26880
  v_lshlrev_b32 v248, 16, v144
  v_and_b32 v249, 0xffff0000, v144
  v_add_f32 v240, v240, v248
  v_fmac_f32 v244, v248, v248
  v_add_f32 v242, v242, v249
  v_mfma_f32_32x32x16_bf16 v[80:95], v[160:163], v[144:147], v[80:95]
  ds_read_b64_tr_b16 v[200:201], v62 offset:25664
  ds_read_b64_tr_b16 v[202:203], v62 offset:26944
  v_fmac_f32 v246, v249, v249
  v_lshlrev_b32 v250, 16, v145
  v_and_b32 v251, 0xffff0000, v145
  v_add_f32 v241, v241, v250
  v_fmac_f32 v245, v250, v250
  v_mfma_f32_32x32x16_bf16 v[96:111], v[164:167], v[144:147], v[96:111]
  ds_read_b64_tr_b16 v[204:205], v62 offset:25728
  ds_read_b64_tr_b16 v[206:207], v62 offset:27008
  v_add_f32 v243, v243, v251
  v_fmac_f32 v247, v251, v251
  v_lshlrev_b32 v248, 16, v146
  v_and_b32 v249, 0xffff0000, v146
  v_add_f32 v240, v240, v248
  v_mfma_f32_32x32x16_bf16 v[112:127], v[168:171], v[144:147], v[112:127]
  ds_read_b64_tr_b16 v[208:209], v62 offset:25792
  ds_read_b64_tr_b16 v[210:211], v62 offset:27072
  v_fmac_f32 v244, v248, v248
  v_add_f32 v242, v242, v249
  v_fmac_f32 v246, v249, v249
  v_lshlrev_b32 v250, 16, v147
  v_and_b32 v251, 0xffff0000, v147
  v_mfma_f32_32x32x16_bf16 v[128:143], v[172:175], v[144:147], v[128:143]
  ds_read_b64_tr_b16 v[212:213], v62 offset:25856
  ds_read_b64_tr_b16 v[214:215], v62 offset:27136
  v_add_f32 v241, v241, v250
  v_fmac_f32 v245, v250, v250
  v_add_f32 v243, v243, v251
  v_fmac_f32 v247, v251, v251
  s_cmp_lg_u32 s29, 3
  s_cbranch_scc1 g1_kernel_cs12
  v_mfma_f32_4x4x4_16b_bf16 v[216:219], v[4:5], v[156:157], v[216:219]
  v_mfma_f32_4x4x4_16b_bf16 v[220:223], v[4:5], v[160:161], v[220:223]
  v_mfma_f32_4x4x4_16b_bf16 v[224:227], v[4:5], v[164:165], v[224:227]
  v_mfma_f32_4x4x4_16b_bf16 v[228:231], v[4:5], v[168:169], v[228:231]
  v_mfma_f32_4x4x4_16b_bf16 v[232:235], v[4:5], v[172:173], v[232:235]
  v_mfma_f32_4x4x4_16b_bf16 v[216:219], v[4:5], v[158:159], v[216:219]
  v_mfma_f32_4x4x4_16b_bf16 v[220:223], v[4:5], v[162:163], v[220:223]
  v_mfma_f32_4x4x4_16b_bf16 v[224:227], v[4:5], v[166:167], v[224:227]
  v_mfma_f32_4x4x4_16b_bf16 v[228:231], v[4:5], v[170:171], v[228:231]
  v_mfma_f32_4x4x4_16b_bf16 v[232:235], v[4:5], v[174:175], v[232:235]
g1_kernel_cs12:
  s_barrier
  s_waitcnt lgkmcnt(11)
  v_mfma_f32_32x32x16_bf16 v[64:79], v[176:179], v[148:151], v[64:79]
  ds_read_b128 v[144:147], v60 offset:16384
  ds_read_b64_tr_b16 v[156:157], v62 offset:30720
  ds_read_b64_tr_b16 v[158:159], v62 offset:32000
  v_lshlrev_b32 v248, 16, v148
  v_and_b32 v249, 0xffff0000, v148
  v_add_f32 v240, v240, v248
  v_fmac_f32 v244, v248, v248
  v_add_f32 v242, v242, v249
  v_mfma_f32_32x32x16_bf16 v[80:95], v[180:183], v[148:151], v[80:95]
  ds_read_b64_tr_b16 v[160:161], v62 offset:30784
  ds_read_b64_tr_b16 v[162:163], v62 offset:32064
  v_fmac_f32 v246, v249, v249
  v_lshlrev_b32 v250, 16, v149
  v_and_b32 v251, 0xffff0000, v149
  v_add_f32 v241, v241, v250
  v_fmac_f32 v245, v250, v250
  v_mfma_f32_32x32x16_bf16 v[96:111], v[184:187], v[148:151], v[96:111]
  ds_read_b64_tr_b16 v[164:165], v62 offset:30848
  ds_read_b64_tr_b16 v[166:167], v62 offset:32128
  v_add_f32 v243, v243, v251
  v_fmac_f32 v247, v251, v251
  v_lshlrev_b32 v248, 16, v150
  v_and_b32 v249, 0xffff0000, v150
  v_add_f32 v240, v240, v248
  v_mfma_f32_32x32x16_bf16 v[112:127], v[188:191], v[148:151], v[112:127]
  ds_read_b64_tr_b16 v[168:169], v62 offset:30912
  ds_read_b64_tr_b16 v[170:171], v62 offset:32192
  v_fmac_f32 v244, v248, v248
  v_add_f32 v242, v242, v249
  v_fmac_f32 v246, v249, v249
  v_lshlrev_b32 v250, 16, v151
  v_and_b32 v251, 0xffff0000, v151
  v_mfma_f32_32x32x16_bf16 v[128:143], v[192:195], v[148:151], v[128:143]
  ds_read_b64_tr_b16 v[172:173], v62 offset:30976
  ds_read_b64_tr_b16 v[174:175], v62 offset:32256
  v_add_f32 v241, v241, v250
  v_fmac_f32 v245, v250, v250
  v_add_f32 v243, v243, v251
  v_fmac_f32 v247, v251, v251
  s_cmp_lg_u32 s29, 0
  s_cbranch_scc1 g1_kernel_cs13
  v_mfma_f32_4x4x4_16b_bf16 v[216:219], v[4:5], v[176:177], v[216:219]
  v_mfma_f32_4x4x4_16b_bf16 v[220:223], v[4:5], v[180:181], v[220:223]
  v_mfma_f32_4x4x4_16b_bf16 v[224:227], v[4:5], v[184:185], v[224:227]
  v_mfma_f32_4x4x4_16b_bf16 v[228:231], v[4:5], v[188:189], v[228:231]
  v_mfma_f32_4x4x4_16b_bf16 v[232:235], v[4:5], v[192:193], v[232:235]
  v_mfma_f32_4x4x4_16b_bf16 v[216:219], v[4:5], v[178:179], v[216:219]
  v_mfma_f32_4x4x4_16b_bf16 v[220:223], v[4:5], v[182:183], v[220:223]
  v_mfma_f32_4x4x4_16b_bf16 v[224:227], v[4:5], v[186:187], v[224:227]
  v_mfma_f32_4x4x4_16b_bf16 v[228:231], v[4:5], v[190:191], v[228:231]
  v_mfma_f32_4x4x4_16b_bf16 v[232:235], v[4:5], v[194:195], v[232:235]
g1_kernel_cs13:
  s_waitcnt lgkmcnt(11)
  v_mfma_f32_32x32x16_bf16 v[64:79], v[196:199], v[152:155], v[64:79]
  ds_read_b128 v[148:151], v61 offset:16384
  ds_read_b64_tr_b16 v[176:177], v62 offset:35840
  ds_read_b64_tr_b16 v[178:179], v62 offset:37120
  v_lshlrev_b32 v248, 16, v152
  v_and_b32 v249, 0xffff0000, v152
  v_add_f32 v240, v240, v248
  v_fmac_f32 v244, v248, v248
  v_add_f32 v242, v242, v249
  v_mfma_f32_32x32x16_bf16 v[80:95], v[200:203], v[152:155], v[80:95]
  ds_read_b64_tr_b16 v[180:181], v62 offset:35904
  ds_read_b64_tr_b16 v[182:183], v62 offset:37184
  v_fmac_f32 v246, v249, v249
  v_lshlrev_b32 v250, 16, v153
  v_and_b32 v251, 0xffff0000, v153
  v_add_f32 v241, v241, v250
  v_fmac_f32 v245, v250, v250
  v_mfma_f32_32x32x16_bf16 v[96:111], v[204:207], v[152:155], v[96:111]
  ds_read_b64_tr_b16 v[184:185], v62 offset:35968
  ds_read_b64_tr_b16 v[186:187], v62 offset:37248
  v_add_f32 v243, v243, v251
  v_fmac_f32 v247, v251, v251
  v_lshlrev_b32 v248, 16, v154
  v_and_b32 v249, 0xffff0000, v154
  v_add_f32 v240, v240, v248
  v_mfma_f32_32x32x16_bf16 v[112:127], v[208:211], v[152:155], v[112:127]
  ds_read_b64_tr_b16 v[188:189], v62 offset:36032
  ds_read_b64_tr_b16 v[190:191], v62 offset:37312
  v_fmac_f32 v244, v248, v248
  v_add_f32 v242, v242, v249
  v_fmac_f32 v246, v249, v249
  v_lshlrev_b32 v250, 16, v155
  v_and_b32 v251, 0xffff0000, v155
  v_mfma_f32_32x32x16_bf16 v[128:143], v[212:215], v[152:155], v[128:143]
  ds_read_b64_tr_b16 v[192:193], v62 offset:36096
  ds_read_b64_tr_b16 v[194:195], v62 offset:37376
  v_add_f32 v241, v241, v250
  v_fmac_f32 v245, v250, v250
  v_add_f32 v243, v243, v251
  v_fmac_f32 v247, v251, v251
  s_cmp_lg_u32 s29, 1
  s_cbranch_scc1 g1_kernel_cs14
  v_mfma_f32_4x4x4_16b_bf16 v[216:219], v[4:5], v[196:197], v[216:219]
  v_mfma_f32_4x4x4_16b_bf16 v[220:223], v[4:5], v[200:201], v[220:223]
  v_mfma_f32_4x4x4_16b_bf16 v[224:227], v[4:5], v[204:205], v[224:227]
  v_mfma_f32_4x4x4_16b_bf16 v[228:231], v[4:5], v[208:209], v[228:231]
  v_mfma_f32_4x4x4_16b_bf16 v[232:235], v[4:5], v[212:213], v[232:235]
  v_mfma_f32_4x4x4_16b_bf16 v[216:219], v[4:5], v[198:199], v[216:219]
  v_mfma_f32_4x4x4_16b_bf16 v[220:223], v[4:5], v[202:203], v[220:223]
  v_mfma_f32_4x4x4_16b_bf16 v[224:227], v[4:5], v[206:207], v[224:227]
  v_mfma_f32_4x4x4_16b_bf16 v[228:231], v[4:5], v[210:211], v[228:231]
  v_mfma_f32_4x4x4_16b_bf16 v[232:235], v[4:5], v[214:215], v[232:235]
g1_kernel_cs14:
  s_waitcnt lgkmcnt(11)
  v_mfma_f32_32x32x16_bf16 v[64:79], v[156:159], v[144:147], v[64:79]
  ds_read_b128 v[152:155], v58 offset:32768
  ds_read_b64_tr_b16 v[196:197], v62 offset:40960
  ds_read_b64_tr_b16 v[198:199], v62 offset:42240
  v_lshlrev_b32 v248, 16, v144
  v_and_b32 v249, 0xffff0000, v144
  v_add_f32 v240, v240, v248
  v_fmac_f32 v244, v248, v248
  v_add_f32 v242, v242, v249
  v_mfma_f32_32x32x16_bf16 v[80:95], v[160:163], v[144:147], v[80:95]
  ds_read_b64_tr_b16 v[200:201], v62 offset:41024
  ds_read_b64_tr_b16 v[202:203], v62 offset:42304
  v_fmac_f32 v246, v249, v249
  v_lshlrev_b32 v250, 16, v145
  v_and_b32 v251, 0xffff0000, v145
  v_add_f32 v241, v241, v250
  v_fmac_f32 v245, v250, v250
  v_mfma_f32_32x32x16_bf16 v[96:111], v[164:167], v[144:147], v[96:111]
  ds_read_b64_tr_b16 v[204:205], v62 offset:41088
  ds_read_b64_tr_b16 v[206:207], v62 offset:42368
  v_add_f32 v243, v243, v251
  v_fmac_f32 v247, v251, v251
  v_lshlrev_b32 v248, 16, v146
  v_and_b32 v249, 0xffff0000, v146
  v_add_f32 v240, v240, v248
  v_mfma_f32_32x32x16_bf16 v[112:127], v[168:171], v[144:147], v[112:127]
  ds_read_b64_tr_b16 v[208:209], v62 offset:41152
  ds_read_b64_tr_b16 v[210:211], v62 offset:42432
  v_fmac_f32 v244, v248, v248
  v_add_f32 v242, v242, v249
  v_fmac_f32 v246, v249, v249
  v_lshlrev_b32 v250, 16, v147
  v_and_b32 v251, 0xffff0000, v147
  v_mfma_f32_32x32x16_bf16 v[128:143], v[172:175], v[144:147], v[128:143]
  ds_read_b64_tr_b16 v[212:213], v62 offset:41216
  ds_read_b64_tr_b16 v[214:215], v62 offset:42496
  v_add_f32 v241, v241, v250
  v_fmac_f32 v245, v250, v250
  v_add_f32 v243, v243, v251
  v_fmac_f32 v247, v251, v251
  s_cmp_lg_u32 s29, 2
  s_cbranch_scc1 g1_kernel_cs15
  v_mfma_f32_4x4x4_16b_bf16 v[216:219], v[4:5], v[156:157], v[216:219]
  v_mfma_f32_4x4x4_16b_bf16 v[220:223], v[4:5], v[160:161], v[220:223]
  v_mfma_f32_4x4x4_16b_bf16 v[224:227], v[4:5], v[164:165], v[224:227]
  v_mfma_f32_4x4x4_16b_bf16 v[228:231], v[4:5], v[168:169], v[228:231]
  v_mfma_f32_4x4x4_16b_bf16 v[232:235], v[4:5], v[172:173], v[232:235]
  v_mfma_f32_4x4x4_16b_bf16 v[216:219], v[4:5], v[158:159], v[216:219]
  v_mfma_f32_4x4x4_16b_bf16 v[220:223], v[4:5], v[162:163], v[220:223]
  v_mfma_f32_4x4x4_16b_bf16 v[224:227], v[4:5], v[166:167], v[224:227]
  v_mfma_f32_4x4x4_16b_bf16 v[228:231], v[4:5], v[170:171], v[228:231]
  v_mfma_f32_4x4x4_16b_bf16 v[232:235], v[4:5], v[174:175], v[232:235]
g1_kernel_cs15:
  s_waitcnt lgkmcnt(11)
  v_mfma_f32_32x32x16_bf16 v[64:79], v[176:179], v[148:151], v[64:79]
  ds_read_b128 v[144:147], v59 offset:32768
  ds_read_b64_tr_b16 v[156:157], v62 offset:46080
  ds_read_b64_tr_b16 v[158:159], v62 offset:47360
  v_lshlrev_b32 v248, 16, v148
  v_and_b32 v249, 0xffff0000, v148
  v_add_f32 v240, v240, v248
  v_fmac_f32 v244, v248, v248
  v_add_f32 v242, v242, v249
  v_mfma_f32_32x32x16_bf16 v[80:95], v[180:183], v[148:151], v[80:95]
  ds_read_b64_tr_b16 v[160:161], v62 offset:46144
  ds_read_b64_tr_b16 v[162:163], v62 offset:47424
  v_fmac_f32 v246, v249, v249
  v_lshlrev_b32 v250, 16, v149
  v_and_b32 v251, 0xffff0000, v149
  v_add_f32 v241, v241, v250
  v_fmac_f32 v245, v250, v250
  v_mfma_f32_32x32x16_bf16 v[96:111], v[184:187], v[148:151], v[96:111]
  ds_read_b64_tr_b16 v[164:165], v62 offset:46208
  ds_read_b64_tr_b16 v[166:167], v62 offset:47488
  v_add_f32 v243, v243, v251
  v_fmac_f32 v247, v251, v251
  v_lshlrev_b32 v248, 16, v150
  v_and_b32 v249, 0xffff0000, v150
  v_add_f32 v240, v240, v248
  v_mfma_f32_32x32x16_bf16 v[112:127], v[188:191], v[148:151], v[112:127]
  ds_read_b64_tr_b16 v[168:169], v62 offset:46272
  ds_read_b64_tr_b16 v[170:171], v62 offset:47552
  v_fmac_f32 v244, v248, v248
  v_add_f32 v242, v242, v249
  v_fmac_f32 v246, v249, v249
  v_lshlrev_b32 v250, 16, v151
  v_and_b32 v251, 0xffff0000, v151
  v_mfma_f32_32x32x16_bf16 v[128:143], v[192:195], v[148:151], v[128:143]
  ds_read_b64_tr_b16 v[172:173], v62 offset:46336
  ds_read_b64_tr_b16 v[174:175], v62 offset:47616
  v_add_f32 v241, v241, v250
  v_fmac_f32 v245, v250, v250
  v_add_f32 v243, v243, v251
  v_fmac_f32 v247, v251, v251
  s_cmp_lg_u32 s29, 3
  s_cbranch_scc1 g1_kernel_cs16
  v_mfma_f32_4x4x4_16b_bf16 v[216:219], v[4:5], v[176:177], v[216:219]
  v_mfma_f32_4x4x4_16b_bf16 v[220:223], v[4:5], v[180:181], v[220:223]
  v_mfma_f32_4x4x4_16b_bf16 v[224:227], v[4:5], v[184:185], v[224:227]
  v_mfma_f32_4x4x4_16b_bf16 v[228:231], v[4:5], v[188:189], v[228:231]
  v_mfma_f32_4x4x4_16b_bf16 v[232:235], v[4:5], v[192:193], v[232:235]
  v_mfma_f32_4x4x4_16b_bf16 v[216:219], v[4:5], v[178:179], v[216:219]
  v_mfma_f32_4x4x4_16b_bf16 v[220:223], v[4:5], v[182:183], v[220:223]
  v_mfma_f32_4x4x4_16b_bf16 v[224:227], v[4:5], v[186:187], v[224:227]
  v_mfma_f32_4x4x4_16b_bf16 v[228:231], v[4:5], v[190:191], v[228:231]
  v_mfma_f32_4x4x4_16b_bf16 v[232:235], v[4:5], v[194:195], v[232:235]
g1_kernel_cs16:
  s_barrier
  s_waitcnt lgkmcnt(11)
  v_mfma_f32_32x32x16_bf16 v[64:79], v[196:199], v[152:155], v[64:79]
  ds_read_b128 v[148:151], v60 offset:32768
  ds_read_b64_tr_b16 v[176:177], v62 offset:51200
  ds_read_b64_tr_b16 v[178:179], v62 offset:52480
  v_lshlrev_b32 v248, 16, v152
  v_and_b32 v249, 0xffff0000, v152
  v_add_f32 v240, v240, v248
  v_fmac_f32 v244, v248, v248
  v_add_f32 v242, v242, v249
  v_mfma_f32_32x32x16_bf16 v[80:95], v[200:203], v[152:155], v[80:95]
  ds_read_b64_tr_b16 v[180:181], v62 offset:51264
  ds_read_b64_tr_b16 v[182:183], v62 offset:52544
  v_fmac_f32 v246, v249, v249
  v_lshlrev_b32 v250, 16, v153
  v_and_b32 v251, 0xffff0000, v153
  v_add_f32 v241, v241, v250
  v_fmac_f32 v245, v250, v250
  v_mfma_f32_32x32x16_bf16 v[96:111], v[204:207], v[152:155], v[96:111]
  ds_read_b64_tr_b16 v[184:185], v62 offset:51328
  ds_read_b64_tr_b16 v[186:187], v62 offset:52608
  v_add_f32 v243, v243, v251
  v_fmac_f32 v247, v251, v251
  v_lshlrev_b32 v248, 16, v154
  v_and_b32 v249, 0xffff0000, v154
  v_add_f32 v240, v240, v248
  v_mfma_f32_32x32x16_bf16 v[112:127], v[208:211], v[152:155], v[112:127]
  ds_read_b64_tr_b16 v[188:189], v62 offset:51392
  ds_read_b64_tr_b16 v[190:191], v62 offset:52672
  v_fmac_f32 v244, v248, v248
  v_add_f32 v242, v242, v249
  v_fmac_f32 v246, v249, v249
  v_lshlrev_b32 v250, 16, v155
  v_and_b32 v251, 0xffff0000, v155
  v_mfma_f32_32x32x16_bf16 v[128:143], v[212:215], v[152:155], v[128:143]
  ds_read_b64_tr_b16 v[192:193], v62 offset:51456
  ds_read_b64_tr_b16 v[194:195], v62 offset:52736
  v_add_f32 v241, v241, v250
  v_fmac_f32 v245, v250, v250
  v_add_f32 v243, v243, v251
  v_fmac_f32 v247, v251, v251
  s_cmp_lg_u32 s29, 0
  s_cbranch_scc1 g1_kernel_cs17
  v_mfma_f32_4x4x4_16b_bf16 v[216:219], v[4:5], v[196:197], v[216:219]
  v_mfma_f32_4x4x4_16b_bf16 v[220:223], v[4:5], v[200:201], v[220:223]
  v_mfma_f32_4x4x4_16b_bf16 v[224:227], v[4:5], v[204:205], v[224:227]
  v_mfma_f32_4x4x4_16b_bf16 v[228:231], v[4:5], v[208:209], v[228:231]
  v_mfma_f32_4x4x4_16b_bf16 v[232:235], v[4:5], v[212:213], v[232:235]
  v_mfma_f32_4x4x4_16b_bf16 v[216:219], v[4:5], v[198:199], v[216:219]
  v_mfma_f32_4x4x4_16b_bf16 v[220:223], v[4:5], v[202:203], v[220:223]
  v_mfma_f32_4x4x4_16b_bf16 v[224:227], v[4:5], v[206:207], v[224:227]
  v_mfma_f32_4x4x4_16b_bf16 v[228:231], v[4:5], v[210:211], v[228:231]
  v_mfma_f32_4x4x4_16b_bf16 v[232:235], v[4:5], v[214:215], v[232:235]
g1_kernel_cs17:
  s_waitcnt lgkmcnt(11)
  v_mfma_f32_32x32x16_bf16 v[64:79], v[156:159], v[144:147], v[64:79]
  ds_read_b128 v[152:155], v61 offset:32768
  ds_read_b64_tr_b16 v[196:197], v62 offset:56320
  ds_read_b64_tr_b16 v[198:199], v62 offset:57600
  v_lshlrev_b32 v248, 16, v144
  v_and_b32 v249, 0xffff0000, v144
  v_add_f32 v240, v240, v248
  v_fmac_f32 v244, v248, v248
  v_add_f32 v242, v242, v249
  v_mfma_f32_32x32x16_bf16 v[80:95], v[160:163], v[144:147], v[80:95]
  ds_read_b64_tr_b16 v[200:201], v62 offset:56384
  ds_read_b64_tr_b16 v[202:203], v62 offset:57664
  v_fmac_f32 v246, v249, v249
  v_lshlrev_b32 v250, 16, v145
  v_and_b32 v251, 0xffff0000, v145
  v_add_f32 v241, v241, v250
  v_fmac_f32 v245, v250, v250
  v_mfma_f32_32x32x16_bf16 v[96:111], v[164:167], v[144:147], v[96:111]
  ds_read_b64_tr_b16 v[204:205], v62 offset:56448
  ds_read_b64_tr_b16 v[206:207], v62 offset:57728
  v_add_f32 v243, v243, v251
  v_fmac_f32 v247, v251, v251
  v_lshlrev_b32 v248, 16, v146
  v_and_b32 v249, 0xffff0000, v146
  v_add_f32 v240, v240, v248
  v_mfma_f32_32x32x16_bf16 v[112:127], v[168:171], v[144:147], v[112:127]
  ds_read_b64_tr_b16 v[208:209], v62 offset:56512
  ds_read_b64_tr_b16 v[210:211], v62 offset:57792
  v_fmac_f32 v244, v248, v248
  v_add_f32 v242, v242, v249
  v_fmac_f32 v246, v249, v249
  v_lshlrev_b32 v250, 16, v147
  v_and_b32 v251, 0xffff0000, v147
  v_mfma_f32_32x32x16_bf16 v[128:143], v[172:175], v[144:147], v[128:143]
  ds_read_b64_tr_b16 v[212:213], v62 offset:56576
  ds_read_b64_tr_b16 v[214:215], v62 offset:57856
  v_add_f32 v241, v241, v250
  v_fmac_f32 v245, v250, v250
  v_add_f32 v243, v243, v251
  v_fmac_f32 v247, v251, v251
  s_cmp_lg_u32 s29, 1
  s_cbranch_scc1 g1_kernel_cs18
  v_mfma_f32_4x4x4_16b_bf16 v[216:219], v[4:5], v[156:157], v[216:219]
  v_mfma_f32_4x4x4_16b_bf16 v[220:223], v[4:5], v[160:161], v[220:223]
  v_mfma_f32_4x4x4_16b_bf16 v[224:227], v[4:5], v[164:165], v[224:227]
  v_mfma_f32_4x4x4_16b_bf16 v[228:231], v[4:5], v[168:169], v[228:231]
  v_mfma_f32_4x4x4_16b_bf16 v[232:235], v[4:5], v[172:173], v[232:235]
  v_mfma_f32_4x4x4_16b_bf16 v[216:219], v[4:5], v[158:159], v[216:219]
  v_mfma_f32_4x4x4_16b_bf16 v[220:223], v[4:5], v[162:163], v[220:223]
  v_mfma_f32_4x4x4_16b_bf16 v[224:227], v[4:5], v[166:167], v[224:227]
  v_mfma_f32_4x4x4_16b_bf16 v[228:231], v[4:5], v[170:171], v[228:231]
  v_mfma_f32_4x4x4_16b_bf16 v[232:235], v[4:5], v[174:175], v[232:235]
g1_kernel_cs18:
  s_waitcnt lgkmcnt(11)
  v_mfma_f32_32x32x16_bf16 v[64:79], v[176:179], v[148:151], v[64:79]
  ds_read_b128 v[144:147], v58 offset:49152
  ds_read_b64_tr_b16 v[156:157], v237 offset:0
  ds_read_b64_tr_b16 v[158:159], v237 offset:1280
  v_lshlrev_b32 v248, 16, v148
  v_and_b32 v249, 0xffff0000, v148
  v_add_f32 v240, v240, v248
  v_fmac_f32 v244, v248, v248
  v_add_f32 v242, v242, v249
  v_mfma_f32_32x32x16_bf16 v[80:95], v[180:183], v[148:151], v[80:95]
  ds_read_b64_tr_b16 v[160:161], v237 offset:64
  ds_read_b64_tr_b16 v[162:163], v237 offset:1344
  v_fmac_f32 v246, v249, v249
  v_lshlrev_b32 v250, 16, v149
  v_and_b32 v251, 0xffff0000, v149
  v_add_f32 v241, v241, v250
  v_fmac_f32 v245, v250, v250
  v_mfma_f32_32x32x16_bf16 v[96:111], v[184:187], v[148:151], v[96:111]
  ds_read_b64_tr_b16 v[164:165], v237 offset:128
  ds_read_b64_tr_b16 v[166:167], v237 offset:1408
  v_add_f32 v243, v243, v251
  v_fmac_f32 v247, v251, v251
  v_lshlrev_b32 v248, 16, v150
  v_and_b32 v249, 0xffff0000, v150
  v_add_f32 v240, v240, v248
  v_mfma_f32_32x32x16_bf16 v[112:127], v[188:191], v[148:151], v[112:127]
  ds_read_b64_tr_b16 v[168:169], v237 offset:192
  ds_read_b64_tr_b16 v[170:171], v237 offset:1472
  v_fmac_f32 v244, v248, v248
  v_add_f32 v242, v242, v249
  v_fmac_f32 v246, v249, v249
  v_lshlrev_b32 v250, 16, v151
  v_and_b32 v251, 0xffff0000, v151
  v_mfma_f32_32x32x16_bf16 v[128:143], v[192:195], v[148:151], v[128:143]
  ds_read_b64_tr_b16 v[172:173], v237 offset:256
  ds_read_b64_tr_b16 v[174:175], v237 offset:1536
  v_add_f32 v241, v241, v250
  v_fmac_f32 v245, v250, v250
  v_add_f32 v243, v243, v251
  v_fmac_f32 v247, v251, v251
  s_cmp_lg_u32 s29, 2
  s_cbranch_scc1 g1_kernel_cs19
  v_mfma_f32_4x4x4_16b_bf16 v[216:219], v[4:5], v[176:177], v[216:219]
  v_mfma_f32_4x4x4_16b_bf16 v[220:223], v[4:5], v[180:181], v[220:223]
  v_mfma_f32_4x4x4_16b_bf16 v[224:227], v[4:5], v[184:185], v[224:227]
  v_mfma_f32_4x4x4_16b_bf16 v[228:231], v[4:5], v[188:189], v[228:231]
  v_mfma_f32_4x4x4_16b_bf16 v[232:235], v[4:5], v[192:193], v[232:235]
  v_mfma_f32_4x4x4_16b_bf16 v[216:219], v[4:5], v[178:179], v[216:219]
  v_mfma_f32_4x4x4_16b_bf16 v[220:223], v[4:5], v[182:183], v[220:223]
  v_mfma_f32_4x4x4_16b_bf16 v[224:227], v[4:5], v[186:187], v[224:227]
  v_mfma_f32_4x4x4_16b_bf16 v[228:231], v[4:5], v[190:191], v[228:231]
  v_mfma_f32_4x4x4_16b_bf16 v[232:235], v[4:5], v[194:195], v[232:235]
g1_kernel_cs19:
  s_waitcnt lgkmcnt(11)
  v_mfma_f32_32x32x16_bf16 v[64:79], v[196:199], v[152:155], v[64:79]
  ds_read_b128 v[148:151], v59 offset:49152
  ds_read_b64_tr_b16 v[176:177], v237 offset:5120
  ds_read_b64_tr_b16 v[178:179], v237 offset:6400
  v_lshlrev_b32 v248, 16, v152
  v_and_b32 v249, 0xffff0000, v152
  v_add_f32 v240, v240, v248
  v_fmac_f32 v244, v248, v248
  v_add_f32 v242, v242, v249
  v_mfma_f32_32x32x16_bf16 v[80:95], v[200:203], v[152:155], v[80:95]
  ds_read_b64_tr_b16 v[180:181], v237 offset:5184
  ds_read_b64_tr_b16 v[182:183], v237 offset:6464
  v_fmac_f32 v246, v249, v249
  v_lshlrev_b32 v250, 16, v153
  v_and_b32 v251, 0xffff0000, v153
  v_add_f32 v241, v241, v250
  v_fmac_f32 v245, v250, v250
  v_mfma_f32_32x32x16_bf16 v[96:111], v[204:207], v[152:155], v[96:111]
  ds_read_b64_tr_b16 v[184:185], v237 offset:5248
  ds_read_b64_tr_b16 v[186:187], v237 offset:6528
  v_add_f32 v243, v243, v251
  v_fmac_f32 v247, v251, v251
  v_lshlrev_b32 v248, 16, v154
  v_and_b32 v249, 0xffff0000, v154
  v_add_f32 v240, v240, v248
  v_mfma_f32_32x32x16_bf16 v[112:127], v[208:211], v[152:155], v[112:127]
  ds_read_b64_tr_b16 v[188:189], v237 offset:5312
  ds_read_b64_tr_b16 v[190:191], v237 offset:6592
  v_fmac_f32 v244, v248, v248
  v_add_f32 v242, v242, v249
  v_fmac_f32 v246, v249, v249
  v_lshlrev_b32 v250, 16, v155
  v_and_b32 v251, 0xffff0000, v155
  v_mfma_f32_32x32x16_bf16 v[128:143], v[212:215], v[152:155], v[128:143]
  ds_read_b64_tr_b16 v[192:193], v237 offset:5376
  ds_read_b64_tr_b16 v[194:195], v237 offset:6656
  v_add_f32 v241, v241, v250
  v_fmac_f32 v245, v250, v250
  v_add_f32 v243, v243, v251
  v_fmac_f32 v247, v251, v251
  s_cmp_lg_u32 s29, 3
  s_cbranch_scc1 g1_kernel_cs20
  v_mfma_f32_4x4x4_16b_bf16 v[216:219], v[4:5], v[196:197], v[216:219]
  v_mfma_f32_4x4x4_16b_bf16 v[220:223], v[4:5], v[200:201], v[220:223]
  v_mfma_f32_4x4x4_16b_bf16 v[224:227], v[4:5], v[204:205], v[224:227]
  v_mfma_f32_4x4x4_16b_bf16 v[228:231], v[4:5], v[208:209], v[228:231]
  v_mfma_f32_4x4x4_16b_bf16 v[232:235], v[4:5], v[212:213], v[232:235]
  v_mfma_f32_4x4x4_16b_bf16 v[216:219], v[4:5], v[198:199], v[216:219]
  v_mfma_f32_4x4x4_16b_bf16 v[220:223], v[4:5], v[202:203], v[220:223]
  v_mfma_f32_4x4x4_16b_bf16 v[224:227], v[4:5], v[206:207], v[224:227]
  v_mfma_f32_4x4x4_16b_bf16 v[228:231], v[4:5], v[210:211], v[228:231]
  v_mfma_f32_4x4x4_16b_bf16 v[232:235], v[4:5], v[214:215], v[232:235]
g1_kernel_cs20:
  s_barrier
  s_waitcnt lgkmcnt(11)
  v_mfma_f32_32x32x16_bf16 v[64:79], v[156:159], v[144:147], v[64:79]
  ds_read_b128 v[152:155], v60 offset:49152
  ds_read_b64_tr_b16 v[196:197], v237 offset:10240
  ds_read_b64_tr_b16 v[198:199], v237 offset:11520
  v_lshlrev_b32 v248, 16, v144
  v_and_b32 v249, 0xffff0000, v144
  v_add_f32 v240, v240, v248
  v_fmac_f32 v244, v248, v248
  v_add_f32 v242, v242, v249
  v_mfma_f32_32x32x16_bf16 v[80:95], v[160:163], v[144:147], v[80:95]
  ds_read_b64_tr_b16 v[200:201], v237 offset:10304
  ds_read_b64_tr_b16 v[202:203], v237 offset:11584
  v_fmac_f32 v246, v249, v249
  v_lshlrev_b32 v250, 16, v145
  v_and_b32 v251, 0xffff0000, v145
  v_add_f32 v241, v241, v250
  v_fmac_f32 v245, v250, v250
  v_mfma_f32_32x32x16_bf16 v[96:111], v[164:167], v[144:147], v[96:111]
  ds_read_b64_tr_b16 v[204:205], v237 offset:10368
  ds_read_b64_tr_b16 v[206:207], v237 offset:11648
  v_add_f32 v243, v243, v251
  v_fmac_f32 v247, v251, v251
  v_lshlrev_b32 v248, 16, v146
  v_and_b32 v249, 0xffff0000, v146
  v_add_f32 v240, v240, v248
  v_mfma_f32_32x32x16_bf16 v[112:127], v[168:171], v[144:147], v[112:127]
  ds_read_b64_tr_b16 v[208:209], v237 offset:10432
  ds_read_b64_tr_b16 v[210:211], v237 offset:11712
  v_fmac_f32 v244, v248, v248
  v_add_f32 v242, v242, v249
  v_fmac_f32 v246, v249, v249
  v_lshlrev_b32 v250, 16, v147
  v_and_b32 v251, 0xffff0000, v147
  v_mfma_f32_32x32x16_bf16 v[128:143], v[172:175], v[144:147], v[128:143]
  ds_read_b64_tr_b16 v[212:213], v237 offset:10496
  ds_read_b64_tr_b16 v[214:215], v237 offset:11776
  v_add_f32 v241, v241, v250
  v_fmac_f32 v245, v250, v250
  v_add_f32 v243, v243, v251
  v_fmac_f32 v247, v251, v251
  s_cmp_lg_u32 s29, 0
  s_cbranch_scc1 g1_kernel_cs21
  v_mfma_f32_4x4x4_16b_bf16 v[216:219], v[4:5], v[156:157], v[216:219]
  v_mfma_f32_4x4x4_16b_bf16 v[220:223], v[4:5], v[160:161], v[220:223]
  v_mfma_f32_4x4x4_16b_bf16 v[224:227], v[4:5], v[164:165], v[224:227]
  v_mfma_f32_4x4x4_16b_bf16 v[228:231], v[4:5], v[168:169], v[228:231]
  v_mfma_f32_4x4x4_16b_bf16 v[232:235], v[4:5], v[172:173], v[232:235]
  v_mfma_f32_4x4x4_16b_bf16 v[216:219], v[4:5], v[158:159], v[216:219]
  v_mfma_f32_4x4x4_16b_bf16 v[220:223], v[4:5], v[162:163], v[220:223]
  v_mfma_f32_4x4x4_16b_bf16 v[224:227], v[4:5], v[166:167], v[224:227]
  v_mfma_f32_4x4x4_16b_bf16 v[228:231], v[4:5], v[170:171], v[228:231]
  v_mfma_f32_4x4x4_16b_bf16 v[232:235], v[4:5], v[174:175], v[232:235]
g1_kernel_cs21:
  s_waitcnt lgkmcnt(11)
  v_mfma_f32_32x32x16_bf16 v[64:79], v[176:179], v[148:151], v[64:79]
  ds_read_b128 v[144:147], v61 offset:49152
  ds_read_b64_tr_b16 v[156:157], v237 offset:15360
  ds_read_b64_tr_b16 v[158:159], v237 offset:16640
  v_lshlrev_b32 v248, 16, v148
  v_and_b32 v249, 0xffff0000, v148
  v_add_f32 v240, v240, v248
  v_fmac_f32 v244, v248, v248
  v_add_f32 v242, v242, v249
  v_mfma_f32_32x32x16_bf16 v[80:95], v[180:183], v[148:151], v[80:95]
  ds_read_b64_tr_b16 v[160:161], v237 offset:15424
  ds_read_b64_tr_b16 v[162:163], v237 offset:16704
  v_fmac_f32 v246, v249, v249
  v_lshlrev_b32 v250, 16, v149
  v_and_b32 v251, 0xffff0000, v149
  v_add_f32 v241, v241, v250
  v_fmac_f32 v245, v250, v250
  v_mfma_f32_32x32x16_bf16 v[96:111], v[184:187], v[148:151], v[96:111]
  ds_read_b64_tr_b16 v[164:165], v237 offset:15488
  ds_read_b64_tr_b16 v[166:167], v237 offset:16768
  v_add_f32 v243, v243, v251
  v_fmac_f32 v247, v251, v251
  v_lshlrev_b32 v248, 16, v150
  v_and_b32 v249, 0xffff0000, v150
  v_add_f32 v240, v240, v248
  v_mfma_f32_32x32x16_bf16 v[112:127], v[188:191], v[148:151], v[112:127]
  ds_read_b64_tr_b16 v[168:169], v237 offset:15552
  ds_read_b64_tr_b16 v[170:171], v237 offset:16832
  v_fmac_f32 v244, v248, v248
  v_add_f32 v242, v242, v249
  v_fmac_f32 v246, v249, v249
  v_lshlrev_b32 v250, 16, v151
  v_and_b32 v251, 0xffff0000, v151
  v_mfma_f32_32x32x16_bf16 v[128:143], v[192:195], v[148:151], v[128:143]
  ds_read_b64_tr_b16 v[172:173], v237 offset:15616
  ds_read_b64_tr_b16 v[174:175], v237 offset:16896
  v_add_f32 v241, v241, v250
  v_fmac_f32 v245, v250, v250
  v_add_f32 v243, v243, v251
  v_fmac_f32 v247, v251, v251
  s_cmp_lg_u32 s29, 1
  s_cbranch_scc1 g1_kernel_cs22
  v_mfma_f32_4x4x4_16b_bf16 v[216:219], v[4:5], v[176:177], v[216:219]
  v_mfma_f32_4x4x4_16b_bf16 v[220:223], v[4:5], v[180:181], v[220:223]
  v_mfma_f32_4x4x4_16b_bf16 v[224:227], v[4:5], v[184:185], v[224:227]
  v_mfma_f32_4x4x4_16b_bf16 v[228:231], v[4:5], v[188:189], v[228:231]
  v_mfma_f32_4x4x4_16b_bf16 v[232:235], v[4:5], v[192:193], v[232:235]
  v_mfma_f32_4x4x4_16b_bf16 v[216:219], v[4:5], v[178:179], v[216:219]
  v_mfma_f32_4x4x4_16b_bf16 v[220:223], v[4:5], v[182:183], v[220:223]
  v_mfma_f32_4x4x4_16b_bf16 v[224:227], v[4:5], v[186:187], v[224:227]
  v_mfma_f32_4x4x4_16b_bf16 v[228:231], v[4:5], v[190:191], v[228:231]
  v_mfma_f32_4x4x4_16b_bf16 v[232:235], v[4:5], v[194:195], v[232:235]
g1_kernel_cs22:
  s_waitcnt lgkmcnt(11)
  v_mfma_f32_32x32x16_bf16 v[64:79], v[196:199], v[152:155], v[64:79]
  ds_read_b128 v[148:151], v58 offset:0
  ds_read_b64_tr_b16 v[176:177], v62 offset:0
  ds_read_b64_tr_b16 v[178:179], v62 offset:1280
  v_lshlrev_b32 v248, 16, v152
  v_and_b32 v249, 0xffff0000, v152
  v_add_f32 v240, v240, v248
  v_fmac_f32 v244, v248, v248
  v_add_f32 v242, v242, v249
  v_mfma_f32_32x32x16_bf16 v[80:95], v[200:203], v[152:155], v[80:95]
  ds_read_b64_tr_b16 v[180:181], v62 offset:64
  ds_read_b64_tr_b16 v[182:183], v62 offset:1344
  v_fmac_f32 v246, v249, v249
  v_lshlrev_b32 v250, 16, v153
  v_and_b32 v251, 0xffff0000, v153
  v_add_f32 v241, v241, v250
  v_fmac_f32 v245, v250, v250
  v_mfma_f32_32x32x16_bf16 v[96:111], v[204:207], v[152:155], v[96:111]
  ds_read_b64_tr_b16 v[184:185], v62 offset:128
  ds_read_b64_tr_b16 v[186:187], v62 offset:1408
  v_add_f32 v243, v243, v251
  v_fmac_f32 v247, v251, v251
  v_lshlrev_b32 v248, 16, v154
  v_and_b32 v249, 0xffff0000, v154
  v_add_f32 v240, v240, v248
  v_mfma_f32_32x32x16_bf16 v[112:127], v[208:211], v[152:155], v[112:127]
  ds_read_b64_tr_b16 v[188:189], v62 offset:192
  ds_read_b64_tr_b16 v[190:191], v62 offset:1472
  v_fmac_f32 v244, v248, v248
  v_add_f32 v242, v242, v249
  v_fmac_f32 v246, v249, v249
  v_lshlrev_b32 v250, 16, v155
  v_and_b32 v251, 0xffff0000, v155
  v_mfma_f32_32x32x16_bf16 v[128:143], v[212:215], v[152:155], v[128:143]
  ds_read_b64_tr_b16 v[192:193], v62 offset:256
  ds_read_b64_tr_b16 v[194:195], v62 offset:1536
  v_add_f32 v241, v241, v250
  v_fmac_f32 v245, v250, v250
  v_add_f32 v243, v243, v251
  v_fmac_f32 v247, v251, v251
  s_cmp_lg_u32 s29, 2
  s_cbranch_scc1 g1_kernel_cs23
  v_mfma_f32_4x4x4_16b_bf16 v[216:219], v[4:5], v[196:197], v[216:219]
  v_mfma_f32_4x4x4_16b_bf16 v[220:223], v[4:5], v[200:201], v[220:223]
  v_mfma_f32_4x4x4_16b_bf16 v[224:227], v[4:5], v[204:205], v[224:227]
  v_mfma_f32_4x4x4_16b_bf16 v[228:231], v[4:5], v[208:209], v[228:231]
  v_mfma_f32_4x4x4_16b_bf16 v[232:235], v[4:5], v[212:213], v[232:235]
  v_mfma_f32_4x4x4_16b_bf16 v[216:219], v[4:5], v[198:199], v[216:219]
  v_mfma_f32_4x4x4_16b_bf16 v[220:223], v[4:5], v[202:203], v[220:223]
  v_mfma_f32_4x4x4_16b_bf16 v[224:227], v[4:5], v[206:207], v[224:227]
  v_mfma_f32_4x4x4_16b_bf16 v[228:231], v[4:5], v[210:211], v[228:231]
  v_mfma_f32_4x4x4_16b_bf16 v[232:235], v[4:5], v[214:215], v[232:235]
g1_kernel_cs23:
  s_waitcnt lgkmcnt(11)
  v_mfma_f32_32x32x16_bf16 v[64:79], v[156:159], v[144:147], v[64:79]
  ds_read_b128 v[152:155], v59 offset:0
  ds_read_b64_tr_b16 v[196:197], v62 offset:5120
  ds_read_b64_tr_b16 v[198:199], v62 offset:6400
  v_lshlrev_b32 v248, 16, v144
  v_and_b32 v249, 0xffff0000, v144
  v_add_f32 v240, v240, v248
  v_fmac_f32 v244, v248, v248
  v_add_f32 v242, v242, v249
  v_mfma_f32_32x32x16_bf16 v[80:95], v[160:163], v[144:147], v[80:95]
  ds_read_b64_tr_b16 v[200:201], v62 offset:5184
  ds_read_b64_tr_b16 v[202:203], v62 offset:6464
  v_fmac_f32 v246, v249, v249
  v_lshlrev_b32 v250, 16, v145
  v_and_b32 v251, 0xffff0000, v145
  v_add_f32 v241, v241, v250
  v_fmac_f32 v245, v250, v250
  v_mfma_f32_32x32x16_bf16 v[96:111], v[164:167], v[144:147], v[96:111]
  ds_read_b64_tr_b16 v[204:205], v62 offset:5248
  ds_read_b64_tr_b16 v[206:207], v62 offset:6528
  v_add_f32 v243, v243, v251
  v_fmac_f32 v247, v251, v251
  v_lshlrev_b32 v248, 16, v146
  v_and_b32 v249, 0xffff0000, v146
  v_add_f32 v240, v240, v248
  v_mfma_f32_32x32x16_bf16 v[112:127], v[168:171], v[144:147], v[112:127]
  ds_read_b64_tr_b16 v[208:209], v62 offset:5312
  ds_read_b64_tr_b16 v[210:211], v62 offset:6592
  v_fmac_f32 v244, v248, v248
  v_add_f32 v242, v242, v249
  v_fmac_f32 v246, v249, v249
  v_lshlrev_b32 v250, 16, v147
  v_and_b32 v251, 0xffff0000, v147
  v_mfma_f32_32x32x16_bf16 v[128:143], v[172:175], v[144:147], v[128:143]
  ds_read_b64_tr_b16 v[212:213], v62 offset:5376
  ds_read_b64_tr_b16 v[214:215], v62 offset:6656
  v_add_f32 v241, v241, v250
  v_fmac_f32 v245, v250, v250
  v_add_f32 v243, v243, v251
  v_fmac_f32 v247, v251, v251
  s_cmp_lg_u32 s29, 3
  s_cbranch_scc1 g1_kernel_cs24
  v_mfma_f32_4x4x4_16b_bf16 v[216:219], v[4:5], v[156:157], v[216:219]
  v_mfma_f32_4x4x4_16b_bf16 v[220:223], v[4:5], v[160:161], v[220:223]
  v_mfma_f32_4x4x4_16b_bf16 v[224:227], v[4:5], v[164:165], v[224:227]
  v_mfma_f32_4x4x4_16b_bf16 v[228:231], v[4:5], v[168:169], v[228:231]
  v_mfma_f32_4x4x4_16b_bf16 v[232:235], v[4:5], v[172:173], v[232:235]
  v_mfma_f32_4x4x4_16b_bf16 v[216:219], v[4:5], v[158:159], v[216:219]
  v_mfma_f32_4x4x4_16b_bf16 v[220:223], v[4:5], v[162:163], v[220:223]
  v_mfma_f32_4x4x4_16b_bf16 v[224:227], v[4:5], v[166:167], v[224:227]
  v_mfma_f32_4x4x4_16b_bf16 v[228:231], v[4:5], v[170:171], v[228:231]
  v_mfma_f32_4x4x4_16b_bf16 v[232:235], v[4:5], v[174:175], v[232:235]
g1_kernel_cs24:
  s_barrier
  s_waitcnt lgkmcnt(11)
  v_mfma_f32_32x32x16_bf16 v[64:79], v[176:179], v[148:151], v[64:79]
  ds_read_b128 v[144:147], v60 offset:0
  ds_read_b64_tr_b16 v[156:157], v62 offset:10240
  ds_read_b64_tr_b16 v[158:159], v62 offset:11520
  v_lshlrev_b32 v248, 16, v148
  v_and_b32 v249, 0xffff0000, v148
  v_add_f32 v240, v240, v248
  v_fmac_f32 v244, v248, v248
  v_add_f32 v242, v242, v249
  v_mfma_f32_32x32x16_bf16 v[80:95], v[180:183], v[148:151], v[80:95]
  ds_read_b64_tr_b16 v[160:161], v62 offset:10304
  ds_read_b64_tr_b16 v[162:163], v62 offset:11584
  v_fmac_f32 v246, v249, v249
  v_lshlrev_b32 v250, 16, v149
  v_and_b32 v251, 0xffff0000, v149
  v_add_f32 v241, v241, v250
  v_fmac_f32 v245, v250, v250
  v_mfma_f32_32x32x16_bf16 v[96:111], v[184:187], v[148:151], v[96:111]
  ds_read_b64_tr_b16 v[164:165], v62 offset:10368
  ds_read_b64_tr_b16 v[166:167], v62 offset:11648
  v_add_f32 v243, v243, v251
  v_fmac_f32 v247, v251, v251
  v_lshlrev_b32 v248, 16, v150
  v_and_b32 v249, 0xffff0000, v150
  v_add_f32 v240, v240, v248
  v_mfma_f32_32x32x16_bf16 v[112:127], v[188:191], v[148:151], v[112:127]
  ds_read_b64_tr_b16 v[168:169], v62 offset:10432
  ds_read_b64_tr_b16 v[170:171], v62 offset:11712
  v_fmac_f32 v244, v248, v248
  v_add_f32 v242, v242, v249
  v_fmac_f32 v246, v249, v249
  v_lshlrev_b32 v250, 16, v151
  v_and_b32 v251, 0xffff0000, v151
  v_mfma_f32_32x32x16_bf16 v[128:143], v[192:195], v[148:151], v[128:143]
  ds_read_b64_tr_b16 v[172:173], v62 offset:10496
  ds_read_b64_tr_b16 v[174:175], v62 offset:11776
  v_add_f32 v241, v241, v250
  v_fmac_f32 v245, v250, v250
  v_add_f32 v243, v243, v251
  v_fmac_f32 v247, v251, v251
  s_cmp_lg_u32 s29, 0
  s_cbranch_scc1 g1_kernel_cs25
  v_mfma_f32_4x4x4_16b_bf16 v[216:219], v[4:5], v[176:177], v[216:219]
  v_mfma_f32_4x4x4_16b_bf16 v[220:223], v[4:5], v[180:181], v[220:223]
  v_mfma_f32_4x4x4_16b_bf16 v[224:227], v[4:5], v[184:185], v[224:227]
  v_mfma_f32_4x4x4_16b_bf16 v[228:231], v[4:5], v[188:189], v[228:231]
  v_mfma_f32_4x4x4_16b_bf16 v[232:235], v[4:5], v[192:193], v[232:235]
  v_mfma_f32_4x4x4_16b_bf16 v[216:219], v[4:5], v[178:179], v[216:219]
  v_mfma_f32_4x4x4_16b_bf16 v[220:223], v[4:5], v[182:183], v[220:223]
  v_mfma_f32_4x4x4_16b_bf16 v[224:227], v[4:5], v[186:187], v[224:227]
  v_mfma_f32_4x4x4_16b_bf16 v[228:231], v[4:5], v[190:191], v[228:231]
  v_mfma_f32_4x4x4_16b_bf16 v[232:235], v[4:5], v[194:195], v[232:235]
g1_kernel_cs25:
  s_waitcnt lgkmcnt(11)
  v_mfma_f32_32x32x16_bf16 v[64:79], v[196:199], v[152:155], v[64:79]
  ds_read_b128 v[148:151], v61 offset:0
  ds_read_b64_tr_b16 v[176:177], v62 offset:15360
  ds_read_b64_tr_b16 v[178:179], v62 offset:16640
  v_lshlrev_b32 v248, 16, v152
  v_and_b32 v249, 0xffff0000, v152
  v_add_f32 v240, v240, v248
  v_fmac_f32 v244, v248, v248
  v_add_f32 v242, v242, v249
  v_mfma_f32_32x32x16_bf16 v[80:95], v[200:203], v[152:155], v[80:95]
  ds_read_b64_tr_b16 v[180:181], v62 offset:15424
  ds_read_b64_tr_b16 v[182:183], v62 offset:16704
  v_fmac_f32 v246, v249, v249
  v_lshlrev_b32 v250, 16, v153
  v_and_b32 v251, 0xffff0000, v153
  v_add_f32 v241, v241, v250
  v_fmac_f32 v245, v250, v250
  v_mfma_f32_32x32x16_bf16 v[96:111], v[204:207], v[152:155], v[96:111]
  ds_read_b64_tr_b16 v[184:185], v62 offset:15488
  ds_read_b64_tr_b16 v[186:187], v62 offset:16768
  v_add_f32 v243, v243, v251
  v_fmac_f32 v247, v251, v251
  v_lshlrev_b32 v248, 16, v154
  v_and_b32 v249, 0xffff0000, v154
  v_add_f32 v240, v240, v248
  v_mfma_f32_32x32x16_bf16 v[112:127], v[208:211], v[152:155], v[112:127]
  ds_read_b64_tr_b16 v[188:189], v62 offset:15552
  ds_read_b64_tr_b16 v[190:191], v62 offset:16832
  v_fmac_f32 v244, v248, v248
  v_add_f32 v242, v242, v249
  v_fmac_f32 v246, v249, v249
  v_lshlrev_b32 v250, 16, v155
  v_and_b32 v251, 0xffff0000, v155
  v_mfma_f32_32x32x16_bf16 v[128:143], v[212:215], v[152:155], v[128:143]
  ds_read_b64_tr_b16 v[192:193], v62 offset:15616
  ds_read_b64_tr_b16 v[194:195], v62 offset:16896
  v_add_f32 v241, v241, v250
  v_fmac_f32 v245, v250, v250
  v_add_f32 v243, v243, v251
  v_fmac_f32 v247, v251, v251
  s_cmp_lg_u32 s29, 1
  s_cbranch_scc1 g1_kernel_cs26
  v_mfma_f32_4x4x4_16b_bf16 v[216:219], v[4:5], v[196:197], v[216:219]
  v_mfma_f32_4x4x4_16b_bf16 v[220:223], v[4:5], v[200:201], v[220:223]
  v_mfma_f32_4x4x4_16b_bf16 v[224:227], v[4:5], v[204:205], v[224:227]
  v_mfma_f32_4x4x4_16b_bf16 v[228:231], v[4:5], v[208:209], v[228:231]
  v_mfma_f32_4x4x4_16b_bf16 v[232:235], v[4:5], v[212:213], v[232:235]
  v_mfma_f32_4x4x4_16b_bf16 v[216:219], v[4:5], v[198:199], v[216:219]
  v_mfma_f32_4x4x4_16b_bf16 v[220:223], v[4:5], v[202:203], v[220:223]
  v_mfma_f32_4x4x4_16b_bf16 v[224:227], v[4:5], v[206:207], v[224:227]
  v_mfma_f32_4x4x4_16b_bf16 v[228:231], v[4:5], v[210:211], v[228:231]
  v_mfma_f32_4x4x4_16b_bf16 v[232:235], v[4:5], v[214:215], v[232:235]
g1_kernel_cs26:
  s_waitcnt lgkmcnt(11)
  v_mfma_f32_32x32x16_bf16 v[64:79], v[156:159], v[144:147], v[64:79]
  ds_read_b128 v[152:155], v58 offset:16384
  ds_read_b64_tr_b16 v[196:197], v62 offset:20480
  ds_read_b64_tr_b16 v[198:199], v62 offset:21760
  v_lshlrev_b32 v248, 16, v144
  v_and_b32 v249, 0xffff0000, v144
  v_add_f32 v240, v240, v248
  v_fmac_f32 v244, v248, v248
  v_add_f32 v242, v242, v249
  v_mfma_f32_32x32x16_bf16 v[80:95], v[160:163], v[144:147], v[80:95]
  ds_read_b64_tr_b16 v[200:201], v62 offset:20544
  ds_read_b64_tr_b16 v[202:203], v62 offset:21824
  v_fmac_f32 v246, v249, v249
  v_lshlrev_b32 v250, 16, v145
  v_and_b32 v251, 0xffff0000, v145
  v_add_f32 v241, v241, v250
  v_fmac_f32 v245, v250, v250
  v_mfma_f32_32x32x16_bf16 v[96:111], v[164:167], v[144:147], v[96:111]
  ds_read_b64_tr_b16 v[204:205], v62 offset:20608
  ds_read_b64_tr_b16 v[206:207], v62 offset:21888
  v_add_f32 v243, v243, v251
  v_fmac_f32 v247, v251, v251
  v_lshlrev_b32 v248, 16, v146
  v_and_b32 v249, 0xffff0000, v146
  v_add_f32 v240, v240, v248
  v_mfma_f32_32x32x16_bf16 v[112:127], v[168:171], v[144:147], v[112:127]
  ds_read_b64_tr_b16 v[208:209], v62 offset:20672
  ds_read_b64_tr_b16 v[210:211], v62 offset:21952
  v_fmac_f32 v244, v248, v248
  v_add_f32 v242, v242, v249
  v_fmac_f32 v246, v249, v249
  v_lshlrev_b32 v250, 16, v147
  v_and_b32 v251, 0xffff0000, v147
  v_mfma_f32_32x32x16_bf16 v[128:143], v[172:175], v[144:147], v[128:143]
  ds_read_b64_tr_b16 v[212:213], v62 offset:20736
  ds_read_b64_tr_b16 v[214:215], v62 offset:22016
  v_add_f32 v241, v241, v250
  v_fmac_f32 v245, v250, v250
  v_add_f32 v243, v243, v251
  v_fmac_f32 v247, v251, v251
  s_cmp_lg_u32 s29, 2
  s_cbranch_scc1 g1_kernel_cs27
  v_mfma_f32_4x4x4_16b_bf16 v[216:219], v[4:5], v[156:157], v[216:219]
  v_mfma_f32_4x4x4_16b_bf16 v[220:223], v[4:5], v[160:161], v[220:223]
  v_mfma_f32_4x4x4_16b_bf16 v[224:227], v[4:5], v[164:165], v[224:227]
  v_mfma_f32_4x4x4_16b_bf16 v[228:231], v[4:5], v[168:169], v[228:231]
  v_mfma_f32_4x4x4_16b_bf16 v[232:235], v[4:5], v[172:173], v[232:235]
  v_mfma_f32_4x4x4_16b_bf16 v[216:219], v[4:5], v[158:159], v[216:219]
  v_mfma_f32_4x4x4_16b_bf16 v[220:223], v[4:5], v[162:163], v[220:223]
  v_mfma_f32_4x4x4_16b_bf16 v[224:227], v[4:5], v[166:167], v[224:227]
  v_mfma_f32_4x4x4_16b_bf16 v[228:231], v[4:5], v[170:171], v[228:231]
  v_mfma_f32_4x4x4_16b_bf16 v[232:235], v[4:5], v[174:175], v[232:235]
g1_kernel_cs27:
  s_waitcnt lgkmcnt(11)
  v_mfma_f32_32x32x16_bf16 v[64:79], v[176:179], v[148:151], v[64:79]
  ds_read_b128 v[144:147], v59 offset:16384
  ds_read_b64_tr_b16 v[156:157], v62 offset:25600
  ds_read_b64_tr_b16 v[158:159], v62 offset:26880
  v_lshlrev_b32 v248, 16, v148
  v_and_b32 v249, 0xffff0000, v148
  v_add_f32 v240, v240, v248
  v_fmac_f32 v244, v248, v248
  v_add_f32 v242, v242, v249
  v_mfma_f32_32x32x16_bf16 v[80:95], v[180:183], v[148:151], v[80:95]
  ds_read_b64_tr_b16 v[160:161], v62 offset:25664
  ds_read_b64_tr_b16 v[162:163], v62 offset:26944
  v_fmac_f32 v246, v249, v249
  v_lshlrev_b32 v250, 16, v149
  v_and_b32 v251, 0xffff0000, v149
  v_add_f32 v241, v241, v250
  v_fmac_f32 v245, v250, v250
  v_mfma_f32_32x32x16_bf16 v[96:111], v[184:187], v[148:151], v[96:111]
  ds_read_b64_tr_b16 v[164:165], v62 offset:25728
  ds_read_b64_tr_b16 v[166:167], v62 offset:27008
  v_add_f32 v243, v243, v251
  v_fmac_f32 v247, v251, v251
  v_lshlrev_b32 v248, 16, v150
  v_and_b32 v249, 0xffff0000, v150
  v_add_f32 v240, v240, v248
  v_mfma_f32_32x32x16_bf16 v[112:127], v[188:191], v[148:151], v[112:127]
  ds_read_b64_tr_b16 v[168:169], v62 offset:25792
  ds_read_b64_tr_b16 v[170:171], v62 offset:27072
  v_fmac_f32 v244, v248, v248
  v_add_f32 v242, v242, v249
  v_fmac_f32 v246, v249, v249
  v_lshlrev_b32 v250, 16, v151
  v_and_b32 v251, 0xffff0000, v151
  v_mfma_f32_32x32x16_bf16 v[128:143], v[192:195], v[148:151], v[128:143]
  ds_read_b64_tr_b16 v[172:173], v62 offset:25856
  ds_read_b64_tr_b16 v[174:175], v62 offset:27136
  v_add_f32 v241, v241, v250
  v_fmac_f32 v245, v250, v250
  v_add_f32 v243, v243, v251
  v_fmac_f32 v247, v251, v251
  s_cmp_lg_u32 s29, 3
  s_cbranch_scc1 g1_kernel_cs28
  v_mfma_f32_4x4x4_16b_bf16 v[216:219], v[4:5], v[176:177], v[216:219]
  v_mfma_f32_4x4x4_16b_bf16 v[220:223], v[4:5], v[180:181], v[220:223]
  v_mfma_f32_4x4x4_16b_bf16 v[224:227], v[4:5], v[184:185], v[224:227]
  v_mfma_f32_4x4x4_16b_bf16 v[228:231], v[4:5], v[188:189], v[228:231]
  v_mfma_f32_4x4x4_16b_bf16 v[232:235], v[4:5], v[192:193], v[232:235]
  v_mfma_f32_4x4x4_16b_bf16 v[216:219], v[4:5], v[178:179], v[216:219]
  v_mfma_f32_4x4x4_16b_bf16 v[220:223], v[4:5], v[182:183], v[220:223]
  v_mfma_f32_4x4x4_16b_bf16 v[224:227], v[4:5], v[186:187], v[224:227]
  v_mfma_f32_4x4x4_16b_bf16 v[228:231], v[4:5], v[190:191], v[228:231]
  v_mfma_f32_4x4x4_16b_bf16 v[232:235], v[4:5], v[194:195], v[232:235]
g1_kernel_cs28:
  s_barrier
  s_waitcnt lgkmcnt(11)
  v_mfma_f32_32x32x16_bf16 v[64:79], v[196:199], v[152:155], v[64:79]
  ds_read_b128 v[148:151], v60 offset:16384
  ds_read_b64_tr_b16 v[176:177], v62 offset:30720
  ds_read_b64_tr_b16 v[178:179], v62 offset:32000
  v_lshlrev_b32 v248, 16, v152
  v_and_b32 v249, 0xffff0000, v152
  v_add_f32 v240, v240, v248
  v_fmac_f32 v244, v248, v248
  v_add_f32 v242, v242, v249
  v_mfma_f32_32x32x16_bf16 v[80:95], v[200:203], v[152:155], v[80:95]
  ds_read_b64_tr_b16 v[180:181], v62 offset:30784
  ds_read_b64_tr_b16 v[182:183], v62 offset:32064
  v_fmac_f32 v246, v249, v249
  v_lshlrev_b32 v250, 16, v153
  v_and_b32 v251, 0xffff0000, v153
  v_add_f32 v241, v241, v250
  v_fmac_f32 v245, v250, v250
  v_mfma_f32_32x32x16_bf16 v[96:111], v[204:207], v[152:155], v[96:111]
  ds_read_b64_tr_b16 v[184:185], v62 offset:30848
  ds_read_b64_tr_b16 v[186:187], v62 offset:32128
  v_add_f32 v243, v243, v251
  v_fmac_f32 v247, v251, v251
  v_lshlrev_b32 v248, 16, v154
  v_and_b32 v249, 0xffff0000, v154
  v_add_f32 v240, v240, v248
  v_mfma_f32_32x32x16_bf16 v[112:127], v[208:211], v[152:155], v[112:127]
  ds_read_b64_tr_b16 v[188:189], v62 offset:30912
  ds_read_b64_tr_b16 v[190:191], v62 offset:32192
  v_fmac_f32 v244, v248, v248
  v_add_f32 v242, v242, v249
  v_fmac_f32 v246, v249, v249
  v_lshlrev_b32 v250, 16, v155
  v_and_b32 v251, 0xffff0000, v155
  v_mfma_f32_32x32x16_bf16 v[128:143], v[212:215], v[152:155], v[128:143]
  ds_read_b64_tr_b16 v[192:193], v62 offset:30976
  ds_read_b64_tr_b16 v[194:195], v62 offset:32256
  v_add_f32 v241, v241, v250
  v_fmac_f32 v245, v250, v250
  v_add_f32 v243, v243, v251
  v_fmac_f32 v247, v251, v251
  s_cmp_lg_u32 s29, 0
  s_cbranch_scc1 g1_kernel_cs29
  v_mfma_f32_4x4x4_16b_bf16 v[216:219], v[4:5], v[196:197], v[216:219]
  v_mfma_f32_4x4x4_16b_bf16 v[220:223], v[4:5], v[200:201], v[220:223]
  v_mfma_f32_4x4x4_16b_bf16 v[224:227], v[4:5], v[204:205], v[224:227]
  v_mfma_f32_4x4x4_16b_bf16 v[228:231], v[4:5], v[208:209], v[228:231]
  v_mfma_f32_4x4x4_16b_bf16 v[232:235], v[4:5], v[212:213], v[232:235]
  v_mfma_f32_4x4x4_16b_bf16 v[216:219], v[4:5], v[198:199], v[216:219]
  v_mfma_f32_4x4x4_16b_bf16 v[220:223], v[4:5], v[202:203], v[220:223]
  v_mfma_f32_4x4x4_16b_bf16 v[224:227], v[4:5], v[206:207], v[224:227]
  v_mfma_f32_4x4x4_16b_bf16 v[228:231], v[4:5], v[210:211], v[228:231]
  v_mfma_f32_4x4x4_16b_bf16 v[232:235], v[4:5], v[214:215], v[232:235]
g1_kernel_cs29:
  s_waitcnt lgkmcnt(11)
  v_mfma_f32_32x32x16_bf16 v[64:79], v[156:159], v[144:147], v[64:79]
  ds_read_b128 v[152:155], v61 offset:16384
  ds_read_b64_tr_b16 v[196:197], v62 offset:35840
  ds_read_b64_tr_b16 v[198:199], v62 offset:37120
  v_lshlrev_b32 v248, 16, v144
  v_and_b32 v249, 0xffff0000, v144
  v_add_f32 v240, v240, v248
  v_fmac_f32 v244, v248, v248
  v_add_f32 v242, v242, v249
  v_mfma_f32_32x32x16_bf16 v[80:95], v[160:163], v[144:147], v[80:95]
  ds_read_b64_tr_b16 v[200:201], v62 offset:35904
  ds_read_b64_tr_b16 v[202:203], v62 offset:37184
  v_fmac_f32 v246, v249, v249
  v_lshlrev_b32 v250, 16, v145
  v_and_b32 v251, 0xffff0000, v145
  v_add_f32 v241, v241, v250
  v_fmac_f32 v245, v250, v250
  v_mfma_f32_32x32x16_bf16 v[96:111], v[164:167], v[144:147], v[96:111]
  ds_read_b64_tr_b16 v[204:205], v62 offset:35968
  ds_read_b64_tr_b16 v[206:207], v62 offset:37248
  v_add_f32 v243, v243, v251
  v_fmac_f32 v247, v251, v251
  v_lshlrev_b32 v248, 16, v146
  v_and_b32 v249, 0xffff0000, v146
  v_add_f32 v240, v240, v248
  v_mfma_f32_32x32x16_bf16 v[112:127], v[168:171], v[144:147], v[112:127]
  ds_read_b64_tr_b16 v[208:209], v62 offset:36032
  ds_read_b64_tr_b16 v[210:211], v62 offset:37312
  v_fmac_f32 v244, v248, v248
  v_add_f32 v242, v242, v249
  v_fmac_f32 v246, v249, v249
  v_lshlrev_b32 v250, 16, v147
  v_and_b32 v251, 0xffff0000, v147
  v_mfma_f32_32x32x16_bf16 v[128:143], v[172:175], v[144:147], v[128:143]
  ds_read_b64_tr_b16 v[212:213], v62 offset:36096
  ds_read_b64_tr_b16 v[214:215], v62 offset:37376
  v_add_f32 v241, v241, v250
  v_fmac_f32 v245, v250, v250
  v_add_f32 v243, v243, v251
  v_fmac_f32 v247, v251, v251
  s_cmp_lg_u32 s29, 1
  s_cbranch_scc1 g1_kernel_cs30
  v_mfma_f32_4x4x4_16b_bf16 v[216:219], v[4:5], v[156:157], v[216:219]
  v_mfma_f32_4x4x4_16b_bf16 v[220:223], v[4:5], v[160:161], v[220:223]
  v_mfma_f32_4x4x4_16b_bf16 v[224:227], v[4:5], v[164:165], v[224:227]
  v_mfma_f32_4x4x4_16b_bf16 v[228:231], v[4:5], v[168:169], v[228:231]
  v_mfma_f32_4x4x4_16b_bf16 v[232:235], v[4:5], v[172:173], v[232:235]
  v_mfma_f32_4x4x4_16b_bf16 v[216:219], v[4:5], v[158:159], v[216:219]
  v_mfma_f32_4x4x4_16b_bf16 v[220:223], v[4:5], v[162:163], v[220:223]
  v_mfma_f32_4x4x4_16b_bf16 v[224:227], v[4:5], v[166:167], v[224:227]
  v_mfma_f32_4x4x4_16b_bf16 v[228:231], v[4:5], v[170:171], v[228:231]
  v_mfma_f32_4x4x4_16b_bf16 v[232:235], v[4:5], v[174:175], v[232:235]
g1_kernel_cs30:
  s_waitcnt lgkmcnt(11)
  v_mfma_f32_32x32x16_bf16 v[64:79], v[176:179], v[148:151], v[64:79]
  ds_read_b128 v[144:147], v58 offset:32768
  ds_read_b64_tr_b16 v[156:157], v62 offset:40960
  ds_read_b64_tr_b16 v[158:159], v62 offset:42240
  v_lshlrev_b32 v248, 16, v148
  v_and_b32 v249, 0xffff0000, v148
  v_add_f32 v240, v240, v248
  v_fmac_f32 v244, v248, v248
  v_add_f32 v242, v242, v249
  v_mfma_f32_32x32x16_bf16 v[80:95], v[180:183], v[148:151], v[80:95]
  ds_read_b64_tr_b16 v[160:161], v62 offset:41024
  ds_read_b64_tr_b16 v[162:163], v62 offset:42304
  v_fmac_f32 v246, v249, v249
  v_lshlrev_b32 v250, 16, v149
  v_and_b32 v251, 0xffff0000, v149
  v_add_f32 v241, v241, v250
  v_fmac_f32 v245, v250, v250
  v_mfma_f32_32x32x16_bf16 v[96:111], v[184:187], v[148:151], v[96:111]
  ds_read_b64_tr_b16 v[164:165], v62 offset:41088
  ds_read_b64_tr_b16 v[166:167], v62 offset:42368
  v_add_f32 v243, v243, v251
  v_fmac_f32 v247, v251, v251
  v_lshlrev_b32 v248, 16, v150
  v_and_b32 v249, 0xffff0000, v150
  v_add_f32 v240, v240, v248
  v_mfma_f32_32x32x16_bf16 v[112:127], v[188:191], v[148:151], v[112:127]
  ds_read_b64_tr_b16 v[168:169], v62 offset:41152
  ds_read_b64_tr_b16 v[170:171], v62 offset:42432
  v_fmac_f32 v244, v248, v248
  v_add_f32 v242, v242, v249
  v_fmac_f32 v246, v249, v249
  v_lshlrev_b32 v250, 16, v151
  v_and_b32 v251, 0xffff0000, v151
  v_mfma_f32_32x32x16_bf16 v[128:143], v[192:195], v[148:151], v[128:143]
  ds_read_b64_tr_b16 v[172:173], v62 offset:41216
  ds_read_b64_tr_b16 v[174:175], v62 offset:42496
  v_add_f32 v241, v241, v250
  v_fmac_f32 v245, v250, v250
  v_add_f32 v243, v243, v251
  v_fmac_f32 v247, v251, v251
  s_cmp_lg_u32 s29, 2
  s_cbranch_scc1 g1_kernel_cs31
  v_mfma_f32_4x4x4_16b_bf16 v[216:219], v[4:5], v[176:177], v[216:219]
  v_mfma_f32_4x4x4_16b_bf16 v[220:223], v[4:5], v[180:181], v[220:223]
  v_mfma_f32_4x4x4_16b_bf16 v[224:227], v[4:5], v[184:185], v[224:227]
  v_mfma_f32_4x4x4_16b_bf16 v[228:231], v[4:5], v[188:189], v[228:231]
  v_mfma_f32_4x4x4_16b_bf16 v[232:235], v[4:5], v[192:193], v[232:235]
  v_mfma_f32_4x4x4_16b_bf16 v[216:219], v[4:5], v[178:179], v[216:219]
  v_mfma_f32_4x4x4_16b_bf16 v[220:223], v[4:5], v[182:183], v[220:223]
  v_mfma_f32_4x4x4_16b_bf16 v[224:227], v[4:5], v[186:187], v[224:227]
  v_mfma_f32_4x4x4_16b_bf16 v[228:231], v[4:5], v[190:191], v[228:231]
  v_mfma_f32_4x4x4_16b_bf16 v[232:235], v[4:5], v[194:195], v[232:235]
g1_kernel_cs31:
  s_waitcnt lgkmcnt(11)
  v_mfma_f32_32x32x16_bf16 v[64:79], v[196:199], v[152:155], v[64:79]
  ds_read_b128 v[148:151], v59 offset:32768
  ds_read_b64_tr_b16 v[176:177], v62 offset:46080
  ds_read_b64_tr_b16 v[178:179], v62 offset:47360
  v_lshlrev_b32 v248, 16, v152
  v_and_b32 v249, 0xffff0000, v152
  v_add_f32 v240, v240, v248
  v_fmac_f32 v244, v248, v248
  v_add_f32 v242, v242, v249
  v_mfma_f32_32x32x16_bf16 v[80:95], v[200:203], v[152:155], v[80:95]
  ds_read_b64_tr_b16 v[180:181], v62 offset:46144
  ds_read_b64_tr_b16 v[182:183], v62 offset:47424
  v_fmac_f32 v246, v249, v249
  v_lshlrev_b32 v250, 16, v153
  v_and_b32 v251, 0xffff0000, v153
  v_add_f32 v241, v241, v250
  v_fmac_f32 v245, v250, v250
  v_mfma_f32_32x32x16_bf16 v[96:111], v[204:207], v[152:155], v[96:111]
  ds_read_b64_tr_b16 v[184:185], v62 offset:46208
  ds_read_b64_tr_b16 v[186:187], v62 offset:47488
  v_add_f32 v243, v243, v251
  v_fmac_f32 v247, v251, v251
  v_lshlrev_b32 v248, 16, v154
  v_and_b32 v249, 0xffff0000, v154
  v_add_f32 v240, v240, v248
  v_mfma_f32_32x32x16_bf16 v[112:127], v[208:211], v[152:155], v[112:127]
  ds_read_b64_tr_b16 v[188:189], v62 offset:46272
  ds_read_b64_tr_b16 v[190:191], v62 offset:47552
  v_fmac_f32 v244, v248, v248
  v_add_f32 v242, v242, v249
  v_fmac_f32 v246, v249, v249
  v_lshlrev_b32 v250, 16, v155
  v_and_b32 v251, 0xffff0000, v155
  v_mfma_f32_32x32x16_bf16 v[128:143], v[212:215], v[152:155], v[128:143]
  ds_read_b64_tr_b16 v[192:193], v62 offset:46336
  ds_read_b64_tr_b16 v[194:195], v62 offset:47616
  v_add_f32 v241, v241, v250
  v_fmac_f32 v245, v250, v250
  v_add_f32 v243, v243, v251
  v_fmac_f32 v247, v251, v251
  s_cmp_lg_u32 s29, 3
  s_cbranch_scc1 g1_kernel_cs32
  v_mfma_f32_4x4x4_16b_bf16 v[216:219], v[4:5], v[196:197], v[216:219]
  v_mfma_f32_4x4x4_16b_bf16 v[220:223], v[4:5], v[200:201], v[220:223]
  v_mfma_f32_4x4x4_16b_bf16 v[224:227], v[4:5], v[204:205], v[224:227]
  v_mfma_f32_4x4x4_16b_bf16 v[228:231], v[4:5], v[208:209], v[228:231]
  v_mfma_f32_4x4x4_16b_bf16 v[232:235], v[4:5], v[212:213], v[232:235]
  v_mfma_f32_4x4x4_16b_bf16 v[216:219], v[4:5], v[198:199], v[216:219]
  v_mfma_f32_4x4x4_16b_bf16 v[220:223], v[4:5], v[202:203], v[220:223]
  v_mfma_f32_4x4x4_16b_bf16 v[224:227], v[4:5], v[206:207], v[224:227]
  v_mfma_f32_4x4x4_16b_bf16 v[228:231], v[4:5], v[210:211], v[228:231]
  v_mfma_f32_4x4x4_16b_bf16 v[232:235], v[4:5], v[214:215], v[232:235]
g1_kernel_cs32:
  s_barrier
  s_waitcnt lgkmcnt(11)
  v_mfma_f32_32x32x16_bf16 v[64:79], v[156:159], v[144:147], v[64:79]
  ds_read_b128 v[152:155], v60 offset:32768
  ds_read_b64_tr_b16 v[196:197], v62 offset:51200
  ds_read_b64_tr_b16 v[198:199], v62 offset:52480
  v_lshlrev_b32 v248, 16, v144
  v_and_b32 v249, 0xffff0000, v144
  v_add_f32 v240, v240, v248
  v_fmac_f32 v244, v248, v248
  v_add_f32 v242, v242, v249
  v_mfma_f32_32x32x16_bf16 v[80:95], v[160:163], v[144:147], v[80:95]
  ds_read_b64_tr_b16 v[200:201], v62 offset:51264
  ds_read_b64_tr_b16 v[202:203], v62 offset:52544
  v_fmac_f32 v246, v249, v249
  v_lshlrev_b32 v250, 16, v145
  v_and_b32 v251, 0xffff0000, v145
  v_add_f32 v241, v241, v250
  v_fmac_f32 v245, v250, v250
  v_mfma_f32_32x32x16_bf16 v[96:111], v[164:167], v[144:147], v[96:111]
  ds_read_b64_tr_b16 v[204:205], v62 offset:51328
  ds_read_b64_tr_b16 v[206:207], v62 offset:52608
  v_add_f32 v243, v243, v251
  v_fmac_f32 v247, v251, v251
  v_lshlrev_b32 v248, 16, v146
  v_and_b32 v249, 0xffff0000, v146
  v_add_f32 v240, v240, v248
  v_mfma_f32_32x32x16_bf16 v[112:127], v[168:171], v[144:147], v[112:127]
  ds_read_b64_tr_b16 v[208:209], v62 offset:51392
  ds_read_b64_tr_b16 v[210:211], v62 offset:52672
  v_fmac_f32 v244, v248, v248
  v_add_f32 v242, v242, v249
  v_fmac_f32 v246, v249, v249
  v_lshlrev_b32 v250, 16, v147
  v_and_b32 v251, 0xffff0000, v147
  v_mfma_f32_32x32x16_bf16 v[128:143], v[172:175], v[144:147], v[128:143]
  ds_read_b64_tr_b16 v[212:213], v62 offset:51456
  ds_read_b64_tr_b16 v[214:215], v62 offset:52736
  v_add_f32 v241, v241, v250
  v_fmac_f32 v245, v250, v250
  v_add_f32 v243, v243, v251
  v_fmac_f32 v247, v251, v251
  s_cmp_lg_u32 s29, 0
  s_cbranch_scc1 g1_kernel_cs33
  v_mfma_f32_4x4x4_16b_bf16 v[216:219], v[4:5], v[156:157], v[216:219]
  v_mfma_f32_4x4x4_16b_bf16 v[220:223], v[4:5], v[160:161], v[220:223]
  v_mfma_f32_4x4x4_16b_bf16 v[224:227], v[4:5], v[164:165], v[224:227]
  v_mfma_f32_4x4x4_16b_bf16 v[228:231], v[4:5], v[168:169], v[228:231]
  v_mfma_f32_4x4x4_16b_bf16 v[232:235], v[4:5], v[172:173], v[232:235]
  v_mfma_f32_4x4x4_16b_bf16 v[216:219], v[4:5], v[158:159], v[216:219]
  v_mfma_f32_4x4x4_16b_bf16 v[220:223], v[4:5], v[162:163], v[220:223]
  v_mfma_f32_4x4x4_16b_bf16 v[224:227], v[4:5], v[166:167], v[224:227]
  v_mfma_f32_4x4x4_16b_bf16 v[228:231], v[4:5], v[170:171], v[228:231]
  v_mfma_f32_4x4x4_16b_bf16 v[232:235], v[4:5], v[174:175], v[232:235]
g1_kernel_cs33:
  s_waitcnt lgkmcnt(11)
  v_mfma_f32_32x32x16_bf16 v[64:79], v[176:179], v[148:151], v[64:79]
  ds_read_b128 v[144:147], v61 offset:32768
  ds_read_b64_tr_b16 v[156:157], v62 offset:56320
  ds_read_b64_tr_b16 v[158:159], v62 offset:57600
  v_lshlrev_b32 v248, 16, v148
  v_and_b32 v249, 0xffff0000, v148
  v_add_f32 v240, v240, v248
  v_fmac_f32 v244, v248, v248
  v_add_f32 v242, v242, v249
  v_mfma_f32_32x32x16_bf16 v[80:95], v[180:183], v[148:151], v[80:95]
  ds_read_b64_tr_b16 v[160:161], v62 offset:56384
  ds_read_b64_tr_b16 v[162:163], v62 offset:57664
  v_fmac_f32 v246, v249, v249
  v_lshlrev_b32 v250, 16, v149
  v_and_b32 v251, 0xffff0000, v149
  v_add_f32 v241, v241, v250
  v_fmac_f32 v245, v250, v250
  v_mfma_f32_32x32x16_bf16 v[96:111], v[184:187], v[148:151], v[96:111]
  ds_read_b64_tr_b16 v[164:165], v62 offset:56448
  ds_read_b64_tr_b16 v[166:167], v62 offset:57728
  v_add_f32 v243, v243, v251
  v_fmac_f32 v247, v251, v251
  v_lshlrev_b32 v248, 16, v150
  v_and_b32 v249, 0xffff0000, v150
  v_add_f32 v240, v240, v248
  v_mfma_f32_32x32x16_bf16 v[112:127], v[188:191], v[148:151], v[112:127]
  ds_read_b64_tr_b16 v[168:169], v62 offset:56512
  ds_read_b64_tr_b16 v[170:171], v62 offset:57792
  v_fmac_f32 v244, v248, v248
  v_add_f32 v242, v242, v249
  v_fmac_f32 v246, v249, v249
  v_lshlrev_b32 v250, 16, v151
  v_and_b32 v251, 0xffff0000, v151
  v_mfma_f32_32x32x16_bf16 v[128:143], v[192:195], v[148:151], v[128:143]
  ds_read_b64_tr_b16 v[172:173], v62 offset:56576
  ds_read_b64_tr_b16 v[174:175], v62 offset:57856
  v_add_f32 v241, v241, v250
  v_fmac_f32 v245, v250, v250
  v_add_f32 v243, v243, v251
  v_fmac_f32 v247, v251, v251
  s_cmp_lg_u32 s29, 1
  s_cbranch_scc1 g1_kernel_cs34
  v_mfma_f32_4x4x4_16b_bf16 v[216:219], v[4:5], v[176:177], v[216:219]
  v_mfma_f32_4x4x4_16b_bf16 v[220:223], v[4:5], v[180:181], v[220:223]
  v_mfma_f32_4x4x4_16b_bf16 v[224:227], v[4:5], v[184:185], v[224:227]
  v_mfma_f32_4x4x4_16b_bf16 v[228:231], v[4:5], v[188:189], v[228:231]
  v_mfma_f32_4x4x4_16b_bf16 v[232:235], v[4:5], v[192:193], v[232:235]
  v_mfma_f32_4x4x4_16b_bf16 v[216:219], v[4:5], v[178:179], v[216:219]
  v_mfma_f32_4x4x4_16b_bf16 v[220:223], v[4:5], v[182:183], v[220:223]
  v_mfma_f32_4x4x4_16b_bf16 v[224:227], v[4:5], v[186:187], v[224:227]
  v_mfma_f32_4x4x4_16b_bf16 v[228:231], v[4:5], v[190:191], v[228:231]
  v_mfma_f32_4x4x4_16b_bf16 v[232:235], v[4:5], v[194:195], v[232:235]
g1_kernel_cs34:
  s_waitcnt lgkmcnt(11)
  v_mfma_f32_32x32x16_bf16 v[64:79], v[196:199], v[152:155], v[64:79]
  ds_read_b128 v[148:151], v58 offset:49152
  ds_read_b64_tr_b16 v[176:177], v237 offset:0
  ds_read_b64_tr_b16 v[178:179], v237 offset:1280
  v_lshlrev_b32 v248, 16, v152
  v_and_b32 v249, 0xffff0000, v152
  v_add_f32 v240, v240, v248
  v_fmac_f32 v244, v248, v248
  v_add_f32 v242, v242, v249
  v_mfma_f32_32x32x16_bf16 v[80:95], v[200:203], v[152:155], v[80:95]
  ds_read_b64_tr_b16 v[180:181], v237 offset:64
  ds_read_b64_tr_b16 v[182:183], v237 offset:1344
  v_fmac_f32 v246, v249, v249
  v_lshlrev_b32 v250, 16, v153
  v_and_b32 v251, 0xffff0000, v153
  v_add_f32 v241, v241, v250
  v_fmac_f32 v245, v250, v250
  v_mfma_f32_32x32x16_bf16 v[96:111], v[204:207], v[152:155], v[96:111]
  ds_read_b64_tr_b16 v[184:185], v237 offset:128
  ds_read_b64_tr_b16 v[186:187], v237 offset:1408
  v_add_f32 v243, v243, v251
  v_fmac_f32 v247, v251, v251
  v_lshlrev_b32 v248, 16, v154
  v_and_b32 v249, 0xffff0000, v154
  v_add_f32 v240, v240, v248
  v_mfma_f32_32x32x16_bf16 v[112:127], v[208:211], v[152:155], v[112:127]
  ds_read_b64_tr_b16 v[188:189], v237 offset:192
  ds_read_b64_tr_b16 v[190:191], v237 offset:1472
  v_fmac_f32 v244, v248, v248
  v_add_f32 v242, v242, v249
  v_fmac_f32 v246, v249, v249
  v_lshlrev_b32 v250, 16, v155
  v_and_b32 v251, 0xffff0000, v155
  v_mfma_f32_32x32x16_bf16 v[128:143], v[212:215], v[152:155], v[128:143]
  ds_read_b64_tr_b16 v[192:193], v237 offset:256
  ds_read_b64_tr_b16 v[194:195], v237 offset:1536
  v_add_f32 v241, v241, v250
  v_fmac_f32 v245, v250, v250
  v_add_f32 v243, v243, v251
  v_fmac_f32 v247, v251, v251
  s_cmp_lg_u32 s29, 2
  s_cbranch_scc1 g1_kernel_cs35
  v_mfma_f32_4x4x4_16b_bf16 v[216:219], v[4:5], v[196:197], v[216:219]
  v_mfma_f32_4x4x4_16b_bf16 v[220:223], v[4:5], v[200:201], v[220:223]
  v_mfma_f32_4x4x4_16b_bf16 v[224:227], v[4:5], v[204:205], v[224:227]
  v_mfma_f32_4x4x4_16b_bf16 v[228:231], v[4:5], v[208:209], v[228:231]
  v_mfma_f32_4x4x4_16b_bf16 v[232:235], v[4:5], v[212:213], v[232:235]
  v_mfma_f32_4x4x4_16b_bf16 v[216:219], v[4:5], v[198:199], v[216:219]
  v_mfma_f32_4x4x4_16b_bf16 v[220:223], v[4:5], v[202:203], v[220:223]
  v_mfma_f32_4x4x4_16b_bf16 v[224:227], v[4:5], v[206:207], v[224:227]
  v_mfma_f32_4x4x4_16b_bf16 v[228:231], v[4:5], v[210:211], v[228:231]
  v_mfma_f32_4x4x4_16b_bf16 v[232:235], v[4:5], v[214:215], v[232:235]
g1_kernel_cs35:
  s_waitcnt lgkmcnt(11)
  v_mfma_f32_32x32x16_bf16 v[64:79], v[156:159], v[144:147], v[64:79]
  ds_read_b128 v[152:155], v59 offset:49152
  ds_read_b64_tr_b16 v[196:197], v237 offset:5120
  ds_read_b64_tr_b16 v[198:199], v237 offset:6400
  v_lshlrev_b32 v248, 16, v144
  v_and_b32 v249, 0xffff0000, v144
  v_add_f32 v240, v240, v248
  v_fmac_f32 v244, v248, v248
  v_add_f32 v242, v242, v249
  v_mfma_f32_32x32x16_bf16 v[80:95], v[160:163], v[144:147], v[80:95]
  ds_read_b64_tr_b16 v[200:201], v237 offset:5184
  ds_read_b64_tr_b16 v[202:203], v237 offset:6464
  v_fmac_f32 v246, v249, v249
  v_lshlrev_b32 v250, 16, v145
  v_and_b32 v251, 0xffff0000, v145
  v_add_f32 v241, v241, v250
  v_fmac_f32 v245, v250, v250
  v_mfma_f32_32x32x16_bf16 v[96:111], v[164:167], v[144:147], v[96:111]
  ds_read_b64_tr_b16 v[204:205], v237 offset:5248
  ds_read_b64_tr_b16 v[206:207], v237 offset:6528
  v_add_f32 v243, v243, v251
  v_fmac_f32 v247, v251, v251
  v_lshlrev_b32 v248, 16, v146
  v_and_b32 v249, 0xffff0000, v146
  v_add_f32 v240, v240, v248
  v_mfma_f32_32x32x16_bf16 v[112:127], v[168:171], v[144:147], v[112:127]
  ds_read_b64_tr_b16 v[208:209], v237 offset:5312
  ds_read_b64_tr_b16 v[210:211], v237 offset:6592
  v_fmac_f32 v244, v248, v248
  v_add_f32 v242, v242, v249
  v_fmac_f32 v246, v249, v249
  v_lshlrev_b32 v250, 16, v147
  v_and_b32 v251, 0xffff0000, v147
  v_mfma_f32_32x32x16_bf16 v[128:143], v[172:175], v[144:147], v[128:143]
  ds_read_b64_tr_b16 v[212:213], v237 offset:5376
  ds_read_b64_tr_b16 v[214:215], v237 offset:6656
  v_add_f32 v241, v241, v250
  v_fmac_f32 v245, v250, v250
  v_add_f32 v243, v243, v251
  v_fmac_f32 v247, v251, v251
  s_cmp_lg_u32 s29, 3
  s_cbranch_scc1 g1_kernel_cs36
  v_mfma_f32_4x4x4_16b_bf16 v[216:219], v[4:5], v[156:157], v[216:219]
  v_mfma_f32_4x4x4_16b_bf16 v[220:223], v[4:5], v[160:161], v[220:223]
  v_mfma_f32_4x4x4_16b_bf16 v[224:227], v[4:5], v[164:165], v[224:227]
  v_mfma_f32_4x4x4_16b_bf16 v[228:231], v[4:5], v[168:169], v[228:231]
  v_mfma_f32_4x4x4_16b_bf16 v[232:235], v[4:5], v[172:173], v[232:235]
  v_mfma_f32_4x4x4_16b_bf16 v[216:219], v[4:5], v[158:159], v[216:219]
  v_mfma_f32_4x4x4_16b_bf16 v[220:223], v[4:5], v[162:163], v[220:223]
  v_mfma_f32_4x4x4_16b_bf16 v[224:227], v[4:5], v[166:167], v[224:227]
  v_mfma_f32_4x4x4_16b_bf16 v[228:231], v[4:5], v[170:171], v[228:231]
  v_mfma_f32_4x4x4_16b_bf16 v[232:235], v[4:5], v[174:175], v[232:235]
g1_kernel_cs36:
  s_barrier
  s_waitcnt lgkmcnt(11)
  v_mfma_f32_32x32x16_bf16 v[64:79], v[176:179], v[148:151], v[64:79]
  ds_read_b128 v[144:147], v60 offset:49152
  ds_read_b64_tr_b16 v[156:157], v237 offset:10240
  ds_read_b64_tr_b16 v[158:159], v237 offset:11520
  v_lshlrev_b32 v248, 16, v148
  v_and_b32 v249, 0xffff0000, v148
  v_add_f32 v240, v240, v248
  v_fmac_f32 v244, v248, v248
  v_add_f32 v242, v242, v249
  v_mfma_f32_32x32x16_bf16 v[80:95], v[180:183], v[148:151], v[80:95]
  ds_read_b64_tr_b16 v[160:161], v237 offset:10304
  ds_read_b64_tr_b16 v[162:163], v237 offset:11584
  v_fmac_f32 v246, v249, v249
  v_lshlrev_b32 v250, 16, v149
  v_and_b32 v251, 0xffff0000, v149
  v_add_f32 v241, v241, v250
  v_fmac_f32 v245, v250, v250
  v_mfma_f32_32x32x16_bf16 v[96:111], v[184:187], v[148:151], v[96:111]
  ds_read_b64_tr_b16 v[164:165], v237 offset:10368
  ds_read_b64_tr_b16 v[166:167], v237 offset:11648
  v_add_f32 v243, v243, v251
  v_fmac_f32 v247, v251, v251
  v_lshlrev_b32 v248, 16, v150
  v_and_b32 v249, 0xffff0000, v150
  v_add_f32 v240, v240, v248
  v_mfma_f32_32x32x16_bf16 v[112:127], v[188:191], v[148:151], v[112:127]
  ds_read_b64_tr_b16 v[168:169], v237 offset:10432
  ds_read_b64_tr_b16 v[170:171], v237 offset:11712
  v_fmac_f32 v244, v248, v248
  v_add_f32 v242, v242, v249
  v_fmac_f32 v246, v249, v249
  v_lshlrev_b32 v250, 16, v151
  v_and_b32 v251, 0xffff0000, v151
  v_mfma_f32_32x32x16_bf16 v[128:143], v[192:195], v[148:151], v[128:143]
  ds_read_b64_tr_b16 v[172:173], v237 offset:10496
  ds_read_b64_tr_b16 v[174:175], v237 offset:11776
  v_add_f32 v241, v241, v250
  v_fmac_f32 v245, v250, v250
  v_add_f32 v243, v243, v251
  v_fmac_f32 v247, v251, v251
  s_cmp_lg_u32 s29, 0
  s_cbranch_scc1 g1_kernel_cs37
  v_mfma_f32_4x4x4_16b_bf16 v[216:219], v[4:5], v[176:177], v[216:219]
  v_mfma_f32_4x4x4_16b_bf16 v[220:223], v[4:5], v[180:181], v[220:223]
  v_mfma_f32_4x4x4_16b_bf16 v[224:227], v[4:5], v[184:185], v[224:227]
  v_mfma_f32_4x4x4_16b_bf16 v[228:231], v[4:5], v[188:189], v[228:231]
  v_mfma_f32_4x4x4_16b_bf16 v[232:235], v[4:5], v[192:193], v[232:235]
  v_mfma_f32_4x4x4_16b_bf16 v[216:219], v[4:5], v[178:179], v[216:219]
  v_mfma_f32_4x4x4_16b_bf16 v[220:223], v[4:5], v[182:183], v[220:223]
  v_mfma_f32_4x4x4_16b_bf16 v[224:227], v[4:5], v[186:187], v[224:227]
  v_mfma_f32_4x4x4_16b_bf16 v[228:231], v[4:5], v[190:191], v[228:231]
  v_mfma_f32_4x4x4_16b_bf16 v[232:235], v[4:5], v[194:195], v[232:235]
g1_kernel_cs37:
  s_waitcnt lgkmcnt(11)
  v_mfma_f32_32x32x16_bf16 v[64:79], v[196:199], v[152:155], v[64:79]
  ds_read_b128 v[148:151], v61 offset:49152
  ds_read_b64_tr_b16 v[176:177], v237 offset:15360
  ds_read_b64_tr_b16 v[178:179], v237 offset:16640
  v_lshlrev_b32 v248, 16, v152
  v_and_b32 v249, 0xffff0000, v152
  v_add_f32 v240, v240, v248
  v_fmac_f32 v244, v248, v248
  v_add_f32 v242, v242, v249
  v_mfma_f32_32x32x16_bf16 v[80:95], v[200:203], v[152:155], v[80:95]
  ds_read_b64_tr_b16 v[180:181], v237 offset:15424
  ds_read_b64_tr_b16 v[182:183], v237 offset:16704
  v_fmac_f32 v246, v249, v249
  v_lshlrev_b32 v250, 16, v153
  v_and_b32 v251, 0xffff0000, v153
  v_add_f32 v241, v241, v250
  v_fmac_f32 v245, v250, v250
  v_mfma_f32_32x32x16_bf16 v[96:111], v[204:207], v[152:155], v[96:111]
  ds_read_b64_tr_b16 v[184:185], v237 offset:15488
  ds_read_b64_tr_b16 v[186:187], v237 offset:16768
  v_add_f32 v243, v243, v251
  v_fmac_f32 v247, v251, v251
  v_lshlrev_b32 v248, 16, v154
  v_and_b32 v249, 0xffff0000, v154
  v_add_f32 v240, v240, v248
  v_mfma_f32_32x32x16_bf16 v[112:127], v[208:211], v[152:155], v[112:127]
  ds_read_b64_tr_b16 v[188:189], v237 offset:15552
  ds_read_b64_tr_b16 v[190:191], v237 offset:16832
  v_fmac_f32 v244, v248, v248
  v_add_f32 v242, v242, v249
  v_fmac_f32 v246, v249, v249
  v_lshlrev_b32 v250, 16, v155
  v_and_b32 v251, 0xffff0000, v155
  v_mfma_f32_32x32x16_bf16 v[128:143], v[212:215], v[152:155], v[128:143]
  ds_read_b64_tr_b16 v[192:193], v237 offset:15616
  ds_read_b64_tr_b16 v[194:195], v237 offset:16896
  v_add_f32 v241, v241, v250
  v_fmac_f32 v245, v250, v250
  v_add_f32 v243, v243, v251
  v_fmac_f32 v247, v251, v251
  s_cmp_lg_u32 s29, 1
  s_cbranch_scc1 g1_kernel_cs38
  v_mfma_f32_4x4x4_16b_bf16 v[216:219], v[4:5], v[196:197], v[216:219]
  v_mfma_f32_4x4x4_16b_bf16 v[220:223], v[4:5], v[200:201], v[220:223]
  v_mfma_f32_4x4x4_16b_bf16 v[224:227], v[4:5], v[204:205], v[224:227]
  v_mfma_f32_4x4x4_16b_bf16 v[228:231], v[4:5], v[208:209], v[228:231]
  v_mfma_f32_4x4x4_16b_bf16 v[232:235], v[4:5], v[212:213], v[232:235]
  v_mfma_f32_4x4x4_16b_bf16 v[216:219], v[4:5], v[198:199], v[216:219]
  v_mfma_f32_4x4x4_16b_bf16 v[220:223], v[4:5], v[202:203], v[220:223]
  v_mfma_f32_4x4x4_16b_bf16 v[224:227], v[4:5], v[206:207], v[224:227]
  v_mfma_f32_4x4x4_16b_bf16 v[228:231], v[4:5], v[210:211], v[228:231]
  v_mfma_f32_4x4x4_16b_bf16 v[232:235], v[4:5], v[214:215], v[232:235]
g1_kernel_cs38:
  s_waitcnt lgkmcnt(11)
  v_mfma_f32_32x32x16_bf16 v[64:79], v[156:159], v[144:147], v[64:79]
  ds_read_b128 v[152:155], v58 offset:0
  ds_read_b64_tr_b16 v[196:197], v62 offset:0
  ds_read_b64_tr_b16 v[198:199], v62 offset:1280
  v_lshlrev_b32 v248, 16, v144
  v_and_b32 v249, 0xffff0000, v144
  v_add_f32 v240, v240, v248
  v_fmac_f32 v244, v248, v248
  v_add_f32 v242, v242, v249
  v_mfma_f32_32x32x16_bf16 v[80:95], v[160:163], v[144:147], v[80:95]
  ds_read_b64_tr_b16 v[200:201], v62 offset:64
  ds_read_b64_tr_b16 v[202:203], v62 offset:1344
  v_fmac_f32 v246, v249, v249
  v_lshlrev_b32 v250, 16, v145
  v_and_b32 v251, 0xffff0000, v145
  v_add_f32 v241, v241, v250
  v_fmac_f32 v245, v250, v250
  v_mfma_f32_32x32x16_bf16 v[96:111], v[164:167], v[144:147], v[96:111]
  ds_read_b64_tr_b16 v[204:205], v62 offset:128
  ds_read_b64_tr_b16 v[206:207], v62 offset:1408
  v_add_f32 v243, v243, v251
  v_fmac_f32 v247, v251, v251
  v_lshlrev_b32 v248, 16, v146
  v_and_b32 v249, 0xffff0000, v146
  v_add_f32 v240, v240, v248
  v_mfma_f32_32x32x16_bf16 v[112:127], v[168:171], v[144:147], v[112:127]
  ds_read_b64_tr_b16 v[208:209], v62 offset:192
  ds_read_b64_tr_b16 v[210:211], v62 offset:1472
  v_fmac_f32 v244, v248, v248
  v_add_f32 v242, v242, v249
  v_fmac_f32 v246, v249, v249
  v_lshlrev_b32 v250, 16, v147
  v_and_b32 v251, 0xffff0000, v147
  v_mfma_f32_32x32x16_bf16 v[128:143], v[172:175], v[144:147], v[128:143]
  ds_read_b64_tr_b16 v[212:213], v62 offset:256
  ds_read_b64_tr_b16 v[214:215], v62 offset:1536
  v_add_f32 v241, v241, v250
  v_fmac_f32 v245, v250, v250
  v_add_f32 v243, v243, v251
  v_fmac_f32 v247, v251, v251
  s_cmp_lg_u32 s29, 2
  s_cbranch_scc1 g1_kernel_cs39
  v_mfma_f32_4x4x4_16b_bf16 v[216:219], v[4:5], v[156:157], v[216:219]
  v_mfma_f32_4x4x4_16b_bf16 v[220:223], v[4:5], v[160:161], v[220:223]
  v_mfma_f32_4x4x4_16b_bf16 v[224:227], v[4:5], v[164:165], v[224:227]
  v_mfma_f32_4x4x4_16b_bf16 v[228:231], v[4:5], v[168:169], v[228:231]
  v_mfma_f32_4x4x4_16b_bf16 v[232:235], v[4:5], v[172:173], v[232:235]
  v_mfma_f32_4x4x4_16b_bf16 v[216:219], v[4:5], v[158:159], v[216:219]
  v_mfma_f32_4x4x4_16b_bf16 v[220:223], v[4:5], v[162:163], v[220:223]
  v_mfma_f32_4x4x4_16b_bf16 v[224:227], v[4:5], v[166:167], v[224:227]
  v_mfma_f32_4x4x4_16b_bf16 v[228:231], v[4:5], v[170:171], v[228:231]
  v_mfma_f32_4x4x4_16b_bf16 v[232:235], v[4:5], v[174:175], v[232:235]
g1_kernel_cs39:
  s_waitcnt lgkmcnt(11)
  v_mfma_f32_32x32x16_bf16 v[64:79], v[176:179], v[148:151], v[64:79]
  ds_read_b128 v[144:147], v59 offset:0
  ds_read_b64_tr_b16 v[156:157], v62 offset:5120
  ds_read_b64_tr_b16 v[158:159], v62 offset:6400
  v_lshlrev_b32 v248, 16, v148
  v_and_b32 v249, 0xffff0000, v148
  v_add_f32 v240, v240, v248
  v_fmac_f32 v244, v248, v248
  v_add_f32 v242, v242, v249
  v_mfma_f32_32x32x16_bf16 v[80:95], v[180:183], v[148:151], v[80:95]
  ds_read_b64_tr_b16 v[160:161], v62 offset:5184
  ds_read_b64_tr_b16 v[162:163], v62 offset:6464
  v_fmac_f32 v246, v249, v249
  v_lshlrev_b32 v250, 16, v149
  v_and_b32 v251, 0xffff0000, v149
  v_add_f32 v241, v241, v250
  v_fmac_f32 v245, v250, v250
  v_mfma_f32_32x32x16_bf16 v[96:111], v[184:187], v[148:151], v[96:111]
  ds_read_b64_tr_b16 v[164:165], v62 offset:5248
  ds_read_b64_tr_b16 v[166:167], v62 offset:6528
  v_add_f32 v243, v243, v251
  v_fmac_f32 v247, v251, v251
  v_lshlrev_b32 v248, 16, v150
  v_and_b32 v249, 0xffff0000, v150
  v_add_f32 v240, v240, v248
  v_mfma_f32_32x32x16_bf16 v[112:127], v[188:191], v[148:151], v[112:127]
  ds_read_b64_tr_b16 v[168:169], v62 offset:5312
  ds_read_b64_tr_b16 v[170:171], v62 offset:6592
  v_fmac_f32 v244, v248, v248
  v_add_f32 v242, v242, v249
  v_fmac_f32 v246, v249, v249
  v_lshlrev_b32 v250, 16, v151
  v_and_b32 v251, 0xffff0000, v151
  v_mfma_f32_32x32x16_bf16 v[128:143], v[192:195], v[148:151], v[128:143]
  ds_read_b64_tr_b16 v[172:173], v62 offset:5376
  ds_read_b64_tr_b16 v[174:175], v62 offset:6656
  v_add_f32 v241, v241, v250
  v_fmac_f32 v245, v250, v250
  v_add_f32 v243, v243, v251
  v_fmac_f32 v247, v251, v251
  s_cmp_lg_u32 s29, 3
  s_cbranch_scc1 g1_kernel_cs40
  v_mfma_f32_4x4x4_16b_bf16 v[216:219], v[4:5], v[176:177], v[216:219]
  v_mfma_f32_4x4x4_16b_bf16 v[220:223], v[4:5], v[180:181], v[220:223]
  v_mfma_f32_4x4x4_16b_bf16 v[224:227], v[4:5], v[184:185], v[224:227]
  v_mfma_f32_4x4x4_16b_bf16 v[228:231], v[4:5], v[188:189], v[228:231]
  v_mfma_f32_4x4x4_16b_bf16 v[232:235], v[4:5], v[192:193], v[232:235]
  v_mfma_f32_4x4x4_16b_bf16 v[216:219], v[4:5], v[178:179], v[216:219]
  v_mfma_f32_4x4x4_16b_bf16 v[220:223], v[4:5], v[182:183], v[220:223]
  v_mfma_f32_4x4x4_16b_bf16 v[224:227], v[4:5], v[186:187], v[224:227]
  v_mfma_f32_4x4x4_16b_bf16 v[228:231], v[4:5], v[190:191], v[228:231]
  v_mfma_f32_4x4x4_16b_bf16 v[232:235], v[4:5], v[194:195], v[232:235]
g1_kernel_cs40:
  s_barrier
  s_waitcnt lgkmcnt(11)
  v_mfma_f32_32x32x16_bf16 v[64:79], v[196:199], v[152:155], v[64:79]
  ds_read_b128 v[148:151], v60 offset:0
  ds_read_b64_tr_b16 v[176:177], v62 offset:10240
  ds_read_b64_tr_b16 v[178:179], v62 offset:11520
  v_lshlrev_b32 v248, 16, v152
  v_and_b32 v249, 0xffff0000, v152
  v_add_f32 v240, v240, v248
  v_fmac_f32 v244, v248, v248
  v_add_f32 v242, v242, v249
  v_mfma_f32_32x32x16_bf16 v[80:95], v[200:203], v[152:155], v[80:95]
  ds_read_b64_tr_b16 v[180:181], v62 offset:10304
  ds_read_b64_tr_b16 v[182:183], v62 offset:11584
  v_fmac_f32 v246, v249, v249
  v_lshlrev_b32 v250, 16, v153
  v_and_b32 v251, 0xffff0000, v153
  v_add_f32 v241, v241, v250
  v_fmac_f32 v245, v250, v250
  v_mfma_f32_32x32x16_bf16 v[96:111], v[204:207], v[152:155], v[96:111]
  ds_read_b64_tr_b16 v[184:185], v62 offset:10368
  ds_read_b64_tr_b16 v[186:187], v62 offset:11648
  v_add_f32 v243, v243, v251
  v_fmac_f32 v247, v251, v251
  v_lshlrev_b32 v248, 16, v154
  v_and_b32 v249, 0xffff0000, v154
  v_add_f32 v240, v240, v248
  v_mfma_f32_32x32x16_bf16 v[112:127], v[208:211], v[152:155], v[112:127]
  ds_read_b64_tr_b16 v[188:189], v62 offset:10432
  ds_read_b64_tr_b16 v[190:191], v62 offset:11712
  v_fmac_f32 v244, v248, v248
  v_add_f32 v242, v242, v249
  v_fmac_f32 v246, v249, v249
  v_lshlrev_b32 v250, 16, v155
  v_and_b32 v251, 0xffff0000, v155
  v_mfma_f32_32x32x16_bf16 v[128:143], v[212:215], v[152:155], v[128:143]
  ds_read_b64_tr_b16 v[192:193], v62 offset:10496
  ds_read_b64_tr_b16 v[194:195], v62 offset:11776
  v_add_f32 v241, v241, v250
  v_fmac_f32 v245, v250, v250
  v_add_f32 v243, v243, v251
  v_fmac_f32 v247, v251, v251
  s_cmp_lg_u32 s29, 0
  s_cbranch_scc1 g1_kernel_cs41
  v_mfma_f32_4x4x4_16b_bf16 v[216:219], v[4:5], v[196:197], v[216:219]
  v_mfma_f32_4x4x4_16b_bf16 v[220:223], v[4:5], v[200:201], v[220:223]
  v_mfma_f32_4x4x4_16b_bf16 v[224:227], v[4:5], v[204:205], v[224:227]
  v_mfma_f32_4x4x4_16b_bf16 v[228:231], v[4:5], v[208:209], v[228:231]
  v_mfma_f32_4x4x4_16b_bf16 v[232:235], v[4:5], v[212:213], v[232:235]
  v_mfma_f32_4x4x4_16b_bf16 v[216:219], v[4:5], v[198:199], v[216:219]
  v_mfma_f32_4x4x4_16b_bf16 v[220:223], v[4:5], v[202:203], v[220:223]
  v_mfma_f32_4x4x4_16b_bf16 v[224:227], v[4:5], v[206:207], v[224:227]
  v_mfma_f32_4x4x4_16b_bf16 v[228:231], v[4:5], v[210:211], v[228:231]
  v_mfma_f32_4x4x4_16b_bf16 v[232:235], v[4:5], v[214:215], v[232:235]
g1_kernel_cs41:
  s_waitcnt lgkmcnt(11)
  v_mfma_f32_32x32x16_bf16 v[64:79], v[156:159], v[144:147], v[64:79]
  ds_read_b128 v[152:155], v61 offset:0
  ds_read_b64_tr_b16 v[196:197], v62 offset:15360
  ds_read_b64_tr_b16 v[198:199], v62 offset:16640
  v_lshlrev_b32 v248, 16, v144
  v_and_b32 v249, 0xffff0000, v144
  v_add_f32 v240, v240, v248
  v_fmac_f32 v244, v248, v248
  v_add_f32 v242, v242, v249
  v_mfma_f32_32x32x16_bf16 v[80:95], v[160:163], v[144:147], v[80:95]
  ds_read_b64_tr_b16 v[200:201], v62 offset:15424
  ds_read_b64_tr_b16 v[202:203], v62 offset:16704
  v_fmac_f32 v246, v249, v249
  v_lshlrev_b32 v250, 16, v145
  v_and_b32 v251, 0xffff0000, v145
  v_add_f32 v241, v241, v250
  v_fmac_f32 v245, v250, v250
  v_mfma_f32_32x32x16_bf16 v[96:111], v[164:167], v[144:147], v[96:111]
  ds_read_b64_tr_b16 v[204:205], v62 offset:15488
  ds_read_b64_tr_b16 v[206:207], v62 offset:16768
  v_add_f32 v243, v243, v251
  v_fmac_f32 v247, v251, v251
  v_lshlrev_b32 v248, 16, v146
  v_and_b32 v249, 0xffff0000, v146
  v_add_f32 v240, v240, v248
  v_mfma_f32_32x32x16_bf16 v[112:127], v[168:171], v[144:147], v[112:127]
  ds_read_b64_tr_b16 v[208:209], v62 offset:15552
  ds_read_b64_tr_b16 v[210:211], v62 offset:16832
  v_fmac_f32 v244, v248, v248
  v_add_f32 v242, v242, v249
  v_fmac_f32 v246, v249, v249
  v_lshlrev_b32 v250, 16, v147
  v_and_b32 v251, 0xffff0000, v147
  v_mfma_f32_32x32x16_bf16 v[128:143], v[172:175], v[144:147], v[128:143]
  ds_read_b64_tr_b16 v[212:213], v62 offset:15616
  ds_read_b64_tr_b16 v[214:215], v62 offset:16896
  v_add_f32 v241, v241, v250
  v_fmac_f32 v245, v250, v250
  v_add_f32 v243, v243, v251
  v_fmac_f32 v247, v251, v251
  s_cmp_lg_u32 s29, 1
  s_cbranch_scc1 g1_kernel_cs42
  v_mfma_f32_4x4x4_16b_bf16 v[216:219], v[4:5], v[156:157], v[216:219]
  v_mfma_f32_4x4x4_16b_bf16 v[220:223], v[4:5], v[160:161], v[220:223]
  v_mfma_f32_4x4x4_16b_bf16 v[224:227], v[4:5], v[164:165], v[224:227]
  v_mfma_f32_4x4x4_16b_bf16 v[228:231], v[4:5], v[168:169], v[228:231]
  v_mfma_f32_4x4x4_16b_bf16 v[232:235], v[4:5], v[172:173], v[232:235]
  v_mfma_f32_4x4x4_16b_bf16 v[216:219], v[4:5], v[158:159], v[216:219]
  v_mfma_f32_4x4x4_16b_bf16 v[220:223], v[4:5], v[162:163], v[220:223]
  v_mfma_f32_4x4x4_16b_bf16 v[224:227], v[4:5], v[166:167], v[224:227]
  v_mfma_f32_4x4x4_16b_bf16 v[228:231], v[4:5], v[170:171], v[228:231]
  v_mfma_f32_4x4x4_16b_bf16 v[232:235], v[4:5], v[174:175], v[232:235]
g1_kernel_cs42:
  s_waitcnt lgkmcnt(11)
  v_mfma_f32_32x32x16_bf16 v[64:79], v[176:179], v[148:151], v[64:79]
  ds_read_b128 v[144:147], v58 offset:16384
  ds_read_b64_tr_b16 v[156:157], v62 offset:20480
  ds_read_b64_tr_b16 v[158:159], v62 offset:21760
  v_lshlrev_b32 v248, 16, v148
  v_and_b32 v249, 0xffff0000, v148
  v_add_f32 v240, v240, v248
  v_fmac_f32 v244, v248, v248
  v_add_f32 v242, v242, v249
  v_mfma_f32_32x32x16_bf16 v[80:95], v[180:183], v[148:151], v[80:95]
  ds_read_b64_tr_b16 v[160:161], v62 offset:20544
  ds_read_b64_tr_b16 v[162:163], v62 offset:21824
  v_fmac_f32 v246, v249, v249
  v_lshlrev_b32 v250, 16, v149
  v_and_b32 v251, 0xffff0000, v149
  v_add_f32 v241, v241, v250
  v_fmac_f32 v245, v250, v250
  v_mfma_f32_32x32x16_bf16 v[96:111], v[184:187], v[148:151], v[96:111]
  ds_read_b64_tr_b16 v[164:165], v62 offset:20608
  ds_read_b64_tr_b16 v[166:167], v62 offset:21888
  v_add_f32 v243, v243, v251
  v_fmac_f32 v247, v251, v251
  v_lshlrev_b32 v248, 16, v150
  v_and_b32 v249, 0xffff0000, v150
  v_add_f32 v240, v240, v248
  v_mfma_f32_32x32x16_bf16 v[112:127], v[188:191], v[148:151], v[112:127]
  ds_read_b64_tr_b16 v[168:169], v62 offset:20672
  ds_read_b64_tr_b16 v[170:171], v62 offset:21952
  v_fmac_f32 v244, v248, v248
  v_add_f32 v242, v242, v249
  v_fmac_f32 v246, v249, v249
  v_lshlrev_b32 v250, 16, v151
  v_and_b32 v251, 0xffff0000, v151
  v_mfma_f32_32x32x16_bf16 v[128:143], v[192:195], v[148:151], v[128:143]
  ds_read_b64_tr_b16 v[172:173], v62 offset:20736
  ds_read_b64_tr_b16 v[174:175], v62 offset:22016
  v_add_f32 v241, v241, v250
  v_fmac_f32 v245, v250, v250
  v_add_f32 v243, v243, v251
  v_fmac_f32 v247, v251, v251
  s_cmp_lg_u32 s29, 2
  s_cbranch_scc1 g1_kernel_cs43
  v_mfma_f32_4x4x4_16b_bf16 v[216:219], v[4:5], v[176:177], v[216:219]
  v_mfma_f32_4x4x4_16b_bf16 v[220:223], v[4:5], v[180:181], v[220:223]
  v_mfma_f32_4x4x4_16b_bf16 v[224:227], v[4:5], v[184:185], v[224:227]
  v_mfma_f32_4x4x4_16b_bf16 v[228:231], v[4:5], v[188:189], v[228:231]
  v_mfma_f32_4x4x4_16b_bf16 v[232:235], v[4:5], v[192:193], v[232:235]
  v_mfma_f32_4x4x4_16b_bf16 v[216:219], v[4:5], v[178:179], v[216:219]
  v_mfma_f32_4x4x4_16b_bf16 v[220:223], v[4:5], v[182:183], v[220:223]
  v_mfma_f32_4x4x4_16b_bf16 v[224:227], v[4:5], v[186:187], v[224:227]
  v_mfma_f32_4x4x4_16b_bf16 v[228:231], v[4:5], v[190:191], v[228:231]
  v_mfma_f32_4x4x4_16b_bf16 v[232:235], v[4:5], v[194:195], v[232:235]
g1_kernel_cs43:
  s_waitcnt lgkmcnt(11)
  v_mfma_f32_32x32x16_bf16 v[64:79], v[196:199], v[152:155], v[64:79]
  ds_read_b128 v[148:151], v59 offset:16384
  ds_read_b64_tr_b16 v[176:177], v62 offset:25600
  ds_read_b64_tr_b16 v[178:179], v62 offset:26880
  v_lshlrev_b32 v248, 16, v152
  v_and_b32 v249, 0xffff0000, v152
  v_add_f32 v240, v240, v248
  v_fmac_f32 v244, v248, v248
  v_add_f32 v242, v242, v249
  v_mfma_f32_32x32x16_bf16 v[80:95], v[200:203], v[152:155], v[80:95]
  ds_read_b64_tr_b16 v[180:181], v62 offset:25664
  ds_read_b64_tr_b16 v[182:183], v62 offset:26944
  v_fmac_f32 v246, v249, v249
  v_lshlrev_b32 v250, 16, v153
  v_and_b32 v251, 0xffff0000, v153
  v_add_f32 v241, v241, v250
  v_fmac_f32 v245, v250, v250
  v_mfma_f32_32x32x16_bf16 v[96:111], v[204:207], v[152:155], v[96:111]
  ds_read_b64_tr_b16 v[184:185], v62 offset:25728
  ds_read_b64_tr_b16 v[186:187], v62 offset:27008
  v_add_f32 v243, v243, v251
  v_fmac_f32 v247, v251, v251
  v_lshlrev_b32 v248, 16, v154
  v_and_b32 v249, 0xffff0000, v154
  v_add_f32 v240, v240, v248
  v_mfma_f32_32x32x16_bf16 v[112:127], v[208:211], v[152:155], v[112:127]
  ds_read_b64_tr_b16 v[188:189], v62 offset:25792
  ds_read_b64_tr_b16 v[190:191], v62 offset:27072
  v_fmac_f32 v244, v248, v248
  v_add_f32 v242, v242, v249
  v_fmac_f32 v246, v249, v249
  v_lshlrev_b32 v250, 16, v155
  v_and_b32 v251, 0xffff0000, v155
  v_mfma_f32_32x32x16_bf16 v[128:143], v[212:215], v[152:155], v[128:143]
  ds_read_b64_tr_b16 v[192:193], v62 offset:25856
  ds_read_b64_tr_b16 v[194:195], v62 offset:27136
  v_add_f32 v241, v241, v250
  v_fmac_f32 v245, v250, v250
  v_add_f32 v243, v243, v251
  v_fmac_f32 v247, v251, v251
  s_cmp_lg_u32 s29, 3
  s_cbranch_scc1 g1_kernel_cs44
  v_mfma_f32_4x4x4_16b_bf16 v[216:219], v[4:5], v[196:197], v[216:219]
  v_mfma_f32_4x4x4_16b_bf16 v[220:223], v[4:5], v[200:201], v[220:223]
  v_mfma_f32_4x4x4_16b_bf16 v[224:227], v[4:5], v[204:205], v[224:227]
  v_mfma_f32_4x4x4_16b_bf16 v[228:231], v[4:5], v[208:209], v[228:231]
  v_mfma_f32_4x4x4_16b_bf16 v[232:235], v[4:5], v[212:213], v[232:235]
  v_mfma_f32_4x4x4_16b_bf16 v[216:219], v[4:5], v[198:199], v[216:219]
  v_mfma_f32_4x4x4_16b_bf16 v[220:223], v[4:5], v[202:203], v[220:223]
  v_mfma_f32_4x4x4_16b_bf16 v[224:227], v[4:5], v[206:207], v[224:227]
  v_mfma_f32_4x4x4_16b_bf16 v[228:231], v[4:5], v[210:211], v[228:231]
  v_mfma_f32_4x4x4_16b_bf16 v[232:235], v[4:5], v[214:215], v[232:235]
g1_kernel_cs44:
  s_barrier
  s_waitcnt lgkmcnt(11)
  v_mfma_f32_32x32x16_bf16 v[64:79], v[156:159], v[144:147], v[64:79]
  ds_read_b128 v[152:155], v60 offset:16384
  ds_read_b64_tr_b16 v[196:197], v62 offset:30720
  ds_read_b64_tr_b16 v[198:199], v62 offset:32000
  v_lshlrev_b32 v248, 16, v144
  v_and_b32 v249, 0xffff0000, v144
  v_add_f32 v240, v240, v248
  v_fmac_f32 v244, v248, v248
  v_add_f32 v242, v242, v249
  v_mfma_f32_32x32x16_bf16 v[80:95], v[160:163], v[144:147], v[80:95]
  ds_read_b64_tr_b16 v[200:201], v62 offset:30784
  ds_read_b64_tr_b16 v[202:203], v62 offset:32064
  v_fmac_f32 v246, v249, v249
  v_lshlrev_b32 v250, 16, v145
  v_and_b32 v251, 0xffff0000, v145
  v_add_f32 v241, v241, v250
  v_fmac_f32 v245, v250, v250
  v_mfma_f32_32x32x16_bf16 v[96:111], v[164:167], v[144:147], v[96:111]
  ds_read_b64_tr_b16 v[204:205], v62 offset:30848
  ds_read_b64_tr_b16 v[206:207], v62 offset:32128
  v_add_f32 v243, v243, v251
  v_fmac_f32 v247, v251, v251
  v_lshlrev_b32 v248, 16, v146
  v_and_b32 v249, 0xffff0000, v146
  v_add_f32 v240, v240, v248
  v_mfma_f32_32x32x16_bf16 v[112:127], v[168:171], v[144:147], v[112:127]
  ds_read_b64_tr_b16 v[208:209], v62 offset:30912
  ds_read_b64_tr_b16 v[210:211], v62 offset:32192
  v_fmac_f32 v244, v248, v248
  v_add_f32 v242, v242, v249
  v_fmac_f32 v246, v249, v249
  v_lshlrev_b32 v250, 16, v147
  v_and_b32 v251, 0xffff0000, v147
  v_mfma_f32_32x32x16_bf16 v[128:143], v[172:175], v[144:147], v[128:143]
  ds_read_b64_tr_b16 v[212:213], v62 offset:30976
  ds_read_b64_tr_b16 v[214:215], v62 offset:32256
  v_add_f32 v241, v241, v250
  v_fmac_f32 v245, v250, v250
  v_add_f32 v243, v243, v251
  v_fmac_f32 v247, v251, v251
  s_cmp_lg_u32 s29, 0
  s_cbranch_scc1 g1_kernel_cs45
  v_mfma_f32_4x4x4_16b_bf16 v[216:219], v[4:5], v[156:157], v[216:219]
  v_mfma_f32_4x4x4_16b_bf16 v[220:223], v[4:5], v[160:161], v[220:223]
  v_mfma_f32_4x4x4_16b_bf16 v[224:227], v[4:5], v[164:165], v[224:227]
  v_mfma_f32_4x4x4_16b_bf16 v[228:231], v[4:5], v[168:169], v[228:231]
  v_mfma_f32_4x4x4_16b_bf16 v[232:235], v[4:5], v[172:173], v[232:235]
  v_mfma_f32_4x4x4_16b_bf16 v[216:219], v[4:5], v[158:159], v[216:219]
  v_mfma_f32_4x4x4_16b_bf16 v[220:223], v[4:5], v[162:163], v[220:223]
  v_mfma_f32_4x4x4_16b_bf16 v[224:227], v[4:5], v[166:167], v[224:227]
  v_mfma_f32_4x4x4_16b_bf16 v[228:231], v[4:5], v[170:171], v[228:231]
  v_mfma_f32_4x4x4_16b_bf16 v[232:235], v[4:5], v[174:175], v[232:235]
g1_kernel_cs45:
  s_waitcnt lgkmcnt(11)
  v_mfma_f32_32x32x16_bf16 v[64:79], v[176:179], v[148:151], v[64:79]
  ds_read_b128 v[144:147], v61 offset:16384
  ds_read_b64_tr_b16 v[156:157], v62 offset:35840
  ds_read_b64_tr_b16 v[158:159], v62 offset:37120
  v_lshlrev_b32 v248, 16, v148
  v_and_b32 v249, 0xffff0000, v148
  v_add_f32 v240, v240, v248
  v_fmac_f32 v244, v248, v248
  v_add_f32 v242, v242, v249
  v_mfma_f32_32x32x16_bf16 v[80:95], v[180:183], v[148:151], v[80:95]
  ds_read_b64_tr_b16 v[160:161], v62 offset:35904
  ds_read_b64_tr_b16 v[162:163], v62 offset:37184
  v_fmac_f32 v246, v249, v249
  v_lshlrev_b32 v250, 16, v149
  v_and_b32 v251, 0xffff0000, v149
  v_add_f32 v241, v241, v250
  v_fmac_f32 v245, v250, v250
  v_mfma_f32_32x32x16_bf16 v[96:111], v[184:187], v[148:151], v[96:111]
  ds_read_b64_tr_b16 v[164:165], v62 offset:35968
  ds_read_b64_tr_b16 v[166:167], v62 offset:37248
  v_add_f32 v243, v243, v251
  v_fmac_f32 v247, v251, v251
  v_lshlrev_b32 v248, 16, v150
  v_and_b32 v249, 0xffff0000, v150
  v_add_f32 v240, v240, v248
  v_mfma_f32_32x32x16_bf16 v[112:127], v[188:191], v[148:151], v[112:127]
  ds_read_b64_tr_b16 v[168:169], v62 offset:36032
  ds_read_b64_tr_b16 v[170:171], v62 offset:37312
  v_fmac_f32 v244, v248, v248
  v_add_f32 v242, v242, v249
  v_fmac_f32 v246, v249, v249
  v_lshlrev_b32 v250, 16, v151
  v_and_b32 v251, 0xffff0000, v151
  v_mfma_f32_32x32x16_bf16 v[128:143], v[192:195], v[148:151], v[128:143]
  ds_read_b64_tr_b16 v[172:173], v62 offset:36096
  ds_read_b64_tr_b16 v[174:175], v62 offset:37376
  v_add_f32 v241, v241, v250
  v_fmac_f32 v245, v250, v250
  v_add_f32 v243, v243, v251
  v_fmac_f32 v247, v251, v251
  s_cmp_lg_u32 s29, 1
  s_cbranch_scc1 g1_kernel_cs46
  v_mfma_f32_4x4x4_16b_bf16 v[216:219], v[4:5], v[176:177], v[216:219]
  v_mfma_f32_4x4x4_16b_bf16 v[220:223], v[4:5], v[180:181], v[220:223]
  v_mfma_f32_4x4x4_16b_bf16 v[224:227], v[4:5], v[184:185], v[224:227]
  v_mfma_f32_4x4x4_16b_bf16 v[228:231], v[4:5], v[188:189], v[228:231]
  v_mfma_f32_4x4x4_16b_bf16 v[232:235], v[4:5], v[192:193], v[232:235]
  v_mfma_f32_4x4x4_16b_bf16 v[216:219], v[4:5], v[178:179], v[216:219]
  v_mfma_f32_4x4x4_16b_bf16 v[220:223], v[4:5], v[182:183], v[220:223]
  v_mfma_f32_4x4x4_16b_bf16 v[224:227], v[4:5], v[186:187], v[224:227]
  v_mfma_f32_4x4x4_16b_bf16 v[228:231], v[4:5], v[190:191], v[228:231]
  v_mfma_f32_4x4x4_16b_bf16 v[232:235], v[4:5], v[194:195], v[232:235]
g1_kernel_cs46:
  s_waitcnt lgkmcnt(11)
  v_mfma_f32_32x32x16_bf16 v[64:79], v[196:199], v[152:155], v[64:79]
  v_lshlrev_b32 v248, 16, v152
  v_and_b32 v249, 0xffff0000, v152
  v_add_f32 v240, v240, v248
  v_fmac_f32 v244, v248, v248
  v_add_f32 v242, v242, v249
  v_mfma_f32_32x32x16_bf16 v[80:95], v[200:203], v[152:155], v[80:95]
  v_fmac_f32 v246, v249, v249
  v_lshlrev_b32 v250, 16, v153
  v_and_b32 v251, 0xffff0000, v153
  v_add_f32 v241, v241, v250
  v_fmac_f32 v245, v250, v250
  v_mfma_f32_32x32x16_bf16 v[96:111], v[204:207], v[152:155], v[96:111]
  v_add_f32 v243, v243, v251
  v_fmac_f32 v247, v251, v251
  v_lshlrev_b32 v248, 16, v154
  v_and_b32 v249, 0xffff0000, v154
  v_add_f32 v240, v240, v248
  v_mfma_f32_32x32x16_bf16 v[112:127], v[208:211], v[152:155], v[112:127]
  v_fmac_f32 v244, v248, v248
  v_add_f32 v242, v242, v249
  v_fmac_f32 v246, v249, v249
  v_lshlrev_b32 v250, 16, v155
  v_and_b32 v251, 0xffff0000, v155
  v_mfma_f32_32x32x16_bf16 v[128:143], v[212:215], v[152:155], v[128:143]
  v_add_f32 v241, v241, v250
  v_fmac_f32 v245, v250, v250
  v_add_f32 v243, v243, v251
  v_fmac_f32 v247, v251, v251
  s_cmp_lg_u32 s29, 2
  s_cbranch_scc1 g1_kernel_cs47
  v_mfma_f32_4x4x4_16b_bf16 v[216:219], v[4:5], v[196:197], v[216:219]
  v_mfma_f32_4x4x4_16b_bf16 v[220:223], v[4:5], v[200:201], v[220:223]
  v_mfma_f32_4x4x4_16b_bf16 v[224:227], v[4:5], v[204:205], v[224:227]
  v_mfma_f32_4x4x4_16b_bf16 v[228:231], v[4:5], v[208:209], v[228:231]
  v_mfma_f32_4x4x4_16b_bf16 v[232:235], v[4:5], v[212:213], v[232:235]
  v_mfma_f32_4x4x4_16b_bf16 v[216:219], v[4:5], v[198:199], v[216:219]
  v_mfma_f32_4x4x4_16b_bf16 v[220:223], v[4:5], v[202:203], v[220:223]
  v_mfma_f32_4x4x4_16b_bf16 v[224:227], v[4:5], v[206:207], v[224:227]
  v_mfma_f32_4x4x4_16b_bf16 v[228:231], v[4:5], v[210:211], v[228:231]
  v_mfma_f32_4x4x4_16b_bf16 v[232:235], v[4:5], v[214:215], v[232:235]
g1_kernel_cs47:
  s_waitcnt lgkmcnt(0)
  v_mfma_f32_32x32x16_bf16 v[64:79], v[156:159], v[144:147], v[64:79]
  v_lshlrev_b32 v248, 16, v144
  v_and_b32 v249, 0xffff0000, v144
  v_add_f32 v240, v240, v248
  v_fmac_f32 v244, v248, v248
  v_add_f32 v242, v242, v249
  v_mfma_f32_32x32x16_bf16 v[80:95], v[160:163], v[144:147], v[80:95]
  v_fmac_f32 v246, v249, v249
  v_lshlrev_b32 v250, 16, v145
  v_and_b32 v251, 0xffff0000, v145
  v_add_f32 v241, v241, v250
  v_fmac_f32 v245, v250, v250
  v_mfma_f32_32x32x16_bf16 v[96:111], v[164:167], v[144:147], v[96:111]
  v_add_f32 v243, v243, v251
  v_fmac_f32 v247, v251, v251
  v_lshlrev_b32 v248, 16, v146
  v_and_b32 v249, 0xffff0000, v146
  v_add_f32 v240, v240, v248
  v_mfma_f32_32x32x16_bf16 v[112:127], v[168:171], v[144:147], v[112:127]
  v_fmac_f32 v244, v248, v248
  v_add_f32 v242, v242, v249
  v_fmac_f32 v246, v249, v249
  v_lshlrev_b32 v250, 16, v147
  v_and_b32 v251, 0xffff0000, v147
  v_mfma_f32_32x32x16_bf16 v[128:143], v[172:175], v[144:147], v[128:143]
  v_add_f32 v241, v241, v250
  v_fmac_f32 v245, v250, v250
  v_add_f32 v243, v243, v251
  v_fmac_f32 v247, v251, v251
  s_cmp_lg_u32 s29, 3
  s_cbranch_scc1 g1_kernel_cs48
  v_mfma_f32_4x4x4_16b_bf16 v[216:219], v[4:5], v[156:157], v[216:219]
  v_mfma_f32_4x4x4_16b_bf16 v[220:223], v[4:5], v[160:161], v[220:223]
  v_mfma_f32_4x4x4_16b_bf16 v[224:227], v[4:5], v[164:165], v[224:227]
  v_mfma_f32_4x4x4_16b_bf16 v[228:231], v[4:5], v[168:169], v[228:231]
  v_mfma_f32_4x4x4_16b_bf16 v[232:235], v[4:5], v[172:173], v[232:235]
  v_mfma_f32_4x4x4_16b_bf16 v[216:219], v[4:5], v[158:159], v[216:219]
  v_mfma_f32_4x4x4_16b_bf16 v[220:223], v[4:5], v[162:163], v[220:223]
  v_mfma_f32_4x4x4_16b_bf16 v[224:227], v[4:5], v[166:167], v[224:227]
  v_mfma_f32_4x4x4_16b_bf16 v[228:231], v[4:5], v[170:171], v[228:231]
  v_mfma_f32_4x4x4_16b_bf16 v[232:235], v[4:5], v[174:175], v[232:235]
g1_kernel_cs48:
  s_branch g1_kernel_ep8
g1_kernel_V7:
  s_barrier
  v_add_u32 v237, 61440, v62
  ds_read_b128 v[144:147], v58 offset:0
  ds_read_b64_tr_b16 v[156:157], v62 offset:0
  ds_read_b64_tr_b16 v[158:159], v62 offset:1280
  ds_read_b64_tr_b16 v[160:161], v62 offset:64
  ds_read_b64_tr_b16 v[162:163], v62 offset:1344
  ds_read_b64_tr_b16 v[164:165], v62 offset:128
  ds_read_b64_tr_b16 v[166:167], v62 offset:1408
  ds_read_b64_tr_b16 v[168:169], v62 offset:192
  ds_read_b64_tr_b16 v[170:171], v62 offset:1472
  ds_read_b64_tr_b16 v[172:173], v62 offset:256
  ds_read_b64_tr_b16 v[174:175], v62 offset:1536
  ds_read_b128 v[148:151], v59 offset:0
  ds_read_b64_tr_b16 v[176:177], v62 offset:5120
  ds_read_b64_tr_b16 v[178:179], v62 offset:6400
  ds_read_b64_tr_b16 v[180:181], v62 offset:5184
  ds_read_b64_tr_b16 v[182:183], v62 offset:6464
  ds_read_b64_tr_b16 v[184:185], v62 offset:5248
  ds_read_b64_tr_b16 v[186:187], v62 offset:6528
  ds_read_b64_tr_b16 v[188:189], v62 offset:5312
  ds_read_b64_tr_b16 v[190:191], v62 offset:6592
  ds_read_b64_tr_b16 v[192:193], v62 offset:5376
  ds_read_b64_tr_b16 v[194:195], v62 offset:6656
  s_waitcnt lgkmcnt(11)
  v_mfma_f32_32x32x16_bf16 v[64:79], v[144:147], v[156:159], 0
  ds_read_b128 v[152:155], v60 offset:0
  ds_read_b64_tr_b16 v[196:197], v62 offset:10240
  ds_read_b64_tr_b16 v[198:199], v62 offset:11520
  v_lshlrev_b32 v248, 16, v144
  v_and_b32 v249, 0xffff0000, v144
  v_add_f32 v240, v240, v248
  v_fmac_f32 v244, v248, v248
  v_add_f32 v242, v242, v249
  v_mfma_f32_32x32x16_bf16 v[80:95], v[144:147], v[160:163], 0
  ds_read_b64_tr_b16 v[200:201], v62 offset:10304
  ds_read_b64_tr_b16 v[202:203], v62 offset:11584
  v_fmac_f32 v246, v249, v249
  v_lshlrev_b32 v250, 16, v145
  v_and_b32 v251, 0xffff0000, v145
  v_add_f32 v241, v241, v250
  v_fmac_f32 v245, v250, v250
  v_mfma_f32_32x32x16_bf16 v[96:111], v[144:147], v[164:167], 0
  ds_read_b64_tr_b16 v[204:205], v62 offset:10368
  ds_read_b64_tr_b16 v[206:207], v62 offset:11648
  v_add_f32 v243, v243, v251
  v_fmac_f32 v247, v251, v251
  v_lshlrev_b32 v248, 16, v146
  v_and_b32 v249, 0xffff0000, v146
  v_add_f32 v240, v240, v248
  v_mfma_f32_32x32x16_bf16 v[112:127], v[144:147], v[168:171], 0
  ds_read_b64_tr_b16 v[208:209], v62 offset:10432
  ds_read_b64_tr_b16 v[210:211], v62 offset:11712
  v_fmac_f32 v244, v248, v248
  v_add_f32 v242, v242, v249
  v_fmac_f32 v246, v249, v249
  v_lshlrev_b32 v250, 16, v147
  v_and_b32 v251, 0xffff0000, v147
  v_mfma_f32_32x32x16_bf16 v[128:143], v[144:147], v[172:175], 0
  ds_read_b64_tr_b16 v[212:213], v62 offset:10496
  ds_read_b64_tr_b16 v[214:215], v62 offset:11776
  v_add_f32 v241, v241, v250
  v_fmac_f32 v245, v250, v250
  v_add_f32 v243, v243, v251
  v_fmac_f32 v247, v251, v251
  s_cmp_lg_u32 s29, 0
  s_cbranch_scc1 g1_kernel_cs49
  v_mfma_f32_4x4x4_16b_bf16 v[216:219], v[4:5], v[156:157], v[216:219]
  v_mfma_f32_4x4x4_16b_bf16 v[220:223], v[4:5], v[160:161], v[220:223]
  v_mfma_f32_4x4x4_16b_bf16 v[224:227], v[4:5], v[164:165], v[224:227]
  v_mfma_f32_4x4x4_16b_bf16 v[228:231], v[4:5], v[168:169], v[228:231]
  v_mfma_f32_4x4x4_16b_bf16 v[232:235], v[4:5], v[172:173], v[232:235]
  v_mfma_f32_4x4x4_16b_bf16 v[216:219], v[4:5], v[158:159], v[216:219]
  v_mfma_f32_4x4x4_16b_bf16 v[220:223], v[4:5], v[162:163], v[220:223]
  v_mfma_f32_4x4x4_16b_bf16 v[224:227], v[4:5], v[166:167], v[224:227]
  v_mfma_f32_4x4x4_16b_bf16 v[228:231], v[4:5], v[170:171], v[228:231]
  v_mfma_f32_4x4x4_16b_bf16 v[232:235], v[4:5], v[174:175], v[232:235]
g1_kernel_cs49:
  s_waitcnt lgkmcnt(11)
  v_mfma_f32_32x32x16_bf16 v[64:79], v[148:151], v[176:179], v[64:79]
  ds_read_b128 v[144:147], v61 offset:0
  ds_read_b64_tr_b16 v[156:157], v62 offset:15360
  ds_read_b64_tr_b16 v[158:159], v62 offset:16640
  v_lshlrev_b32 v248, 16, v148
  v_and_b32 v249, 0xffff0000, v148
  v_add_f32 v240, v240, v248
  v_fmac_f32 v244, v248, v248
  v_add_f32 v242, v242, v249
  v_mfma_f32_32x32x16_bf16 v[80:95], v[148:151], v[180:183], v[80:95]
  ds_read_b64_tr_b16 v[160:161], v62 offset:15424
  ds_read_b64_tr_b16 v[162:163], v62 offset:16704
  v_fmac_f32 v246, v249, v249
  v_lshlrev_b32 v250, 16, v149
  v_and_b32 v251, 0xffff0000, v149
  v_add_f32 v241, v241, v250
  v_fmac_f32 v245, v250, v250
  v_mfma_f32_32x32x16_bf16 v[96:111], v[148:151], v[184:187], v[96:111]
  ds_read_b64_tr_b16 v[164:165], v62 offset:15488
  ds_read_b64_tr_b16 v[166:167], v62 offset:16768
  v_add_f32 v243, v243, v251
  v_fmac_f32 v247, v251, v251
  v_lshlrev_b32 v248, 16, v150
  v_and_b32 v249, 0xffff0000, v150
  v_add_f32 v240, v240, v248
  v_mfma_f32_32x32x16_bf16 v[112:127], v[148:151], v[188:191], v[112:127]
  ds_read_b64_tr_b16 v[168:169], v62 offset:15552
  ds_read_b64_tr_b16 v[170:171], v62 offset:16832
  v_fmac_f32 v244, v248, v248
  v_add_f32 v242, v242, v249
  v_fmac_f32 v246, v249, v249
  v_lshlrev_b32 v250, 16, v151
  v_and_b32 v251, 0xffff0000, v151
  v_mfma_f32_32x32x16_bf16 v[128:143], v[148:151], v[192:195], v[128:143]
  ds_read_b64_tr_b16 v[172:173], v62 offset:15616
  ds_read_b64_tr_b16 v[174:175], v62 offset:16896
  v_add_f32 v241, v241, v250
  v_fmac_f32 v245, v250, v250
  v_add_f32 v243, v243, v251
  v_fmac_f32 v247, v251, v251
  s_cmp_lg_u32 s29, 1
  s_cbranch_scc1 g1_kernel_cs50
  v_mfma_f32_4x4x4_16b_bf16 v[216:219], v[4:5], v[176:177], v[216:219]
  v_mfma_f32_4x4x4_16b_bf16 v[220:223], v[4:5], v[180:181], v[220:223]
  v_mfma_f32_4x4x4_16b_bf16 v[224:227], v[4:5], v[184:185], v[224:227]
  v_mfma_f32_4x4x4_16b_bf16 v[228:231], v[4:5], v[188:189], v[228:231]
  v_mfma_f32_4x4x4_16b_bf16 v[232:235], v[4:5], v[192:193], v[232:235]
  v_mfma_f32_4x4x4_16b_bf16 v[216:219], v[4:5], v[178:179], v[216:219]
  v_mfma_f32_4x4x4_16b_bf16 v[220:223], v[4:5], v[182:183], v[220:223]
  v_mfma_f32_4x4x4_16b_bf16 v[224:227], v[4:5], v[186:187], v[224:227]
  v_mfma_f32_4x4x4_16b_bf16 v[228:231], v[4:5], v[190:191], v[228:231]
  v_mfma_f32_4x4x4_16b_bf16 v[232:235], v[4:5], v[194:195], v[232:235]
g1_kernel_cs50:
  s_barrier
  s_waitcnt lgkmcnt(11)
  v_mfma_f32_32x32x16_bf16 v[64:79], v[152:155], v[196:199], v[64:79]
  ds_read_b128 v[148:151], v58 offset:16384
  ds_read_b64_tr_b16 v[176:177], v62 offset:20480
  ds_read_b64_tr_b16 v[178:179], v62 offset:21760
  v_lshlrev_b32 v248, 16, v152
  v_and_b32 v249, 0xffff0000, v152
  v_add_f32 v240, v240, v248
  v_fmac_f32 v244, v248, v248
  v_add_f32 v242, v242, v249
  v_mfma_f32_32x32x16_bf16 v[80:95], v[152:155], v[200:203], v[80:95]
  ds_read_b64_tr_b16 v[180:181], v62 offset:20544
  ds_read_b64_tr_b16 v[182:183], v62 offset:21824
  v_fmac_f32 v246, v249, v249
  v_lshlrev_b32 v250, 16, v153
  v_and_b32 v251, 0xffff0000, v153
  v_add_f32 v241, v241, v250
  v_fmac_f32 v245, v250, v250
  v_mfma_f32_32x32x16_bf16 v[96:111], v[152:155], v[204:207], v[96:111]
  ds_read_b64_tr_b16 v[184:185], v62 offset:20608
  ds_read_b64_tr_b16 v[186:187], v62 offset:21888
  v_add_f32 v243, v243, v251
  v_fmac_f32 v247, v251, v251
  v_lshlrev_b32 v248, 16, v154
  v_and_b32 v249, 0xffff0000, v154
  v_add_f32 v240, v240, v248
  v_mfma_f32_32x32x16_bf16 v[112:127], v[152:155], v[208:211], v[112:127]
  ds_read_b64_tr_b16 v[188:189], v62 offset:20672
  ds_read_b64_tr_b16 v[190:191], v62 offset:21952
  v_fmac_f32 v244, v248, v248
  v_add_f32 v242, v242, v249
  v_fmac_f32 v246, v249, v249
  v_lshlrev_b32 v250, 16, v155
  v_and_b32 v251, 0xffff0000, v155
  v_mfma_f32_32x32x16_bf16 v[128:143], v[152:155], v[212:215], v[128:143]
  ds_read_b64_tr_b16 v[192:193], v62 offset:20736
  ds_read_b64_tr_b16 v[194:195], v62 offset:22016
  v_add_f32 v241, v241, v250
  v_fmac_f32 v245, v250, v250
  v_add_f32 v243, v243, v251
  v_fmac_f32 v247, v251, v251
  s_cmp_lg_u32 s29, 2
  s_cbranch_scc1 g1_kernel_cs51
  v_mfma_f32_4x4x4_16b_bf16 v[216:219], v[4:5], v[196:197], v[216:219]
  v_mfma_f32_4x4x4_16b_bf16 v[220:223], v[4:5], v[200:201], v[220:223]
  v_mfma_f32_4x4x4_16b_bf16 v[224:227], v[4:5], v[204:205], v[224:227]
  v_mfma_f32_4x4x4_16b_bf16 v[228:231], v[4:5], v[208:209], v[228:231]
  v_mfma_f32_4x4x4_16b_bf16 v[232:235], v[4:5], v[212:213], v[232:235]
  v_mfma_f32_4x4x4_16b_bf16 v[216:219], v[4:5], v[198:199], v[216:219]
  v_mfma_f32_4x4x4_16b_bf16 v[220:223], v[4:5], v[202:203], v[220:223]
  v_mfma_f32_4x4x4_16b_bf16 v[224:227], v[4:5], v[206:207], v[224:227]
  v_mfma_f32_4x4x4_16b_bf16 v[228:231], v[4:5], v[210:211], v[228:231]
  v_mfma_f32_4x4x4_16b_bf16 v[232:235], v[4:5], v[214:215], v[232:235]
g1_kernel_cs51:
  s_waitcnt lgkmcnt(11)
  v_mfma_f32_32x32x16_bf16 v[64:79], v[144:147], v[156:159], v[64:79]
  ds_read_b128 v[152:155], v59 offset:16384
  ds_read_b64_tr_b16 v[196:197], v62 offset:25600
  ds_read_b64_tr_b16 v[198:199], v62 offset:26880
  v_lshlrev_b32 v248, 16, v144
  v_and_b32 v249, 0xffff0000, v144
  v_add_f32 v240, v240, v248
  v_fmac_f32 v244, v248, v248
  v_add_f32 v242, v242, v249
  v_mfma_f32_32x32x16_bf16 v[80:95], v[144:147], v[160:163], v[80:95]
  ds_read_b64_tr_b16 v[200:201], v62 offset:25664
  ds_read_b64_tr_b16 v[202:203], v62 offset:26944
  v_fmac_f32 v246, v249, v249
  v_lshlrev_b32 v250, 16, v145
  v_and_b32 v251, 0xffff0000, v145
  v_add_f32 v241, v241, v250
  v_fmac_f32 v245, v250, v250
  v_mfma_f32_32x32x16_bf16 v[96:111], v[144:147], v[164:167], v[96:111]
  ds_read_b64_tr_b16 v[204:205], v62 offset:25728
  ds_read_b64_tr_b16 v[206:207], v62 offset:27008
  v_add_f32 v243, v243, v251
  v_fmac_f32 v247, v251, v251
  v_lshlrev_b32 v248, 16, v146
  v_and_b32 v249, 0xffff0000, v146
  v_add_f32 v240, v240, v248
  v_mfma_f32_32x32x16_bf16 v[112:127], v[144:147], v[168:171], v[112:127]
  ds_read_b64_tr_b16 v[208:209], v62 offset:25792
  ds_read_b64_tr_b16 v[210:211], v62 offset:27072
  v_fmac_f32 v244, v248, v248
  v_add_f32 v242, v242, v249
  v_fmac_f32 v246, v249, v249
  v_lshlrev_b32 v250, 16, v147
  v_and_b32 v251, 0xffff0000, v147
  v_mfma_f32_32x32x16_bf16 v[128:143], v[144:147], v[172:175], v[128:143]
  ds_read_b64_tr_b16 v[212:213], v62 offset:25856
  ds_read_b64_tr_b16 v[214:215], v62 offset:27136
  v_add_f32 v241, v241, v250
  v_fmac_f32 v245, v250, v250
  v_add_f32 v243, v243, v251
  v_fmac_f32 v247, v251, v251
  s_cmp_lg_u32 s29, 3
  s_cbranch_scc1 g1_kernel_cs52
  v_mfma_f32_4x4x4_16b_bf16 v[216:219], v[4:5], v[156:157], v[216:219]
  v_mfma_f32_4x4x4_16b_bf16 v[220:223], v[4:5], v[160:161], v[220:223]
  v_mfma_f32_4x4x4_16b_bf16 v[224:227], v[4:5], v[164:165], v[224:227]
  v_mfma_f32_4x4x4_16b_bf16 v[228:231], v[4:5], v[168:169], v[228:231]
  v_mfma_f32_4x4x4_16b_bf16 v[232:235], v[4:5], v[172:173], v[232:235]
  v_mfma_f32_4x4x4_16b_bf16 v[216:219], v[4:5], v[158:159], v[216:219]
  v_mfma_f32_4x4x4_16b_bf16 v[220:223], v[4:5], v[162:163], v[220:223]
  v_mfma_f32_4x4x4_16b_bf16 v[224:227], v[4:5], v[166:167], v[224:227]
  v_mfma_f32_4x4x4_16b_bf16 v[228:231], v[4:5], v[170:171], v[228:231]
  v_mfma_f32_4x4x4_16b_bf16 v[232:235], v[4:5], v[174:175], v[232:235]
g1_kernel_cs52:
  s_barrier
  s_waitcnt lgkmcnt(11)
  v_mfma_f32_32x32x16_bf16 v[64:79], v[148:151], v[176:179], v[64:79]
  ds_read_b128 v[144:147], v60 offset:16384
  ds_read_b64_tr_b16 v[156:157], v62 offset:30720
  ds_read_b64_tr_b16 v[158:159], v62 offset:32000
  v_lshlrev_b32 v248, 16, v148
  v_and_b32 v249, 0xffff0000, v148
  v_add_f32 v240, v240, v248
  v_fmac_f32 v244, v248, v248
  v_add_f32 v242, v242, v249
  v_mfma_f32_32x32x16_bf16 v[80:95], v[148:151], v[180:183], v[80:95]
  ds_read_b64_tr_b16 v[160:161], v62 offset:30784
  ds_read_b64_tr_b16 v[162:163], v62 offset:32064
  v_fmac_f32 v246, v249, v249
  v_lshlrev_b32 v250, 16, v149
  v_and_b32 v251, 0xffff0000, v149
  v_add_f32 v241, v241, v250
  v_fmac_f32 v245, v250, v250
  v_mfma_f32_32x32x16_bf16 v[96:111], v[148:151], v[184:187], v[96:111]
  ds_read_b64_tr_b16 v[164:165], v62 offset:30848
  ds_read_b64_tr_b16 v[166:167], v62 offset:32128
  v_add_f32 v243, v243, v251
  v_fmac_f32 v247, v251, v251
  v_lshlrev_b32 v248, 16, v150
  v_and_b32 v249, 0xffff0000, v150
  v_add_f32 v240, v240, v248
  v_mfma_f32_32x32x16_bf16 v[112:127], v[148:151], v[188:191], v[112:127]
  ds_read_b64_tr_b16 v[168:169], v62 offset:30912
  ds_read_b64_tr_b16 v[170:171], v62 offset:32192
  v_fmac_f32 v244, v248, v248
  v_add_f32 v242, v242, v249
  v_fmac_f32 v246, v249, v249
  v_lshlrev_b32 v250, 16, v151
  v_and_b32 v251, 0xffff0000, v151
  v_mfma_f32_32x32x16_bf16 v[128:143], v[148:151], v[192:195], v[128:143]
  ds_read_b64_tr_b16 v[172:173], v62 offset:30976
  ds_read_b64_tr_b16 v[174:175], v62 offset:32256
  v_add_f32 v241, v241, v250
  v_fmac_f32 v245, v250, v250
  v_add_f32 v243, v243, v251
  v_fmac_f32 v247, v251, v251
  s_cmp_lg_u32 s29, 0
  s_cbranch_scc1 g1_kernel_cs53
  v_mfma_f32_4x4x4_16b_bf16 v[216:219], v[4:5], v[176:177], v[216:219]
  v_mfma_f32_4x4x4_16b_bf16 v[220:223], v[4:5], v[180:181], v[220:223]
  v_mfma_f32_4x4x4_16b_bf16 v[224:227], v[4:5], v[184:185], v[224:227]
  v_mfma_f32_4x4x4_16b_bf16 v[228:231], v[4:5], v[188:189], v[228:231]
  v_mfma_f32_4x4x4_16b_bf16 v[232:235], v[4:5], v[192:193], v[232:235]
  v_mfma_f32_4x4x4_16b_bf16 v[216:219], v[4:5], v[178:179], v[216:219]
  v_mfma_f32_4x4x4_16b_bf16 v[220:223], v[4:5], v[182:183], v[220:223]
  v_mfma_f32_4x4x4_16b_bf16 v[224:227], v[4:5], v[186:187], v[224:227]
  v_mfma_f32_4x4x4_16b_bf16 v[228:231], v[4:5], v[190:191], v[228:231]
  v_mfma_f32_4x4x4_16b_bf16 v[232:235], v[4:5], v[194:195], v[232:235]
g1_kernel_cs53:
  s_waitcnt lgkmcnt(11)
  v_mfma_f32_32x32x16_bf16 v[64:79], v[152:155], v[196:199], v[64:79]
  ds_read_b128 v[148:151], v61 offset:16384
  ds_read_b64_tr_b16 v[176:177], v62 offset:35840
  ds_read_b64_tr_b16 v[178:179], v62 offset:37120
  v_lshlrev_b32 v248, 16, v152
  v_and_b32 v249, 0xffff0000, v152
  v_add_f32 v240, v240, v248
  v_fmac_f32 v244, v248, v248
  v_add_f32 v242, v242, v249
  v_mfma_f32_32x32x16_bf16 v[80:95], v[152:155], v[200:203], v[80:95]
  ds_read_b64_tr_b16 v[180:181], v62 offset:35904
  ds_read_b64_tr_b16 v[182:183], v62 offset:37184
  v_fmac_f32 v246, v249, v249
  v_lshlrev_b32 v250, 16, v153
  v_and_b32 v251, 0xffff0000, v153
  v_add_f32 v241, v241, v250
  v_fmac_f32 v245, v250, v250
  v_mfma_f32_32x32x16_bf16 v[96:111], v[152:155], v[204:207], v[96:111]
  ds_read_b64_tr_b16 v[184:185], v62 offset:35968
  ds_read_b64_tr_b16 v[186:187], v62 offset:37248
  v_add_f32 v243, v243, v251
  v_fmac_f32 v247, v251, v251
  v_lshlrev_b32 v248, 16, v154
  v_and_b32 v249, 0xffff0000, v154
  v_add_f32 v240, v240, v248
  v_mfma_f32_32x32x16_bf16 v[112:127], v[152:155], v[208:211], v[112:127]
  ds_read_b64_tr_b16 v[188:189], v62 offset:36032
  ds_read_b64_tr_b16 v[190:191], v62 offset:37312
  v_fmac_f32 v244, v248, v248
  v_add_f32 v242, v242, v249
  v_fmac_f32 v246, v249, v249
  v_lshlrev_b32 v250, 16, v155
  v_and_b32 v251, 0xffff0000, v155
  v_mfma_f32_32x32x16_bf16 v[128:143], v[152:155], v[212:215], v[128:143]
  ds_read_b64_tr_b16 v[192:193], v62 offset:36096
  ds_read_b64_tr_b16 v[194:195], v62 offset:37376
  v_add_f32 v241, v241, v250
  v_fmac_f32 v245, v250, v250
  v_add_f32 v243, v243, v251
  v_fmac_f32 v247, v251, v251
  s_cmp_lg_u32 s29, 1
  s_cbranch_scc1 g1_kernel_cs54
  v_mfma_f32_4x4x4_16b_bf16 v[216:219], v[4:5], v[196:197], v[216:219]
  v_mfma_f32_4x4x4_16b_bf16 v[220:223], v[4:5], v[200:201], v[220:223]
  v_mfma_f32_4x4x4_16b_bf16 v[224:227], v[4:5], v[204:205], v[224:227]
  v_mfma_f32_4x4x4_16b_bf16 v[228:231], v[4:5], v[208:209], v[228:231]
  v_mfma_f32_4x4x4_16b_bf16 v[232:235], v[4:5], v[212:213], v[232:235]
  v_mfma_f32_4x4x4_16b_bf16 v[216:219], v[4:5], v[198:199], v[216:219]
  v_mfma_f32_4x4x4_16b_bf16 v[220:223], v[4:5], v[202:203], v[220:223]
  v_mfma_f32_4x4x4_16b_bf16 v[224:227], v[4:5], v[206:207], v[224:227]
  v_mfma_f32_4x4x4_16b_bf16 v[228:231], v[4:5], v[210:211], v[228:231]
  v_mfma_f32_4x4x4_16b_bf16 v[232:235], v[4:5], v[214:215], v[232:235]
g1_kernel_cs54:
  s_waitcnt lgkmcnt(11)
  v_mfma_f32_32x32x16_bf16 v[64:79], v[144:147], v[156:159], v[64:79]
  ds_read_b128 v[152:155], v58 offset:32768
  ds_read_b64_tr_b16 v[196:197], v62 offset:40960
  ds_read_b64_tr_b16 v[198:199], v62 offset:42240
  v_lshlrev_b32 v248, 16, v144
  v_and_b32 v249, 0xffff0000, v144
  v_add_f32 v240, v240, v248
  v_fmac_f32 v244, v248, v248
  v_add_f32 v242, v242, v249
  v_mfma_f32_32x32x16_bf16 v[80:95], v[144:147], v[160:163], v[80:95]
  ds_read_b64_tr_b16 v[200:201], v62 offset:41024
  ds_read_b64_tr_b16 v[202:203], v62 offset:42304
  v_fmac_f32 v246, v249, v249
  v_lshlrev_b32 v250, 16, v145
  v_and_b32 v251, 0xffff0000, v145
  v_add_f32 v241, v241, v250
  v_fmac_f32 v245, v250, v250
  v_mfma_f32_32x32x16_bf16 v[96:111], v[144:147], v[164:167], v[96:111]
  ds_read_b64_tr_b16 v[204:205], v62 offset:41088
  ds_read_b64_tr_b16 v[206:207], v62 offset:42368
  v_add_f32 v243, v243, v251
  v_fmac_f32 v247, v251, v251
  v_lshlrev_b32 v248, 16, v146
  v_and_b32 v249, 0xffff0000, v146
  v_add_f32 v240, v240, v248
  v_mfma_f32_32x32x16_bf16 v[112:127], v[144:147], v[168:171], v[112:127]
  ds_read_b64_tr_b16 v[208:209], v62 offset:41152
  ds_read_b64_tr_b16 v[210:211], v62 offset:42432
  v_fmac_f32 v244, v248, v248
  v_add_f32 v242, v242, v249
  v_fmac_f32 v246, v249, v249
  v_lshlrev_b32 v250, 16, v147
  v_and_b32 v251, 0xffff0000, v147
  v_mfma_f32_32x32x16_bf16 v[128:143], v[144:147], v[172:175], v[128:143]
  ds_read_b64_tr_b16 v[212:213], v62 offset:41216
  ds_read_b64_tr_b16 v[214:215], v62 offset:42496
  v_add_f32 v241, v241, v250
  v_fmac_f32 v245, v250, v250
  v_add_f32 v243, v243, v251
  v_fmac_f32 v247, v251, v251
  s_cmp_lg_u32 s29, 2
  s_cbranch_scc1 g1_kernel_cs55
  v_mfma_f32_4x4x4_16b_bf16 v[216:219], v[4:5], v[156:157], v[216:219]
  v_mfma_f32_4x4x4_16b_bf16 v[220:223], v[4:5], v[160:161], v[220:223]
  v_mfma_f32_4x4x4_16b_bf16 v[224:227], v[4:5], v[164:165], v[224:227]
  v_mfma_f32_4x4x4_16b_bf16 v[228:231], v[4:5], v[168:169], v[228:231]
  v_mfma_f32_4x4x4_16b_bf16 v[232:235], v[4:5], v[172:173], v[232:235]
  v_mfma_f32_4x4x4_16b_bf16 v[216:219], v[4:5], v[158:159], v[216:219]
  v_mfma_f32_4x4x4_16b_bf16 v[220:223], v[4:5], v[162:163], v[220:223]
  v_mfma_f32_4x4x4_16b_bf16 v[224:227], v[4:5], v[166:167], v[224:227]
  v_mfma_f32_4x4x4_16b_bf16 v[228:231], v[4:5], v[170:171], v[228:231]
  v_mfma_f32_4x4x4_16b_bf16 v[232:235], v[4:5], v[174:175], v[232:235]
g1_kernel_cs55:
  s_waitcnt lgkmcnt(11)
  v_mfma_f32_32x32x16_bf16 v[64:79], v[148:151], v[176:179], v[64:79]
  ds_read_b128 v[144:147], v59 offset:32768
  ds_read_b64_tr_b16 v[156:157], v62 offset:46080
  ds_read_b64_tr_b16 v[158:159], v62 offset:47360
  v_lshlrev_b32 v248, 16, v148
  v_and_b32 v249, 0xffff0000, v148
  v_add_f32 v240, v240, v248
  v_fmac_f32 v244, v248, v248
  v_add_f32 v242, v242, v249
  v_mfma_f32_32x32x16_bf16 v[80:95], v[148:151], v[180:183], v[80:95]
  ds_read_b64_tr_b16 v[160:161], v62 offset:46144
  ds_read_b64_tr_b16 v[162:163], v62 offset:47424
  v_fmac_f32 v246, v249, v249
  v_lshlrev_b32 v250, 16, v149
  v_and_b32 v251, 0xffff0000, v149
  v_add_f32 v241, v241, v250
  v_fmac_f32 v245, v250, v250
  v_mfma_f32_32x32x16_bf16 v[96:111], v[148:151], v[184:187], v[96:111]
  ds_read_b64_tr_b16 v[164:165], v62 offset:46208
  ds_read_b64_tr_b16 v[166:167], v62 offset:47488
  v_add_f32 v243, v243, v251
  v_fmac_f32 v247, v251, v251
  v_lshlrev_b32 v248, 16, v150
  v_and_b32 v249, 0xffff0000, v150
  v_add_f32 v240, v240, v248
  v_mfma_f32_32x32x16_bf16 v[112:127], v[148:151], v[188:191], v[112:127]
  ds_read_b64_tr_b16 v[168:169], v62 offset:46272
  ds_read_b64_tr_b16 v[170:171], v62 offset:47552
  v_fmac_f32 v244, v248, v248
  v_add_f32 v242, v242, v249
  v_fmac_f32 v246, v249, v249
  v_lshlrev_b32 v250, 16, v151
  v_and_b32 v251, 0xffff0000, v151
  v_mfma_f32_32x32x16_bf16 v[128:143], v[148:151], v[192:195], v[128:143]
  ds_read_b64_tr_b16 v[172:173], v62 offset:46336
  ds_read_b64_tr_b16 v[174:175], v62 offset:47616
  v_add_f32 v241, v241, v250
  v_fmac_f32 v245, v250, v250
  v_add_f32 v243, v243, v251
  v_fmac_f32 v247, v251, v251
  s_cmp_lg_u32 s29, 3
  s_cbranch_scc1 g1_kernel_cs56
  v_mfma_f32_4x4x4_16b_bf16 v[216:219], v[4:5], v[176:177], v[216:219]
  v_mfma_f32_4x4x4_16b_bf16 v[220:223], v[4:5], v[180:181], v[220:223]
  v_mfma_f32_4x4x4_16b_bf16 v[224:227], v[4:5], v[184:185], v[224:227]
  v_mfma_f32_4x4x4_16b_bf16 v[228:231], v[4:5], v[188:189], v[228:231]
  v_mfma_f32_4x4x4_16b_bf16 v[232:235], v[4:5], v[192:193], v[232:235]
  v_mfma_f32_4x4x4_16b_bf16 v[216:219], v[4:5], v[178:179], v[216:219]
  v_mfma_f32_4x4x4_16b_bf16 v[220:223], v[4:5], v[182:183], v[220:223]
  v_mfma_f32_4x4x4_16b_bf16 v[224:227], v[4:5], v[186:187], v[224:227]
  v_mfma_f32_4x4x4_16b_bf16 v[228:231], v[4:5], v[190:191], v[228:231]
  v_mfma_f32_4x4x4_16b_bf16 v[232:235], v[4:5], v[194:195], v[232:235]
g1_kernel_cs56:
  s_barrier
  s_waitcnt lgkmcnt(11)
  v_mfma_f32_32x32x16_bf16 v[64:79], v[152:155], v[196:199], v[64:79]
  ds_read_b128 v[148:151], v60 offset:32768
  ds_read_b64_tr_b16 v[176:177], v62 offset:51200
  ds_read_b64_tr_b16 v[178:179], v62 offset:52480
  v_lshlrev_b32 v248, 16, v152
  v_and_b32 v249, 0xffff0000, v152
  v_add_f32 v240, v240, v248
  v_fmac_f32 v244, v248, v248
  v_add_f32 v242, v242, v249
  v_mfma_f32_32x32x16_bf16 v[80:95], v[152:155], v[200:203], v[80:95]
  ds_read_b64_tr_b16 v[180:181], v62 offset:51264
  ds_read_b64_tr_b16 v[182:183], v62 offset:52544
  v_fmac_f32 v246, v249, v249
  v_lshlrev_b32 v250, 16, v153
  v_and_b32 v251, 0xffff0000, v153
  v_add_f32 v241, v241, v250
  v_fmac_f32 v245, v250, v250
  v_mfma_f32_32x32x16_bf16 v[96:111], v[152:155], v[204:207], v[96:111]
  ds_read_b64_tr_b16 v[184:185], v62 offset:51328
  ds_read_b64_tr_b16 v[186:187], v62 offset:52608
  v_add_f32 v243, v243, v251
  v_fmac_f32 v247, v251, v251
  v_lshlrev_b32 v248, 16, v154
  v_and_b32 v249, 0xffff0000, v154
  v_add_f32 v240, v240, v248
  v_mfma_f32_32x32x16_bf16 v[112:127], v[152:155], v[208:211], v[112:127]
  ds_read_b64_tr_b16 v[188:189], v62 offset:51392
  ds_read_b64_tr_b16 v[190:191], v62 offset:52672
  v_fmac_f32 v244, v248, v248
  v_add_f32 v242, v242, v249
  v_fmac_f32 v246, v249, v249
  v_lshlrev_b32 v250, 16, v155
  v_and_b32 v251, 0xffff0000, v155
  v_mfma_f32_32x32x16_bf16 v[128:143], v[152:155], v[212:215], v[128:143]
  ds_read_b64_tr_b16 v[192:193], v62 offset:51456
  ds_read_b64_tr_b16 v[194:195], v62 offset:52736
  v_add_f32 v241, v241, v250
  v_fmac_f32 v245, v250, v250
  v_add_f32 v243, v243, v251
  v_fmac_f32 v247, v251, v251
  s_cmp_lg_u32 s29, 0
  s_cbranch_scc1 g1_kernel_cs57
  v_mfma_f32_4x4x4_16b_bf16 v[216:219], v[4:5], v[196:197], v[216:219]
  v_mfma_f32_4x4x4_16b_bf16 v[220:223], v[4:5], v[200:201], v[220:223]
  v_mfma_f32_4x4x4_16b_bf16 v[224:227], v[4:5], v[204:205], v[224:227]
  v_mfma_f32_4x4x4_16b_bf16 v[228:231], v[4:5], v[208:209], v[228:231]
  v_mfma_f32_4x4x4_16b_bf16 v[232:235], v[4:5], v[212:213], v[232:235]
  v_mfma_f32_4x4x4_16b_bf16 v[216:219], v[4:5], v[198:199], v[216:219]
  v_mfma_f32_4x4x4_16b_bf16 v[220:223], v[4:5], v[202:203], v[220:223]
  v_mfma_f32_4x4x4_16b_bf16 v[224:227], v[4:5], v[206:207], v[224:227]
  v_mfma_f32_4x4x4_16b_bf16 v[228:231], v[4:5], v[210:211], v[228:231]
  v_mfma_f32_4x4x4_16b_bf16 v[232:235], v[4:5], v[214:215], v[232:235]
g1_kernel_cs57:
  s_waitcnt lgkmcnt(11)
  v_mfma_f32_32x32x16_bf16 v[64:79], v[144:147], v[156:159], v[64:79]
  ds_read_b128 v[152:155], v61 offset:32768
  ds_read_b64_tr_b16 v[196:197], v62 offset:56320
  ds_read_b64_tr_b16 v[198:199], v62 offset:57600
  v_lshlrev_b32 v248, 16, v144
  v_and_b32 v249, 0xffff0000, v144
  v_add_f32 v240, v240, v248
  v_fmac_f32 v244, v248, v248
  v_add_f32 v242, v242, v249
  v_mfma_f32_32x32x16_bf16 v[80:95], v[144:147], v[160:163], v[80:95]
  ds_read_b64_tr_b16 v[200:201], v62 offset:56384
  ds_read_b64_tr_b16 v[202:203], v62 offset:57664
  v_fmac_f32 v246, v249, v249
  v_lshlrev_b32 v250, 16, v145
  v_and_b32 v251, 0xffff0000, v145
  v_add_f32 v241, v241, v250
  v_fmac_f32 v245, v250, v250
  v_mfma_f32_32x32x16_bf16 v[96:111], v[144:147], v[164:167], v[96:111]
  ds_read_b64_tr_b16 v[204:205], v62 offset:56448
  ds_read_b64_tr_b16 v[206:207], v62 offset:57728
  v_add_f32 v243, v243, v251
  v_fmac_f32 v247, v251, v251
  v_lshlrev_b32 v248, 16, v146
  v_and_b32 v249, 0xffff0000, v146
  v_add_f32 v240, v240, v248
  v_mfma_f32_32x32x16_bf16 v[112:127], v[144:147], v[168:171], v[112:127]
  ds_read_b64_tr_b16 v[208:209], v62 offset:56512
  ds_read_b64_tr_b16 v[210:211], v62 offset:57792
  v_fmac_f32 v244, v248, v248
  v_add_f32 v242, v242, v249
  v_fmac_f32 v246, v249, v249
  v_lshlrev_b32 v250, 16, v147
  v_and_b32 v251, 0xffff0000, v147
  v_mfma_f32_32x32x16_bf16 v[128:143], v[144:147], v[172:175], v[128:143]
  ds_read_b64_tr_b16 v[212:213], v62 offset:56576
  ds_read_b64_tr_b16 v[214:215], v62 offset:57856
  v_add_f32 v241, v241, v250
  v_fmac_f32 v245, v250, v250
  v_add_f32 v243, v243, v251
  v_fmac_f32 v247, v251, v251
  s_cmp_lg_u32 s29, 1
  s_cbranch_scc1 g1_kernel_cs58
  v_mfma_f32_4x4x4_16b_bf16 v[216:219], v[4:5], v[156:157], v[216:219]
  v_mfma_f32_4x4x4_16b_bf16 v[220:223], v[4:5], v[160:161], v[220:223]
  v_mfma_f32_4x4x4_16b_bf16 v[224:227], v[4:5], v[164:165], v[224:227]
  v_mfma_f32_4x4x4_16b_bf16 v[228:231], v[4:5], v[168:169], v[228:231]
  v_mfma_f32_4x4x4_16b_bf16 v[232:235], v[4:5], v[172:173], v[232:235]
  v_mfma_f32_4x4x4_16b_bf16 v[216:219], v[4:5], v[158:159], v[216:219]
  v_mfma_f32_4x4x4_16b_bf16 v[220:223], v[4:5], v[162:163], v[220:223]
  v_mfma_f32_4x4x4_16b_bf16 v[224:227], v[4:5], v[166:167], v[224:227]
  v_mfma_f32_4x4x4_16b_bf16 v[228:231], v[4:5], v[170:171], v[228:231]
  v_mfma_f32_4x4x4_16b_bf16 v[232:235], v[4:5], v[174:175], v[232:235]
g1_kernel_cs58:
  s_waitcnt lgkmcnt(11)
  v_mfma_f32_32x32x16_bf16 v[64:79], v[148:151], v[176:179], v[64:79]
  ds_read_b128 v[144:147], v58 offset:49152
  ds_read_b64_tr_b16 v[156:157], v237 offset:0
  ds_read_b64_tr_b16 v[158:159], v237 offset:1280
  v_lshlrev_b32 v248, 16, v148
  v_and_b32 v249, 0xffff0000, v148
  v_add_f32 v240, v240, v248
  v_fmac_f32 v244, v248, v248
  v_add_f32 v242, v242, v249
  v_mfma_f32_32x32x16_bf16 v[80:95], v[148:151], v[180:183], v[80:95]
  ds_read_b64_tr_b16 v[160:161], v237 offset:64
  ds_read_b64_tr_b16 v[162:163], v237 offset:1344
  v_fmac_f32 v246, v249, v249
  v_lshlrev_b32 v250, 16, v149
  v_and_b32 v251, 0xffff0000, v149
  v_add_f32 v241, v241, v250
  v_fmac_f32 v245, v250, v250
  v_mfma_f32_32x32x16_bf16 v[96:111], v[148:151], v[184:187], v[96:111]
  ds_read_b64_tr_b16 v[164:165], v237 offset:128
  ds_read_b64_tr_b16 v[166:167], v237 offset:1408
  v_add_f32 v243, v243, v251
  v_fmac_f32 v247, v251, v251
  v_lshlrev_b32 v248, 16, v150
  v_and_b32 v249, 0xffff0000, v150
  v_add_f32 v240, v240, v248
  v_mfma_f32_32x32x16_bf16 v[112:127], v[148:151], v[188:191], v[112:127]
  ds_read_b64_tr_b16 v[168:169], v237 offset:192
  ds_read_b64_tr_b16 v[170:171], v237 offset:1472
  v_fmac_f32 v244, v248, v248
  v_add_f32 v242, v242, v249
  v_fmac_f32 v246, v249, v249
  v_lshlrev_b32 v250, 16, v151
  v_and_b32 v251, 0xffff0000, v151
  v_mfma_f32_32x32x16_bf16 v[128:143], v[148:151], v[192:195], v[128:143]
  ds_read_b64_tr_b16 v[172:173], v237 offset:256
  ds_read_b64_tr_b16 v[174:175], v237 offset:1536
  v_add_f32 v241, v241, v250
  v_fmac_f32 v245, v250, v250
  v_add_f32 v243, v243, v251
  v_fmac_f32 v247, v251, v251
  s_cmp_lg_u32 s29, 2
  s_cbranch_scc1 g1_kernel_cs59
  v_mfma_f32_4x4x4_16b_bf16 v[216:219], v[4:5], v[176:177], v[216:219]
  v_mfma_f32_4x4x4_16b_bf16 v[220:223], v[4:5], v[180:181], v[220:223]
  v_mfma_f32_4x4x4_16b_bf16 v[224:227], v[4:5], v[184:185], v[224:227]
  v_mfma_f32_4x4x4_16b_bf16 v[228:231], v[4:5], v[188:189], v[228:231]
  v_mfma_f32_4x4x4_16b_bf16 v[232:235], v[4:5], v[192:193], v[232:235]
  v_mfma_f32_4x4x4_16b_bf16 v[216:219], v[4:5], v[178:179], v[216:219]
  v_mfma_f32_4x4x4_16b_bf16 v[220:223], v[4:5], v[182:183], v[220:223]
  v_mfma_f32_4x4x4_16b_bf16 v[224:227], v[4:5], v[186:187], v[224:227]
  v_mfma_f32_4x4x4_16b_bf16 v[228:231], v[4:5], v[190:191], v[228:231]
  v_mfma_f32_4x4x4_16b_bf16 v[232:235], v[4:5], v[194:195], v[232:235]
g1_kernel_cs59:
  s_waitcnt lgkmcnt(11)
  v_mfma_f32_32x32x16_bf16 v[64:79], v[152:155], v[196:199], v[64:79]
  ds_read_b128 v[148:151], v59 offset:49152
  ds_read_b64_tr_b16 v[176:177], v237 offset:5120
  ds_read_b64_tr_b16 v[178:179], v237 offset:6400
  v_lshlrev_b32 v248, 16, v152
  v_and_b32 v249, 0xffff0000, v152
  v_add_f32 v240, v240, v248
  v_fmac_f32 v244, v248, v248
  v_add_f32 v242, v242, v249
  v_mfma_f32_32x32x16_bf16 v[80:95], v[152:155], v[200:203], v[80:95]
  ds_read_b64_tr_b16 v[180:181], v237 offset:5184
  ds_read_b64_tr_b16 v[182:183], v237 offset:6464
  v_fmac_f32 v246, v249, v249
  v_lshlrev_b32 v250, 16, v153
  v_and_b32 v251, 0xffff0000, v153
  v_add_f32 v241, v241, v250
  v_fmac_f32 v245, v250, v250
  v_mfma_f32_32x32x16_bf16 v[96:111], v[152:155], v[204:207], v[96:111]
  ds_read_b64_tr_b16 v[184:185], v237 offset:5248
  ds_read_b64_tr_b16 v[186:187], v237 offset:6528
  v_add_f32 v243, v243, v251
  v_fmac_f32 v247, v251, v251
  v_lshlrev_b32 v248, 16, v154
  v_and_b32 v249, 0xffff0000, v154
  v_add_f32 v240, v240, v248
  v_mfma_f32_32x32x16_bf16 v[112:127], v[152:155], v[208:211], v[112:127]
  ds_read_b64_tr_b16 v[188:189], v237 offset:5312
  ds_read_b64_tr_b16 v[190:191], v237 offset:6592
  v_fmac_f32 v244, v248, v248
  v_add_f32 v242, v242, v249
  v_fmac_f32 v246, v249, v249
  v_lshlrev_b32 v250, 16, v155
  v_and_b32 v251, 0xffff0000, v155
  v_mfma_f32_32x32x16_bf16 v[128:143], v[152:155], v[212:215], v[128:143]
  ds_read_b64_tr_b16 v[192:193], v237 offset:5376
  ds_read_b64_tr_b16 v[194:195], v237 offset:6656
  v_add_f32 v241, v241, v250
  v_fmac_f32 v245, v250, v250
  v_add_f32 v243, v243, v251
  v_fmac_f32 v247, v251, v251
  s_cmp_lg_u32 s29, 3
  s_cbranch_scc1 g1_kernel_cs60
  v_mfma_f32_4x4x4_16b_bf16 v[216:219], v[4:5], v[196:197], v[216:219]
  v_mfma_f32_4x4x4_16b_bf16 v[220:223], v[4:5], v[200:201], v[220:223]
  v_mfma_f32_4x4x4_16b_bf16 v[224:227], v[4:5], v[204:205], v[224:227]
  v_mfma_f32_4x4x4_16b_bf16 v[228:231], v[4:5], v[208:209], v[228:231]
  v_mfma_f32_4x4x4_16b_bf16 v[232:235], v[4:5], v[212:213], v[232:235]
  v_mfma_f32_4x4x4_16b_bf16 v[216:219], v[4:5], v[198:199], v[216:219]
  v_mfma_f32_4x4x4_16b_bf16 v[220:223], v[4:5], v[202:203], v[220:223]
  v_mfma_f32_4x4x4_16b_bf16 v[224:227], v[4:5], v[206:207], v[224:227]
  v_mfma_f32_4x4x4_16b_bf16 v[228:231], v[4:5], v[210:211], v[228:231]
  v_mfma_f32_4x4x4_16b_bf16 v[232:235], v[4:5], v[214:215], v[232:235]
g1_kernel_cs60:
  s_barrier
  s_waitcnt lgkmcnt(11)
  v_mfma_f32_32x32x16_bf16 v[64:79], v[144:147], v[156:159], v[64:79]
  ds_read_b128 v[152:155], v60 offset:49152
  ds_read_b64_tr_b16 v[196:197], v237 offset:10240
  ds_read_b64_tr_b16 v[198:199], v237 offset:11520
  v_lshlrev_b32 v248, 16, v144
  v_and_b32 v249, 0xffff0000, v144
  v_add_f32 v240, v240, v248
  v_fmac_f32 v244, v248, v248
  v_add_f32 v242, v242, v249
  v_mfma_f32_32x32x16_bf16 v[80:95], v[144:147], v[160:163], v[80:95]
  ds_read_b64_tr_b16 v[200:201], v237 offset:10304
  ds_read_b64_tr_b16 v[202:203], v237 offset:11584
  v_fmac_f32 v246, v249, v249
  v_lshlrev_b32 v250, 16, v145
  v_and_b32 v251, 0xffff0000, v145
  v_add_f32 v241, v241, v250
  v_fmac_f32 v245, v250, v250
  v_mfma_f32_32x32x16_bf16 v[96:111], v[144:147], v[164:167], v[96:111]
  ds_read_b64_tr_b16 v[204:205], v237 offset:10368
  ds_read_b64_tr_b16 v[206:207], v237 offset:11648
  v_add_f32 v243, v243, v251
  v_fmac_f32 v247, v251, v251
  v_lshlrev_b32 v248, 16, v146
  v_and_b32 v249, 0xffff0000, v146
  v_add_f32 v240, v240, v248
  v_mfma_f32_32x32x16_bf16 v[112:127], v[144:147], v[168:171], v[112:127]
  ds_read_b64_tr_b16 v[208:209], v237 offset:10432
  ds_read_b64_tr_b16 v[210:211], v237 offset:11712
  v_fmac_f32 v244, v248, v248
  v_add_f32 v242, v242, v249
  v_fmac_f32 v246, v249, v249
  v_lshlrev_b32 v250, 16, v147
  v_and_b32 v251, 0xffff0000, v147
  v_mfma_f32_32x32x16_bf16 v[128:143], v[144:147], v[172:175], v[128:143]
  ds_read_b64_tr_b16 v[212:213], v237 offset:10496
  ds_read_b64_tr_b16 v[214:215], v237 offset:11776
  v_add_f32 v241, v241, v250
  v_fmac_f32 v245, v250, v250
  v_add_f32 v243, v243, v251
  v_fmac_f32 v247, v251, v251
  s_cmp_lg_u32 s29, 0
  s_cbranch_scc1 g1_kernel_cs61
  v_mfma_f32_4x4x4_16b_bf16 v[216:219], v[4:5], v[156:157], v[216:219]
  v_mfma_f32_4x4x4_16b_bf16 v[220:223], v[4:5], v[160:161], v[220:223]
  v_mfma_f32_4x4x4_16b_bf16 v[224:227], v[4:5], v[164:165], v[224:227]
  v_mfma_f32_4x4x4_16b_bf16 v[228:231], v[4:5], v[168:169], v[228:231]
  v_mfma_f32_4x4x4_16b_bf16 v[232:235], v[4:5], v[172:173], v[232:235]
  v_mfma_f32_4x4x4_16b_bf16 v[216:219], v[4:5], v[158:159], v[216:219]
  v_mfma_f32_4x4x4_16b_bf16 v[220:223], v[4:5], v[162:163], v[220:223]
  v_mfma_f32_4x4x4_16b_bf16 v[224:227], v[4:5], v[166:167], v[224:227]
  v_mfma_f32_4x4x4_16b_bf16 v[228:231], v[4:5], v[170:171], v[228:231]
  v_mfma_f32_4x4x4_16b_bf16 v[232:235], v[4:5], v[174:175], v[232:235]
g1_kernel_cs61:
  s_waitcnt lgkmcnt(11)
  v_mfma_f32_32x32x16_bf16 v[64:79], v[148:151], v[176:179], v[64:79]
  ds_read_b128 v[144:147], v61 offset:49152
  ds_read_b64_tr_b16 v[156:157], v237 offset:15360
  ds_read_b64_tr_b16 v[158:159], v237 offset:16640
  v_lshlrev_b32 v248, 16, v148
  v_and_b32 v249, 0xffff0000, v148
  v_add_f32 v240, v240, v248
  v_fmac_f32 v244, v248, v248
  v_add_f32 v242, v242, v249
  v_mfma_f32_32x32x16_bf16 v[80:95], v[148:151], v[180:183], v[80:95]
  ds_read_b64_tr_b16 v[160:161], v237 offset:15424
  ds_read_b64_tr_b16 v[162:163], v237 offset:16704
  v_fmac_f32 v246, v249, v249
  v_lshlrev_b32 v250, 16, v149
  v_and_b32 v251, 0xffff0000, v149
  v_add_f32 v241, v241, v250
  v_fmac_f32 v245, v250, v250
  v_mfma_f32_32x32x16_bf16 v[96:111], v[148:151], v[184:187], v[96:111]
  ds_read_b64_tr_b16 v[164:165], v237 offset:15488
  ds_read_b64_tr_b16 v[166:167], v237 offset:16768
  v_add_f32 v243, v243, v251
  v_fmac_f32 v247, v251, v251
  v_lshlrev_b32 v248, 16, v150
  v_and_b32 v249, 0xffff0000, v150
  v_add_f32 v240, v240, v248
  v_mfma_f32_32x32x16_bf16 v[112:127], v[148:151], v[188:191], v[112:127]
  ds_read_b64_tr_b16 v[168:169], v237 offset:15552
  ds_read_b64_tr_b16 v[170:171], v237 offset:16832
  v_fmac_f32 v244, v248, v248
  v_add_f32 v242, v242, v249
  v_fmac_f32 v246, v249, v249
  v_lshlrev_b32 v250, 16, v151
  v_and_b32 v251, 0xffff0000, v151
  v_mfma_f32_32x32x16_bf16 v[128:143], v[148:151], v[192:195], v[128:143]
  ds_read_b64_tr_b16 v[172:173], v237 offset:15616
  ds_read_b64_tr_b16 v[174:175], v237 offset:16896
  v_add_f32 v241, v241, v250
  v_fmac_f32 v245, v250, v250
  v_add_f32 v243, v243, v251
  v_fmac_f32 v247, v251, v251
  s_cmp_lg_u32 s29, 1
  s_cbranch_scc1 g1_kernel_cs62
  v_mfma_f32_4x4x4_16b_bf16 v[216:219], v[4:5], v[176:177], v[216:219]
  v_mfma_f32_4x4x4_16b_bf16 v[220:223], v[4:5], v[180:181], v[220:223]
  v_mfma_f32_4x4x4_16b_bf16 v[224:227], v[4:5], v[184:185], v[224:227]
  v_mfma_f32_4x4x4_16b_bf16 v[228:231], v[4:5], v[188:189], v[228:231]
  v_mfma_f32_4x4x4_16b_bf16 v[232:235], v[4:5], v[192:193], v[232:235]
  v_mfma_f32_4x4x4_16b_bf16 v[216:219], v[4:5], v[178:179], v[216:219]
  v_mfma_f32_4x4x4_16b_bf16 v[220:223], v[4:5], v[182:183], v[220:223]
  v_mfma_f32_4x4x4_16b_bf16 v[224:227], v[4:5], v[186:187], v[224:227]
  v_mfma_f32_4x4x4_16b_bf16 v[228:231], v[4:5], v[190:191], v[228:231]
  v_mfma_f32_4x4x4_16b_bf16 v[232:235], v[4:5], v[194:195], v[232:235]
g1_kernel_cs62:
  s_waitcnt lgkmcnt(11)
  v_mfma_f32_32x32x16_bf16 v[64:79], v[152:155], v[196:199], v[64:79]
  ds_read_b128 v[148:151], v58 offset:0
  ds_read_b64_tr_b16 v[176:177], v62 offset:0
  ds_read_b64_tr_b16 v[178:179], v62 offset:1280
  v_lshlrev_b32 v248, 16, v152
  v_and_b32 v249, 0xffff0000, v152
  v_add_f32 v240, v240, v248
  v_fmac_f32 v244, v248, v248
  v_add_f32 v242, v242, v249
  v_mfma_f32_32x32x16_bf16 v[80:95], v[152:155], v[200:203], v[80:95]
  ds_read_b64_tr_b16 v[180:181], v62 offset:64
  ds_read_b64_tr_b16 v[182:183], v62 offset:1344
  v_fmac_f32 v246, v249, v249
  v_lshlrev_b32 v250, 16, v153
  v_and_b32 v251, 0xffff0000, v153
  v_add_f32 v241, v241, v250
  v_fmac_f32 v245, v250, v250
  v_mfma_f32_32x32x16_bf16 v[96:111], v[152:155], v[204:207], v[96:111]
  ds_read_b64_tr_b16 v[184:185], v62 offset:128
  ds_read_b64_tr_b16 v[186:187], v62 offset:1408
  v_add_f32 v243, v243, v251
  v_fmac_f32 v247, v251, v251
  v_lshlrev_b32 v248, 16, v154
  v_and_b32 v249, 0xffff0000, v154
  v_add_f32 v240, v240, v248
  v_mfma_f32_32x32x16_bf16 v[112:127], v[152:155], v[208:211], v[112:127]
  ds_read_b64_tr_b16 v[188:189], v62 offset:192
  ds_read_b64_tr_b16 v[190:191], v62 offset:1472
  v_fmac_f32 v244, v248, v248
  v_add_f32 v242, v242, v249
  v_fmac_f32 v246, v249, v249
  v_lshlrev_b32 v250, 16, v155
  v_and_b32 v251, 0xffff0000, v155
  v_mfma_f32_32x32x16_bf16 v[128:143], v[152:155], v[212:215], v[128:143]
  ds_read_b64_tr_b16 v[192:193], v62 offset:256
  ds_read_b64_tr_b16 v[194:195], v62 offset:1536
  v_add_f32 v241, v241, v250
  v_fmac_f32 v245, v250, v250
  v_add_f32 v243, v243, v251
  v_fmac_f32 v247, v251, v251
  s_cmp_lg_u32 s29, 2
  s_cbranch_scc1 g1_kernel_cs63
  v_mfma_f32_4x4x4_16b_bf16 v[216:219], v[4:5], v[196:197], v[216:219]
  v_mfma_f32_4x4x4_16b_bf16 v[220:223], v[4:5], v[200:201], v[220:223]
  v_mfma_f32_4x4x4_16b_bf16 v[224:227], v[4:5], v[204:205], v[224:227]
  v_mfma_f32_4x4x4_16b_bf16 v[228:231], v[4:5], v[208:209], v[228:231]
  v_mfma_f32_4x4x4_16b_bf16 v[232:235], v[4:5], v[212:213], v[232:235]
  v_mfma_f32_4x4x4_16b_bf16 v[216:219], v[4:5], v[198:199], v[216:219]
  v_mfma_f32_4x4x4_16b_bf16 v[220:223], v[4:5], v[202:203], v[220:223]
  v_mfma_f32_4x4x4_16b_bf16 v[224:227], v[4:5], v[206:207], v[224:227]
  v_mfma_f32_4x4x4_16b_bf16 v[228:231], v[4:5], v[210:211], v[228:231]
  v_mfma_f32_4x4x4_16b_bf16 v[232:235], v[4:5], v[214:215], v[232:235]
g1_kernel_cs63:
  s_waitcnt lgkmcnt(11)
  v_mfma_f32_32x32x16_bf16 v[64:79], v[144:147], v[156:159], v[64:79]
  ds_read_b128 v[152:155], v59 offset:0
  ds_read_b64_tr_b16 v[196:197], v62 offset:5120
  ds_read_b64_tr_b16 v[198:199], v62 offset:6400
  v_lshlrev_b32 v248, 16, v144
  v_and_b32 v249, 0xffff0000, v144
  v_add_f32 v240, v240, v248
  v_fmac_f32 v244, v248, v248
  v_add_f32 v242, v242, v249
  v_mfma_f32_32x32x16_bf16 v[80:95], v[144:147], v[160:163], v[80:95]
  ds_read_b64_tr_b16 v[200:201], v62 offset:5184
  ds_read_b64_tr_b16 v[202:203], v62 offset:6464
  v_fmac_f32 v246, v249, v249
  v_lshlrev_b32 v250, 16, v145
  v_and_b32 v251, 0xffff0000, v145
  v_add_f32 v241, v241, v250
  v_fmac_f32 v245, v250, v250
  v_mfma_f32_32x32x16_bf16 v[96:111], v[144:147], v[164:167], v[96:111]
  ds_read_b64_tr_b16 v[204:205], v62 offset:5248
  ds_read_b64_tr_b16 v[206:207], v62 offset:6528
  v_add_f32 v243, v243, v251
  v_fmac_f32 v247, v251, v251
  v_lshlrev_b32 v248, 16, v146
  v_and_b32 v249, 0xffff0000, v146
  v_add_f32 v240, v240, v248
  v_mfma_f32_32x32x16_bf16 v[112:127], v[144:147], v[168:171], v[112:127]
  ds_read_b64_tr_b16 v[208:209], v62 offset:5312
  ds_read_b64_tr_b16 v[210:211], v62 offset:6592
  v_fmac_f32 v244, v248, v248
  v_add_f32 v242, v242, v249
  v_fmac_f32 v246, v249, v249
  v_lshlrev_b32 v250, 16, v147
  v_and_b32 v251, 0xffff0000, v147
  v_mfma_f32_32x32x16_bf16 v[128:143], v[144:147], v[172:175], v[128:143]
  ds_read_b64_tr_b16 v[212:213], v62 offset:5376
  ds_read_b64_tr_b16 v[214:215], v62 offset:6656
  v_add_f32 v241, v241, v250
  v_fmac_f32 v245, v250, v250
  v_add_f32 v243, v243, v251
  v_fmac_f32 v247, v251, v251
  s_cmp_lg_u32 s29, 3
  s_cbranch_scc1 g1_kernel_cs64
  v_mfma_f32_4x4x4_16b_bf16 v[216:219], v[4:5], v[156:157], v[216:219]
  v_mfma_f32_4x4x4_16b_bf16 v[220:223], v[4:5], v[160:161], v[220:223]
  v_mfma_f32_4x4x4_16b_bf16 v[224:227], v[4:5], v[164:165], v[224:227]
  v_mfma_f32_4x4x4_16b_bf16 v[228:231], v[4:5], v[168:169], v[228:231]
  v_mfma_f32_4x4x4_16b_bf16 v[232:235], v[4:5], v[172:173], v[232:235]
  v_mfma_f32_4x4x4_16b_bf16 v[216:219], v[4:5], v[158:159], v[216:219]
  v_mfma_f32_4x4x4_16b_bf16 v[220:223], v[4:5], v[162:163], v[220:223]
  v_mfma_f32_4x4x4_16b_bf16 v[224:227], v[4:5], v[166:167], v[224:227]
  v_mfma_f32_4x4x4_16b_bf16 v[228:231], v[4:5], v[170:171], v[228:231]
  v_mfma_f32_4x4x4_16b_bf16 v[232:235], v[4:5], v[174:175], v[232:235]
g1_kernel_cs64:
  s_barrier
  s_waitcnt lgkmcnt(11)
  v_mfma_f32_32x32x16_bf16 v[64:79], v[148:151], v[176:179], v[64:79]
  ds_read_b128 v[144:147], v60 offset:0
  ds_read_b64_tr_b16 v[156:157], v62 offset:10240
  ds_read_b64_tr_b16 v[158:159], v62 offset:11520
  v_lshlrev_b32 v248, 16, v148
  v_and_b32 v249, 0xffff0000, v148
  v_add_f32 v240, v240, v248
  v_fmac_f32 v244, v248, v248
  v_add_f32 v242, v242, v249
  v_mfma_f32_32x32x16_bf16 v[80:95], v[148:151], v[180:183], v[80:95]
  ds_read_b64_tr_b16 v[160:161], v62 offset:10304
  ds_read_b64_tr_b16 v[162:163], v62 offset:11584
  v_fmac_f32 v246, v249, v249
  v_lshlrev_b32 v250, 16, v149
  v_and_b32 v251, 0xffff0000, v149
  v_add_f32 v241, v241, v250
  v_fmac_f32 v245, v250, v250
  v_mfma_f32_32x32x16_bf16 v[96:111], v[148:151], v[184:187], v[96:111]
  ds_read_b64_tr_b16 v[164:165], v62 offset:10368
  ds_read_b64_tr_b16 v[166:167], v62 offset:11648
  v_add_f32 v243, v243, v251
  v_fmac_f32 v247, v251, v251
  v_lshlrev_b32 v248, 16, v150
  v_and_b32 v249, 0xffff0000, v150
  v_add_f32 v240, v240, v248
  v_mfma_f32_32x32x16_bf16 v[112:127], v[148:151], v[188:191], v[112:127]
  ds_read_b64_tr_b16 v[168:169], v62 offset:10432
  ds_read_b64_tr_b16 v[170:171], v62 offset:11712
  v_fmac_f32 v244, v248, v248
  v_add_f32 v242, v242, v249
  v_fmac_f32 v246, v249, v249
  v_lshlrev_b32 v250, 16, v151
  v_and_b32 v251, 0xffff0000, v151
  v_mfma_f32_32x32x16_bf16 v[128:143], v[148:151], v[192:195], v[128:143]
  ds_read_b64_tr_b16 v[172:173], v62 offset:10496
  ds_read_b64_tr_b16 v[174:175], v62 offset:11776
  v_add_f32 v241, v241, v250
  v_fmac_f32 v245, v250, v250
  v_add_f32 v243, v243, v251
  v_fmac_f32 v247, v251, v251
  s_cmp_lg_u32 s29, 0
  s_cbranch_scc1 g1_kernel_cs65
  v_mfma_f32_4x4x4_16b_bf16 v[216:219], v[4:5], v[176:177], v[216:219]
  v_mfma_f32_4x4x4_16b_bf16 v[220:223], v[4:5], v[180:181], v[220:223]
  v_mfma_f32_4x4x4_16b_bf16 v[224:227], v[4:5], v[184:185], v[224:227]
  v_mfma_f32_4x4x4_16b_bf16 v[228:231], v[4:5], v[188:189], v[228:231]
  v_mfma_f32_4x4x4_16b_bf16 v[232:235], v[4:5], v[192:193], v[232:235]
  v_mfma_f32_4x4x4_16b_bf16 v[216:219], v[4:5], v[178:179], v[216:219]
  v_mfma_f32_4x4x4_16b_bf16 v[220:223], v[4:5], v[182:183], v[220:223]
  v_mfma_f32_4x4x4_16b_bf16 v[224:227], v[4:5], v[186:187], v[224:227]
  v_mfma_f32_4x4x4_16b_bf16 v[228:231], v[4:5], v[190:191], v[228:231]
  v_mfma_f32_4x4x4_16b_bf16 v[232:235], v[4:5], v[194:195], v[232:235]
g1_kernel_cs65:
  s_waitcnt lgkmcnt(11)
  v_mfma_f32_32x32x16_bf16 v[64:79], v[152:155], v[196:199], v[64:79]
  ds_read_b128 v[148:151], v61 offset:0
  ds_read_b64_tr_b16 v[176:177], v62 offset:15360
  ds_read_b64_tr_b16 v[178:179], v62 offset:16640
  v_lshlrev_b32 v248, 16, v152
  v_and_b32 v249, 0xffff0000, v152
  v_add_f32 v240, v240, v248
  v_fmac_f32 v244, v248, v248
  v_add_f32 v242, v242, v249
  v_mfma_f32_32x32x16_bf16 v[80:95], v[152:155], v[200:203], v[80:95]
  ds_read_b64_tr_b16 v[180:181], v62 offset:15424
  ds_read_b64_tr_b16 v[182:183], v62 offset:16704
  v_fmac_f32 v246, v249, v249
  v_lshlrev_b32 v250, 16, v153
  v_and_b32 v251, 0xffff0000, v153
  v_add_f32 v241, v241, v250
  v_fmac_f32 v245, v250, v250
  v_mfma_f32_32x32x16_bf16 v[96:111], v[152:155], v[204:207], v[96:111]
  ds_read_b64_tr_b16 v[184:185], v62 offset:15488
  ds_read_b64_tr_b16 v[186:187], v62 offset:16768
  v_add_f32 v243, v243, v251
  v_fmac_f32 v247, v251, v251
  v_lshlrev_b32 v248, 16, v154
  v_and_b32 v249, 0xffff0000, v154
  v_add_f32 v240, v240, v248
  v_mfma_f32_32x32x16_bf16 v[112:127], v[152:155], v[208:211], v[112:127]
  ds_read_b64_tr_b16 v[188:189], v62 offset:15552
  ds_read_b64_tr_b16 v[190:191], v62 offset:16832
  v_fmac_f32 v244, v248, v248
  v_add_f32 v242, v242, v249
  v_fmac_f32 v246, v249, v249
  v_lshlrev_b32 v250, 16, v155
  v_and_b32 v251, 0xffff0000, v155
  v_mfma_f32_32x32x16_bf16 v[128:143], v[152:155], v[212:215], v[128:143]
  ds_read_b64_tr_b16 v[192:193], v62 offset:15616
  ds_read_b64_tr_b16 v[194:195], v62 offset:16896
  v_add_f32 v241, v241, v250
  v_fmac_f32 v245, v250, v250
  v_add_f32 v243, v243, v251
  v_fmac_f32 v247, v251, v251
  s_cmp_lg_u32 s29, 1
  s_cbranch_scc1 g1_kernel_cs66
  v_mfma_f32_4x4x4_16b_bf16 v[216:219], v[4:5], v[196:197], v[216:219]
  v_mfma_f32_4x4x4_16b_bf16 v[220:223], v[4:5], v[200:201], v[220:223]
  v_mfma_f32_4x4x4_16b_bf16 v[224:227], v[4:5], v[204:205], v[224:227]
  v_mfma_f32_4x4x4_16b_bf16 v[228:231], v[4:5], v[208:209], v[228:231]
  v_mfma_f32_4x4x4_16b_bf16 v[232:235], v[4:5], v[212:213], v[232:235]
  v_mfma_f32_4x4x4_16b_bf16 v[216:219], v[4:5], v[198:199], v[216:219]
  v_mfma_f32_4x4x4_16b_bf16 v[220:223], v[4:5], v[202:203], v[220:223]
  v_mfma_f32_4x4x4_16b_bf16 v[224:227], v[4:5], v[206:207], v[224:227]
  v_mfma_f32_4x4x4_16b_bf16 v[228:231], v[4:5], v[210:211], v[228:231]
  v_mfma_f32_4x4x4_16b_bf16 v[232:235], v[4:5], v[214:215], v[232:235]
g1_kernel_cs66:
  s_waitcnt lgkmcnt(11)
  v_mfma_f32_32x32x16_bf16 v[64:79], v[144:147], v[156:159], v[64:79]
  ds_read_b128 v[152:155], v58 offset:16384
  ds_read_b64_tr_b16 v[196:197], v62 offset:20480
  ds_read_b64_tr_b16 v[198:199], v62 offset:21760
  v_lshlrev_b32 v248, 16, v144
  v_and_b32 v249, 0xffff0000, v144
  v_add_f32 v240, v240, v248
  v_fmac_f32 v244, v248, v248
  v_add_f32 v242, v242, v249
  v_mfma_f32_32x32x16_bf16 v[80:95], v[144:147], v[160:163], v[80:95]
  ds_read_b64_tr_b16 v[200:201], v62 offset:20544
  ds_read_b64_tr_b16 v[202:203], v62 offset:21824
  v_fmac_f32 v246, v249, v249
  v_lshlrev_b32 v250, 16, v145
  v_and_b32 v251, 0xffff0000, v145
  v_add_f32 v241, v241, v250
  v_fmac_f32 v245, v250, v250
  v_mfma_f32_32x32x16_bf16 v[96:111], v[144:147], v[164:167], v[96:111]
  ds_read_b64_tr_b16 v[204:205], v62 offset:20608
  ds_read_b64_tr_b16 v[206:207], v62 offset:21888
  v_add_f32 v243, v243, v251
  v_fmac_f32 v247, v251, v251
  v_lshlrev_b32 v248, 16, v146
  v_and_b32 v249, 0xffff0000, v146
  v_add_f32 v240, v240, v248
  v_mfma_f32_32x32x16_bf16 v[112:127], v[144:147], v[168:171], v[112:127]
  ds_read_b64_tr_b16 v[208:209], v62 offset:20672
  ds_read_b64_tr_b16 v[210:211], v62 offset:21952
  v_fmac_f32 v244, v248, v248
  v_add_f32 v242, v242, v249
  v_fmac_f32 v246, v249, v249
  v_lshlrev_b32 v250, 16, v147
  v_and_b32 v251, 0xffff0000, v147
  v_mfma_f32_32x32x16_bf16 v[128:143], v[144:147], v[172:175], v[128:143]
  ds_read_b64_tr_b16 v[212:213], v62 offset:20736
  ds_read_b64_tr_b16 v[214:215], v62 offset:22016
  v_add_f32 v241, v241, v250
  v_fmac_f32 v245, v250, v250
  v_add_f32 v243, v243, v251
  v_fmac_f32 v247, v251, v251
  s_cmp_lg_u32 s29, 2
  s_cbranch_scc1 g1_kernel_cs67
  v_mfma_f32_4x4x4_16b_bf16 v[216:219], v[4:5], v[156:157], v[216:219]
  v_mfma_f32_4x4x4_16b_bf16 v[220:223], v[4:5], v[160:161], v[220:223]
  v_mfma_f32_4x4x4_16b_bf16 v[224:227], v[4:5], v[164:165], v[224:227]
  v_mfma_f32_4x4x4_16b_bf16 v[228:231], v[4:5], v[168:169], v[228:231]
  v_mfma_f32_4x4x4_16b_bf16 v[232:235], v[4:5], v[172:173], v[232:235]
  v_mfma_f32_4x4x4_16b_bf16 v[216:219], v[4:5], v[158:159], v[216:219]
  v_mfma_f32_4x4x4_16b_bf16 v[220:223], v[4:5], v[162:163], v[220:223]
  v_mfma_f32_4x4x4_16b_bf16 v[224:227], v[4:5], v[166:167], v[224:227]
  v_mfma_f32_4x4x4_16b_bf16 v[228:231], v[4:5], v[170:171], v[228:231]
  v_mfma_f32_4x4x4_16b_bf16 v[232:235], v[4:5], v[174:175], v[232:235]
g1_kernel_cs67:
  s_waitcnt lgkmcnt(11)
  v_mfma_f32_32x32x16_bf16 v[64:79], v[148:151], v[176:179], v[64:79]
  ds_read_b128 v[144:147], v59 offset:16384
  ds_read_b64_tr_b16 v[156:157], v62 offset:25600
  ds_read_b64_tr_b16 v[158:159], v62 offset:26880
  v_lshlrev_b32 v248, 16, v148
  v_and_b32 v249, 0xffff0000, v148
  v_add_f32 v240, v240, v248
  v_fmac_f32 v244, v248, v248
  v_add_f32 v242, v242, v249
  v_mfma_f32_32x32x16_bf16 v[80:95], v[148:151], v[180:183], v[80:95]
  ds_read_b64_tr_b16 v[160:161], v62 offset:25664
  ds_read_b64_tr_b16 v[162:163], v62 offset:26944
  v_fmac_f32 v246, v249, v249
  v_lshlrev_b32 v250, 16, v149
  v_and_b32 v251, 0xffff0000, v149
  v_add_f32 v241, v241, v250
  v_fmac_f32 v245, v250, v250
  v_mfma_f32_32x32x16_bf16 v[96:111], v[148:151], v[184:187], v[96:111]
  ds_read_b64_tr_b16 v[164:165], v62 offset:25728
  ds_read_b64_tr_b16 v[166:167], v62 offset:27008
  v_add_f32 v243, v243, v251
  v_fmac_f32 v247, v251, v251
  v_lshlrev_b32 v248, 16, v150
  v_and_b32 v249, 0xffff0000, v150
  v_add_f32 v240, v240, v248
  v_mfma_f32_32x32x16_bf16 v[112:127], v[148:151], v[188:191], v[112:127]
  ds_read_b64_tr_b16 v[168:169], v62 offset:25792
  ds_read_b64_tr_b16 v[170:171], v62 offset:27072
  v_fmac_f32 v244, v248, v248
  v_add_f32 v242, v242, v249
  v_fmac_f32 v246, v249, v249
  v_lshlrev_b32 v250, 16, v151
  v_and_b32 v251, 0xffff0000, v151
  v_mfma_f32_32x32x16_bf16 v[128:143], v[148:151], v[192:195], v[128:143]
  ds_read_b64_tr_b16 v[172:173], v62 offset:25856
  ds_read_b64_tr_b16 v[174:175], v62 offset:27136
  v_add_f32 v241, v241, v250
  v_fmac_f32 v245, v250, v250
  v_add_f32 v243, v243, v251
  v_fmac_f32 v247, v251, v251
  s_cmp_lg_u32 s29, 3
  s_cbranch_scc1 g1_kernel_cs68
  v_mfma_f32_4x4x4_16b_bf16 v[216:219], v[4:5], v[176:177], v[216:219]
  v_mfma_f32_4x4x4_16b_bf16 v[220:223], v[4:5], v[180:181], v[220:223]
  v_mfma_f32_4x4x4_16b_bf16 v[224:227], v[4:5], v[184:185], v[224:227]
  v_mfma_f32_4x4x4_16b_bf16 v[228:231], v[4:5], v[188:189], v[228:231]
  v_mfma_f32_4x4x4_16b_bf16 v[232:235], v[4:5], v[192:193], v[232:235]
  v_mfma_f32_4x4x4_16b_bf16 v[216:219], v[4:5], v[178:179], v[216:219]
  v_mfma_f32_4x4x4_16b_bf16 v[220:223], v[4:5], v[182:183], v[220:223]
  v_mfma_f32_4x4x4_16b_bf16 v[224:227], v[4:5], v[186:187], v[224:227]
  v_mfma_f32_4x4x4_16b_bf16 v[228:231], v[4:5], v[190:191], v[228:231]
  v_mfma_f32_4x4x4_16b_bf16 v[232:235], v[4:5], v[194:195], v[232:235]
g1_kernel_cs68:
  s_barrier
  s_waitcnt lgkmcnt(11)
  v_mfma_f32_32x32x16_bf16 v[64:79], v[152:155], v[196:199], v[64:79]
  ds_read_b128 v[148:151], v60 offset:16384
  ds_read_b64_tr_b16 v[176:177], v62 offset:30720
  ds_read_b64_tr_b16 v[178:179], v62 offset:32000
  v_lshlrev_b32 v248, 16, v152
  v_and_b32 v249, 0xffff0000, v152
  v_add_f32 v240, v240, v248
  v_fmac_f32 v244, v248, v248
  v_add_f32 v242, v242, v249
  v_mfma_f32_32x32x16_bf16 v[80:95], v[152:155], v[200:203], v[80:95]
  ds_read_b64_tr_b16 v[180:181], v62 offset:30784
  ds_read_b64_tr_b16 v[182:183], v62 offset:32064
  v_fmac_f32 v246, v249, v249
  v_lshlrev_b32 v250, 16, v153
  v_and_b32 v251, 0xffff0000, v153
  v_add_f32 v241, v241, v250
  v_fmac_f32 v245, v250, v250
  v_mfma_f32_32x32x16_bf16 v[96:111], v[152:155], v[204:207], v[96:111]
  ds_read_b64_tr_b16 v[184:185], v62 offset:30848
  ds_read_b64_tr_b16 v[186:187], v62 offset:32128
  v_add_f32 v243, v243, v251
  v_fmac_f32 v247, v251, v251
  v_lshlrev_b32 v248, 16, v154
  v_and_b32 v249, 0xffff0000, v154
  v_add_f32 v240, v240, v248
  v_mfma_f32_32x32x16_bf16 v[112:127], v[152:155], v[208:211], v[112:127]
  ds_read_b64_tr_b16 v[188:189], v62 offset:30912
  ds_read_b64_tr_b16 v[190:191], v62 offset:32192
  v_fmac_f32 v244, v248, v248
  v_add_f32 v242, v242, v249
  v_fmac_f32 v246, v249, v249
  v_lshlrev_b32 v250, 16, v155
  v_and_b32 v251, 0xffff0000, v155
  v_mfma_f32_32x32x16_bf16 v[128:143], v[152:155], v[212:215], v[128:143]
  ds_read_b64_tr_b16 v[192:193], v62 offset:30976
  ds_read_b64_tr_b16 v[194:195], v62 offset:32256
  v_add_f32 v241, v241, v250
  v_fmac_f32 v245, v250, v250
  v_add_f32 v243, v243, v251
  v_fmac_f32 v247, v251, v251
  s_cmp_lg_u32 s29, 0
  s_cbranch_scc1 g1_kernel_cs69
  v_mfma_f32_4x4x4_16b_bf16 v[216:219], v[4:5], v[196:197], v[216:219]
  v_mfma_f32_4x4x4_16b_bf16 v[220:223], v[4:5], v[200:201], v[220:223]
  v_mfma_f32_4x4x4_16b_bf16 v[224:227], v[4:5], v[204:205], v[224:227]
  v_mfma_f32_4x4x4_16b_bf16 v[228:231], v[4:5], v[208:209], v[228:231]
  v_mfma_f32_4x4x4_16b_bf16 v[232:235], v[4:5], v[212:213], v[232:235]
  v_mfma_f32_4x4x4_16b_bf16 v[216:219], v[4:5], v[198:199], v[216:219]
  v_mfma_f32_4x4x4_16b_bf16 v[220:223], v[4:5], v[202:203], v[220:223]
  v_mfma_f32_4x4x4_16b_bf16 v[224:227], v[4:5], v[206:207], v[224:227]
  v_mfma_f32_4x4x4_16b_bf16 v[228:231], v[4:5], v[210:211], v[228:231]
  v_mfma_f32_4x4x4_16b_bf16 v[232:235], v[4:5], v[214:215], v[232:235]
g1_kernel_cs69:
  s_waitcnt lgkmcnt(11)
  v_mfma_f32_32x32x16_bf16 v[64:79], v[144:147], v[156:159], v[64:79]
  ds_read_b128 v[152:155], v61 offset:16384
  ds_read_b64_tr_b16 v[196:197], v62 offset:35840
  ds_read_b64_tr_b16 v[198:199], v62 offset:37120
  v_lshlrev_b32 v248, 16, v144
  v_and_b32 v249, 0xffff0000, v144
  v_add_f32 v240, v240, v248
  v_fmac_f32 v244, v248, v248
  v_add_f32 v242, v242, v249
  v_mfma_f32_32x32x16_bf16 v[80:95], v[144:147], v[160:163], v[80:95]
  ds_read_b64_tr_b16 v[200:201], v62 offset:35904
  ds_read_b64_tr_b16 v[202:203], v62 offset:37184
  v_fmac_f32 v246, v249, v249
  v_lshlrev_b32 v250, 16, v145
  v_and_b32 v251, 0xffff0000, v145
  v_add_f32 v241, v241, v250
  v_fmac_f32 v245, v250, v250
  v_mfma_f32_32x32x16_bf16 v[96:111], v[144:147], v[164:167], v[96:111]
  ds_read_b64_tr_b16 v[204:205], v62 offset:35968
  ds_read_b64_tr_b16 v[206:207], v62 offset:37248
  v_add_f32 v243, v243, v251
  v_fmac_f32 v247, v251, v251
  v_lshlrev_b32 v248, 16, v146
  v_and_b32 v249, 0xffff0000, v146
  v_add_f32 v240, v240, v248
  v_mfma_f32_32x32x16_bf16 v[112:127], v[144:147], v[168:171], v[112:127]
  ds_read_b64_tr_b16 v[208:209], v62 offset:36032
  ds_read_b64_tr_b16 v[210:211], v62 offset:37312
  v_fmac_f32 v244, v248, v248
  v_add_f32 v242, v242, v249
  v_fmac_f32 v246, v249, v249
  v_lshlrev_b32 v250, 16, v147
  v_and_b32 v251, 0xffff0000, v147
  v_mfma_f32_32x32x16_bf16 v[128:143], v[144:147], v[172:175], v[128:143]
  ds_read_b64_tr_b16 v[212:213], v62 offset:36096
  ds_read_b64_tr_b16 v[214:215], v62 offset:37376
  v_add_f32 v241, v241, v250
  v_fmac_f32 v245, v250, v250
  v_add_f32 v243, v243, v251
  v_fmac_f32 v247, v251, v251
  s_cmp_lg_u32 s29, 1
  s_cbranch_scc1 g1_kernel_cs70
  v_mfma_f32_4x4x4_16b_bf16 v[216:219], v[4:5], v[156:157], v[216:219]
  v_mfma_f32_4x4x4_16b_bf16 v[220:223], v[4:5], v[160:161], v[220:223]
  v_mfma_f32_4x4x4_16b_bf16 v[224:227], v[4:5], v[164:165], v[224:227]
  v_mfma_f32_4x4x4_16b_bf16 v[228:231], v[4:5], v[168:169], v[228:231]
  v_mfma_f32_4x4x4_16b_bf16 v[232:235], v[4:5], v[172:173], v[232:235]
  v_mfma_f32_4x4x4_16b_bf16 v[216:219], v[4:5], v[158:159], v[216:219]
  v_mfma_f32_4x4x4_16b_bf16 v[220:223], v[4:5], v[162:163], v[220:223]
  v_mfma_f32_4x4x4_16b_bf16 v[224:227], v[4:5], v[166:167], v[224:227]
  v_mfma_f32_4x4x4_16b_bf16 v[228:231], v[4:5], v[170:171], v[228:231]
  v_mfma_f32_4x4x4_16b_bf16 v[232:235], v[4:5], v[174:175], v[232:235]
g1_kernel_cs70:
  s_waitcnt lgkmcnt(11)
  v_mfma_f32_32x32x16_bf16 v[64:79], v[148:151], v[176:179], v[64:79]
  ds_read_b128 v[144:147], v58 offset:32768
  ds_read_b64_tr_b16 v[156:157], v62 offset:40960
  ds_read_b64_tr_b16 v[158:159], v62 offset:42240
  v_lshlrev_b32 v248, 16, v148
  v_and_b32 v249, 0xffff0000, v148
  v_add_f32 v240, v240, v248
  v_fmac_f32 v244, v248, v248
  v_add_f32 v242, v242, v249
  v_mfma_f32_32x32x16_bf16 v[80:95], v[148:151], v[180:183], v[80:95]
  ds_read_b64_tr_b16 v[160:161], v62 offset:41024
  ds_read_b64_tr_b16 v[162:163], v62 offset:42304
  v_fmac_f32 v246, v249, v249
  v_lshlrev_b32 v250, 16, v149
  v_and_b32 v251, 0xffff0000, v149
  v_add_f32 v241, v241, v250
  v_fmac_f32 v245, v250, v250
  v_mfma_f32_32x32x16_bf16 v[96:111], v[148:151], v[184:187], v[96:111]
  ds_read_b64_tr_b16 v[164:165], v62 offset:41088
  ds_read_b64_tr_b16 v[166:167], v62 offset:42368
  v_add_f32 v243, v243, v251
  v_fmac_f32 v247, v251, v251
  v_lshlrev_b32 v248, 16, v150
  v_and_b32 v249, 0xffff0000, v150
  v_add_f32 v240, v240, v248
  v_mfma_f32_32x32x16_bf16 v[112:127], v[148:151], v[188:191], v[112:127]
  ds_read_b64_tr_b16 v[168:169], v62 offset:41152
  ds_read_b64_tr_b16 v[170:171], v62 offset:42432
  v_fmac_f32 v244, v248, v248
  v_add_f32 v242, v242, v249
  v_fmac_f32 v246, v249, v249
  v_lshlrev_b32 v250, 16, v151
  v_and_b32 v251, 0xffff0000, v151
  v_mfma_f32_32x32x16_bf16 v[128:143], v[148:151], v[192:195], v[128:143]
  ds_read_b64_tr_b16 v[172:173], v62 offset:41216
  ds_read_b64_tr_b16 v[174:175], v62 offset:42496
  v_add_f32 v241, v241, v250
  v_fmac_f32 v245, v250, v250
  v_add_f32 v243, v243, v251
  v_fmac_f32 v247, v251, v251
  s_cmp_lg_u32 s29, 2
  s_cbranch_scc1 g1_kernel_cs71
  v_mfma_f32_4x4x4_16b_bf16 v[216:219], v[4:5], v[176:177], v[216:219]
  v_mfma_f32_4x4x4_16b_bf16 v[220:223], v[4:5], v[180:181], v[220:223]
  v_mfma_f32_4x4x4_16b_bf16 v[224:227], v[4:5], v[184:185], v[224:227]
  v_mfma_f32_4x4x4_16b_bf16 v[228:231], v[4:5], v[188:189], v[228:231]
  v_mfma_f32_4x4x4_16b_bf16 v[232:235], v[4:5], v[192:193], v[232:235]
  v_mfma_f32_4x4x4_16b_bf16 v[216:219], v[4:5], v[178:179], v[216:219]
  v_mfma_f32_4x4x4_16b_bf16 v[220:223], v[4:5], v[182:183], v[220:223]
  v_mfma_f32_4x4x4_16b_bf16 v[224:227], v[4:5], v[186:187], v[224:227]
  v_mfma_f32_4x4x4_16b_bf16 v[228:231], v[4:5], v[190:191], v[228:231]
  v_mfma_f32_4x4x4_16b_bf16 v[232:235], v[4:5], v[194:195], v[232:235]
g1_kernel_cs71:
  s_waitcnt lgkmcnt(11)
  v_mfma_f32_32x32x16_bf16 v[64:79], v[152:155], v[196:199], v[64:79]
  ds_read_b128 v[148:151], v59 offset:32768
  ds_read_b64_tr_b16 v[176:177], v62 offset:46080
  ds_read_b64_tr_b16 v[178:179], v62 offset:47360
  v_lshlrev_b32 v248, 16, v152
  v_and_b32 v249, 0xffff0000, v152
  v_add_f32 v240, v240, v248
  v_fmac_f32 v244, v248, v248
  v_add_f32 v242, v242, v249
  v_mfma_f32_32x32x16_bf16 v[80:95], v[152:155], v[200:203], v[80:95]
  ds_read_b64_tr_b16 v[180:181], v62 offset:46144
  ds_read_b64_tr_b16 v[182:183], v62 offset:47424
  v_fmac_f32 v246, v249, v249
  v_lshlrev_b32 v250, 16, v153
  v_and_b32 v251, 0xffff0000, v153
  v_add_f32 v241, v241, v250
  v_fmac_f32 v245, v250, v250
  v_mfma_f32_32x32x16_bf16 v[96:111], v[152:155], v[204:207], v[96:111]
  ds_read_b64_tr_b16 v[184:185], v62 offset:46208
  ds_read_b64_tr_b16 v[186:187], v62 offset:47488
  v_add_f32 v243, v243, v251
  v_fmac_f32 v247, v251, v251
  v_lshlrev_b32 v248, 16, v154
  v_and_b32 v249, 0xffff0000, v154
  v_add_f32 v240, v240, v248
  v_mfma_f32_32x32x16_bf16 v[112:127], v[152:155], v[208:211], v[112:127]
  ds_read_b64_tr_b16 v[188:189], v62 offset:46272
  ds_read_b64_tr_b16 v[190:191], v62 offset:47552
  v_fmac_f32 v244, v248, v248
  v_add_f32 v242, v242, v249
  v_fmac_f32 v246, v249, v249
  v_lshlrev_b32 v250, 16, v155
  v_and_b32 v251, 0xffff0000, v155
  v_mfma_f32_32x32x16_bf16 v[128:143], v[152:155], v[212:215], v[128:143]
  ds_read_b64_tr_b16 v[192:193], v62 offset:46336
  ds_read_b64_tr_b16 v[194:195], v62 offset:47616
  v_add_f32 v241, v241, v250
  v_fmac_f32 v245, v250, v250
  v_add_f32 v243, v243, v251
  v_fmac_f32 v247, v251, v251
  s_cmp_lg_u32 s29, 3
  s_cbranch_scc1 g1_kernel_cs72
  v_mfma_f32_4x4x4_16b_bf16 v[216:219], v[4:5], v[196:197], v[216:219]
  v_mfma_f32_4x4x4_16b_bf16 v[220:223], v[4:5], v[200:201], v[220:223]
  v_mfma_f32_4x4x4_16b_bf16 v[224:227], v[4:5], v[204:205], v[224:227]
  v_mfma_f32_4x4x4_16b_bf16 v[228:231], v[4:5], v[208:209], v[228:231]
  v_mfma_f32_4x4x4_16b_bf16 v[232:235], v[4:5], v[212:213], v[232:235]
  v_mfma_f32_4x4x4_16b_bf16 v[216:219], v[4:5], v[198:199], v[216:219]
  v_mfma_f32_4x4x4_16b_bf16 v[220:223], v[4:5], v[202:203], v[220:223]
  v_mfma_f32_4x4x4_16b_bf16 v[224:227], v[4:5], v[206:207], v[224:227]
  v_mfma_f32_4x4x4_16b_bf16 v[228:231], v[4:5], v[210:211], v[228:231]
  v_mfma_f32_4x4x4_16b_bf16 v[232:235], v[4:5], v[214:215], v[232:235]
g1_kernel_cs72:
  s_barrier
  s_waitcnt lgkmcnt(11)
  v_mfma_f32_32x32x16_bf16 v[64:79], v[144:147], v[156:159], v[64:79]
  ds_read_b128 v[152:155], v60 offset:32768
  ds_read_b64_tr_b16 v[196:197], v62 offset:51200
  ds_read_b64_tr_b16 v[198:199], v62 offset:52480
  v_lshlrev_b32 v248, 16, v144
  v_and_b32 v249, 0xffff0000, v144
  v_add_f32 v240, v240, v248
  v_fmac_f32 v244, v248, v248
  v_add_f32 v242, v242, v249
  v_mfma_f32_32x32x16_bf16 v[80:95], v[144:147], v[160:163], v[80:95]
  ds_read_b64_tr_b16 v[200:201], v62 offset:51264
  ds_read_b64_tr_b16 v[202:203], v62 offset:52544
  v_fmac_f32 v246, v249, v249
  v_lshlrev_b32 v250, 16, v145
  v_and_b32 v251, 0xffff0000, v145
  v_add_f32 v241, v241, v250
  v_fmac_f32 v245, v250, v250
  v_mfma_f32_32x32x16_bf16 v[96:111], v[144:147], v[164:167], v[96:111]
  ds_read_b64_tr_b16 v[204:205], v62 offset:51328
  ds_read_b64_tr_b16 v[206:207], v62 offset:52608
  v_add_f32 v243, v243, v251
  v_fmac_f32 v247, v251, v251
  v_lshlrev_b32 v248, 16, v146
  v_and_b32 v249, 0xffff0000, v146
  v_add_f32 v240, v240, v248
  v_mfma_f32_32x32x16_bf16 v[112:127], v[144:147], v[168:171], v[112:127]
  ds_read_b64_tr_b16 v[208:209], v62 offset:51392
  ds_read_b64_tr_b16 v[210:211], v62 offset:52672
  v_fmac_f32 v244, v248, v248
  v_add_f32 v242, v242, v249
  v_fmac_f32 v246, v249, v249
  v_lshlrev_b32 v250, 16, v147
  v_and_b32 v251, 0xffff0000, v147
  v_mfma_f32_32x32x16_bf16 v[128:143], v[144:147], v[172:175], v[128:143]
  ds_read_b64_tr_b16 v[212:213], v62 offset:51456
  ds_read_b64_tr_b16 v[214:215], v62 offset:52736
  v_add_f32 v241, v241, v250
  v_fmac_f32 v245, v250, v250
  v_add_f32 v243, v243, v251
  v_fmac_f32 v247, v251, v251
  s_cmp_lg_u32 s29, 0
  s_cbranch_scc1 g1_kernel_cs73
  v_mfma_f32_4x4x4_16b_bf16 v[216:219], v[4:5], v[156:157], v[216:219]
  v_mfma_f32_4x4x4_16b_bf16 v[220:223], v[4:5], v[160:161], v[220:223]
  v_mfma_f32_4x4x4_16b_bf16 v[224:227], v[4:5], v[164:165], v[224:227]
  v_mfma_f32_4x4x4_16b_bf16 v[228:231], v[4:5], v[168:169], v[228:231]
  v_mfma_f32_4x4x4_16b_bf16 v[232:235], v[4:5], v[172:173], v[232:235]
  v_mfma_f32_4x4x4_16b_bf16 v[216:219], v[4:5], v[158:159], v[216:219]
  v_mfma_f32_4x4x4_16b_bf16 v[220:223], v[4:5], v[162:163], v[220:223]
  v_mfma_f32_4x4x4_16b_bf16 v[224:227], v[4:5], v[166:167], v[224:227]
  v_mfma_f32_4x4x4_16b_bf16 v[228:231], v[4:5], v[170:171], v[228:231]
  v_mfma_f32_4x4x4_16b_bf16 v[232:235], v[4:5], v[174:175], v[232:235]
g1_kernel_cs73:
  s_waitcnt lgkmcnt(11)
  v_mfma_f32_32x32x16_bf16 v[64:79], v[148:151], v[176:179], v[64:79]
  ds_read_b128 v[144:147], v61 offset:32768
  ds_read_b64_tr_b16 v[156:157], v62 offset:56320
  ds_read_b64_tr_b16 v[158:159], v62 offset:57600
  v_lshlrev_b32 v248, 16, v148
  v_and_b32 v249, 0xffff0000, v148
  v_add_f32 v240, v240, v248
  v_fmac_f32 v244, v248, v248
  v_add_f32 v242, v242, v249
  v_mfma_f32_32x32x16_bf16 v[80:95], v[148:151], v[180:183], v[80:95]
  ds_read_b64_tr_b16 v[160:161], v62 offset:56384
  ds_read_b64_tr_b16 v[162:163], v62 offset:57664
  v_fmac_f32 v246, v249, v249
  v_lshlrev_b32 v250, 16, v149
  v_and_b32 v251, 0xffff0000, v149
  v_add_f32 v241, v241, v250
  v_fmac_f32 v245, v250, v250
  v_mfma_f32_32x32x16_bf16 v[96:111], v[148:151], v[184:187], v[96:111]
  ds_read_b64_tr_b16 v[164:165], v62 offset:56448
  ds_read_b64_tr_b16 v[166:167], v62 offset:57728
  v_add_f32 v243, v243, v251
  v_fmac_f32 v247, v251, v251
  v_lshlrev_b32 v248, 16, v150
  v_and_b32 v249, 0xffff0000, v150
  v_add_f32 v240, v240, v248
  v_mfma_f32_32x32x16_bf16 v[112:127], v[148:151], v[188:191], v[112:127]
  ds_read_b64_tr_b16 v[168:169], v62 offset:56512
  ds_read_b64_tr_b16 v[170:171], v62 offset:57792
  v_fmac_f32 v244, v248, v248
  v_add_f32 v242, v242, v249
  v_fmac_f32 v246, v249, v249
  v_lshlrev_b32 v250, 16, v151
  v_and_b32 v251, 0xffff0000, v151
  v_mfma_f32_32x32x16_bf16 v[128:143], v[148:151], v[192:195], v[128:143]
  ds_read_b64_tr_b16 v[172:173], v62 offset:56576
  ds_read_b64_tr_b16 v[174:175], v62 offset:57856
  v_add_f32 v241, v241, v250
  v_fmac_f32 v245, v250, v250
  v_add_f32 v243, v243, v251
  v_fmac_f32 v247, v251, v251
  s_cmp_lg_u32 s29, 1
  s_cbranch_scc1 g1_kernel_cs74
  v_mfma_f32_4x4x4_16b_bf16 v[216:219], v[4:5], v[176:177], v[216:219]
  v_mfma_f32_4x4x4_16b_bf16 v[220:223], v[4:5], v[180:181], v[220:223]
  v_mfma_f32_4x4x4_16b_bf16 v[224:227], v[4:5], v[184:185], v[224:227]
  v_mfma_f32_4x4x4_16b_bf16 v[228:231], v[4:5], v[188:189], v[228:231]
  v_mfma_f32_4x4x4_16b_bf16 v[232:235], v[4:5], v[192:193], v[232:235]
  v_mfma_f32_4x4x4_16b_bf16 v[216:219], v[4:5], v[178:179], v[216:219]
  v_mfma_f32_4x4x4_16b_bf16 v[220:223], v[4:5], v[182:183], v[220:223]
  v_mfma_f32_4x4x4_16b_bf16 v[224:227], v[4:5], v[186:187], v[224:227]
  v_mfma_f32_4x4x4_16b_bf16 v[228:231], v[4:5], v[190:191], v[228:231]
  v_mfma_f32_4x4x4_16b_bf16 v[232:235], v[4:5], v[194:195], v[232:235]
g1_kernel_cs74:
  s_waitcnt lgkmcnt(11)
  v_mfma_f32_32x32x16_bf16 v[64:79], v[152:155], v[196:199], v[64:79]
  ds_read_b128 v[148:151], v58 offset:49152
  ds_read_b64_tr_b16 v[176:177], v237 offset:0
  ds_read_b64_tr_b16 v[178:179], v237 offset:1280
  v_lshlrev_b32 v248, 16, v152
  v_and_b32 v249, 0xffff0000, v152
  v_add_f32 v240, v240, v248
  v_fmac_f32 v244, v248, v248
  v_add_f32 v242, v242, v249
  v_mfma_f32_32x32x16_bf16 v[80:95], v[152:155], v[200:203], v[80:95]
  ds_read_b64_tr_b16 v[180:181], v237 offset:64
  ds_read_b64_tr_b16 v[182:183], v237 offset:1344
  v_fmac_f32 v246, v249, v249
  v_lshlrev_b32 v250, 16, v153
  v_and_b32 v251, 0xffff0000, v153
  v_add_f32 v241, v241, v250
  v_fmac_f32 v245, v250, v250
  v_mfma_f32_32x32x16_bf16 v[96:111], v[152:155], v[204:207], v[96:111]
  ds_read_b64_tr_b16 v[184:185], v237 offset:128
  ds_read_b64_tr_b16 v[186:187], v237 offset:1408
  v_add_f32 v243, v243, v251
  v_fmac_f32 v247, v251, v251
  v_lshlrev_b32 v248, 16, v154
  v_and_b32 v249, 0xffff0000, v154
  v_add_f32 v240, v240, v248
  v_mfma_f32_32x32x16_bf16 v[112:127], v[152:155], v[208:211], v[112:127]
  ds_read_b64_tr_b16 v[188:189], v237 offset:192
  ds_read_b64_tr_b16 v[190:191], v237 offset:1472
  v_fmac_f32 v244, v248, v248
  v_add_f32 v242, v242, v249
  v_fmac_f32 v246, v249, v249
  v_lshlrev_b32 v250, 16, v155
  v_and_b32 v251, 0xffff0000, v155
  v_mfma_f32_32x32x16_bf16 v[128:143], v[152:155], v[212:215], v[128:143]
  ds_read_b64_tr_b16 v[192:193], v237 offset:256
  ds_read_b64_tr_b16 v[194:195], v237 offset:1536
  v_add_f32 v241, v241, v250
  v_fmac_f32 v245, v250, v250
  v_add_f32 v243, v243, v251
  v_fmac_f32 v247, v251, v251
  s_cmp_lg_u32 s29, 2
  s_cbranch_scc1 g1_kernel_cs75
  v_mfma_f32_4x4x4_16b_bf16 v[216:219], v[4:5], v[196:197], v[216:219]
  v_mfma_f32_4x4x4_16b_bf16 v[220:223], v[4:5], v[200:201], v[220:223]
  v_mfma_f32_4x4x4_16b_bf16 v[224:227], v[4:5], v[204:205], v[224:227]
  v_mfma_f32_4x4x4_16b_bf16 v[228:231], v[4:5], v[208:209], v[228:231]
  v_mfma_f32_4x4x4_16b_bf16 v[232:235], v[4:5], v[212:213], v[232:235]
  v_mfma_f32_4x4x4_16b_bf16 v[216:219], v[4:5], v[198:199], v[216:219]
  v_mfma_f32_4x4x4_16b_bf16 v[220:223], v[4:5], v[202:203], v[220:223]
  v_mfma_f32_4x4x4_16b_bf16 v[224:227], v[4:5], v[206:207], v[224:227]
  v_mfma_f32_4x4x4_16b_bf16 v[228:231], v[4:5], v[210:211], v[228:231]
  v_mfma_f32_4x4x4_16b_bf16 v[232:235], v[4:5], v[214:215], v[232:235]
g1_kernel_cs75:
  s_waitcnt lgkmcnt(11)
  v_mfma_f32_32x32x16_bf16 v[64:79], v[144:147], v[156:159], v[64:79]
  ds_read_b128 v[152:155], v59 offset:49152
  ds_read_b64_tr_b16 v[196:197], v237 offset:5120
  ds_read_b64_tr_b16 v[198:199], v237 offset:6400
  v_lshlrev_b32 v248, 16, v144
  v_and_b32 v249, 0xffff0000, v144
  v_add_f32 v240, v240, v248
  v_fmac_f32 v244, v248, v248
  v_add_f32 v242, v242, v249
  v_mfma_f32_32x32x16_bf16 v[80:95], v[144:147], v[160:163], v[80:95]
  ds_read_b64_tr_b16 v[200:201], v237 offset:5184
  ds_read_b64_tr_b16 v[202:203], v237 offset:6464
  v_fmac_f32 v246, v249, v249
  v_lshlrev_b32 v250, 16, v145
  v_and_b32 v251, 0xffff0000, v145
  v_add_f32 v241, v241, v250
  v_fmac_f32 v245, v250, v250
  v_mfma_f32_32x32x16_bf16 v[96:111], v[144:147], v[164:167], v[96:111]
  ds_read_b64_tr_b16 v[204:205], v237 offset:5248
  ds_read_b64_tr_b16 v[206:207], v237 offset:6528
  v_add_f32 v243, v243, v251
  v_fmac_f32 v247, v251, v251
  v_lshlrev_b32 v248, 16, v146
  v_and_b32 v249, 0xffff0000, v146
  v_add_f32 v240, v240, v248
  v_mfma_f32_32x32x16_bf16 v[112:127], v[144:147], v[168:171], v[112:127]
  ds_read_b64_tr_b16 v[208:209], v237 offset:5312
  ds_read_b64_tr_b16 v[210:211], v237 offset:6592
  v_fmac_f32 v244, v248, v248
  v_add_f32 v242, v242, v249
  v_fmac_f32 v246, v249, v249
  v_lshlrev_b32 v250, 16, v147
  v_and_b32 v251, 0xffff0000, v147
  v_mfma_f32_32x32x16_bf16 v[128:143], v[144:147], v[172:175], v[128:143]
  ds_read_b64_tr_b16 v[212:213], v237 offset:5376
  ds_read_b64_tr_b16 v[214:215], v237 offset:6656
  v_add_f32 v241, v241, v250
  v_fmac_f32 v245, v250, v250
  v_add_f32 v243, v243, v251
  v_fmac_f32 v247, v251, v251
  s_cmp_lg_u32 s29, 3
  s_cbranch_scc1 g1_kernel_cs76
  v_mfma_f32_4x4x4_16b_bf16 v[216:219], v[4:5], v[156:157], v[216:219]
  v_mfma_f32_4x4x4_16b_bf16 v[220:223], v[4:5], v[160:161], v[220:223]
  v_mfma_f32_4x4x4_16b_bf16 v[224:227], v[4:5], v[164:165], v[224:227]
  v_mfma_f32_4x4x4_16b_bf16 v[228:231], v[4:5], v[168:169], v[228:231]
  v_mfma_f32_4x4x4_16b_bf16 v[232:235], v[4:5], v[172:173], v[232:235]
  v_mfma_f32_4x4x4_16b_bf16 v[216:219], v[4:5], v[158:159], v[216:219]
  v_mfma_f32_4x4x4_16b_bf16 v[220:223], v[4:5], v[162:163], v[220:223]
  v_mfma_f32_4x4x4_16b_bf16 v[224:227], v[4:5], v[166:167], v[224:227]
  v_mfma_f32_4x4x4_16b_bf16 v[228:231], v[4:5], v[170:171], v[228:231]
  v_mfma_f32_4x4x4_16b_bf16 v[232:235], v[4:5], v[174:175], v[232:235]
g1_kernel_cs76:
  s_barrier
  s_waitcnt lgkmcnt(11)
  v_mfma_f32_32x32x16_bf16 v[64:79], v[148:151], v[176:179], v[64:79]
  ds_read_b128 v[144:147], v60 offset:49152
  ds_read_b64_tr_b16 v[156:157], v237 offset:10240
  ds_read_b64_tr_b16 v[158:159], v237 offset:11520
  v_lshlrev_b32 v248, 16, v148
  v_and_b32 v249, 0xffff0000, v148
  v_add_f32 v240, v240, v248
  v_fmac_f32 v244, v248, v248
  v_add_f32 v242, v242, v249
  v_mfma_f32_32x32x16_bf16 v[80:95], v[148:151], v[180:183], v[80:95]
  ds_read_b64_tr_b16 v[160:161], v237 offset:10304
  ds_read_b64_tr_b16 v[162:163], v237 offset:11584
  v_fmac_f32 v246, v249, v249
  v_lshlrev_b32 v250, 16, v149
  v_and_b32 v251, 0xffff0000, v149
  v_add_f32 v241, v241, v250
  v_fmac_f32 v245, v250, v250
  v_mfma_f32_32x32x16_bf16 v[96:111], v[148:151], v[184:187], v[96:111]
  ds_read_b64_tr_b16 v[164:165], v237 offset:10368
  ds_read_b64_tr_b16 v[166:167], v237 offset:11648
  v_add_f32 v243, v243, v251
  v_fmac_f32 v247, v251, v251
  v_lshlrev_b32 v248, 16, v150
  v_and_b32 v249, 0xffff0000, v150
  v_add_f32 v240, v240, v248
  v_mfma_f32_32x32x16_bf16 v[112:127], v[148:151], v[188:191], v[112:127]
  ds_read_b64_tr_b16 v[168:169], v237 offset:10432
  ds_read_b64_tr_b16 v[170:171], v237 offset:11712
  v_fmac_f32 v244, v248, v248
  v_add_f32 v242, v242, v249
  v_fmac_f32 v246, v249, v249
  v_lshlrev_b32 v250, 16, v151
  v_and_b32 v251, 0xffff0000, v151
  v_mfma_f32_32x32x16_bf16 v[128:143], v[148:151], v[192:195], v[128:143]
  ds_read_b64_tr_b16 v[172:173], v237 offset:10496
  ds_read_b64_tr_b16 v[174:175], v237 offset:11776
  v_add_f32 v241, v241, v250
  v_fmac_f32 v245, v250, v250
  v_add_f32 v243, v243, v251
  v_fmac_f32 v247, v251, v251
  s_cmp_lg_u32 s29, 0
  s_cbranch_scc1 g1_kernel_cs77
  v_mfma_f32_4x4x4_16b_bf16 v[216:219], v[4:5], v[176:177], v[216:219]
  v_mfma_f32_4x4x4_16b_bf16 v[220:223], v[4:5], v[180:181], v[220:223]
  v_mfma_f32_4x4x4_16b_bf16 v[224:227], v[4:5], v[184:185], v[224:227]
  v_mfma_f32_4x4x4_16b_bf16 v[228:231], v[4:5], v[188:189], v[228:231]
  v_mfma_f32_4x4x4_16b_bf16 v[232:235], v[4:5], v[192:193], v[232:235]
  v_mfma_f32_4x4x4_16b_bf16 v[216:219], v[4:5], v[178:179], v[216:219]
  v_mfma_f32_4x4x4_16b_bf16 v[220:223], v[4:5], v[182:183], v[220:223]
  v_mfma_f32_4x4x4_16b_bf16 v[224:227], v[4:5], v[186:187], v[224:227]
  v_mfma_f32_4x4x4_16b_bf16 v[228:231], v[4:5], v[190:191], v[228:231]
  v_mfma_f32_4x4x4_16b_bf16 v[232:235], v[4:5], v[194:195], v[232:235]
g1_kernel_cs77:
  s_waitcnt lgkmcnt(11)
  v_mfma_f32_32x32x16_bf16 v[64:79], v[152:155], v[196:199], v[64:79]
  ds_read_b128 v[148:151], v61 offset:49152
  ds_read_b64_tr_b16 v[176:177], v237 offset:15360
  ds_read_b64_tr_b16 v[178:179], v237 offset:16640
  v_lshlrev_b32 v248, 16, v152
  v_and_b32 v249, 0xffff0000, v152
  v_add_f32 v240, v240, v248
  v_fmac_f32 v244, v248, v248
  v_add_f32 v242, v242, v249
  v_mfma_f32_32x32x16_bf16 v[80:95], v[152:155], v[200:203], v[80:95]
  ds_read_b64_tr_b16 v[180:181], v237 offset:15424
  ds_read_b64_tr_b16 v[182:183], v237 offset:16704
  v_fmac_f32 v246, v249, v249
  v_lshlrev_b32 v250, 16, v153
  v_and_b32 v251, 0xffff0000, v153
  v_add_f32 v241, v241, v250
  v_fmac_f32 v245, v250, v250
  v_mfma_f32_32x32x16_bf16 v[96:111], v[152:155], v[204:207], v[96:111]
  ds_read_b64_tr_b16 v[184:185], v237 offset:15488
  ds_read_b64_tr_b16 v[186:187], v237 offset:16768
  v_add_f32 v243, v243, v251
  v_fmac_f32 v247, v251, v251
  v_lshlrev_b32 v248, 16, v154
  v_and_b32 v249, 0xffff0000, v154
  v_add_f32 v240, v240, v248
  v_mfma_f32_32x32x16_bf16 v[112:127], v[152:155], v[208:211], v[112:127]
  ds_read_b64_tr_b16 v[188:189], v237 offset:15552
  ds_read_b64_tr_b16 v[190:191], v237 offset:16832
  v_fmac_f32 v244, v248, v248
  v_add_f32 v242, v242, v249
  v_fmac_f32 v246, v249, v249
  v_lshlrev_b32 v250, 16, v155
  v_and_b32 v251, 0xffff0000, v155
  v_mfma_f32_32x32x16_bf16 v[128:143], v[152:155], v[212:215], v[128:143]
  ds_read_b64_tr_b16 v[192:193], v237 offset:15616
  ds_read_b64_tr_b16 v[194:195], v237 offset:16896
  v_add_f32 v241, v241, v250
  v_fmac_f32 v245, v250, v250
  v_add_f32 v243, v243, v251
  v_fmac_f32 v247, v251, v251
  s_cmp_lg_u32 s29, 1
  s_cbranch_scc1 g1_kernel_cs78
  v_mfma_f32_4x4x4_16b_bf16 v[216:219], v[4:5], v[196:197], v[216:219]
  v_mfma_f32_4x4x4_16b_bf16 v[220:223], v[4:5], v[200:201], v[220:223]
  v_mfma_f32_4x4x4_16b_bf16 v[224:227], v[4:5], v[204:205], v[224:227]
  v_mfma_f32_4x4x4_16b_bf16 v[228:231], v[4:5], v[208:209], v[228:231]
  v_mfma_f32_4x4x4_16b_bf16 v[232:235], v[4:5], v[212:213], v[232:235]
  v_mfma_f32_4x4x4_16b_bf16 v[216:219], v[4:5], v[198:199], v[216:219]
  v_mfma_f32_4x4x4_16b_bf16 v[220:223], v[4:5], v[202:203], v[220:223]
  v_mfma_f32_4x4x4_16b_bf16 v[224:227], v[4:5], v[206:207], v[224:227]
  v_mfma_f32_4x4x4_16b_bf16 v[228:231], v[4:5], v[210:211], v[228:231]
  v_mfma_f32_4x4x4_16b_bf16 v[232:235], v[4:5], v[214:215], v[232:235]
g1_kernel_cs78:
  s_waitcnt lgkmcnt(11)
  v_mfma_f32_32x32x16_bf16 v[64:79], v[144:147], v[156:159], v[64:79]
  ds_read_b128 v[152:155], v58 offset:0
  ds_read_b64_tr_b16 v[196:197], v62 offset:0
  ds_read_b64_tr_b16 v[198:199], v62 offset:1280
  v_lshlrev_b32 v248, 16, v144
  v_and_b32 v249, 0xffff0000, v144
  v_add_f32 v240, v240, v248
  v_fmac_f32 v244, v248, v248
  v_add_f32 v242, v242, v249
  v_mfma_f32_32x32x16_bf16 v[80:95], v[144:147], v[160:163], v[80:95]
  ds_read_b64_tr_b16 v[200:201], v62 offset:64
  ds_read_b64_tr_b16 v[202:203], v62 offset:1344
  v_fmac_f32 v246, v249, v249
  v_lshlrev_b32 v250, 16, v145
  v_and_b32 v251, 0xffff0000, v145
  v_add_f32 v241, v241, v250
  v_fmac_f32 v245, v250, v250
  v_mfma_f32_32x32x16_bf16 v[96:111], v[144:147], v[164:167], v[96:111]
  ds_read_b64_tr_b16 v[204:205], v62 offset:128
  ds_read_b64_tr_b16 v[206:207], v62 offset:1408
  v_add_f32 v243, v243, v251
  v_fmac_f32 v247, v251, v251
  v_lshlrev_b32 v248, 16, v146
  v_and_b32 v249, 0xffff0000, v146
  v_add_f32 v240, v240, v248
  v_mfma_f32_32x32x16_bf16 v[112:127], v[144:147], v[168:171], v[112:127]
  ds_read_b64_tr_b16 v[208:209], v62 offset:192
  ds_read_b64_tr_b16 v[210:211], v62 offset:1472
  v_fmac_f32 v244, v248, v248
  v_add_f32 v242, v242, v249
  v_fmac_f32 v246, v249, v249
  v_lshlrev_b32 v250, 16, v147
  v_and_b32 v251, 0xffff0000, v147
  v_mfma_f32_32x32x16_bf16 v[128:143], v[144:147], v[172:175], v[128:143]
  ds_read_b64_tr_b16 v[212:213], v62 offset:256
  ds_read_b64_tr_b16 v[214:215], v62 offset:1536
  v_add_f32 v241, v241, v250
  v_fmac_f32 v245, v250, v250
  v_add_f32 v243, v243, v251
  v_fmac_f32 v247, v251, v251
  s_cmp_lg_u32 s29, 2
  s_cbranch_scc1 g1_kernel_cs79
  v_mfma_f32_4x4x4_16b_bf16 v[216:219], v[4:5], v[156:157], v[216:219]
  v_mfma_f32_4x4x4_16b_bf16 v[220:223], v[4:5], v[160:161], v[220:223]
  v_mfma_f32_4x4x4_16b_bf16 v[224:227], v[4:5], v[164:165], v[224:227]
  v_mfma_f32_4x4x4_16b_bf16 v[228:231], v[4:5], v[168:169], v[228:231]
  v_mfma_f32_4x4x4_16b_bf16 v[232:235], v[4:5], v[172:173], v[232:235]
  v_mfma_f32_4x4x4_16b_bf16 v[216:219], v[4:5], v[158:159], v[216:219]
  v_mfma_f32_4x4x4_16b_bf16 v[220:223], v[4:5], v[162:163], v[220:223]
  v_mfma_f32_4x4x4_16b_bf16 v[224:227], v[4:5], v[166:167], v[224:227]
  v_mfma_f32_4x4x4_16b_bf16 v[228:231], v[4:5], v[170:171], v[228:231]
  v_mfma_f32_4x4x4_16b_bf16 v[232:235], v[4:5], v[174:175], v[232:235]
g1_kernel_cs79:
  s_waitcnt lgkmcnt(11)
  v_mfma_f32_32x32x16_bf16 v[64:79], v[148:151], v[176:179], v[64:79]
  ds_read_b128 v[144:147], v59 offset:0
  ds_read_b64_tr_b16 v[156:157], v62 offset:5120
  ds_read_b64_tr_b16 v[158:159], v62 offset:6400
  v_lshlrev_b32 v248, 16, v148
  v_and_b32 v249, 0xffff0000, v148
  v_add_f32 v240, v240, v248
  v_fmac_f32 v244, v248, v248
  v_add_f32 v242, v242, v249
  v_mfma_f32_32x32x16_bf16 v[80:95], v[148:151], v[180:183], v[80:95]
  ds_read_b64_tr_b16 v[160:161], v62 offset:5184
  ds_read_b64_tr_b16 v[162:163], v62 offset:6464
  v_fmac_f32 v246, v249, v249
  v_lshlrev_b32 v250, 16, v149
  v_and_b32 v251, 0xffff0000, v149
  v_add_f32 v241, v241, v250
  v_fmac_f32 v245, v250, v250
  v_mfma_f32_32x32x16_bf16 v[96:111], v[148:151], v[184:187], v[96:111]
  ds_read_b64_tr_b16 v[164:165], v62 offset:5248
  ds_read_b64_tr_b16 v[166:167], v62 offset:6528
  v_add_f32 v243, v243, v251
  v_fmac_f32 v247, v251, v251
  v_lshlrev_b32 v248, 16, v150
  v_and_b32 v249, 0xffff0000, v150
  v_add_f32 v240, v240, v248
  v_mfma_f32_32x32x16_bf16 v[112:127], v[148:151], v[188:191], v[112:127]
  ds_read_b64_tr_b16 v[168:169], v62 offset:5312
  ds_read_b64_tr_b16 v[170:171], v62 offset:6592
  v_fmac_f32 v244, v248, v248
  v_add_f32 v242, v242, v249
  v_fmac_f32 v246, v249, v249
  v_lshlrev_b32 v250, 16, v151
  v_and_b32 v251, 0xffff0000, v151
  v_mfma_f32_32x32x16_bf16 v[128:143], v[148:151], v[192:195], v[128:143]
  ds_read_b64_tr_b16 v[172:173], v62 offset:5376
  ds_read_b64_tr_b16 v[174:175], v62 offset:6656
  v_add_f32 v241, v241, v250
  v_fmac_f32 v245, v250, v250
  v_add_f32 v243, v243, v251
  v_fmac_f32 v247, v251, v251
  s_cmp_lg_u32 s29, 3
  s_cbranch_scc1 g1_kernel_cs80
  v_mfma_f32_4x4x4_16b_bf16 v[216:219], v[4:5], v[176:177], v[216:219]
  v_mfma_f32_4x4x4_16b_bf16 v[220:223], v[4:5], v[180:181], v[220:223]
  v_mfma_f32_4x4x4_16b_bf16 v[224:227], v[4:5], v[184:185], v[224:227]
  v_mfma_f32_4x4x4_16b_bf16 v[228:231], v[4:5], v[188:189], v[228:231]
  v_mfma_f32_4x4x4_16b_bf16 v[232:235], v[4:5], v[192:193], v[232:235]
  v_mfma_f32_4x4x4_16b_bf16 v[216:219], v[4:5], v[178:179], v[216:219]
  v_mfma_f32_4x4x4_16b_bf16 v[220:223], v[4:5], v[182:183], v[220:223]
  v_mfma_f32_4x4x4_16b_bf16 v[224:227], v[4:5], v[186:187], v[224:227]
  v_mfma_f32_4x4x4_16b_bf16 v[228:231], v[4:5], v[190:191], v[228:231]
  v_mfma_f32_4x4x4_16b_bf16 v[232:235], v[4:5], v[194:195], v[232:235]
g1_kernel_cs80:
  s_barrier
  s_waitcnt lgkmcnt(11)
  v_mfma_f32_32x32x16_bf16 v[64:79], v[152:155], v[196:199], v[64:79]
  ds_read_b128 v[148:151], v60 offset:0
  ds_read_b64_tr_b16 v[176:177], v62 offset:10240
  ds_read_b64_tr_b16 v[178:179], v62 offset:11520
  v_lshlrev_b32 v248, 16, v152
  v_and_b32 v249, 0xffff0000, v152
  v_add_f32 v240, v240, v248
  v_fmac_f32 v244, v248, v248
  v_add_f32 v242, v242, v249
  v_mfma_f32_32x32x16_bf16 v[80:95], v[152:155], v[200:203], v[80:95]
  ds_read_b64_tr_b16 v[180:181], v62 offset:10304
  ds_read_b64_tr_b16 v[182:183], v62 offset:11584
  v_fmac_f32 v246, v249, v249
  v_lshlrev_b32 v250, 16, v153
  v_and_b32 v251, 0xffff0000, v153
  v_add_f32 v241, v241, v250
  v_fmac_f32 v245, v250, v250
  v_mfma_f32_32x32x16_bf16 v[96:111], v[152:155], v[204:207], v[96:111]
  ds_read_b64_tr_b16 v[184:185], v62 offset:10368
  ds_read_b64_tr_b16 v[186:187], v62 offset:11648
  v_add_f32 v243, v243, v251
  v_fmac_f32 v247, v251, v251
  v_lshlrev_b32 v248, 16, v154
  v_and_b32 v249, 0xffff0000, v154
  v_add_f32 v240, v240, v248
  v_mfma_f32_32x32x16_bf16 v[112:127], v[152:155], v[208:211], v[112:127]
  ds_read_b64_tr_b16 v[188:189], v62 offset:10432
  ds_read_b64_tr_b16 v[190:191], v62 offset:11712
  v_fmac_f32 v244, v248, v248
  v_add_f32 v242, v242, v249
  v_fmac_f32 v246, v249, v249
  v_lshlrev_b32 v250, 16, v155
  v_and_b32 v251, 0xffff0000, v155
  v_mfma_f32_32x32x16_bf16 v[128:143], v[152:155], v[212:215], v[128:143]
  ds_read_b64_tr_b16 v[192:193], v62 offset:10496
  ds_read_b64_tr_b16 v[194:195], v62 offset:11776
  v_add_f32 v241, v241, v250
  v_fmac_f32 v245, v250, v250
  v_add_f32 v243, v243, v251
  v_fmac_f32 v247, v251, v251
  s_cmp_lg_u32 s29, 0
  s_cbranch_scc1 g1_kernel_cs81
  v_mfma_f32_4x4x4_16b_bf16 v[216:219], v[4:5], v[196:197], v[216:219]
  v_mfma_f32_4x4x4_16b_bf16 v[220:223], v[4:5], v[200:201], v[220:223]
  v_mfma_f32_4x4x4_16b_bf16 v[224:227], v[4:5], v[204:205], v[224:227]
  v_mfma_f32_4x4x4_16b_bf16 v[228:231], v[4:5], v[208:209], v[228:231]
  v_mfma_f32_4x4x4_16b_bf16 v[232:235], v[4:5], v[212:213], v[232:235]
  v_mfma_f32_4x4x4_16b_bf16 v[216:219], v[4:5], v[198:199], v[216:219]
  v_mfma_f32_4x4x4_16b_bf16 v[220:223], v[4:5], v[202:203], v[220:223]
  v_mfma_f32_4x4x4_16b_bf16 v[224:227], v[4:5], v[206:207], v[224:227]
  v_mfma_f32_4x4x4_16b_bf16 v[228:231], v[4:5], v[210:211], v[228:231]
  v_mfma_f32_4x4x4_16b_bf16 v[232:235], v[4:5], v[214:215], v[232:235]
g1_kernel_cs81:
  s_waitcnt lgkmcnt(11)
  v_mfma_f32_32x32x16_bf16 v[64:79], v[144:147], v[156:159], v[64:79]
  ds_read_b128 v[152:155], v61 offset:0
  ds_read_b64_tr_b16 v[196:197], v62 offset:15360
  ds_read_b64_tr_b16 v[198:199], v62 offset:16640
  v_lshlrev_b32 v248, 16, v144
  v_and_b32 v249, 0xffff0000, v144
  v_add_f32 v240, v240, v248
  v_fmac_f32 v244, v248, v248
  v_add_f32 v242, v242, v249
  v_mfma_f32_32x32x16_bf16 v[80:95], v[144:147], v[160:163], v[80:95]
  ds_read_b64_tr_b16 v[200:201], v62 offset:15424
  ds_read_b64_tr_b16 v[202:203], v62 offset:16704
  v_fmac_f32 v246, v249, v249
  v_lshlrev_b32 v250, 16, v145
  v_and_b32 v251, 0xffff0000, v145
  v_add_f32 v241, v241, v250
  v_fmac_f32 v245, v250, v250
  v_mfma_f32_32x32x16_bf16 v[96:111], v[144:147], v[164:167], v[96:111]
  ds_read_b64_tr_b16 v[204:205], v62 offset:15488
  ds_read_b64_tr_b16 v[206:207], v62 offset:16768
  v_add_f32 v243, v243, v251
  v_fmac_f32 v247, v251, v251
  v_lshlrev_b32 v248, 16, v146
  v_and_b32 v249, 0xffff0000, v146
  v_add_f32 v240, v240, v248
  v_mfma_f32_32x32x16_bf16 v[112:127], v[144:147], v[168:171], v[112:127]
  ds_read_b64_tr_b16 v[208:209], v62 offset:15552
  ds_read_b64_tr_b16 v[210:211], v62 offset:16832
  v_fmac_f32 v244, v248, v248
  v_add_f32 v242, v242, v249
  v_fmac_f32 v246, v249, v249
  v_lshlrev_b32 v250, 16, v147
  v_and_b32 v251, 0xffff0000, v147
  v_mfma_f32_32x32x16_bf16 v[128:143], v[144:147], v[172:175], v[128:143]
  ds_read_b64_tr_b16 v[212:213], v62 offset:15616
  ds_read_b64_tr_b16 v[214:215], v62 offset:16896
  v_add_f32 v241, v241, v250
  v_fmac_f32 v245, v250, v250
  v_add_f32 v243, v243, v251
  v_fmac_f32 v247, v251, v251
  s_cmp_lg_u32 s29, 1
  s_cbranch_scc1 g1_kernel_cs82
  v_mfma_f32_4x4x4_16b_bf16 v[216:219], v[4:5], v[156:157], v[216:219]
  v_mfma_f32_4x4x4_16b_bf16 v[220:223], v[4:5], v[160:161], v[220:223]
  v_mfma_f32_4x4x4_16b_bf16 v[224:227], v[4:5], v[164:165], v[224:227]
  v_mfma_f32_4x4x4_16b_bf16 v[228:231], v[4:5], v[168:169], v[228:231]
  v_mfma_f32_4x4x4_16b_bf16 v[232:235], v[4:5], v[172:173], v[232:235]
  v_mfma_f32_4x4x4_16b_bf16 v[216:219], v[4:5], v[158:159], v[216:219]
  v_mfma_f32_4x4x4_16b_bf16 v[220:223], v[4:5], v[162:163], v[220:223]
  v_mfma_f32_4x4x4_16b_bf16 v[224:227], v[4:5], v[166:167], v[224:227]
  v_mfma_f32_4x4x4_16b_bf16 v[228:231], v[4:5], v[170:171], v[228:231]
  v_mfma_f32_4x4x4_16b_bf16 v[232:235], v[4:5], v[174:175], v[232:235]
g1_kernel_cs82:
  s_waitcnt lgkmcnt(11)
  v_mfma_f32_32x32x16_bf16 v[64:79], v[148:151], v[176:179], v[64:79]
  ds_read_b128 v[144:147], v58 offset:16384
  ds_read_b64_tr_b16 v[156:157], v62 offset:20480
  ds_read_b64_tr_b16 v[158:159], v62 offset:21760
  v_lshlrev_b32 v248, 16, v148
  v_and_b32 v249, 0xffff0000, v148
  v_add_f32 v240, v240, v248
  v_fmac_f32 v244, v248, v248
  v_add_f32 v242, v242, v249
  v_mfma_f32_32x32x16_bf16 v[80:95], v[148:151], v[180:183], v[80:95]
  ds_read_b64_tr_b16 v[160:161], v62 offset:20544
  ds_read_b64_tr_b16 v[162:163], v62 offset:21824
  v_fmac_f32 v246, v249, v249
  v_lshlrev_b32 v250, 16, v149
  v_and_b32 v251, 0xffff0000, v149
  v_add_f32 v241, v241, v250
  v_fmac_f32 v245, v250, v250
  v_mfma_f32_32x32x16_bf16 v[96:111], v[148:151], v[184:187], v[96:111]
  ds_read_b64_tr_b16 v[164:165], v62 offset:20608
  ds_read_b64_tr_b16 v[166:167], v62 offset:21888
  v_add_f32 v243, v243, v251
  v_fmac_f32 v247, v251, v251
  v_lshlrev_b32 v248, 16, v150
  v_and_b32 v249, 0xffff0000, v150
  v_add_f32 v240, v240, v248
  v_mfma_f32_32x32x16_bf16 v[112:127], v[148:151], v[188:191], v[112:127]
  ds_read_b64_tr_b16 v[168:169], v62 offset:20672
  ds_read_b64_tr_b16 v[170:171], v62 offset:21952
  v_fmac_f32 v244, v248, v248
  v_add_f32 v242, v242, v249
  v_fmac_f32 v246, v249, v249
  v_lshlrev_b32 v250, 16, v151
  v_and_b32 v251, 0xffff0000, v151
  v_mfma_f32_32x32x16_bf16 v[128:143], v[148:151], v[192:195], v[128:143]
  ds_read_b64_tr_b16 v[172:173], v62 offset:20736
  ds_read_b64_tr_b16 v[174:175], v62 offset:22016
  v_add_f32 v241, v241, v250
  v_fmac_f32 v245, v250, v250
  v_add_f32 v243, v243, v251
  v_fmac_f32 v247, v251, v251
  s_cmp_lg_u32 s29, 2
  s_cbranch_scc1 g1_kernel_cs83
  v_mfma_f32_4x4x4_16b_bf16 v[216:219], v[4:5], v[176:177], v[216:219]
  v_mfma_f32_4x4x4_16b_bf16 v[220:223], v[4:5], v[180:181], v[220:223]
  v_mfma_f32_4x4x4_16b_bf16 v[224:227], v[4:5], v[184:185], v[224:227]
  v_mfma_f32_4x4x4_16b_bf16 v[228:231], v[4:5], v[188:189], v[228:231]
  v_mfma_f32_4x4x4_16b_bf16 v[232:235], v[4:5], v[192:193], v[232:235]
  v_mfma_f32_4x4x4_16b_bf16 v[216:219], v[4:5], v[178:179], v[216:219]
  v_mfma_f32_4x4x4_16b_bf16 v[220:223], v[4:5], v[182:183], v[220:223]
  v_mfma_f32_4x4x4_16b_bf16 v[224:227], v[4:5], v[186:187], v[224:227]
  v_mfma_f32_4x4x4_16b_bf16 v[228:231], v[4:5], v[190:191], v[228:231]
  v_mfma_f32_4x4x4_16b_bf16 v[232:235], v[4:5], v[194:195], v[232:235]
g1_kernel_cs83:
  s_waitcnt lgkmcnt(11)
  v_mfma_f32_32x32x16_bf16 v[64:79], v[152:155], v[196:199], v[64:79]
  ds_read_b128 v[148:151], v59 offset:16384
  ds_read_b64_tr_b16 v[176:177], v62 offset:25600
  ds_read_b64_tr_b16 v[178:179], v62 offset:26880
  v_lshlrev_b32 v248, 16, v152
  v_and_b32 v249, 0xffff0000, v152
  v_add_f32 v240, v240, v248
  v_fmac_f32 v244, v248, v248
  v_add_f32 v242, v242, v249
  v_mfma_f32_32x32x16_bf16 v[80:95], v[152:155], v[200:203], v[80:95]
  ds_read_b64_tr_b16 v[180:181], v62 offset:25664
  ds_read_b64_tr_b16 v[182:183], v62 offset:26944
  v_fmac_f32 v246, v249, v249
  v_lshlrev_b32 v250, 16, v153
  v_and_b32 v251, 0xffff0000, v153
  v_add_f32 v241, v241, v250
  v_fmac_f32 v245, v250, v250
  v_mfma_f32_32x32x16_bf16 v[96:111], v[152:155], v[204:207], v[96:111]
  ds_read_b64_tr_b16 v[184:185], v62 offset:25728
  ds_read_b64_tr_b16 v[186:187], v62 offset:27008
  v_add_f32 v243, v243, v251
  v_fmac_f32 v247, v251, v251
  v_lshlrev_b32 v248, 16, v154
  v_and_b32 v249, 0xffff0000, v154
  v_add_f32 v240, v240, v248
  v_mfma_f32_32x32x16_bf16 v[112:127], v[152:155], v[208:211], v[112:127]
  ds_read_b64_tr_b16 v[188:189], v62 offset:25792
  ds_read_b64_tr_b16 v[190:191], v62 offset:27072
  v_fmac_f32 v244, v248, v248
  v_add_f32 v242, v242, v249
  v_fmac_f32 v246, v249, v249
  v_lshlrev_b32 v250, 16, v155
  v_and_b32 v251, 0xffff0000, v155
  v_mfma_f32_32x32x16_bf16 v[128:143], v[152:155], v[212:215], v[128:143]
  ds_read_b64_tr_b16 v[192:193], v62 offset:25856
  ds_read_b64_tr_b16 v[194:195], v62 offset:27136
  v_add_f32 v241, v241, v250
  v_fmac_f32 v245, v250, v250
  v_add_f32 v243, v243, v251
  v_fmac_f32 v247, v251, v251
  s_cmp_lg_u32 s29, 3
  s_cbranch_scc1 g1_kernel_cs84
  v_mfma_f32_4x4x4_16b_bf16 v[216:219], v[4:5], v[196:197], v[216:219]
  v_mfma_f32_4x4x4_16b_bf16 v[220:223], v[4:5], v[200:201], v[220:223]
  v_mfma_f32_4x4x4_16b_bf16 v[224:227], v[4:5], v[204:205], v[224:227]
  v_mfma_f32_4x4x4_16b_bf16 v[228:231], v[4:5], v[208:209], v[228:231]
  v_mfma_f32_4x4x4_16b_bf16 v[232:235], v[4:5], v[212:213], v[232:235]
  v_mfma_f32_4x4x4_16b_bf16 v[216:219], v[4:5], v[198:199], v[216:219]
  v_mfma_f32_4x4x4_16b_bf16 v[220:223], v[4:5], v[202:203], v[220:223]
  v_mfma_f32_4x4x4_16b_bf16 v[224:227], v[4:5], v[206:207], v[224:227]
  v_mfma_f32_4x4x4_16b_bf16 v[228:231], v[4:5], v[210:211], v[228:231]
  v_mfma_f32_4x4x4_16b_bf16 v[232:235], v[4:5], v[214:215], v[232:235]
g1_kernel_cs84:
  s_barrier
  s_waitcnt lgkmcnt(11)
  v_mfma_f32_32x32x16_bf16 v[64:79], v[144:147], v[156:159], v[64:79]
  ds_read_b128 v[152:155], v60 offset:16384
  ds_read_b64_tr_b16 v[196:197], v62 offset:30720
  ds_read_b64_tr_b16 v[198:199], v62 offset:32000
  v_lshlrev_b32 v248, 16, v144
  v_and_b32 v249, 0xffff0000, v144
  v_add_f32 v240, v240, v248
  v_fmac_f32 v244, v248, v248
  v_add_f32 v242, v242, v249
  v_mfma_f32_32x32x16_bf16 v[80:95], v[144:147], v[160:163], v[80:95]
  ds_read_b64_tr_b16 v[200:201], v62 offset:30784
  ds_read_b64_tr_b16 v[202:203], v62 offset:32064
  v_fmac_f32 v246, v249, v249
  v_lshlrev_b32 v250, 16, v145
  v_and_b32 v251, 0xffff0000, v145
  v_add_f32 v241, v241, v250
  v_fmac_f32 v245, v250, v250
  v_mfma_f32_32x32x16_bf16 v[96:111], v[144:147], v[164:167], v[96:111]
  ds_read_b64_tr_b16 v[204:205], v62 offset:30848
  ds_read_b64_tr_b16 v[206:207], v62 offset:32128
  v_add_f32 v243, v243, v251
  v_fmac_f32 v247, v251, v251
  v_lshlrev_b32 v248, 16, v146
  v_and_b32 v249, 0xffff0000, v146
  v_add_f32 v240, v240, v248
  v_mfma_f32_32x32x16_bf16 v[112:127], v[144:147], v[168:171], v[112:127]
  ds_read_b64_tr_b16 v[208:209], v62 offset:30912
  ds_read_b64_tr_b16 v[210:211], v62 offset:32192
  v_fmac_f32 v244, v248, v248
  v_add_f32 v242, v242, v249
  v_fmac_f32 v246, v249, v249
  v_lshlrev_b32 v250, 16, v147
  v_and_b32 v251, 0xffff0000, v147
  v_mfma_f32_32x32x16_bf16 v[128:143], v[144:147], v[172:175], v[128:143]
  ds_read_b64_tr_b16 v[212:213], v62 offset:30976
  ds_read_b64_tr_b16 v[214:215], v62 offset:32256
  v_add_f32 v241, v241, v250
  v_fmac_f32 v245, v250, v250
  v_add_f32 v243, v243, v251
  v_fmac_f32 v247, v251, v251
  s_cmp_lg_u32 s29, 0
  s_cbranch_scc1 g1_kernel_cs85
  v_mfma_f32_4x4x4_16b_bf16 v[216:219], v[4:5], v[156:157], v[216:219]
  v_mfma_f32_4x4x4_16b_bf16 v[220:223], v[4:5], v[160:161], v[220:223]
  v_mfma_f32_4x4x4_16b_bf16 v[224:227], v[4:5], v[164:165], v[224:227]
  v_mfma_f32_4x4x4_16b_bf16 v[228:231], v[4:5], v[168:169], v[228:231]
  v_mfma_f32_4x4x4_16b_bf16 v[232:235], v[4:5], v[172:173], v[232:235]
  v_mfma_f32_4x4x4_16b_bf16 v[216:219], v[4:5], v[158:159], v[216:219]
  v_mfma_f32_4x4x4_16b_bf16 v[220:223], v[4:5], v[162:163], v[220:223]
  v_mfma_f32_4x4x4_16b_bf16 v[224:227], v[4:5], v[166:167], v[224:227]
  v_mfma_f32_4x4x4_16b_bf16 v[228:231], v[4:5], v[170:171], v[228:231]
  v_mfma_f32_4x4x4_16b_bf16 v[232:235], v[4:5], v[174:175], v[232:235]
g1_kernel_cs85:
  s_waitcnt lgkmcnt(11)
  v_mfma_f32_32x32x16_bf16 v[64:79], v[148:151], v[176:179], v[64:79]
  ds_read_b128 v[144:147], v61 offset:16384
  ds_read_b64_tr_b16 v[156:157], v62 offset:35840
  ds_read_b64_tr_b16 v[158:159], v62 offset:37120
  v_lshlrev_b32 v248, 16, v148
  v_and_b32 v249, 0xffff0000, v148
  v_add_f32 v240, v240, v248
  v_fmac_f32 v244, v248, v248
  v_add_f32 v242, v242, v249
  v_mfma_f32_32x32x16_bf16 v[80:95], v[148:151], v[180:183], v[80:95]
  ds_read_b64_tr_b16 v[160:161], v62 offset:35904
  ds_read_b64_tr_b16 v[162:163], v62 offset:37184
  v_fmac_f32 v246, v249, v249
  v_lshlrev_b32 v250, 16, v149
  v_and_b32 v251, 0xffff0000, v149
  v_add_f32 v241, v241, v250
  v_fmac_f32 v245, v250, v250
  v_mfma_f32_32x32x16_bf16 v[96:111], v[148:151], v[184:187], v[96:111]
  ds_read_b64_tr_b16 v[164:165], v62 offset:35968
  ds_read_b64_tr_b16 v[166:167], v62 offset:37248
  v_add_f32 v243, v243, v251
  v_fmac_f32 v247, v251, v251
  v_lshlrev_b32 v248, 16, v150
  v_and_b32 v249, 0xffff0000, v150
  v_add_f32 v240, v240, v248
  v_mfma_f32_32x32x16_bf16 v[112:127], v[148:151], v[188:191], v[112:127]
  ds_read_b64_tr_b16 v[168:169], v62 offset:36032
  ds_read_b64_tr_b16 v[170:171], v62 offset:37312
  v_fmac_f32 v244, v248, v248
  v_add_f32 v242, v242, v249
  v_fmac_f32 v246, v249, v249
  v_lshlrev_b32 v250, 16, v151
  v_and_b32 v251, 0xffff0000, v151
  v_mfma_f32_32x32x16_bf16 v[128:143], v[148:151], v[192:195], v[128:143]
  ds_read_b64_tr_b16 v[172:173], v62 offset:36096
  ds_read_b64_tr_b16 v[174:175], v62 offset:37376
  v_add_f32 v241, v241, v250
  v_fmac_f32 v245, v250, v250
  v_add_f32 v243, v243, v251
  v_fmac_f32 v247, v251, v251
  s_cmp_lg_u32 s29, 1
  s_cbranch_scc1 g1_kernel_cs86
  v_mfma_f32_4x4x4_16b_bf16 v[216:219], v[4:5], v[176:177], v[216:219]
  v_mfma_f32_4x4x4_16b_bf16 v[220:223], v[4:5], v[180:181], v[220:223]
  v_mfma_f32_4x4x4_16b_bf16 v[224:227], v[4:5], v[184:185], v[224:227]
  v_mfma_f32_4x4x4_16b_bf16 v[228:231], v[4:5], v[188:189], v[228:231]
  v_mfma_f32_4x4x4_16b_bf16 v[232:235], v[4:5], v[192:193], v[232:235]
  v_mfma_f32_4x4x4_16b_bf16 v[216:219], v[4:5], v[178:179], v[216:219]
  v_mfma_f32_4x4x4_16b_bf16 v[220:223], v[4:5], v[182:183], v[220:223]
  v_mfma_f32_4x4x4_16b_bf16 v[224:227], v[4:5], v[186:187], v[224:227]
  v_mfma_f32_4x4x4_16b_bf16 v[228:231], v[4:5], v[190:191], v[228:231]
  v_mfma_f32_4x4x4_16b_bf16 v[232:235], v[4:5], v[194:195], v[232:235]
g1_kernel_cs86:
  s_waitcnt lgkmcnt(11)
  v_mfma_f32_32x32x16_bf16 v[64:79], v[152:155], v[196:199], v[64:79]
  v_lshlrev_b32 v248, 16, v152
  v_and_b32 v249, 0xffff0000, v152
  v_add_f32 v240, v240, v248
  v_fmac_f32 v244, v248, v248
  v_add_f32 v242, v242, v249
  v_mfma_f32_32x32x16_bf16 v[80:95], v[152:155], v[200:203], v[80:95]
  v_fmac_f32 v246, v249, v249
  v_lshlrev_b32 v250, 16, v153
  v_and_b32 v251, 0xffff0000, v153
  v_add_f32 v241, v241, v250
  v_fmac_f32 v245, v250, v250
  v_mfma_f32_32x32x16_bf16 v[96:111], v[152:155], v[204:207], v[96:111]
  v_add_f32 v243, v243, v251
  v_fmac_f32 v247, v251, v251
  v_lshlrev_b32 v248, 16, v154
  v_and_b32 v249, 0xffff0000, v154
  v_add_f32 v240, v240, v248
  v_mfma_f32_32x32x16_bf16 v[112:127], v[152:155], v[208:211], v[112:127]
  v_fmac_f32 v244, v248, v248
  v_add_f32 v242, v242, v249
  v_fmac_f32 v246, v249, v249
  v_lshlrev_b32 v250, 16, v155
  v_and_b32 v251, 0xffff0000, v155
  v_mfma_f32_32x32x16_bf16 v[128:143], v[152:155], v[212:215], v[128:143]
  v_add_f32 v241, v241, v250
  v_fmac_f32 v245, v250, v250
  v_add_f32 v243, v243, v251
  v_fmac_f32 v247, v251, v251
  s_cmp_lg_u32 s29, 2
  s_cbranch_scc1 g1_kernel_cs87
  v_mfma_f32_4x4x4_16b_bf16 v[216:219], v[4:5], v[196:197], v[216:219]
  v_mfma_f32_4x4x4_16b_bf16 v[220:223], v[4:5], v[200:201], v[220:223]
  v_mfma_f32_4x4x4_16b_bf16 v[224:227], v[4:5], v[204:205], v[224:227]
  v_mfma_f32_4x4x4_16b_bf16 v[228:231], v[4:5], v[208:209], v[228:231]
  v_mfma_f32_4x4x4_16b_bf16 v[232:235], v[4:5], v[212:213], v[232:235]
  v_mfma_f32_4x4x4_16b_bf16 v[216:219], v[4:5], v[198:199], v[216:219]
  v_mfma_f32_4x4x4_16b_bf16 v[220:223], v[4:5], v[202:203], v[220:223]
  v_mfma_f32_4x4x4_16b_bf16 v[224:227], v[4:5], v[206:207], v[224:227]
  v_mfma_f32_4x4x4_16b_bf16 v[228:231], v[4:5], v[210:211], v[228:231]
  v_mfma_f32_4x4x4_16b_bf16 v[232:235], v[4:5], v[214:215], v[232:235]
g1_kernel_cs87:
  s_waitcnt lgkmcnt(0)
  v_mfma_f32_32x32x16_bf16 v[64:79], v[144:147], v[156:159], v[64:79]
  v_lshlrev_b32 v248, 16, v144
  v_and_b32 v249, 0xffff0000, v144
  v_add_f32 v240, v240, v248
  v_fmac_f32 v244, v248, v248
  v_add_f32 v242, v242, v249
  v_mfma_f32_32x32x16_bf16 v[80:95], v[144:147], v[160:163], v[80:95]
  v_fmac_f32 v246, v249, v249
  v_lshlrev_b32 v250, 16, v145
  v_and_b32 v251, 0xffff0000, v145
  v_add_f32 v241, v241, v250
  v_fmac_f32 v245, v250, v250
  v_mfma_f32_32x32x16_bf16 v[96:111], v[144:147], v[164:167], v[96:111]
  v_add_f32 v243, v243, v251
  v_fmac_f32 v247, v251, v251
  v_lshlrev_b32 v248, 16, v146
  v_and_b32 v249, 0xffff0000, v146
  v_add_f32 v240, v240, v248
  v_mfma_f32_32x32x16_bf16 v[112:127], v[144:147], v[168:171], v[112:127]
  v_fmac_f32 v244, v248, v248
  v_add_f32 v242, v242, v249
  v_fmac_f32 v246, v249, v249
  v_lshlrev_b32 v250, 16, v147
  v_and_b32 v251, 0xffff0000, v147
  v_mfma_f32_32x32x16_bf16 v[128:143], v[144:147], v[172:175], v[128:143]
  v_add_f32 v241, v241, v250
  v_fmac_f32 v245, v250, v250
  v_add_f32 v243, v243, v251
  v_fmac_f32 v247, v251, v251
  s_cmp_lg_u32 s29, 3
  s_cbranch_scc1 g1_kernel_cs88
  v_mfma_f32_4x4x4_16b_bf16 v[216:219], v[4:5], v[156:157], v[216:219]
  v_mfma_f32_4x4x4_16b_bf16 v[220:223], v[4:5], v[160:161], v[220:223]
  v_mfma_f32_4x4x4_16b_bf16 v[224:227], v[4:5], v[164:165], v[224:227]
  v_mfma_f32_4x4x4_16b_bf16 v[228:231], v[4:5], v[168:169], v[228:231]
  v_mfma_f32_4x4x4_16b_bf16 v[232:235], v[4:5], v[172:173], v[232:235]
  v_mfma_f32_4x4x4_16b_bf16 v[216:219], v[4:5], v[158:159], v[216:219]
  v_mfma_f32_4x4x4_16b_bf16 v[220:223], v[4:5], v[162:163], v[220:223]
  v_mfma_f32_4x4x4_16b_bf16 v[224:227], v[4:5], v[166:167], v[224:227]
  v_mfma_f32_4x4x4_16b_bf16 v[228:231], v[4:5], v[170:171], v[228:231]
  v_mfma_f32_4x4x4_16b_bf16 v[232:235], v[4:5], v[174:175], v[232:235]
g1_kernel_cs88:
g1_kernel_ep8:
  v_add_f32 v240, v240, v241
  v_add_f32 v242, v242, v243
  v_add_f32 v244, v244, v245
  v_add_f32 v246, v246, v247
  v_add_f32 v240, v240, v242
  v_add_f32 v244, v244, v246
  v_mov_b32 v13, v240
  s_nop 1
  v_permlane32_swap_b32 v240, v13
  v_add_f32 v240, v240, v13
  v_mov_b32 v14, v244
  s_nop 1
  v_permlane32_swap_b32 v244, v14
  v_add_f32 v244, v244, v14
  v_mul_f32 v8, 0x3acccccd, v240
  v_mul_f32 v10, 0x3acccccd, v244
  v_fma_f32 v10, -v8, v8, v10
  v_max_f32 v10, 0, v10
  v_add_f32 v9, 0x3727c5ac, v10
  v_rsq_f32 v9, v9
  v_lshlrev_b32 v12, 4, v2
  s_lshl_b32 s34, s29, 9
  s_add_u32 s34, s34, 152576
  v_add_u32 v12, s34, v12
  v_mul_f32 v11, v8, v9
  ds_write_b96 v12, v[8:10]
  v_lshlrev_b32 v12, 2, v2
  s_lshl_b32 s34, s29, 7
  s_add_u32 s34, s34, 154624
  v_add_u32 v12, s34, v12
  ds_write_b32 v12, v9
  ds_write_b32 v12, v11 offset:512
  s_cmp_lg_u32 s32, 0
  s_cbranch_scc1 g1_kernel_ns89
  s_lshl_b32 s34, s33, 8
  s_add_u32 s34, s34, 14163968
  v_lshlrev_b32 v11, 3, v2
  s_mov_b32 exec_hi, 0
  buffer_store_dwordx2 v[8:9], v11, s[16:19], s34 offen
  s_mov_b64 exec, -1
g1_kernel_ns89:
  v_mov_b32 v217, v216
  s_nop 1
  v_permlane32_swap_b32 v216, v217
  v_add_f32 v216, v216, v217
  v_mov_b32 v221, v220
  s_nop 1
  v_permlane32_swap_b32 v220, v221
  v_add_f32 v220, v220, v221
  v_mov_b32 v225, v224
  s_nop 1
  v_permlane32_swap_b32 v224, v225
  v_add_f32 v224, v224, v225
  v_mov_b32 v229, v228
  s_nop 1
  v_permlane32_swap_b32 v228, v229
  v_add_f32 v228, v228, v229
  v_mov_b32 v233, v232
  s_nop 1
  v_permlane32_swap_b32 v232, v233
  v_add_f32 v232, v232, v233
  s_mul_i32 s34, s29, 640
  v_lshlrev_b32 v12, 2, v2
  v_add_u32 v12, s34, v12
  v_add_u32 v12, 147456, v12
  ds_write_b32 v12, v216 offset:0
  ds_write_b32 v12, v220 offset:128
  ds_write_b32 v12, v224 offset:256
  ds_write_b32 v12, v228 offset:384
  ds_write_b32 v12, v232 offset:512
  s_waitcnt lgkmcnt(0)
  s_barrier
  v_lshlrev_b32 v12, 2, v1
  v_add_u32 v13, 147456, v12
  v_add_u32 v12, s34, v12
  v_add_u32 v12, 150016, v12
  ds_read_b32 v216, v13 offset:0
  ds_read_b32 v217, v13 offset:640
  ds_read_b32 v218, v13 offset:1280
  ds_read_b32 v219, v13 offset:1920
  ds_read_b32 v220, v13 offset:256
  ds_read_b32 v221, v13 offset:896
  ds_read_b32 v222, v13 offset:1536
  ds_read_b32 v223, v13 offset:2176
  ds_read_b32 v224, v13 offset:512
  ds_read_b32 v225, v13 offset:1152
  ds_read_b32 v226, v13 offset:1792
  ds_read_b32 v227, v13 offset:2432
  s_waitcnt lgkmcnt(0)
  v_add_f32 v216, v216, v217
  v_add_f32 v218, v218, v219
  v_add_f32 v220, v220, v221
  v_add_f32 v222, v222, v223
  v_add_f32 v224, v224, v225
  v_add_f32 v226, v226, v227
  v_add_f32 v216, v216, v218
  v_add_f32 v220, v220, v222
  v_add_f32 v224, v224, v226
  ds_write_b32 v12, v216 offset:0
  ds_write_b32 v12, v220 offset:256
  s_mov_b32 exec_hi, 0
  ds_write_b32 v12, v224 offset:512
  s_mov_b64 exec, -1
  s_add_u32 s34, s34, 150016
  s_waitcnt lgkmcnt(0)
  s_cmp_eq_u32 s23, 2
  s_cbranch_scc1 g1_kernel_eV91
  v_lshlrev_b32 v12, 4, v2
  s_lshl_b32 s39, s29, 9
  s_add_u32 s39, s39, 152576
  v_add_u32 v12, s39, v12
  ds_read_b96 v[8:10], v12
  v_lshlrev_b32 v15, 4, v3
  v_add_u32 v15, s34, v15
  ds_read_b128 v[144:147], v15 offset:0
  ds_read_b128 v[148:151], v15 offset:32
  ds_read_b128 v[152:155], v15 offset:64
  ds_read_b128 v[156:159], v15 offset:96
  ds_read_b128 v[160:163], v15 offset:128
  ds_read_b128 v[164:167], v15 offset:160
  ds_read_b128 v[168:171], v15 offset:192
  ds_read_b128 v[172:175], v15 offset:224
  ds_read_b128 v[176:179], v15 offset:256
  ds_read_b128 v[180:183], v15 offset:288
  ds_read_b128 v[184:187], v15 offset:320
  ds_read_b128 v[188:191], v15 offset:352
  ds_read_b128 v[192:195], v15 offset:384
  ds_read_b128 v[196:199], v15 offset:416
  ds_read_b128 v[200:203], v15 offset:448
  ds_read_b128 v[204:207], v15 offset:480
  ds_read_b128 v[208:211], v15 offset:512
  ds_read_b128 v[212:215], v15 offset:544
  ds_read_b128 v[216:219], v15 offset:576
  ds_read_b128 v[220:223], v15 offset:608
  s_waitcnt lgkmcnt(15)
  s_cmp_eq_u32 s23, 1
  s_cbranch_scc1 g1_kernel_eK90
  s_cmp_eq_u32 s23, 3
  s_cbranch_scc1 g1_kernel_eH92
  v_sub_f32 v40, 0, v8
  v_sub_f32 v41, 0, v8
  v_mul_f32 v42, 0x3ea52b5c, v9
  v_mul_f32 v43, 0x3ea52b5c, v9
  v_lshlrev_b32 v44, 4, v1
  s_mov_b32 s35, 98304
  v_mul_lo_u32 v45, v3, s35
  v_lshl_add_u32 v45, v2, 4, v45
  s_mul_i32 s35, s24, 786432
  s_mul_i32 s36, s33, 1536
  s_add_u32 s35, s35, s36
  s_add_u32 s35, s35, 0
  v_lshlrev_b32 v46, 14, v3
  v_lshl_add_u32 v46, v2, 3, v46
  s_lshl_b32 s38, s33, 8
  s_lshl_b32 s36, s24, 17
  s_add_u32 s38, s38, s36
  s_add_u32 s38, s38, 30408704
  s_waitcnt lgkmcnt(0)
  v_pk_fma_f32 v[64:65], v[144:145], v[40:41], v[64:65]
  v_pk_fma_f32 v[66:67], v[146:147], v[40:41], v[66:67]
  v_pk_fma_f32 v[68:69], v[148:149], v[40:41], v[68:69]
  v_pk_fma_f32 v[70:71], v[150:151], v[40:41], v[70:71]
  v_pk_fma_f32 v[72:73], v[152:153], v[40:41], v[72:73]
  v_pk_fma_f32 v[74:75], v[154:155], v[40:41], v[74:75]
  v_pk_fma_f32 v[76:77], v[156:157], v[40:41], v[76:77]
  v_pk_fma_f32 v[78:79], v[158:159], v[40:41], v[78:79]
  v_pk_fma_f32 v[80:81], v[160:161], v[40:41], v[80:81]
  v_pk_fma_f32 v[82:83], v[162:163], v[40:41], v[82:83]
  v_pk_fma_f32 v[84:85], v[164:165], v[40:41], v[84:85]
  v_pk_fma_f32 v[86:87], v[166:167], v[40:41], v[86:87]
  v_pk_fma_f32 v[88:89], v[168:169], v[40:41], v[88:89]
  v_pk_fma_f32 v[90:91], v[170:171], v[40:41], v[90:91]
  v_pk_fma_f32 v[92:93], v[172:173], v[40:41], v[92:93]
  v_pk_fma_f32 v[94:95], v[174:175], v[40:41], v[94:95]
  v_pk_fma_f32 v[96:97], v[176:177], v[40:41], v[96:97]
  v_pk_fma_f32 v[98:99], v[178:179], v[40:41], v[98:99]
  v_pk_fma_f32 v[100:101], v[180:181], v[40:41], v[100:101]
  v_pk_fma_f32 v[102:103], v[182:183], v[40:41], v[102:103]
  v_pk_fma_f32 v[104:105], v[184:185], v[40:41], v[104:105]
  v_pk_fma_f32 v[106:107], v[186:187], v[40:41], v[106:107]
  v_pk_fma_f32 v[108:109], v[188:189], v[40:41], v[108:109]
  v_pk_fma_f32 v[110:111], v[190:191], v[40:41], v[110:111]
  v_pk_fma_f32 v[112:113], v[192:193], v[40:41], v[112:113]
  v_pk_fma_f32 v[114:115], v[194:195], v[40:41], v[114:115]
  v_pk_fma_f32 v[116:117], v[196:197], v[40:41], v[116:117]
  v_pk_fma_f32 v[118:119], v[198:199], v[40:41], v[118:119]
  v_pk_fma_f32 v[120:121], v[200:201], v[40:41], v[120:121]
  v_pk_fma_f32 v[122:123], v[202:203], v[40:41], v[122:123]
  v_pk_fma_f32 v[124:125], v[204:205], v[40:41], v[124:125]
  v_pk_fma_f32 v[126:127], v[206:207], v[40:41], v[126:127]
  v_pk_fma_f32 v[128:129], v[208:209], v[40:41], v[128:129]
  v_pk_fma_f32 v[130:131], v[210:211], v[40:41], v[130:131]
  v_pk_fma_f32 v[132:133], v[212:213], v[40:41], v[132:133]
  v_pk_fma_f32 v[134:135], v[214:215], v[40:41], v[134:135]
  v_pk_fma_f32 v[136:137], v[216:217], v[40:41], v[136:137]
  v_pk_fma_f32 v[138:139], v[218:219], v[40:41], v[138:139]
  v_pk_fma_f32 v[140:141], v[220:221], v[40:41], v[140:141]
  v_pk_fma_f32 v[142:143], v[222:223], v[40:41], v[142:143]
  v_pk_mul_f32 v[64:65], v[64:65], v[42:43]
  v_pk_mul_f32 v[66:67], v[66:67], v[42:43]
  v_pk_mul_f32 v[68:69], v[68:69], v[42:43]
  v_pk_mul_f32 v[70:71], v[70:71], v[42:43]
  v_pk_mul_f32 v[72:73], v[72:73], v[42:43]
  v_pk_mul_f32 v[74:75], v[74:75], v[42:43]
  v_pk_mul_f32 v[76:77], v[76:77], v[42:43]
  v_pk_mul_f32 v[78:79], v[78:79], v[42:43]
  v_pk_mul_f32 v[80:81], v[80:81], v[42:43]
  v_pk_mul_f32 v[82:83], v[82:83], v[42:43]
  v_pk_mul_f32 v[84:85], v[84:85], v[42:43]
  v_pk_mul_f32 v[86:87], v[86:87], v[42:43]
  v_pk_mul_f32 v[88:89], v[88:89], v[42:43]
  v_pk_mul_f32 v[90:91], v[90:91], v[42:43]
  v_pk_mul_f32 v[92:93], v[92:93], v[42:43]
  v_pk_mul_f32 v[94:95], v[94:95], v[42:43]
  v_pk_mul_f32 v[96:97], v[96:97], v[42:43]
  v_pk_mul_f32 v[98:99], v[98:99], v[42:43]
  v_pk_mul_f32 v[100:101], v[100:101], v[42:43]
  v_pk_mul_f32 v[102:103], v[102:103], v[42:43]
  v_pk_mul_f32 v[104:105], v[104:105], v[42:43]
  v_pk_mul_f32 v[106:107], v[106:107], v[42:43]
  v_pk_mul_f32 v[108:109], v[108:109], v[42:43]
  v_pk_mul_f32 v[110:111], v[110:111], v[42:43]
  v_pk_mul_f32 v[112:113], v[112:113], v[42:43]
  v_pk_mul_f32 v[114:115], v[114:115], v[42:43]
  v_pk_mul_f32 v[116:117], v[116:117], v[42:43]
  v_pk_mul_f32 v[118:119], v[118:119], v[42:43]
  v_pk_mul_f32 v[120:121], v[120:121], v[42:43]
  v_pk_mul_f32 v[122:123], v[122:123], v[42:43]
  v_pk_mul_f32 v[124:125], v[124:125], v[42:43]
  v_pk_mul_f32 v[126:127], v[126:127], v[42:43]
  v_pk_mul_f32 v[128:129], v[128:129], v[42:43]
  v_pk_mul_f32 v[130:131], v[130:131], v[42:43]
  v_pk_mul_f32 v[132:133], v[132:133], v[42:43]
  v_pk_mul_f32 v[134:135], v[134:135], v[42:43]
  v_pk_mul_f32 v[136:137], v[136:137], v[42:43]
  v_pk_mul_f32 v[138:139], v[138:139], v[42:43]
  v_pk_mul_f32 v[140:141], v[140:141], v[42:43]
  v_pk_mul_f32 v[142:143], v[142:143], v[42:43]
  v_cvt_pk_bf16_f32 v144, v64, v65
  v_cvt_pk_bf16_f32 v145, v66, v67
  v_cvt_pk_bf16_f32 v146, v68, v69
  v_cvt_pk_bf16_f32 v147, v70, v71
  v_cvt_pk_bf16_f32 v148, v76, v77
  v_cvt_pk_bf16_f32 v149, v78, v79
  v_cvt_pk_bf16_f32 v150, v80, v81
  v_cvt_pk_bf16_f32 v151, v82, v83
  v_cvt_pk_bf16_f32 v152, v72, v73
  v_cvt_pk_bf16_f32 v153, v74, v75
  v_permlane32_swap_b32 v144, v146
  v_permlane32_swap_b32 v145, v147
  v_permlane32_swap_b32 v148, v150
  v_permlane32_swap_b32 v149, v151
  s_add_u32 s36, s35, 0
  buffer_store_dwordx4 v[144:147], v44, s[16:19], s36 offen sc1
  s_add_u32 s36, s35, 98304
  buffer_store_dwordx4 v[148:151], v44, s[16:19], s36 offen sc1
  s_add_u32 s36, s38, 0
  buffer_store_dwordx2 v[152:153], v46, s[16:19], s36 offen
  v_cvt_pk_bf16_f32 v156, v84, v85
  v_cvt_pk_bf16_f32 v157, v86, v87
  v_cvt_pk_bf16_f32 v158, v88, v89
  v_cvt_pk_bf16_f32 v159, v90, v91
  v_cvt_pk_bf16_f32 v160, v96, v97
  v_cvt_pk_bf16_f32 v161, v98, v99
  v_cvt_pk_bf16_f32 v162, v100, v101
  v_cvt_pk_bf16_f32 v163, v102, v103
  v_cvt_pk_bf16_f32 v164, v92, v93
  v_cvt_pk_bf16_f32 v165, v94, v95
  v_permlane32_swap_b32 v156, v158
  v_permlane32_swap_b32 v157, v159
  v_permlane32_swap_b32 v160, v162
  v_permlane32_swap_b32 v161, v163
  s_add_u32 s36, s35, 196608
  buffer_store_dwordx4 v[156:159], v44, s[16:19], s36 offen sc1
  s_add_u32 s36, s35, 294912
  buffer_store_dwordx4 v[160:163], v44, s[16:19], s36 offen sc1
  s_add_u32 s36, s38, 32768
  buffer_store_dwordx2 v[164:165], v46, s[16:19], s36 offen
  v_cvt_pk_bf16_f32 v168, v104, v105
  v_cvt_pk_bf16_f32 v169, v106, v107
  v_cvt_pk_bf16_f32 v170, v108, v109
  v_cvt_pk_bf16_f32 v171, v110, v111
  v_cvt_pk_bf16_f32 v172, v116, v117
  v_cvt_pk_bf16_f32 v173, v118, v119
  v_cvt_pk_bf16_f32 v174, v120, v121
  v_cvt_pk_bf16_f32 v175, v122, v123
  v_cvt_pk_bf16_f32 v176, v112, v113
  v_cvt_pk_bf16_f32 v177, v114, v115
  v_permlane32_swap_b32 v168, v170
  v_permlane32_swap_b32 v169, v171
  v_permlane32_swap_b32 v172, v174
  v_permlane32_swap_b32 v173, v175
  s_add_u32 s36, s35, 393216
  buffer_store_dwordx4 v[168:171], v44, s[16:19], s36 offen sc1
  s_add_u32 s36, s35, 491520
  buffer_store_dwordx4 v[172:175], v44, s[16:19], s36 offen sc1
  s_add_u32 s36, s38, 65536
  buffer_store_dwordx2 v[176:177], v46, s[16:19], s36 offen
  v_cvt_pk_bf16_f32 v180, v124, v125
  v_cvt_pk_bf16_f32 v181, v126, v127
  v_cvt_pk_bf16_f32 v182, v128, v129
  v_cvt_pk_bf16_f32 v183, v130, v131
  v_cvt_pk_bf16_f32 v184, v136, v137
  v_cvt_pk_bf16_f32 v185, v138, v139
  v_cvt_pk_bf16_f32 v186, v140, v141
  v_cvt_pk_bf16_f32 v187, v142, v143
  v_cvt_pk_bf16_f32 v188, v132, v133
  v_cvt_pk_bf16_f32 v189, v134, v135
  v_permlane32_swap_b32 v180, v182
  v_permlane32_swap_b32 v181, v183
  v_permlane32_swap_b32 v184, v186
  v_permlane32_swap_b32 v185, v187
  s_add_u32 s36, s35, 589824
  buffer_store_dwordx4 v[180:183], v44, s[16:19], s36 offen sc1
  s_add_u32 s36, s35, 688128
  buffer_store_dwordx4 v[184:187], v44, s[16:19], s36 offen sc1
  s_add_u32 s36, s38, 98304
  buffer_store_dwordx2 v[188:189], v46, s[16:19], s36 offen
  v_cmp_eq_u32 vcc, 1, v3
  v_mov_b32 v200, 0
  v_dot2_f32_bf16 v200, v144, v144, v200
  v_dot2_f32_bf16 v200, v145, v145, v200
  v_dot2_f32_bf16 v200, v146, v146, v200
  v_dot2_f32_bf16 v200, v147, v147, v200
  v_mov_b32 v201, 0
  v_dot2_f32_bf16 v201, v148, v148, v201
  v_dot2_f32_bf16 v201, v149, v149, v201
  v_dot2_f32_bf16 v201, v150, v150, v201
  v_dot2_f32_bf16 v201, v151, v151, v201
  v_mov_b32 v202, 0
  v_dot2_f32_bf16 v202, v152, v152, v202
  v_dot2_f32_bf16 v202, v153, v153, v202
  v_mov_b32 v203, v200
  s_nop 1
  v_permlane32_swap_b32 v200, v203
  v_add_f32 v200, v200, v203
  v_mov_b32 v203, v201
  s_nop 1
  v_permlane32_swap_b32 v201, v203
  v_add_f32 v201, v201, v203
  v_cndmask_b32 v192, v200, v201, vcc
  v_add_f32 v192, v192, v202
  v_mov_b32 v204, 0
  v_dot2_f32_bf16 v204, v156, v156, v204
  v_dot2_f32_bf16 v204, v157, v157, v204
  v_dot2_f32_bf16 v204, v158, v158, v204
  v_dot2_f32_bf16 v204, v159, v159, v204
  v_mov_b32 v205, 0
  v_dot2_f32_bf16 v205, v160, v160, v205
  v_dot2_f32_bf16 v205, v161, v161, v205
  v_dot2_f32_bf16 v205, v162, v162, v205
  v_dot2_f32_bf16 v205, v163, v163, v205
  v_mov_b32 v206, 0
  v_dot2_f32_bf16 v206, v164, v164, v206
  v_dot2_f32_bf16 v206, v165, v165, v206
  v_mov_b32 v207, v204
  s_nop 1
  v_permlane32_swap_b32 v204, v207
  v_add_f32 v204, v204, v207
  v_mov_b32 v207, v205
  s_nop 1
  v_permlane32_swap_b32 v205, v207
  v_add_f32 v205, v205, v207
  v_cndmask_b32 v193, v204, v205, vcc
  v_add_f32 v193, v193, v206
  v_mov_b32 v200, 0
  v_dot2_f32_bf16 v200, v168, v168, v200
  v_dot2_f32_bf16 v200, v169, v169, v200
  v_dot2_f32_bf16 v200, v170, v170, v200
  v_dot2_f32_bf16 v200, v171, v171, v200
  v_mov_b32 v201, 0
  v_dot2_f32_bf16 v201, v172, v172, v201
  v_dot2_f32_bf16 v201, v173, v173, v201
  v_dot2_f32_bf16 v201, v174, v174, v201
  v_dot2_f32_bf16 v201, v175, v175, v201
  v_mov_b32 v202, 0
  v_dot2_f32_bf16 v202, v176, v176, v202
  v_dot2_f32_bf16 v202, v177, v177, v202
  v_mov_b32 v203, v200
  s_nop 1
  v_permlane32_swap_b32 v200, v203
  v_add_f32 v200, v200, v203
  v_mov_b32 v203, v201
  s_nop 1
  v_permlane32_swap_b32 v201, v203
  v_add_f32 v201, v201, v203
  v_cndmask_b32 v194, v200, v201, vcc
  v_add_f32 v194, v194, v202
  v_mov_b32 v204, 0
  v_dot2_f32_bf16 v204, v180, v180, v204
  v_dot2_f32_bf16 v204, v181, v181, v204
  v_dot2_f32_bf16 v204, v182, v182, v204
  v_dot2_f32_bf16 v204, v183, v183, v204
  v_mov_b32 v205, 0
  v_dot2_f32_bf16 v205, v184, v184, v205
  v_dot2_f32_bf16 v205, v185, v185, v205
  v_dot2_f32_bf16 v205, v186, v186, v205
  v_dot2_f32_bf16 v205, v187, v187, v205
  v_mov_b32 v206, 0
  v_dot2_f32_bf16 v206, v188, v188, v206
  v_dot2_f32_bf16 v206, v189, v189, v206
  v_mov_b32 v207, v204
  s_nop 1
  v_permlane32_swap_b32 v204, v207
  v_add_f32 v204, v204, v207
  v_mov_b32 v207, v205
  s_nop 1
  v_permlane32_swap_b32 v205, v207
  v_add_f32 v205, v205, v207
  v_cndmask_b32 v195, v204, v205, vcc
  v_add_f32 v195, v195, v206
  v_lshlrev_b32 v11, 13, v3
  v_lshl_add_u32 v11, v2, 2, v11
  s_lshl_b32 s36, s33, 7
  s_lshl_b32 s37, s24, 16
  s_add_u32 s36, s36, s37
  s_add_u32 s36, s36, 30932992
  s_add_u32 s37, s36, 0
  buffer_store_dword v192, v11, s[16:19], s37 offen
  s_add_u32 s37, s36, 16384
  buffer_store_dword v193, v11, s[16:19], s37 offen
  s_add_u32 s37, s36, 32768
  buffer_store_dword v194, v11, s[16:19], s37 offen
  s_add_u32 s37, s36, 49152
  buffer_store_dword v195, v11, s[16:19], s37 offen
  s_branch g1_kernel_end1
g1_kernel_eK90:
  v_sub_f32 v40, 0, v8
  v_sub_f32 v41, 0, v8
  v_mul_f32 v42, 0x3f800000, v9
  v_mul_f32 v43, 0x3f800000, v9
  v_lshlrev_b32 v44, 4, v1
  s_mov_b32 s35, 98304
  v_mul_lo_u32 v45, v3, s35
  v_lshl_add_u32 v45, v2, 4, v45
  s_mul_i32 s35, s24, 786432
  s_mul_i32 s36, s33, 1536
  s_add_u32 s35, s35, s36
  s_add_u32 s35, s35, 3145728
  s_waitcnt lgkmcnt(0)
  v_pk_fma_f32 v[64:65], v[144:145], v[40:41], v[64:65]
  v_pk_fma_f32 v[66:67], v[146:147], v[40:41], v[66:67]
  v_pk_fma_f32 v[68:69], v[148:149], v[40:41], v[68:69]
  v_pk_fma_f32 v[70:71], v[150:151], v[40:41], v[70:71]
  v_pk_fma_f32 v[72:73], v[152:153], v[40:41], v[72:73]
  v_pk_fma_f32 v[74:75], v[154:155], v[40:41], v[74:75]
  v_pk_fma_f32 v[76:77], v[156:157], v[40:41], v[76:77]
  v_pk_fma_f32 v[78:79], v[158:159], v[40:41], v[78:79]
  v_pk_fma_f32 v[80:81], v[160:161], v[40:41], v[80:81]
  v_pk_fma_f32 v[82:83], v[162:163], v[40:41], v[82:83]
  v_pk_fma_f32 v[84:85], v[164:165], v[40:41], v[84:85]
  v_pk_fma_f32 v[86:87], v[166:167], v[40:41], v[86:87]
  v_pk_fma_f32 v[88:89], v[168:169], v[40:41], v[88:89]
  v_pk_fma_f32 v[90:91], v[170:171], v[40:41], v[90:91]
  v_pk_fma_f32 v[92:93], v[172:173], v[40:41], v[92:93]
  v_pk_fma_f32 v[94:95], v[174:175], v[40:41], v[94:95]
  v_pk_fma_f32 v[96:97], v[176:177], v[40:41], v[96:97]
  v_pk_fma_f32 v[98:99], v[178:179], v[40:41], v[98:99]
  v_pk_fma_f32 v[100:101], v[180:181], v[40:41], v[100:101]
  v_pk_fma_f32 v[102:103], v[182:183], v[40:41], v[102:103]
  v_pk_fma_f32 v[104:105], v[184:185], v[40:41], v[104:105]
  v_pk_fma_f32 v[106:107], v[186:187], v[40:41], v[106:107]
  v_pk_fma_f32 v[108:109], v[188:189], v[40:41], v[108:109]
  v_pk_fma_f32 v[110:111], v[190:191], v[40:41], v[110:111]
  v_pk_fma_f32 v[112:113], v[192:193], v[40:41], v[112:113]
  v_pk_fma_f32 v[114:115], v[194:195], v[40:41], v[114:115]
  v_pk_fma_f32 v[116:117], v[196:197], v[40:41], v[116:117]
  v_pk_fma_f32 v[118:119], v[198:199], v[40:41], v[118:119]
  v_pk_fma_f32 v[120:121], v[200:201], v[40:41], v[120:121]
  v_pk_fma_f32 v[122:123], v[202:203], v[40:41], v[122:123]
  v_pk_fma_f32 v[124:125], v[204:205], v[40:41], v[124:125]
  v_pk_fma_f32 v[126:127], v[206:207], v[40:41], v[126:127]
  v_pk_fma_f32 v[128:129], v[208:209], v[40:41], v[128:129]
  v_pk_fma_f32 v[130:131], v[210:211], v[40:41], v[130:131]
  v_pk_fma_f32 v[132:133], v[212:213], v[40:41], v[132:133]
  v_pk_fma_f32 v[134:135], v[214:215], v[40:41], v[134:135]
  v_pk_fma_f32 v[136:137], v[216:217], v[40:41], v[136:137]
  v_pk_fma_f32 v[138:139], v[218:219], v[40:41], v[138:139]
  v_pk_fma_f32 v[140:141], v[220:221], v[40:41], v[140:141]
  v_pk_fma_f32 v[142:143], v[222:223], v[40:41], v[142:143]
  v_pk_mul_f32 v[64:65], v[64:65], v[42:43]
  v_pk_mul_f32 v[66:67], v[66:67], v[42:43]
  v_pk_mul_f32 v[68:69], v[68:69], v[42:43]
  v_pk_mul_f32 v[70:71], v[70:71], v[42:43]
  v_pk_mul_f32 v[72:73], v[72:73], v[42:43]
  v_pk_mul_f32 v[74:75], v[74:75], v[42:43]
  v_pk_mul_f32 v[76:77], v[76:77], v[42:43]
  v_pk_mul_f32 v[78:79], v[78:79], v[42:43]
  v_pk_mul_f32 v[80:81], v[80:81], v[42:43]
  v_pk_mul_f32 v[82:83], v[82:83], v[42:43]
  v_pk_mul_f32 v[84:85], v[84:85], v[42:43]
  v_pk_mul_f32 v[86:87], v[86:87], v[42:43]
  v_pk_mul_f32 v[88:89], v[88:89], v[42:43]
  v_pk_mul_f32 v[90:91], v[90:91], v[42:43]
  v_pk_mul_f32 v[92:93], v[92:93], v[42:43]
  v_pk_mul_f32 v[94:95], v[94:95], v[42:43]
  v_pk_mul_f32 v[96:97], v[96:97], v[42:43]
  v_pk_mul_f32 v[98:99], v[98:99], v[42:43]
  v_pk_mul_f32 v[100:101], v[100:101], v[42:43]
  v_pk_mul_f32 v[102:103], v[102:103], v[42:43]
  v_pk_mul_f32 v[104:105], v[104:105], v[42:43]
  v_pk_mul_f32 v[106:107], v[106:107], v[42:43]
  v_pk_mul_f32 v[108:109], v[108:109], v[42:43]
  v_pk_mul_f32 v[110:111], v[110:111], v[42:43]
  v_pk_mul_f32 v[112:113], v[112:113], v[42:43]
  v_pk_mul_f32 v[114:115], v[114:115], v[42:43]
  v_pk_mul_f32 v[116:117], v[116:117], v[42:43]
  v_pk_mul_f32 v[118:119], v[118:119], v[42:43]
  v_pk_mul_f32 v[120:121], v[120:121], v[42:43]
  v_pk_mul_f32 v[122:123], v[122:123], v[42:43]
  v_pk_mul_f32 v[124:125], v[124:125], v[42:43]
  v_pk_mul_f32 v[126:127], v[126:127], v[42:43]
  v_pk_mul_f32 v[128:129], v[128:129], v[42:43]
  v_pk_mul_f32 v[130:131], v[130:131], v[42:43]
  v_pk_mul_f32 v[132:133], v[132:133], v[42:43]
  v_pk_mul_f32 v[134:135], v[134:135], v[42:43]
  v_pk_mul_f32 v[136:137], v[136:137], v[42:43]
  v_pk_mul_f32 v[138:139], v[138:139], v[42:43]
  v_pk_mul_f32 v[140:141], v[140:141], v[42:43]
  v_pk_mul_f32 v[142:143], v[142:143], v[42:43]
  v_cvt_pk_bf16_f32 v144, v64, v65
  v_cvt_pk_bf16_f32 v145, v66, v67
  v_cvt_pk_bf16_f32 v146, v68, v69
  v_cvt_pk_bf16_f32 v147, v70, v71
  v_cvt_pk_bf16_f32 v148, v76, v77
  v_cvt_pk_bf16_f32 v149, v78, v79
  v_cvt_pk_bf16_f32 v150, v80, v81
  v_cvt_pk_bf16_f32 v151, v82, v83
  v_cvt_pk_bf16_f32 v152, v72, v73
  v_cvt_pk_bf16_f32 v153, v74, v75
  v_permlane32_swap_b32 v144, v146
  v_permlane32_swap_b32 v145, v147
  v_permlane32_swap_b32 v148, v150
  v_permlane32_swap_b32 v149, v151
  s_add_u32 s36, s35, 0
  buffer_store_dwordx4 v[144:147], v44, s[16:19], s36 offen sc1
  s_add_u32 s36, s35, 98304
  buffer_store_dwordx4 v[148:151], v44, s[16:19], s36 offen sc1
  v_mov_b32 v154, 0x3f803f80
  v_mov_b32 v155, 0
  s_add_u32 s36, s35, 1024
  buffer_store_dwordx4 v[152:155], v45, s[16:19], s36 offen sc1
  v_cvt_pk_bf16_f32 v156, v84, v85
  v_cvt_pk_bf16_f32 v157, v86, v87
  v_cvt_pk_bf16_f32 v158, v88, v89
  v_cvt_pk_bf16_f32 v159, v90, v91
  v_cvt_pk_bf16_f32 v160, v96, v97
  v_cvt_pk_bf16_f32 v161, v98, v99
  v_cvt_pk_bf16_f32 v162, v100, v101
  v_cvt_pk_bf16_f32 v163, v102, v103
  v_cvt_pk_bf16_f32 v164, v92, v93
  v_cvt_pk_bf16_f32 v165, v94, v95
  v_permlane32_swap_b32 v156, v158
  v_permlane32_swap_b32 v157, v159
  v_permlane32_swap_b32 v160, v162
  v_permlane32_swap_b32 v161, v163
  s_add_u32 s36, s35, 196608
  buffer_store_dwordx4 v[156:159], v44, s[16:19], s36 offen sc1
  s_add_u32 s36, s35, 294912
  buffer_store_dwordx4 v[160:163], v44, s[16:19], s36 offen sc1
  v_mov_b32 v166, 0x3f803f80
  v_mov_b32 v167, 0
  s_add_u32 s36, s35, 197632
  buffer_store_dwordx4 v[164:167], v45, s[16:19], s36 offen sc1
  v_cvt_pk_bf16_f32 v168, v104, v105
  v_cvt_pk_bf16_f32 v169, v106, v107
  v_cvt_pk_bf16_f32 v170, v108, v109
  v_cvt_pk_bf16_f32 v171, v110, v111
  v_cvt_pk_bf16_f32 v172, v116, v117
  v_cvt_pk_bf16_f32 v173, v118, v119
  v_cvt_pk_bf16_f32 v174, v120, v121
  v_cvt_pk_bf16_f32 v175, v122, v123
  v_cvt_pk_bf16_f32 v176, v112, v113
  v_cvt_pk_bf16_f32 v177, v114, v115
  v_permlane32_swap_b32 v168, v170
  v_permlane32_swap_b32 v169, v171
  v_permlane32_swap_b32 v172, v174
  v_permlane32_swap_b32 v173, v175
  s_add_u32 s36, s35, 393216
  buffer_store_dwordx4 v[168:171], v44, s[16:19], s36 offen sc1
  s_add_u32 s36, s35, 491520
  buffer_store_dwordx4 v[172:175], v44, s[16:19], s36 offen sc1
  v_mov_b32 v178, 0x3f803f80
  v_mov_b32 v179, 0
  s_add_u32 s36, s35, 394240
  buffer_store_dwordx4 v[176:179], v45, s[16:19], s36 offen sc1
  v_cvt_pk_bf16_f32 v180, v124, v125
  v_cvt_pk_bf16_f32 v181, v126, v127
  v_cvt_pk_bf16_f32 v182, v128, v129
  v_cvt_pk_bf16_f32 v183, v130, v131
  v_cvt_pk_bf16_f32 v184, v136, v137
  v_cvt_pk_bf16_f32 v185, v138, v139
  v_cvt_pk_bf16_f32 v186, v140, v141
  v_cvt_pk_bf16_f32 v187, v142, v143
  v_cvt_pk_bf16_f32 v188, v132, v133
  v_cvt_pk_bf16_f32 v189, v134, v135
  v_permlane32_swap_b32 v180, v182
  v_permlane32_swap_b32 v181, v183
  v_permlane32_swap_b32 v184, v186
  v_permlane32_swap_b32 v185, v187
  s_add_u32 s36, s35, 589824
  buffer_store_dwordx4 v[180:183], v44, s[16:19], s36 offen sc1
  s_add_u32 s36, s35, 688128
  buffer_store_dwordx4 v[184:187], v44, s[16:19], s36 offen sc1
  v_mov_b32 v190, 0x3f803f80
  v_mov_b32 v191, 0
  s_add_u32 s36, s35, 590848
  buffer_store_dwordx4 v[188:191], v45, s[16:19], s36 offen sc1
  v_cmp_eq_u32 vcc, 1, v3
  v_mov_b32 v200, 0
  v_dot2_f32_bf16 v200, v144, v144, v200
  v_dot2_f32_bf16 v200, v145, v145, v200
  v_dot2_f32_bf16 v200, v146, v146, v200
  v_dot2_f32_bf16 v200, v147, v147, v200
  v_mov_b32 v201, 0
  v_dot2_f32_bf16 v201, v148, v148, v201
  v_dot2_f32_bf16 v201, v149, v149, v201
  v_dot2_f32_bf16 v201, v150, v150, v201
  v_dot2_f32_bf16 v201, v151, v151, v201
  v_mov_b32 v202, 0
  v_dot2_f32_bf16 v202, v152, v152, v202
  v_dot2_f32_bf16 v202, v153, v153, v202
  v_mov_b32 v203, v200
  s_nop 1
  v_permlane32_swap_b32 v200, v203
  v_add_f32 v200, v200, v203
  v_mov_b32 v203, v201
  s_nop 1
  v_permlane32_swap_b32 v201, v203
  v_add_f32 v201, v201, v203
  v_cndmask_b32 v192, v200, v201, vcc
  v_add_f32 v192, v192, v202
  v_mov_b32 v204, 0
  v_dot2_f32_bf16 v204, v156, v156, v204
  v_dot2_f32_bf16 v204, v157, v157, v204
  v_dot2_f32_bf16 v204, v158, v158, v204
  v_dot2_f32_bf16 v204, v159, v159, v204
  v_mov_b32 v205, 0
  v_dot2_f32_bf16 v205, v160, v160, v205
  v_dot2_f32_bf16 v205, v161, v161, v205
  v_dot2_f32_bf16 v205, v162, v162, v205
  v_dot2_f32_bf16 v205, v163, v163, v205
  v_mov_b32 v206, 0
  v_dot2_f32_bf16 v206, v164, v164, v206
  v_dot2_f32_bf16 v206, v165, v165, v206
  v_mov_b32 v207, v204
  s_nop 1
  v_permlane32_swap_b32 v204, v207
  v_add_f32 v204, v204, v207
  v_mov_b32 v207, v205
  s_nop 1
  v_permlane32_swap_b32 v205, v207
  v_add_f32 v205, v205, v207
  v_cndmask_b32 v193, v204, v205, vcc
  v_add_f32 v193, v193, v206
  v_mov_b32 v200, 0
  v_dot2_f32_bf16 v200, v168, v168, v200
  v_dot2_f32_bf16 v200, v169, v169, v200
  v_dot2_f32_bf16 v200, v170, v170, v200
  v_dot2_f32_bf16 v200, v171, v171, v200
  v_mov_b32 v201, 0
  v_dot2_f32_bf16 v201, v172, v172, v201
  v_dot2_f32_bf16 v201, v173, v173, v201
  v_dot2_f32_bf16 v201, v174, v174, v201
  v_dot2_f32_bf16 v201, v175, v175, v201
  v_mov_b32 v202, 0
  v_dot2_f32_bf16 v202, v176, v176, v202
  v_dot2_f32_bf16 v202, v177, v177, v202
  v_mov_b32 v203, v200
  s_nop 1
  v_permlane32_swap_b32 v200, v203
  v_add_f32 v200, v200, v203
  v_mov_b32 v203, v201
  s_nop 1
  v_permlane32_swap_b32 v201, v203
  v_add_f32 v201, v201, v203
  v_cndmask_b32 v194, v200, v201, vcc
  v_add_f32 v194, v194, v202
  v_mov_b32 v204, 0
  v_dot2_f32_bf16 v204, v180, v180, v204
  v_dot2_f32_bf16 v204, v181, v181, v204
  v_dot2_f32_bf16 v204, v182, v182, v204
  v_dot2_f32_bf16 v204, v183, v183, v204
  v_mov_b32 v205, 0
  v_dot2_f32_bf16 v205, v184, v184, v205
  v_dot2_f32_bf16 v205, v185, v185, v205
  v_dot2_f32_bf16 v205, v186, v186, v205
  v_dot2_f32_bf16 v205, v187, v187, v205
  v_mov_b32 v206, 0
  v_dot2_f32_bf16 v206, v188, v188, v206
  v_dot2_f32_bf16 v206, v189, v189, v206
  v_mov_b32 v207, v204
  s_nop 1
  v_permlane32_swap_b32 v204, v207
  v_add_f32 v204, v204, v207
  v_mov_b32 v207, v205
  s_nop 1
  v_permlane32_swap_b32 v205, v207
  v_add_f32 v205, v205, v207
  v_cndmask_b32 v195, v204, v205, vcc
  v_add_f32 v195, v195, v206
  v_max_f32_dpp v192, v192, v192 quad_perm:[1,0,3,2] row_mask:0xf bank_mask:0xf
  v_max_f32_dpp v193, v193, v193 quad_perm:[1,0,3,2] row_mask:0xf bank_mask:0xf
  v_max_f32_dpp v194, v194, v194 quad_perm:[1,0,3,2] row_mask:0xf bank_mask:0xf
  v_max_f32_dpp v195, v195, v195 quad_perm:[1,0,3,2] row_mask:0xf bank_mask:0xf
  v_max_f32_dpp v192, v192, v192 quad_perm:[2,3,0,1] row_mask:0xf bank_mask:0xf
  v_max_f32_dpp v193, v193, v193 quad_perm:[2,3,0,1] row_mask:0xf bank_mask:0xf
  v_max_f32_dpp v194, v194, v194 quad_perm:[2,3,0,1] row_mask:0xf bank_mask:0xf
  v_max_f32_dpp v195, v195, v195 quad_perm:[2,3,0,1] row_mask:0xf bank_mask:0xf
  v_max_f32_dpp v192, v192, v192 row_half_mirror row_mask:0xf bank_mask:0xf
  v_max_f32_dpp v193, v193, v193 row_half_mirror row_mask:0xf bank_mask:0xf
  v_max_f32_dpp v194, v194, v194 row_half_mirror row_mask:0xf bank_mask:0xf
  v_max_f32_dpp v195, v195, v195 row_half_mirror row_mask:0xf bank_mask:0xf
  v_max_f32_dpp v192, v192, v192 row_mirror row_mask:0xf bank_mask:0xf
  v_max_f32_dpp v193, v193, v193 row_mirror row_mask:0xf bank_mask:0xf
  v_max_f32_dpp v194, v194, v194 row_mirror row_mask:0xf bank_mask:0xf
  v_max_f32_dpp v195, v195, v195 row_mirror row_mask:0xf bank_mask:0xf
  v_mov_b32 v200, v192
  s_nop 1
  v_permlane16_swap_b32 v192, v200
  v_max_f32 v192, v192, v200
  v_mov_b32 v201, v193
  s_nop 1
  v_permlane16_swap_b32 v193, v201
  v_max_f32 v193, v193, v201
  v_mov_b32 v202, v194
  s_nop 1
  v_permlane16_swap_b32 v194, v202
  v_max_f32 v194, v194, v202
  v_mov_b32 v203, v195
  s_nop 1
  v_permlane16_swap_b32 v195, v203
  v_max_f32 v195, v195, v203
  s_lshl_b32 s36, s24, 11
  s_lshl_b32 s37, s33, 2
  s_add_u32 s36, s36, s37
  s_add_u32 s36, s36, 14155776
  v_lshlrev_b32 v11, 8, v3
  s_mov_b32 exec_lo, 1
  s_mov_b32 exec_hi, 1
  buffer_store_dword v192, v11, s[16:19], s36 offen offset:0
  buffer_store_dword v193, v11, s[16:19], s36 offen offset:512
  buffer_store_dword v194, v11, s[16:19], s36 offen offset:1024
  buffer_store_dword v195, v11, s[16:19], s36 offen offset:1536
  s_branch g1_kernel_end1
g1_kernel_eH92:
  v_mul_f32 v12, v9, v9
  v_mul_f32 v12, v12, v10
  v_add_f32 v12, 0x3727c5ac, v12
  v_rsq_f32 v12, v12
  s_lshl_b32 s35, s33, 5
  v_add_u32 v11, s35, v2
  s_and_b32 s36, s24, 1
  s_lshr_b32 s37, s24, 1
  s_add_u32 s37, s37, 1
  s_sub_u32 s38, 0, s37
  s_cmp_eq_u32 s36, 0
  s_cselect_b32 s37, s37, s38
  s_mov_b32 s37, 0
  v_add_u32 v11, s37, v11
  v_mul_f32 v9, v9, v12
  v_cmp_gt_u32 vcc, 2048, v11
  s_nop 1
  v_cndmask_b32 v9, 0, v9, vcc
  v_and_b32 v11, 2047, v11
  v_lshrrev_b32 v12, 4, v11
  v_mul_u32_u24 v12, 20480, v12
  v_and_b32 v11, 15, v11
  v_lshlrev_b32 v11, 4, v11
  v_lshlrev_b32 v13, 8, v3
  v_add3_u32 v11, v11, v12, v13
  s_mul_i32 s35, s24, 5120
  s_add_u32 s35, s35, 8912896
  s_add_u32 s36, s35, 4096
  v_mov_b32 v44, 0xc0135761
  v_mov_b32 v45, 0xc0135761
  v_mov_b32 v46, 0xbdd2d3e8
  v_mov_b32 v47, 0xbdd2d3e8
  v_mov_b32 v48, 1.0
  v_mov_b32 v49, 1.0
  v_sub_f32 v40, 0, v8
  v_sub_f32 v41, 0, v8
  v_mul_f32 v42, 0x3f800000, v9
  v_mul_f32 v43, 0x3f800000, v9
  s_waitcnt lgkmcnt(0)
  v_pk_fma_f32 v[64:65], v[144:145], v[40:41], v[64:65]
  v_pk_fma_f32 v[66:67], v[146:147], v[40:41], v[66:67]
  v_pk_fma_f32 v[68:69], v[148:149], v[40:41], v[68:69]
  v_pk_fma_f32 v[70:71], v[150:151], v[40:41], v[70:71]
  v_pk_fma_f32 v[72:73], v[152:153], v[40:41], v[72:73]
  v_pk_fma_f32 v[74:75], v[154:155], v[40:41], v[74:75]
  v_pk_fma_f32 v[76:77], v[156:157], v[40:41], v[76:77]
  v_pk_fma_f32 v[78:79], v[158:159], v[40:41], v[78:79]
  v_pk_fma_f32 v[80:81], v[160:161], v[40:41], v[80:81]
  v_pk_fma_f32 v[82:83], v[162:163], v[40:41], v[82:83]
  v_pk_fma_f32 v[84:85], v[164:165], v[40:41], v[84:85]
  v_pk_fma_f32 v[86:87], v[166:167], v[40:41], v[86:87]
  v_pk_fma_f32 v[88:89], v[168:169], v[40:41], v[88:89]
  v_pk_fma_f32 v[90:91], v[170:171], v[40:41], v[90:91]
  v_pk_fma_f32 v[92:93], v[172:173], v[40:41], v[92:93]
  v_pk_fma_f32 v[94:95], v[174:175], v[40:41], v[94:95]
  v_pk_fma_f32 v[96:97], v[176:177], v[40:41], v[96:97]
  v_pk_fma_f32 v[98:99], v[178:179], v[40:41], v[98:99]
  v_pk_fma_f32 v[100:101], v[180:181], v[40:41], v[100:101]
  v_pk_fma_f32 v[102:103], v[182:183], v[40:41], v[102:103]
  v_pk_fma_f32 v[104:105], v[184:185], v[40:41], v[104:105]
  v_pk_fma_f32 v[106:107], v[186:187], v[40:41], v[106:107]
  v_pk_fma_f32 v[108:109], v[188:189], v[40:41], v[108:109]
  v_pk_fma_f32 v[110:111], v[190:191], v[40:41], v[110:111]
  v_pk_fma_f32 v[112:113], v[192:193], v[40:41], v[112:113]
  v_pk_fma_f32 v[114:115], v[194:195], v[40:41], v[114:115]
  v_pk_fma_f32 v[116:117], v[196:197], v[40:41], v[116:117]
  v_pk_fma_f32 v[118:119], v[198:199], v[40:41], v[118:119]
  v_pk_fma_f32 v[120:121], v[200:201], v[40:41], v[120:121]
  v_pk_fma_f32 v[122:123], v[202:203], v[40:41], v[122:123]
  v_pk_fma_f32 v[124:125], v[204:205], v[40:41], v[124:125]
  v_pk_fma_f32 v[126:127], v[206:207], v[40:41], v[126:127]
  v_pk_fma_f32 v[128:129], v[208:209], v[40:41], v[128:129]
  v_pk_fma_f32 v[130:131], v[210:211], v[40:41], v[130:131]
  v_pk_fma_f32 v[132:133], v[212:213], v[40:41], v[132:133]
  v_pk_fma_f32 v[134:135], v[214:215], v[40:41], v[134:135]
  v_pk_fma_f32 v[136:137], v[216:217], v[40:41], v[136:137]
  v_pk_fma_f32 v[138:139], v[218:219], v[40:41], v[138:139]
  v_pk_fma_f32 v[140:141], v[220:221], v[40:41], v[140:141]
  v_pk_fma_f32 v[142:143], v[222:223], v[40:41], v[142:143]
  v_pk_mul_f32 v[64:65], v[64:65], v[42:43]
  v_pk_mul_f32 v[66:67], v[66:67], v[42:43]
  v_pk_mul_f32 v[68:69], v[68:69], v[42:43]
  v_pk_mul_f32 v[70:71], v[70:71], v[42:43]
  v_pk_mul_f32 v[72:73], v[72:73], v[42:43]
  v_pk_mul_f32 v[74:75], v[74:75], v[42:43]
  v_pk_mul_f32 v[76:77], v[76:77], v[42:43]
  v_pk_mul_f32 v[78:79], v[78:79], v[42:43]
  v_pk_mul_f32 v[80:81], v[80:81], v[42:43]
  v_pk_mul_f32 v[82:83], v[82:83], v[42:43]
  v_pk_mul_f32 v[84:85], v[84:85], v[42:43]
  v_pk_mul_f32 v[86:87], v[86:87], v[42:43]
  v_pk_mul_f32 v[88:89], v[88:89], v[42:43]
  v_pk_mul_f32 v[90:91], v[90:91], v[42:43]
  v_pk_mul_f32 v[92:93], v[92:93], v[42:43]
  v_pk_mul_f32 v[94:95], v[94:95], v[42:43]
  v_pk_mul_f32 v[96:97], v[96:97], v[42:43]
  v_pk_mul_f32 v[98:99], v[98:99], v[42:43]
  v_pk_mul_f32 v[100:101], v[100:101], v[42:43]
  v_pk_mul_f32 v[102:103], v[102:103], v[42:43]
  v_pk_mul_f32 v[104:105], v[104:105], v[42:43]
  v_pk_mul_f32 v[106:107], v[106:107], v[42:43]
  v_pk_mul_f32 v[108:109], v[108:109], v[42:43]
  v_pk_mul_f32 v[110:111], v[110:111], v[42:43]
  v_pk_mul_f32 v[112:113], v[112:113], v[42:43]
  v_pk_mul_f32 v[114:115], v[114:115], v[42:43]
  v_pk_mul_f32 v[116:117], v[116:117], v[42:43]
  v_pk_mul_f32 v[118:119], v[118:119], v[42:43]
  v_pk_mul_f32 v[120:121], v[120:121], v[42:43]
  v_pk_mul_f32 v[122:123], v[122:123], v[42:43]
  v_pk_mul_f32 v[124:125], v[124:125], v[42:43]
  v_pk_mul_f32 v[126:127], v[126:127], v[42:43]
  v_pk_mul_f32 v[128:129], v[128:129], v[42:43]
  v_pk_mul_f32 v[130:131], v[130:131], v[42:43]
  v_pk_mul_f32 v[132:133], v[132:133], v[42:43]
  v_pk_mul_f32 v[134:135], v[134:135], v[42:43]
  v_pk_mul_f32 v[136:137], v[136:137], v[42:43]
  v_pk_mul_f32 v[138:139], v[138:139], v[42:43]
  v_pk_mul_f32 v[140:141], v[140:141], v[42:43]
  v_pk_mul_f32 v[142:143], v[142:143], v[42:43]
  v_pk_mul_f32 v[144:145], v[64:65], v[64:65]
  v_pk_fma_f32 v[144:145], v[144:145], v[46:47], v[44:45]
  v_pk_mul_f32 v[144:145], v[144:145], v[64:65]
  v_exp_f32 v146, v144
  v_exp_f32 v147, v145
  s_nop 0
  v_pk_add_f32 v[146:147], v[146:147], v[48:49]
  v_rcp_f32 v146, v146
  v_rcp_f32 v147, v147
  s_nop 0
  v_pk_mul_f32 v[64:65], v[64:65], v[146:147]
  v_pk_mul_f32 v[148:149], v[66:67], v[66:67]
  v_pk_fma_f32 v[148:149], v[148:149], v[46:47], v[44:45]
  v_pk_mul_f32 v[148:149], v[148:149], v[66:67]
  v_exp_f32 v150, v148
  v_exp_f32 v151, v149
  s_nop 0
  v_pk_add_f32 v[150:151], v[150:151], v[48:49]
  v_rcp_f32 v150, v150
  v_rcp_f32 v151, v151
  s_nop 0
  v_pk_mul_f32 v[66:67], v[66:67], v[150:151]
  v_cvt_pk_bf16_f32 v184, v64, v65
  v_cvt_pk_bf16_f32 v185, v66, v67
  v_pk_mul_f32 v[152:153], v[68:69], v[68:69]
  v_pk_fma_f32 v[152:153], v[152:153], v[46:47], v[44:45]
  v_pk_mul_f32 v[152:153], v[152:153], v[68:69]
  v_exp_f32 v154, v152
  v_exp_f32 v155, v153
  s_nop 0
  v_pk_add_f32 v[154:155], v[154:155], v[48:49]
  v_rcp_f32 v154, v154
  v_rcp_f32 v155, v155
  s_nop 0
  v_pk_mul_f32 v[68:69], v[68:69], v[154:155]
  v_pk_mul_f32 v[156:157], v[70:71], v[70:71]
  v_pk_fma_f32 v[156:157], v[156:157], v[46:47], v[44:45]
  v_pk_mul_f32 v[156:157], v[156:157], v[70:71]
  v_exp_f32 v158, v156
  v_exp_f32 v159, v157
  s_nop 0
  v_pk_add_f32 v[158:159], v[158:159], v[48:49]
  v_rcp_f32 v158, v158
  v_rcp_f32 v159, v159
  s_nop 0
  v_pk_mul_f32 v[70:71], v[70:71], v[158:159]
  v_cvt_pk_bf16_f32 v186, v68, v69
  v_cvt_pk_bf16_f32 v187, v70, v71
  buffer_store_dwordx4 v[184:187], v11, s[16:19], s35 offen offset:0 sc1
  v_pk_mul_f32 v[160:161], v[72:73], v[72:73]
  v_pk_fma_f32 v[160:161], v[160:161], v[46:47], v[44:45]
  v_pk_mul_f32 v[160:161], v[160:161], v[72:73]
  v_exp_f32 v162, v160
  v_exp_f32 v163, v161
  s_nop 0
  v_pk_add_f32 v[162:163], v[162:163], v[48:49]
  v_rcp_f32 v162, v162
  v_rcp_f32 v163, v163
  s_nop 0
  v_pk_mul_f32 v[72:73], v[72:73], v[162:163]
  v_pk_mul_f32 v[164:165], v[74:75], v[74:75]
  v_pk_fma_f32 v[164:165], v[164:165], v[46:47], v[44:45]
  v_pk_mul_f32 v[164:165], v[164:165], v[74:75]
  v_exp_f32 v166, v164
  v_exp_f32 v167, v165
  s_nop 0
  v_pk_add_f32 v[166:167], v[166:167], v[48:49]
  v_rcp_f32 v166, v166
  v_rcp_f32 v167, v167
  s_nop 0
  v_pk_mul_f32 v[74:75], v[74:75], v[166:167]
  v_cvt_pk_bf16_f32 v188, v72, v73
  v_cvt_pk_bf16_f32 v189, v74, v75
  v_pk_mul_f32 v[168:169], v[76:77], v[76:77]
  v_pk_fma_f32 v[168:169], v[168:169], v[46:47], v[44:45]
  v_pk_mul_f32 v[168:169], v[168:169], v[76:77]
  v_exp_f32 v170, v168
  v_exp_f32 v171, v169
  s_nop 0
  v_pk_add_f32 v[170:171], v[170:171], v[48:49]
  v_rcp_f32 v170, v170
  v_rcp_f32 v171, v171
  s_nop 0
  v_pk_mul_f32 v[76:77], v[76:77], v[170:171]
  v_pk_mul_f32 v[172:173], v[78:79], v[78:79]
  v_pk_fma_f32 v[172:173], v[172:173], v[46:47], v[44:45]
  v_pk_mul_f32 v[172:173], v[172:173], v[78:79]
  v_exp_f32 v174, v172
  v_exp_f32 v175, v173
  s_nop 0
  v_pk_add_f32 v[174:175], v[174:175], v[48:49]
  v_rcp_f32 v174, v174
  v_rcp_f32 v175, v175
  s_nop 0
  v_pk_mul_f32 v[78:79], v[78:79], v[174:175]
  v_cvt_pk_bf16_f32 v190, v76, v77
  v_cvt_pk_bf16_f32 v191, v78, v79
  buffer_store_dwordx4 v[188:191], v11, s[16:19], s35 offen offset:512 sc1
  v_pk_mul_f32 v[144:145], v[80:81], v[80:81]
  v_pk_fma_f32 v[144:145], v[144:145], v[46:47], v[44:45]
  v_pk_mul_f32 v[144:145], v[144:145], v[80:81]
  v_exp_f32 v146, v144
  v_exp_f32 v147, v145
  s_nop 0
  v_pk_add_f32 v[146:147], v[146:147], v[48:49]
  v_rcp_f32 v146, v146
  v_rcp_f32 v147, v147
  s_nop 0
  v_pk_mul_f32 v[80:81], v[80:81], v[146:147]
  v_pk_mul_f32 v[148:149], v[82:83], v[82:83]
  v_pk_fma_f32 v[148:149], v[148:149], v[46:47], v[44:45]
  v_pk_mul_f32 v[148:149], v[148:149], v[82:83]
  v_exp_f32 v150, v148
  v_exp_f32 v151, v149
  s_nop 0
  v_pk_add_f32 v[150:151], v[150:151], v[48:49]
  v_rcp_f32 v150, v150
  v_rcp_f32 v151, v151
  s_nop 0
  v_pk_mul_f32 v[82:83], v[82:83], v[150:151]
  v_cvt_pk_bf16_f32 v192, v80, v81
  v_cvt_pk_bf16_f32 v193, v82, v83
  v_pk_mul_f32 v[152:153], v[84:85], v[84:85]
  v_pk_fma_f32 v[152:153], v[152:153], v[46:47], v[44:45]
  v_pk_mul_f32 v[152:153], v[152:153], v[84:85]
  v_exp_f32 v154, v152
  v_exp_f32 v155, v153
  s_nop 0
  v_pk_add_f32 v[154:155], v[154:155], v[48:49]
  v_rcp_f32 v154, v154
  v_rcp_f32 v155, v155
  s_nop 0
  v_pk_mul_f32 v[84:85], v[84:85], v[154:155]
  v_pk_mul_f32 v[156:157], v[86:87], v[86:87]
  v_pk_fma_f32 v[156:157], v[156:157], v[46:47], v[44:45]
  v_pk_mul_f32 v[156:157], v[156:157], v[86:87]
  v_exp_f32 v158, v156
  v_exp_f32 v159, v157
  s_nop 0
  v_pk_add_f32 v[158:159], v[158:159], v[48:49]
  v_rcp_f32 v158, v158
  v_rcp_f32 v159, v159
  s_nop 0
  v_pk_mul_f32 v[86:87], v[86:87], v[158:159]
  v_cvt_pk_bf16_f32 v194, v84, v85
  v_cvt_pk_bf16_f32 v195, v86, v87
  buffer_store_dwordx4 v[192:195], v11, s[16:19], s35 offen offset:1024 sc1
  v_pk_mul_f32 v[160:161], v[88:89], v[88:89]
  v_pk_fma_f32 v[160:161], v[160:161], v[46:47], v[44:45]
  v_pk_mul_f32 v[160:161], v[160:161], v[88:89]
  v_exp_f32 v162, v160
  v_exp_f32 v163, v161
  s_nop 0
  v_pk_add_f32 v[162:163], v[162:163], v[48:49]
  v_rcp_f32 v162, v162
  v_rcp_f32 v163, v163
  s_nop 0
  v_pk_mul_f32 v[88:89], v[88:89], v[162:163]
  v_pk_mul_f32 v[164:165], v[90:91], v[90:91]
  v_pk_fma_f32 v[164:165], v[164:165], v[46:47], v[44:45]
  v_pk_mul_f32 v[164:165], v[164:165], v[90:91]
  v_exp_f32 v166, v164
  v_exp_f32 v167, v165
  s_nop 0
  v_pk_add_f32 v[166:167], v[166:167], v[48:49]
  v_rcp_f32 v166, v166
  v_rcp_f32 v167, v167
  s_nop 0
  v_pk_mul_f32 v[90:91], v[90:91], v[166:167]
  v_cvt_pk_bf16_f32 v196, v88, v89
  v_cvt_pk_bf16_f32 v197, v90, v91
  v_pk_mul_f32 v[168:169], v[92:93], v[92:93]
  v_pk_fma_f32 v[168:169], v[168:169], v[46:47], v[44:45]
  v_pk_mul_f32 v[168:169], v[168:169], v[92:93]
  v_exp_f32 v170, v168
  v_exp_f32 v171, v169
  s_nop 0
  v_pk_add_f32 v[170:171], v[170:171], v[48:49]
  v_rcp_f32 v170, v170
  v_rcp_f32 v171, v171
  s_nop 0
  v_pk_mul_f32 v[92:93], v[92:93], v[170:171]
  v_pk_mul_f32 v[172:173], v[94:95], v[94:95]
  v_pk_fma_f32 v[172:173], v[172:173], v[46:47], v[44:45]
  v_pk_mul_f32 v[172:173], v[172:173], v[94:95]
  v_exp_f32 v174, v172
  v_exp_f32 v175, v173
  s_nop 0
  v_pk_add_f32 v[174:175], v[174:175], v[48:49]
  v_rcp_f32 v174, v174
  v_rcp_f32 v175, v175
  s_nop 0
  v_pk_mul_f32 v[94:95], v[94:95], v[174:175]
  v_cvt_pk_bf16_f32 v198, v92, v93
  v_cvt_pk_bf16_f32 v199, v94, v95
  buffer_store_dwordx4 v[196:199], v11, s[16:19], s35 offen offset:1536 sc1
  v_pk_mul_f32 v[144:145], v[96:97], v[96:97]
  v_pk_fma_f32 v[144:145], v[144:145], v[46:47], v[44:45]
  v_pk_mul_f32 v[144:145], v[144:145], v[96:97]
  v_exp_f32 v146, v144
  v_exp_f32 v147, v145
  s_nop 0
  v_pk_add_f32 v[146:147], v[146:147], v[48:49]
  v_rcp_f32 v146, v146
  v_rcp_f32 v147, v147
  s_nop 0
  v_pk_mul_f32 v[96:97], v[96:97], v[146:147]
  v_pk_mul_f32 v[148:149], v[98:99], v[98:99]
  v_pk_fma_f32 v[148:149], v[148:149], v[46:47], v[44:45]
  v_pk_mul_f32 v[148:149], v[148:149], v[98:99]
  v_exp_f32 v150, v148
  v_exp_f32 v151, v149
  s_nop 0
  v_pk_add_f32 v[150:151], v[150:151], v[48:49]
  v_rcp_f32 v150, v150
  v_rcp_f32 v151, v151
  s_nop 0
  v_pk_mul_f32 v[98:99], v[98:99], v[150:151]
  v_cvt_pk_bf16_f32 v184, v96, v97
  v_cvt_pk_bf16_f32 v185, v98, v99
  v_pk_mul_f32 v[152:153], v[100:101], v[100:101]
  v_pk_fma_f32 v[152:153], v[152:153], v[46:47], v[44:45]
  v_pk_mul_f32 v[152:153], v[152:153], v[100:101]
  v_exp_f32 v154, v152
  v_exp_f32 v155, v153
  s_nop 0
  v_pk_add_f32 v[154:155], v[154:155], v[48:49]
  v_rcp_f32 v154, v154
  v_rcp_f32 v155, v155
  s_nop 0
  v_pk_mul_f32 v[100:101], v[100:101], v[154:155]
  v_pk_mul_f32 v[156:157], v[102:103], v[102:103]
  v_pk_fma_f32 v[156:157], v[156:157], v[46:47], v[44:45]
  v_pk_mul_f32 v[156:157], v[156:157], v[102:103]
  v_exp_f32 v158, v156
  v_exp_f32 v159, v157
  s_nop 0
  v_pk_add_f32 v[158:159], v[158:159], v[48:49]
  v_rcp_f32 v158, v158
  v_rcp_f32 v159, v159
  s_nop 0
  v_pk_mul_f32 v[102:103], v[102:103], v[158:159]
  v_cvt_pk_bf16_f32 v186, v100, v101
  v_cvt_pk_bf16_f32 v187, v102, v103
  buffer_store_dwordx4 v[184:187], v11, s[16:19], s35 offen offset:2048 sc1
  v_pk_mul_f32 v[160:161], v[104:105], v[104:105]
  v_pk_fma_f32 v[160:161], v[160:161], v[46:47], v[44:45]
  v_pk_mul_f32 v[160:161], v[160:161], v[104:105]
  v_exp_f32 v162, v160
  v_exp_f32 v163, v161
  s_nop 0
  v_pk_add_f32 v[162:163], v[162:163], v[48:49]
  v_rcp_f32 v162, v162
  v_rcp_f32 v163, v163
  s_nop 0
  v_pk_mul_f32 v[104:105], v[104:105], v[162:163]
  v_pk_mul_f32 v[164:165], v[106:107], v[106:107]
  v_pk_fma_f32 v[164:165], v[164:165], v[46:47], v[44:45]
  v_pk_mul_f32 v[164:165], v[164:165], v[106:107]
  v_exp_f32 v166, v164
  v_exp_f32 v167, v165
  s_nop 0
  v_pk_add_f32 v[166:167], v[166:167], v[48:49]
  v_rcp_f32 v166, v166
  v_rcp_f32 v167, v167
  s_nop 0
  v_pk_mul_f32 v[106:107], v[106:107], v[166:167]
  v_cvt_pk_bf16_f32 v188, v104, v105
  v_cvt_pk_bf16_f32 v189, v106, v107
  v_pk_mul_f32 v[168:169], v[108:109], v[108:109]
  v_pk_fma_f32 v[168:169], v[168:169], v[46:47], v[44:45]
  v_pk_mul_f32 v[168:169], v[168:169], v[108:109]
  v_exp_f32 v170, v168
  v_exp_f32 v171, v169
  s_nop 0
  v_pk_add_f32 v[170:171], v[170:171], v[48:49]
  v_rcp_f32 v170, v170
  v_rcp_f32 v171, v171
  s_nop 0
  v_pk_mul_f32 v[108:109], v[108:109], v[170:171]
  v_pk_mul_f32 v[172:173], v[110:111], v[110:111]
  v_pk_fma_f32 v[172:173], v[172:173], v[46:47], v[44:45]
  v_pk_mul_f32 v[172:173], v[172:173], v[110:111]
  v_exp_f32 v174, v172
  v_exp_f32 v175, v173
  s_nop 0
  v_pk_add_f32 v[174:175], v[174:175], v[48:49]
  v_rcp_f32 v174, v174
  v_rcp_f32 v175, v175
  s_nop 0
  v_pk_mul_f32 v[110:111], v[110:111], v[174:175]
  v_cvt_pk_bf16_f32 v190, v108, v109
  v_cvt_pk_bf16_f32 v191, v110, v111
  buffer_store_dwordx4 v[188:191], v11, s[16:19], s35 offen offset:2560 sc1
  v_pk_mul_f32 v[144:145], v[112:113], v[112:113]
  v_pk_fma_f32 v[144:145], v[144:145], v[46:47], v[44:45]
  v_pk_mul_f32 v[144:145], v[144:145], v[112:113]
  v_exp_f32 v146, v144
  v_exp_f32 v147, v145
  s_nop 0
  v_pk_add_f32 v[146:147], v[146:147], v[48:49]
  v_rcp_f32 v146, v146
  v_rcp_f32 v147, v147
  s_nop 0
  v_pk_mul_f32 v[112:113], v[112:113], v[146:147]
  v_pk_mul_f32 v[148:149], v[114:115], v[114:115]
  v_pk_fma_f32 v[148:149], v[148:149], v[46:47], v[44:45]
  v_pk_mul_f32 v[148:149], v[148:149], v[114:115]
  v_exp_f32 v150, v148
  v_exp_f32 v151, v149
  s_nop 0
  v_pk_add_f32 v[150:151], v[150:151], v[48:49]
  v_rcp_f32 v150, v150
  v_rcp_f32 v151, v151
  s_nop 0
  v_pk_mul_f32 v[114:115], v[114:115], v[150:151]
  v_cvt_pk_bf16_f32 v192, v112, v113
  v_cvt_pk_bf16_f32 v193, v114, v115
  v_pk_mul_f32 v[152:153], v[116:117], v[116:117]
  v_pk_fma_f32 v[152:153], v[152:153], v[46:47], v[44:45]
  v_pk_mul_f32 v[152:153], v[152:153], v[116:117]
  v_exp_f32 v154, v152
  v_exp_f32 v155, v153
  s_nop 0
  v_pk_add_f32 v[154:155], v[154:155], v[48:49]
  v_rcp_f32 v154, v154
  v_rcp_f32 v155, v155
  s_nop 0
  v_pk_mul_f32 v[116:117], v[116:117], v[154:155]
  v_pk_mul_f32 v[156:157], v[118:119], v[118:119]
  v_pk_fma_f32 v[156:157], v[156:157], v[46:47], v[44:45]
  v_pk_mul_f32 v[156:157], v[156:157], v[118:119]
  v_exp_f32 v158, v156
  v_exp_f32 v159, v157
  s_nop 0
  v_pk_add_f32 v[158:159], v[158:159], v[48:49]
  v_rcp_f32 v158, v158
  v_rcp_f32 v159, v159
  s_nop 0
  v_pk_mul_f32 v[118:119], v[118:119], v[158:159]
  v_cvt_pk_bf16_f32 v194, v116, v117
  v_cvt_pk_bf16_f32 v195, v118, v119
  buffer_store_dwordx4 v[192:195], v11, s[16:19], s35 offen offset:3072 sc1
  v_pk_mul_f32 v[160:161], v[120:121], v[120:121]
  v_pk_fma_f32 v[160:161], v[160:161], v[46:47], v[44:45]
  v_pk_mul_f32 v[160:161], v[160:161], v[120:121]
  v_exp_f32 v162, v160
  v_exp_f32 v163, v161
  s_nop 0
  v_pk_add_f32 v[162:163], v[162:163], v[48:49]
  v_rcp_f32 v162, v162
  v_rcp_f32 v163, v163
  s_nop 0
  v_pk_mul_f32 v[120:121], v[120:121], v[162:163]
  v_pk_mul_f32 v[164:165], v[122:123], v[122:123]
  v_pk_fma_f32 v[164:165], v[164:165], v[46:47], v[44:45]
  v_pk_mul_f32 v[164:165], v[164:165], v[122:123]
  v_exp_f32 v166, v164
  v_exp_f32 v167, v165
  s_nop 0
  v_pk_add_f32 v[166:167], v[166:167], v[48:49]
  v_rcp_f32 v166, v166
  v_rcp_f32 v167, v167
  s_nop 0
  v_pk_mul_f32 v[122:123], v[122:123], v[166:167]
  v_cvt_pk_bf16_f32 v196, v120, v121
  v_cvt_pk_bf16_f32 v197, v122, v123
  v_pk_mul_f32 v[168:169], v[124:125], v[124:125]
  v_pk_fma_f32 v[168:169], v[168:169], v[46:47], v[44:45]
  v_pk_mul_f32 v[168:169], v[168:169], v[124:125]
  v_exp_f32 v170, v168
  v_exp_f32 v171, v169
  s_nop 0
  v_pk_add_f32 v[170:171], v[170:171], v[48:49]
  v_rcp_f32 v170, v170
  v_rcp_f32 v171, v171
  s_nop 0
  v_pk_mul_f32 v[124:125], v[124:125], v[170:171]
  v_pk_mul_f32 v[172:173], v[126:127], v[126:127]
  v_pk_fma_f32 v[172:173], v[172:173], v[46:47], v[44:45]
  v_pk_mul_f32 v[172:173], v[172:173], v[126:127]
  v_exp_f32 v174, v172
  v_exp_f32 v175, v173
  s_nop 0
  v_pk_add_f32 v[174:175], v[174:175], v[48:49]
  v_rcp_f32 v174, v174
  v_rcp_f32 v175, v175
  s_nop 0
  v_pk_mul_f32 v[126:127], v[126:127], v[174:175]
  v_cvt_pk_bf16_f32 v198, v124, v125
  v_cvt_pk_bf16_f32 v199, v126, v127
  buffer_store_dwordx4 v[196:199], v11, s[16:19], s35 offen offset:3584 sc1
  v_pk_mul_f32 v[144:145], v[128:129], v[128:129]
  v_pk_fma_f32 v[144:145], v[144:145], v[46:47], v[44:45]
  v_pk_mul_f32 v[144:145], v[144:145], v[128:129]
  v_exp_f32 v146, v144
  v_exp_f32 v147, v145
  s_nop 0
  v_pk_add_f32 v[146:147], v[146:147], v[48:49]
  v_rcp_f32 v146, v146
  v_rcp_f32 v147, v147
  s_nop 0
  v_pk_mul_f32 v[128:129], v[128:129], v[146:147]
  v_pk_mul_f32 v[148:149], v[130:131], v[130:131]
  v_pk_fma_f32 v[148:149], v[148:149], v[46:47], v[44:45]
  v_pk_mul_f32 v[148:149], v[148:149], v[130:131]
  v_exp_f32 v150, v148
  v_exp_f32 v151, v149
  s_nop 0
  v_pk_add_f32 v[150:151], v[150:151], v[48:49]
  v_rcp_f32 v150, v150
  v_rcp_f32 v151, v151
  s_nop 0
  v_pk_mul_f32 v[130:131], v[130:131], v[150:151]
  v_cvt_pk_bf16_f32 v184, v128, v129
  v_cvt_pk_bf16_f32 v185, v130, v131
  v_pk_mul_f32 v[152:153], v[132:133], v[132:133]
  v_pk_fma_f32 v[152:153], v[152:153], v[46:47], v[44:45]
  v_pk_mul_f32 v[152:153], v[152:153], v[132:133]
  v_exp_f32 v154, v152
  v_exp_f32 v155, v153
  s_nop 0
  v_pk_add_f32 v[154:155], v[154:155], v[48:49]
  v_rcp_f32 v154, v154
  v_rcp_f32 v155, v155
  s_nop 0
  v_pk_mul_f32 v[132:133], v[132:133], v[154:155]
  v_pk_mul_f32 v[156:157], v[134:135], v[134:135]
  v_pk_fma_f32 v[156:157], v[156:157], v[46:47], v[44:45]
  v_pk_mul_f32 v[156:157], v[156:157], v[134:135]
  v_exp_f32 v158, v156
  v_exp_f32 v159, v157
  s_nop 0
  v_pk_add_f32 v[158:159], v[158:159], v[48:49]
  v_rcp_f32 v158, v158
  v_rcp_f32 v159, v159
  s_nop 0
  v_pk_mul_f32 v[134:135], v[134:135], v[158:159]
  v_cvt_pk_bf16_f32 v186, v132, v133
  v_cvt_pk_bf16_f32 v187, v134, v135
  buffer_store_dwordx4 v[184:187], v11, s[16:19], s36 offen offset:0 sc1
  v_pk_mul_f32 v[160:161], v[136:137], v[136:137]
  v_pk_fma_f32 v[160:161], v[160:161], v[46:47], v[44:45]
  v_pk_mul_f32 v[160:161], v[160:161], v[136:137]
  v_exp_f32 v162, v160
  v_exp_f32 v163, v161
  s_nop 0
  v_pk_add_f32 v[162:163], v[162:163], v[48:49]
  v_rcp_f32 v162, v162
  v_rcp_f32 v163, v163
  s_nop 0
  v_pk_mul_f32 v[136:137], v[136:137], v[162:163]
  v_pk_mul_f32 v[164:165], v[138:139], v[138:139]
  v_pk_fma_f32 v[164:165], v[164:165], v[46:47], v[44:45]
  v_pk_mul_f32 v[164:165], v[164:165], v[138:139]
  v_exp_f32 v166, v164
  v_exp_f32 v167, v165
  s_nop 0
  v_pk_add_f32 v[166:167], v[166:167], v[48:49]
  v_rcp_f32 v166, v166
  v_rcp_f32 v167, v167
  s_nop 0
  v_pk_mul_f32 v[138:139], v[138:139], v[166:167]
  v_cvt_pk_bf16_f32 v188, v136, v137
  v_cvt_pk_bf16_f32 v189, v138, v139
  v_pk_mul_f32 v[168:169], v[140:141], v[140:141]
  v_pk_fma_f32 v[168:169], v[168:169], v[46:47], v[44:45]
  v_pk_mul_f32 v[168:169], v[168:169], v[140:141]
  v_exp_f32 v170, v168
  v_exp_f32 v171, v169
  s_nop 0
  v_pk_add_f32 v[170:171], v[170:171], v[48:49]
  v_rcp_f32 v170, v170
  v_rcp_f32 v171, v171
  s_nop 0
  v_pk_mul_f32 v[140:141], v[140:141], v[170:171]
  v_pk_mul_f32 v[172:173], v[142:143], v[142:143]
  v_pk_fma_f32 v[172:173], v[172:173], v[46:47], v[44:45]
  v_pk_mul_f32 v[172:173], v[172:173], v[142:143]
  v_exp_f32 v174, v172
  v_exp_f32 v175, v173
  s_nop 0
  v_pk_add_f32 v[174:175], v[174:175], v[48:49]
  v_rcp_f32 v174, v174
  v_rcp_f32 v175, v175
  s_nop 0
  v_pk_mul_f32 v[142:143], v[142:143], v[174:175]
  v_cvt_pk_bf16_f32 v190, v140, v141
  v_cvt_pk_bf16_f32 v191, v142, v143
  buffer_store_dwordx4 v[188:191], v11, s[16:19], s36 offen offset:512 sc1
  s_branch g1_kernel_end1
g1_kernel_eV91:
  s_lshl_b32 s35, s29, 7
  s_add_u32 s35, s35, 154624
  v_lshlrev_b32 v13, 4, v3
  v_add_u32 v13, s35, v13
  v_lshlrev_b32 v12, 2, v2
  v_add_u32 v12, s34, v12
  ds_read_b128 v[144:147], v13 offset:0
  ds_read_b128 v[160:163], v13 offset:512
  ds_read_b128 v[148:151], v13 offset:32
  ds_read_b128 v[164:167], v13 offset:544
  ds_read_b128 v[152:155], v13 offset:64
  ds_read_b128 v[168:171], v13 offset:576
  ds_read_b128 v[156:159], v13 offset:96
  ds_read_b128 v[172:175], v13 offset:608
  ds_read_b32 v176, v12 offset:0
  ds_read_b32 v177, v12 offset:128
  ds_read_b32 v178, v12 offset:256
  ds_read_b32 v179, v12 offset:384
  ds_read_b32 v180, v12 offset:512
  s_mul_i32 s35, s24, 655360
  s_mul_i32 s36, s33, 1280
  s_add_u32 s35, s35, s36
  s_add_u32 s35, s35, 6291456
  s_mov_b32 s37, 81920
  v_mul_u32_u24 v191, 320, v3
  v_add_u32 v184, 0, v2
  v_mul_u32_u24 v189, 205, v184
  v_lshrrev_b32 v189, 12, v189
  v_mul_u32_u24 v190, 20, v189
  v_sub_u32 v184, v184, v190
  v_lshlrev_b32 v184, 4, v184
  v_mul_lo_u32 v189, v189, s37
  v_add3_u32 v184, v184, v189, v191
  v_add_u32 v185, 32, v2
  v_mul_u32_u24 v189, 205, v185
  v_lshrrev_b32 v189, 12, v189
  v_mul_u32_u24 v190, 20, v189
  v_sub_u32 v185, v185, v190
  v_lshlrev_b32 v185, 4, v185
  v_mul_lo_u32 v189, v189, s37
  v_add3_u32 v185, v185, v189, v191
  v_add_u32 v186, 64, v2
  v_mul_u32_u24 v189, 205, v186
  v_lshrrev_b32 v189, 12, v189
  v_mul_u32_u24 v190, 20, v189
  v_sub_u32 v186, v186, v190
  v_lshlrev_b32 v186, 4, v186
  v_mul_lo_u32 v189, v189, s37
  v_add3_u32 v186, v186, v189, v191
  v_add_u32 v187, 96, v2
  v_mul_u32_u24 v189, 205, v187
  v_lshrrev_b32 v189, 12, v189
  v_mul_u32_u24 v190, 20, v189
  v_sub_u32 v187, v187, v190
  v_lshlrev_b32 v187, 4, v187
  v_mul_lo_u32 v189, v189, s37
  v_add3_u32 v187, v187, v189, v191
  v_add_u32 v188, 128, v2
  v_mul_u32_u24 v189, 205, v188
  v_lshrrev_b32 v189, 12, v189
  v_mul_u32_u24 v190, 20, v189
  v_sub_u32 v188, v188, v190
  v_lshlrev_b32 v188, 4, v188
  v_mul_lo_u32 v189, v189, s37
  v_add3_u32 v188, v188, v189, v191
  s_waitcnt lgkmcnt(0)
  v_mul_f32 v64, v64, v144
  v_mul_f32 v65, v65, v145
  v_mul_f32 v66, v66, v146
  v_mul_f32 v67, v67, v147
  v_mul_f32 v68, v68, v148
  v_mul_f32 v69, v69, v149
  v_mul_f32 v70, v70, v150
  v_mul_f32 v71, v71, v151
  v_mul_f32 v72, v72, v152
  v_mul_f32 v73, v73, v153
  v_mul_f32 v74, v74, v154
  v_mul_f32 v75, v75, v155
  v_mul_f32 v76, v76, v156
  v_mul_f32 v77, v77, v157
  v_mul_f32 v78, v78, v158
  v_mul_f32 v79, v79, v159
  v_fma_f32 v64, -v160, v176, v64
  v_fma_f32 v65, -v161, v176, v65
  v_fma_f32 v66, -v162, v176, v66
  v_fma_f32 v67, -v163, v176, v67
  v_fma_f32 v68, -v164, v176, v68
  v_fma_f32 v69, -v165, v176, v69
  v_fma_f32 v70, -v166, v176, v70
  v_fma_f32 v71, -v167, v176, v71
  v_fma_f32 v72, -v168, v176, v72
  v_fma_f32 v73, -v169, v176, v73
  v_fma_f32 v74, -v170, v176, v74
  v_fma_f32 v75, -v171, v176, v75
  v_fma_f32 v76, -v172, v176, v76
  v_fma_f32 v77, -v173, v176, v77
  v_fma_f32 v78, -v174, v176, v78
  v_fma_f32 v79, -v175, v176, v79
  v_cvt_pk_bf16_f32 v192, v64, v65
  v_cvt_pk_bf16_f32 v193, v66, v67
  v_cvt_pk_bf16_f32 v194, v68, v69
  v_cvt_pk_bf16_f32 v195, v70, v71
  buffer_store_dwordx4 v[192:195], v184, s[16:19], s35 offen offset:0 sc1
  v_cvt_pk_bf16_f32 v196, v72, v73
  v_cvt_pk_bf16_f32 v197, v74, v75
  v_cvt_pk_bf16_f32 v198, v76, v77
  v_cvt_pk_bf16_f32 v199, v78, v79
  buffer_store_dwordx4 v[196:199], v184, s[16:19], s35 offen offset:640 sc1
  v_mul_f32 v80, v80, v144
  v_mul_f32 v81, v81, v145
  v_mul_f32 v82, v82, v146
  v_mul_f32 v83, v83, v147
  v_mul_f32 v84, v84, v148
  v_mul_f32 v85, v85, v149
  v_mul_f32 v86, v86, v150
  v_mul_f32 v87, v87, v151
  v_mul_f32 v88, v88, v152
  v_mul_f32 v89, v89, v153
  v_mul_f32 v90, v90, v154
  v_mul_f32 v91, v91, v155
  v_mul_f32 v92, v92, v156
  v_mul_f32 v93, v93, v157
  v_mul_f32 v94, v94, v158
  v_mul_f32 v95, v95, v159
  v_fma_f32 v80, -v160, v177, v80
  v_fma_f32 v81, -v161, v177, v81
  v_fma_f32 v82, -v162, v177, v82
  v_fma_f32 v83, -v163, v177, v83
  v_fma_f32 v84, -v164, v177, v84
  v_fma_f32 v85, -v165, v177, v85
  v_fma_f32 v86, -v166, v177, v86
  v_fma_f32 v87, -v167, v177, v87
  v_fma_f32 v88, -v168, v177, v88
  v_fma_f32 v89, -v169, v177, v89
  v_fma_f32 v90, -v170, v177, v90
  v_fma_f32 v91, -v171, v177, v91
  v_fma_f32 v92, -v172, v177, v92
  v_fma_f32 v93, -v173, v177, v93
  v_fma_f32 v94, -v174, v177, v94
  v_fma_f32 v95, -v175, v177, v95
  v_cvt_pk_bf16_f32 v200, v80, v81
  v_cvt_pk_bf16_f32 v201, v82, v83
  v_cvt_pk_bf16_f32 v202, v84, v85
  v_cvt_pk_bf16_f32 v203, v86, v87
  buffer_store_dwordx4 v[200:203], v185, s[16:19], s35 offen offset:0 sc1
  v_cvt_pk_bf16_f32 v204, v88, v89
  v_cvt_pk_bf16_f32 v205, v90, v91
  v_cvt_pk_bf16_f32 v206, v92, v93
  v_cvt_pk_bf16_f32 v207, v94, v95
  buffer_store_dwordx4 v[204:207], v185, s[16:19], s35 offen offset:640 sc1
  v_mul_f32 v96, v96, v144
  v_mul_f32 v97, v97, v145
  v_mul_f32 v98, v98, v146
  v_mul_f32 v99, v99, v147
  v_mul_f32 v100, v100, v148
  v_mul_f32 v101, v101, v149
  v_mul_f32 v102, v102, v150
  v_mul_f32 v103, v103, v151
  v_mul_f32 v104, v104, v152
  v_mul_f32 v105, v105, v153
  v_mul_f32 v106, v106, v154
  v_mul_f32 v107, v107, v155
  v_mul_f32 v108, v108, v156
  v_mul_f32 v109, v109, v157
  v_mul_f32 v110, v110, v158
  v_mul_f32 v111, v111, v159
  v_fma_f32 v96, -v160, v178, v96
  v_fma_f32 v97, -v161, v178, v97
  v_fma_f32 v98, -v162, v178, v98
  v_fma_f32 v99, -v163, v178, v99
  v_fma_f32 v100, -v164, v178, v100
  v_fma_f32 v101, -v165, v178, v101
  v_fma_f32 v102, -v166, v178, v102
  v_fma_f32 v103, -v167, v178, v103
  v_fma_f32 v104, -v168, v178, v104
  v_fma_f32 v105, -v169, v178, v105
  v_fma_f32 v106, -v170, v178, v106
  v_fma_f32 v107, -v171, v178, v107
  v_fma_f32 v108, -v172, v178, v108
  v_fma_f32 v109, -v173, v178, v109
  v_fma_f32 v110, -v174, v178, v110
  v_fma_f32 v111, -v175, v178, v111
  v_cvt_pk_bf16_f32 v192, v96, v97
  v_cvt_pk_bf16_f32 v193, v98, v99
  v_cvt_pk_bf16_f32 v194, v100, v101
  v_cvt_pk_bf16_f32 v195, v102, v103
  buffer_store_dwordx4 v[192:195], v186, s[16:19], s35 offen offset:0 sc1
  v_cvt_pk_bf16_f32 v196, v104, v105
  v_cvt_pk_bf16_f32 v197, v106, v107
  v_cvt_pk_bf16_f32 v198, v108, v109
  v_cvt_pk_bf16_f32 v199, v110, v111
  buffer_store_dwordx4 v[196:199], v186, s[16:19], s35 offen offset:640 sc1
  v_mul_f32 v112, v112, v144
  v_mul_f32 v113, v113, v145
  v_mul_f32 v114, v114, v146
  v_mul_f32 v115, v115, v147
  v_mul_f32 v116, v116, v148
  v_mul_f32 v117, v117, v149
  v_mul_f32 v118, v118, v150
  v_mul_f32 v119, v119, v151
  v_mul_f32 v120, v120, v152
  v_mul_f32 v121, v121, v153
  v_mul_f32 v122, v122, v154
  v_mul_f32 v123, v123, v155
  v_mul_f32 v124, v124, v156
  v_mul_f32 v125, v125, v157
  v_mul_f32 v126, v126, v158
  v_mul_f32 v127, v127, v159
  v_fma_f32 v112, -v160, v179, v112
  v_fma_f32 v113, -v161, v179, v113
  v_fma_f32 v114, -v162, v179, v114
  v_fma_f32 v115, -v163, v179, v115
  v_fma_f32 v116, -v164, v179, v116
  v_fma_f32 v117, -v165, v179, v117
  v_fma_f32 v118, -v166, v179, v118
  v_fma_f32 v119, -v167, v179, v119
  v_fma_f32 v120, -v168, v179, v120
  v_fma_f32 v121, -v169, v179, v121
  v_fma_f32 v122, -v170, v179, v122
  v_fma_f32 v123, -v171, v179, v123
  v_fma_f32 v124, -v172, v179, v124
  v_fma_f32 v125, -v173, v179, v125
  v_fma_f32 v126, -v174, v179, v126
  v_fma_f32 v127, -v175, v179, v127
  v_cvt_pk_bf16_f32 v200, v112, v113
  v_cvt_pk_bf16_f32 v201, v114, v115
  v_cvt_pk_bf16_f32 v202, v116, v117
  v_cvt_pk_bf16_f32 v203, v118, v119
  buffer_store_dwordx4 v[200:203], v187, s[16:19], s35 offen offset:0 sc1
  v_cvt_pk_bf16_f32 v204, v120, v121
  v_cvt_pk_bf16_f32 v205, v122, v123
  v_cvt_pk_bf16_f32 v206, v124, v125
  v_cvt_pk_bf16_f32 v207, v126, v127
  buffer_store_dwordx4 v[204:207], v187, s[16:19], s35 offen offset:640 sc1
  v_mul_f32 v128, v128, v144
  v_mul_f32 v129, v129, v145
  v_mul_f32 v130, v130, v146
  v_mul_f32 v131, v131, v147
  v_mul_f32 v132, v132, v148
  v_mul_f32 v133, v133, v149
  v_mul_f32 v134, v134, v150
  v_mul_f32 v135, v135, v151
  v_mul_f32 v136, v136, v152
  v_mul_f32 v137, v137, v153
  v_mul_f32 v138, v138, v154
  v_mul_f32 v139, v139, v155
  v_mul_f32 v140, v140, v156
  v_mul_f32 v141, v141, v157
  v_mul_f32 v142, v142, v158
  v_mul_f32 v143, v143, v159
  v_fma_f32 v128, -v160, v180, v128
  v_fma_f32 v129, -v161, v180, v129
  v_fma_f32 v130, -v162, v180, v130
  v_fma_f32 v131, -v163, v180, v131
  v_fma_f32 v132, -v164, v180, v132
  v_fma_f32 v133, -v165, v180, v133
  v_fma_f32 v134, -v166, v180, v134
  v_fma_f32 v135, -v167, v180, v135
  v_fma_f32 v136, -v168, v180, v136
  v_fma_f32 v137, -v169, v180, v137
  v_fma_f32 v138, -v170, v180, v138
  v_fma_f32 v139, -v171, v180, v139
  v_fma_f32 v140, -v172, v180, v140
  v_fma_f32 v141, -v173, v180, v141
  v_fma_f32 v142, -v174, v180, v142
  v_fma_f32 v143, -v175, v180, v143
  v_cvt_pk_bf16_f32 v192, v128, v129
  v_cvt_pk_bf16_f32 v193, v130, v131
  v_cvt_pk_bf16_f32 v194, v132, v133
  v_cvt_pk_bf16_f32 v195, v134, v135
  buffer_store_dwordx4 v[192:195], v188, s[16:19], s35 offen offset:0 sc1
  v_cvt_pk_bf16_f32 v196, v136, v137
  v_cvt_pk_bf16_f32 v197, v138, v139
  v_cvt_pk_bf16_f32 v198, v140, v141
  v_cvt_pk_bf16_f32 v199, v142, v143
  buffer_store_dwordx4 v[196:199], v188, s[16:19], s35 offen offset:640 sc1
  s_branch g1_kernel_end1
g1_kernel_loader2:
  s_setprio 1
  s_mul_i32 s28, s29, 5120
  s_add_u32 s28, s28, 65536
  v_lshrrev_b32 v8, 3, v1
  s_lshl_b32 s34, s29, 5
  v_add_u32 v8, s34, v8
  v_lshrrev_b32 v9, 4, v1
  v_and_b32 v10, 7, v1
  v_add_u32 v11, 0, v8
  v_mul_u32_u24 v11, 1280, v11
  v_add_u32 v58, 0, v9
  v_xor_b32 v58, v58, v10
  v_lshlrev_b32 v58, 4, v58
  v_add_u32 v58, v58, v11
  v_add_u32 v11, 8, v8
  v_mul_u32_u24 v11, 1280, v11
  v_add_u32 v59, 4, v9
  v_xor_b32 v59, v59, v10
  v_lshlrev_b32 v59, 4, v59
  v_add_u32 v59, v59, v11
  v_add_u32 v11, 16, v8
  v_mul_u32_u24 v11, 1280, v11
  v_add_u32 v60, 0, v9
  v_xor_b32 v60, v60, v10
  v_lshlrev_b32 v60, 4, v60
  v_add_u32 v60, v60, v11
  v_add_u32 v11, 24, v8
  v_mul_u32_u24 v11, 1280, v11
  v_add_u32 v61, 4, v9
  v_xor_b32 v61, v61, v10
  v_lshlrev_b32 v61, 4, v61
  v_add_u32 v61, v61, v11
  s_mul_i32 s34, s29, 320
  v_add_u32 v8, s34, v1
  v_add_u32 v8, 0, v8
  v_mul_u32_u24 v9, 3277, v8
  v_lshrrev_b32 v9, 16, v9
  v_mul_u32_u24 v10, 20, v9
  v_sub_u32 v10, v8, v10
  v_lshlrev_b32 v10, 4, v10
  v_mul_lo_u32 v9, v9, s25
  v_add_u32 v62, v9, v10
  v_add_u32 v8, s34, v1
  v_add_u32 v8, 64, v8
  v_mul_u32_u24 v9, 3277, v8
  v_lshrrev_b32 v9, 16, v9
  v_mul_u32_u24 v10, 20, v9
  v_sub_u32 v10, v8, v10
  v_lshlrev_b32 v10, 4, v10
  v_mul_lo_u32 v9, v9, s25
  v_add_u32 v63, v9, v10
  v_add_u32 v8, s34, v1
  v_add_u32 v8, 128, v8
  v_mul_u32_u24 v9, 3277, v8
  v_lshrrev_b32 v9, 16, v9
  v_mul_u32_u24 v10, 20, v9
  v_sub_u32 v10, v8, v10
  v_lshlrev_b32 v10, 4, v10
  v_mul_lo_u32 v9, v9, s25
  v_add_u32 v64, v9, v10
  v_add_u32 v8, s34, v1
  v_add_u32 v8, 192, v8
  v_mul_u32_u24 v9, 3277, v8
  v_lshrrev_b32 v9, 16, v9
  v_mul_u32_u24 v10, 20, v9
  v_sub_u32 v10, v8, v10
  v_lshlrev_b32 v10, 4, v10
  v_mul_lo_u32 v9, v9, s25
  v_add_u32 v65, v9, v10
  v_add_u32 v8, s34, v1
  v_add_u32 v8, 256, v8
  v_mul_u32_u24 v9, 3277, v8
  v_lshrrev_b32 v9, 16, v9
  v_mul_u32_u24 v10, 20, v9
  v_sub_u32 v10, v8, v10
  v_lshlrev_b32 v10, 4, v10
  v_mul_lo_u32 v9, v9, s25
  v_add_u32 v66, v9, v10
  s_waitcnt lgkmcnt(0)
  s_mul_i32 s34, s21, 163840
  s_add_u32 s4, s40, s34
  s_addc_u32 s5, s41, 0
  s_mov_b32 s8, s4
  s_and_b32 s9, s5, 0xffff
  s_mov_b32 s10, 163840
  s_mov_b32 s11, 0x20000
  s_mul_i32 s35, s24, 320
  s_cmp_eq_u32 s23, 3
  s_cbranch_scc1 g1_kernel_w193
  s_mul_i32 s36, s23, 1280
  s_add_u32 s35, s35, s36
  s_add_u32 s6, s42, s35
  s_addc_u32 s7, s43, 0
  s_sub_u32 s36, 2457600, s35
  s_branch g1_kernel_wd94
g1_kernel_w193:
  s_add_u32 s6, s48, s35
  s_addc_u32 s7, s49, 0
  s_sub_u32 s36, 819200, s35
g1_kernel_wd94:
  s_mov_b32 s12, s6
  s_and_b32 s13, s7, 0xffff
  s_mov_b32 s14, s36
  s_mov_b32 s15, 0x20000
  s_mov_b32 s30, 0
  s_mul_i32 s31, s26, 0
  s_add_u32 m0, s27, 0
  s_nop 0
  buffer_load_dwordx4 v58, s[8:11], s30 offen  lds
  s_add_u32 m0, s27, 1024
  s_nop 0
  buffer_load_dwordx4 v59, s[8:11], s30 offen  lds
  s_add_u32 m0, s27, 2048
  s_nop 0
  buffer_load_dwordx4 v60, s[8:11], s30 offen  lds
  s_add_u32 m0, s27, 3072
  s_nop 0
  buffer_load_dwordx4 v61, s[8:11], s30 offen  lds
  s_add_u32 m0, s28, 0
  s_nop 0
  buffer_load_dwordx4 v62, s[12:15], s31 offen  lds
  s_add_u32 m0, s28, 1024
  s_nop 0
  buffer_load_dwordx4 v63, s[12:15], s31 offen  lds
  s_add_u32 m0, s28, 2048
  s_nop 0
  buffer_load_dwordx4 v64, s[12:15], s31 offen  lds
  s_add_u32 m0, s28, 3072
  s_nop 0
  buffer_load_dwordx4 v65, s[12:15], s31 offen  lds
  s_add_u32 m0, s28, 4096
  s_nop 0
  buffer_load_dwordx4 v66, s[12:15], s31 offen  lds
  s_mov_b32 s30, 128
  s_mul_i32 s31, s26, 1
  s_add_u32 m0, s27, 16384
  s_nop 0
  buffer_load_dwordx4 v58, s[8:11], s30 offen  lds
  s_add_u32 m0, s27, 17408
  s_nop 0
  buffer_load_dwordx4 v59, s[8:11], s30 offen  lds
  s_add_u32 m0, s27, 18432
  s_nop 0
  buffer_load_dwordx4 v60, s[8:11], s30 offen  lds
  s_add_u32 m0, s27, 19456
  s_nop 0
  buffer_load_dwordx4 v61, s[8:11], s30 offen  lds
  s_add_u32 m0, s28, 20480
  s_nop 0
  buffer_load_dwordx4 v62, s[12:15], s31 offen  lds
  s_add_u32 m0, s28, 21504
  s_nop 0
  buffer_load_dwordx4 v63, s[12:15], s31 offen  lds
  s_add_u32 m0, s28, 22528
  s_nop 0
  buffer_load_dwordx4 v64, s[12:15], s31 offen  lds
  s_add_u32 m0, s28, 23552
  s_nop 0
  buffer_load_dwordx4 v65, s[12:15], s31 offen  lds
  s_add_u32 m0, s28, 24576
  s_nop 0
  buffer_load_dwordx4 v66, s[12:15], s31 offen  lds
  s_mov_b32 s16, s56
  s_and_b32 s17, s57, 0xffff
  s_mov_b32 s18, 37748736
  s_mov_b32 s19, 0x20000
  v_lshrrev_b32 v8, 1, v2
  v_and_b32 v8, 7, v8
  v_lshlrev_b32 v9, 7, v2
  v_add_u32 v9, s27, v9
  v_lshlrev_b32 v10, 2, v3
  v_add_u32 v10, 0, v10
  v_xor_b32 v10, v10, v8
  v_lshlrev_b32 v10, 4, v10
  v_add_u32 v68, v9, v10
  v_lshlrev_b32 v10, 2, v3
  v_add_u32 v10, 1, v10
  v_xor_b32 v10, v10, v8
  v_lshlrev_b32 v10, 4, v10
  v_add_u32 v69, v9, v10
  v_lshlrev_b32 v10, 2, v3
  v_add_u32 v10, 2, v10
  v_xor_b32 v10, v10, v8
  v_lshlrev_b32 v10, 4, v10
  v_add_u32 v70, v9, v10
  v_lshlrev_b32 v10, 2, v3
  v_add_u32 v10, 3, v10
  v_xor_b32 v10, v10, v8
  v_lshlrev_b32 v10, 4, v10
  v_add_u32 v71, v9, v10
  v_mov_b32 v104, 0
  v_mov_b32 v105, 0
  v_mov_b32 v106, 0
  v_mov_b32 v107, 0
  v_mov_b32 v108, 0
  v_mov_b32 v109, 0
  v_mov_b32 v110, 0
  v_mov_b32 v111, 0
  v_mov_b32 v144, 0
  v_mov_b32 v145, 0
  v_mov_b32 v146, 0
  v_mov_b32 v147, 0
  v_mov_b32 v148, 0
  s_cmp_lg_u32 s29, 0
  s_cbranch_scc1 g1_kernel_rp395
  s_mov_b32 s76, s52
  s_and_b32 s77, s53, 0xffff
  s_mov_b32 s78, 1966080
  s_mov_b32 s79, 0x20000
  v_add_u32 v28, 0, v1
  v_mul_u32_u24 v29, 5462, v28
  v_lshrrev_b32 v29, 16, v29
  v_mul_u32_u24 v30, 12, v29
  v_sub_u32 v30, v28, v30
  v_lshlrev_b32 v30, 4, v30
  v_mul_u32_u24 v29, 3072, v29
  v_add_u32 v144, v29, v30
  v_add_u32 v28, 64, v1
  v_mul_u32_u24 v29, 5462, v28
  v_lshrrev_b32 v29, 16, v29
  v_mul_u32_u24 v30, 12, v29
  v_sub_u32 v30, v28, v30
  v_lshlrev_b32 v30, 4, v30
  v_mul_u32_u24 v29, 3072, v29
  v_add_u32 v145, v29, v30
  v_add_u32 v28, 128, v1
  v_mul_u32_u24 v29, 5462, v28
  v_lshrrev_b32 v29, 16, v29
  v_mul_u32_u24 v30, 12, v29
  v_sub_u32 v30, v28, v30
  v_lshlrev_b32 v30, 4, v30
  v_mul_u32_u24 v29, 3072, v29
  v_add_u32 v146, v29, v30
  s_mul_i32 s69, s21, 49152
  s_mul_i32 s70, s32, 192
  s_add_u32 s69, s69, s70
  s_mov_b32 s65, 0
  s_mov_b32 s67, 24641536
  s_mov_b32 s70, 106496
  s_branch g1_kernel_rp1696
g1_kernel_rp395:
  s_sub_u32 s68, s29, 1
  s_lshl_b32 s68, s68, 8
  s_add_u32 s68, s68, s2
  s_cmp_lt_u32 s68, 736
  s_cselect_b32 s65, 1, 0
  s_mov_b32 s66, s68
  s_mul_i32 s67, s68, 5120
  s_add_u32 s67, s67, 24641536
  s_cmp_lt_u32 s68, 352
  s_cbranch_scc0 g1_kernel_rpa97
  s_cmp_lt_u32 s68, 160
  s_cbranch_scc0 g1_kernel_rpb98
  s_mov_b32 s72, s50
  s_mov_b32 s73, s51
  s_branch g1_kernel_rpc99b
g1_kernel_rpb98:
  s_sub_u32 s68, s68, 160
  s_mov_b32 s72, s44
  s_mov_b32 s73, s45
g1_kernel_rpc99b:
  s_mul_i32 s69, s68, 3277
  s_lshr_b32 s69, s69, 16
  s_mul_i32 s70, s69, 20
  s_sub_u32 s70, s68, s70
  s_mov_b32 s74, 819200
  s_branch g1_kernel_rpc99
g1_kernel_rpa97:
  s_sub_u32 s68, s68, 352
  s_mov_b32 s72, s54
  s_mov_b32 s73, s55
  s_mul_i32 s69, s68, 1366
  s_lshr_b32 s69, s69, 16
  s_mul_i32 s70, s69, 48
  s_sub_u32 s70, s68, s70
  s_mov_b32 s74, 1966080
g1_kernel_rpc99:
  s_mul_i32 s70, s70, 40960
  s_mul_i32 s69, s69, 160
  s_add_u32 s69, s69, s70
  s_mov_b32 s76, s72
  s_and_b32 s77, s73, 0xffff
  s_mov_b32 s78, s74
  s_mov_b32 s79, 0x20000
  s_sub_u32 s70, s29, 1
  s_mul_i32 s70, s70, 5120
  s_add_u32 s70, s70, 106496
  v_add_u32 v28, 0, v1
  v_mul_u32_u24 v29, 6554, v28
  v_lshrrev_b32 v29, 16, v29
  v_mul_u32_u24 v30, 10, v29
  v_sub_u32 v30, v28, v30
  v_lshlrev_b32 v30, 4, v30
  v_mul_u32_u24 v29, 1280, v29
  v_add_u32 v144, v29, v30
  v_add_u32 v28, 64, v1
  v_mul_u32_u24 v29, 6554, v28
  v_lshrrev_b32 v29, 16, v29
  v_mul_u32_u24 v30, 10, v29
  v_sub_u32 v30, v28, v30
  v_lshlrev_b32 v30, 4, v30
  v_mul_u32_u24 v29, 1280, v29
  v_add_u32 v145, v29, v30
  v_add_u32 v28, 128, v1
  v_mul_u32_u24 v29, 6554, v28
  v_lshrrev_b32 v29, 16, v29
  v_mul_u32_u24 v30, 10, v29
  v_sub_u32 v30, v28, v30
  v_lshlrev_b32 v30, 4, v30
  v_mul_u32_u24 v29, 1280, v29
  v_add_u32 v146, v29, v30
  v_add_u32 v28, 192, v1
  v_mul_u32_u24 v29, 6554, v28
  v_lshrrev_b32 v29, 16, v29
  v_mul_u32_u24 v30, 10, v29
  v_sub_u32 v30, v28, v30
  v_lshlrev_b32 v30, 4, v30
  v_mul_u32_u24 v29, 1280, v29
  v_add_u32 v147, v29, v30
  v_add_u32 v28, 256, v1
  v_mul_u32_u24 v29, 6554, v28
  v_lshrrev_b32 v29, 16, v29
  v_mul_u32_u24 v30, 10, v29
  v_sub_u32 v30, v28, v30
  v_lshlrev_b32 v30, 4, v30
  v_mul_u32_u24 v29, 1280, v29
  v_add_u32 v148, v29, v30
  s_sub_u32 s34, s66, 160
  s_cmp_lt_u32 s34, 192
  s_cbranch_scc0 g1_kernel_rp1696
  s_mul_i32 s35, s34, 2731
  s_lshr_b32 s35, s35, 16
  s_mul_i32 s36, s35, 24
  s_sub_u32 s36, s34, s36
  s_mul_i32 s69, s35, 160
  s_lshl_b32 s36, s36, 2
  v_add_u32 v28, 0, v1
  v_mul_u32_u24 v29, 6554, v28
  v_lshrrev_b32 v29, 16, v29
  v_mul_u32_u24 v30, 10, v29
  v_sub_u32 v30, v28, v30
  v_lshrrev_b32 v31, 4, v29
  v_bfe_u32 v32, v29, 2, 1
  v_lshl_add_u32 v31, v31, 1, v32
  v_add_u32 v31, s36, v31
  v_mul_u32_u24 v32, 171, v31
  v_lshrrev_b32 v32, 9, v32
  v_mul_u32_u24 v33, 3, v32
  v_sub_u32 v31, v31, v33
  v_mul_u32_u24 v32, 20, v32
  v_bfe_u32 v33, v29, 3, 1
  v_and_b32 v29, 3, v29
  v_lshl_add_u32 v34, v33, 2, v29
  v_lshl_add_u32 v34, v31, 3, v34
  v_add_u32 v32, v32, v34
  v_mul_u32_u24 v32, 1280, v32
  v_lshl_add_u32 v144, v30, 4, v32
  v_cmp_le_u32 vcc, 20, v34
  v_mov_b32 v28, 0x7fff0000
  s_nop 0
  v_cndmask_b32 v144, v144, v28, vcc
  v_add_u32 v28, 64, v1
  v_mul_u32_u24 v29, 6554, v28
  v_lshrrev_b32 v29, 16, v29
  v_mul_u32_u24 v30, 10, v29
  v_sub_u32 v30, v28, v30
  v_lshrrev_b32 v31, 4, v29
  v_bfe_u32 v32, v29, 2, 1
  v_lshl_add_u32 v31, v31, 1, v32
  v_add_u32 v31, s36, v31
  v_mul_u32_u24 v32, 171, v31
  v_lshrrev_b32 v32, 9, v32
  v_mul_u32_u24 v33, 3, v32
  v_sub_u32 v31, v31, v33
  v_mul_u32_u24 v32, 20, v32
  v_bfe_u32 v33, v29, 3, 1
  v_and_b32 v29, 3, v29
  v_lshl_add_u32 v34, v33, 2, v29
  v_lshl_add_u32 v34, v31, 3, v34
  v_add_u32 v32, v32, v34
  v_mul_u32_u24 v32, 1280, v32
  v_lshl_add_u32 v145, v30, 4, v32
  v_cmp_le_u32 vcc, 20, v34
  v_mov_b32 v28, 0x7fff0000
  s_nop 0
  v_cndmask_b32 v145, v145, v28, vcc
  v_add_u32 v28, 128, v1
  v_mul_u32_u24 v29, 6554, v28
  v_lshrrev_b32 v29, 16, v29
  v_mul_u32_u24 v30, 10, v29
  v_sub_u32 v30, v28, v30
  v_lshrrev_b32 v31, 4, v29
  v_bfe_u32 v32, v29, 2, 1
  v_lshl_add_u32 v31, v31, 1, v32
  v_add_u32 v31, s36, v31
  v_mul_u32_u24 v32, 171, v31
  v_lshrrev_b32 v32, 9, v32
  v_mul_u32_u24 v33, 3, v32
  v_sub_u32 v31, v31, v33
  v_mul_u32_u24 v32, 20, v32
  v_bfe_u32 v33, v29, 3, 1
  v_and_b32 v29, 3, v29
  v_lshl_add_u32 v34, v33, 2, v29
  v_lshl_add_u32 v34, v31, 3, v34
  v_add_u32 v32, v32, v34
  v_mul_u32_u24 v32, 1280, v32
  v_lshl_add_u32 v146, v30, 4, v32
  v_cmp_le_u32 vcc, 20, v34
  v_mov_b32 v28, 0x7fff0000
  s_nop 0
  v_cndmask_b32 v146, v146, v28, vcc
  v_add_u32 v28, 192, v1
  v_mul_u32_u24 v29, 6554, v28
  v_lshrrev_b32 v29, 16, v29
  v_mul_u32_u24 v30, 10, v29
  v_sub_u32 v30, v28, v30
  v_lshrrev_b32 v31, 4, v29
  v_bfe_u32 v32, v29, 2, 1
  v_lshl_add_u32 v31, v31, 1, v32
  v_add_u32 v31, s36, v31
  v_mul_u32_u24 v32, 171, v31
  v_lshrrev_b32 v32, 9, v32
  v_mul_u32_u24 v33, 3, v32
  v_sub_u32 v31, v31, v33
  v_mul_u32_u24 v32, 20, v32
  v_bfe_u32 v33, v29, 3, 1
  v_and_b32 v29, 3, v29
  v_lshl_add_u32 v34, v33, 2, v29
  v_lshl_add_u32 v34, v31, 3, v34
  v_add_u32 v32, v32, v34
  v_mul_u32_u24 v32, 1280, v32
  v_lshl_add_u32 v147, v30, 4, v32
  v_cmp_le_u32 vcc, 20, v34
  v_mov_b32 v28, 0x7fff0000
  s_nop 0
  v_cndmask_b32 v147, v147, v28, vcc
  v_add_u32 v28, 256, v1
  v_mul_u32_u24 v29, 6554, v28
  v_lshrrev_b32 v29, 16, v29
  v_mul_u32_u24 v30, 10, v29
  v_sub_u32 v30, v28, v30
  v_lshrrev_b32 v31, 4, v29
  v_bfe_u32 v32, v29, 2, 1
  v_lshl_add_u32 v31, v31, 1, v32
  v_add_u32 v31, s36, v31
  v_mul_u32_u24 v32, 171, v31
  v_lshrrev_b32 v32, 9, v32
  v_mul_u32_u24 v33, 3, v32
  v_sub_u32 v31, v31, v33
  v_mul_u32_u24 v32, 20, v32
  v_bfe_u32 v33, v29, 3, 1
  v_and_b32 v29, 3, v29
  v_lshl_add_u32 v34, v33, 2, v29
  v_lshl_add_u32 v34, v31, 3, v34
  v_add_u32 v32, v32, v34
  v_mul_u32_u24 v32, 1280, v32
  v_lshl_add_u32 v148, v30, 4, v32
  v_cmp_le_u32 vcc, 20, v34
  v_mov_b32 v28, 0x7fff0000
  s_nop 0
  v_cndmask_b32 v148, v148, v28, vcc
g1_kernel_rp1696:
  s_waitcnt vmcnt(9) lgkmcnt(0)
  s_barrier
  s_mov_b32 s30, 256
  s_mul_i32 s31, s26, 2
  s_add_u32 m0, s27, 32768
  s_nop 0
  buffer_load_dwordx4 v58, s[8:11], s30 offen  lds
  s_add_u32 m0, s27, 33792
  s_nop 0
  buffer_load_dwordx4 v59, s[8:11], s30 offen  lds
  s_add_u32 m0, s27, 34816
  s_nop 0
  buffer_load_dwordx4 v60, s[8:11], s30 offen  lds
  s_add_u32 m0, s27, 35840
  s_nop 0
  buffer_load_dwordx4 v61, s[8:11], s30 offen  lds
  s_add_u32 m0, s28, 40960
  s_nop 0
  buffer_load_dwordx4 v62, s[12:15], s31 offen  lds
  s_add_u32 m0, s28, 41984
  s_nop 0
  buffer_load_dwordx4 v63, s[12:15], s31 offen  lds
  s_add_u32 m0, s28, 43008
  s_nop 0
  buffer_load_dwordx4 v64, s[12:15], s31 offen  lds
  s_add_u32 m0, s28, 44032
  s_nop 0
  buffer_load_dwordx4 v65, s[12:15], s31 offen  lds
  s_add_u32 m0, s28, 45056
  s_nop 0
  buffer_load_dwordx4 v66, s[12:15], s31 offen  lds
  s_waitcnt vmcnt(9)
  s_barrier
  s_mov_b32 s30, 384
  s_mul_i32 s31, s26, 3
  s_add_u32 m0, s27, 49152
  s_nop 0
  buffer_load_dwordx4 v58, s[8:11], s30 offen  lds
  s_add_u32 m0, s27, 50176
  s_nop 0
  buffer_load_dwordx4 v59, s[8:11], s30 offen  lds
  s_add_u32 m0, s27, 51200
  s_nop 0
  buffer_load_dwordx4 v60, s[8:11], s30 offen  lds
  s_add_u32 m0, s27, 52224
  s_nop 0
  buffer_load_dwordx4 v61, s[8:11], s30 offen  lds
  s_add_u32 m0, s28, 61440
  s_nop 0
  buffer_load_dwordx4 v62, s[12:15], s31 offen  lds
  s_add_u32 m0, s28, 62464
  s_nop 0
  buffer_load_dwordx4 v63, s[12:15], s31 offen  lds
  s_add_u32 m0, s28, 63488
  s_nop 0
  buffer_load_dwordx4 v64, s[12:15], s31 offen  lds
  s_add_u32 m0, s28, 64512
  s_nop 0
  buffer_load_dwordx4 v65, s[12:15], s31 offen  lds
  s_add_u32 m0, s28, 65536
  s_nop 0
  buffer_load_dwordx4 v66, s[12:15], s31 offen  lds
  s_waitcnt vmcnt(9)
  s_barrier
  s_mov_b32 s30, 512
  s_mul_i32 s31, s26, 4
  s_add_u32 m0, s27, 0
  s_nop 0
  buffer_load_dwordx4 v58, s[8:11], s30 offen  lds
  s_add_u32 m0, s27, 1024
  s_nop 0
  buffer_load_dwordx4 v59, s[8:11], s30 offen  lds
  s_add_u32 m0, s27, 2048
  s_nop 0
  buffer_load_dwordx4 v60, s[8:11], s30 offen  lds
  s_add_u32 m0, s27, 3072
  s_nop 0
  buffer_load_dwordx4 v61, s[8:11], s30 offen  lds
  s_add_u32 m0, s28, 0
  s_nop 0
  buffer_load_dwordx4 v62, s[12:15], s31 offen  lds
  s_add_u32 m0, s28, 1024
  s_nop 0
  buffer_load_dwordx4 v63, s[12:15], s31 offen  lds
  s_add_u32 m0, s28, 2048
  s_nop 0
  buffer_load_dwordx4 v64, s[12:15], s31 offen  lds
  s_add_u32 m0, s28, 3072
  s_nop 0
  buffer_load_dwordx4 v65, s[12:15], s31 offen  lds
  s_add_u32 m0, s28, 4096
  s_nop 0
  buffer_load_dwordx4 v66, s[12:15], s31 offen  lds
  s_waitcnt vmcnt(9)
  s_barrier
  s_mov_b32 s30, 640
  s_mul_i32 s31, s26, 5
  s_add_u32 m0, s27, 16384
  s_nop 0
  buffer_load_dwordx4 v58, s[8:11], s30 offen  lds
  s_add_u32 m0, s27, 17408
  s_nop 0
  buffer_load_dwordx4 v59, s[8:11], s30 offen  lds
  s_add_u32 m0, s27, 18432
  s_nop 0
  buffer_load_dwordx4 v60, s[8:11], s30 offen  lds
  s_add_u32 m0, s27, 19456
  s_nop 0
  buffer_load_dwordx4 v61, s[8:11], s30 offen  lds
  s_add_u32 m0, s28, 20480
  s_nop 0
  buffer_load_dwordx4 v62, s[12:15], s31 offen  lds
  s_add_u32 m0, s28, 21504
  s_nop 0
  buffer_load_dwordx4 v63, s[12:15], s31 offen  lds
  s_add_u32 m0, s28, 22528
  s_nop 0
  buffer_load_dwordx4 v64, s[12:15], s31 offen  lds
  s_add_u32 m0, s28, 23552
  s_nop 0
  buffer_load_dwordx4 v65, s[12:15], s31 offen  lds
  s_add_u32 m0, s28, 24576
  s_nop 0
  buffer_load_dwordx4 v66, s[12:15], s31 offen  lds
  s_waitcnt vmcnt(9)
  s_barrier
  s_mov_b32 s30, 768
  s_mul_i32 s31, s26, 6
  s_add_u32 m0, s27, 32768
  s_nop 0
  buffer_load_dwordx4 v58, s[8:11], s30 offen  lds
  s_add_u32 m0, s27, 33792
  s_nop 0
  buffer_load_dwordx4 v59, s[8:11], s30 offen  lds
  s_add_u32 m0, s27, 34816
  s_nop 0
  buffer_load_dwordx4 v60, s[8:11], s30 offen  lds
  s_add_u32 m0, s27, 35840
  s_nop 0
  buffer_load_dwordx4 v61, s[8:11], s30 offen  lds
  s_add_u32 m0, s28, 40960
  s_nop 0
  buffer_load_dwordx4 v62, s[12:15], s31 offen  lds
  s_add_u32 m0, s28, 41984
  s_nop 0
  buffer_load_dwordx4 v63, s[12:15], s31 offen  lds
  s_add_u32 m0, s28, 43008
  s_nop 0
  buffer_load_dwordx4 v64, s[12:15], s31 offen  lds
  s_add_u32 m0, s28, 44032
  s_nop 0
  buffer_load_dwordx4 v65, s[12:15], s31 offen  lds
  s_add_u32 m0, s28, 45056
  s_nop 0
  buffer_load_dwordx4 v66, s[12:15], s31 offen  lds
  s_waitcnt vmcnt(9)
  s_barrier
  s_mov_b32 s30, 896
  s_mul_i32 s31, s26, 7
  s_add_u32 m0, s27, 49152
  s_nop 0
  buffer_load_dwordx4 v58, s[8:11], s30 offen  lds
  s_add_u32 m0, s27, 50176
  s_nop 0
  buffer_load_dwordx4 v59, s[8:11], s30 offen  lds
  s_add_u32 m0, s27, 51200
  s_nop 0
  buffer_load_dwordx4 v60, s[8:11], s30 offen  lds
  s_add_u32 m0, s27, 52224
  s_nop 0
  buffer_load_dwordx4 v61, s[8:11], s30 offen  lds
  s_add_u32 m0, s28, 61440
  s_nop 0
  buffer_load_dwordx4 v62, s[12:15], s31 offen  lds
  s_add_u32 m0, s28, 62464
  s_nop 0
  buffer_load_dwordx4 v63, s[12:15], s31 offen  lds
  s_add_u32 m0, s28, 63488
  s_nop 0
  buffer_load_dwordx4 v64, s[12:15], s31 offen  lds
  s_add_u32 m0, s28, 64512
  s_nop 0
  buffer_load_dwordx4 v65, s[12:15], s31 offen  lds
  s_add_u32 m0, s28, 65536
  s_nop 0
  buffer_load_dwordx4 v66, s[12:15], s31 offen  lds
  s_waitcnt vmcnt(9)
  s_barrier
  s_mov_b32 s30, 1024
  s_mul_i32 s31, s26, 8
  s_add_u32 m0, s27, 0
  s_nop 0
  buffer_load_dwordx4 v58, s[8:11], s30 offen  lds
  s_add_u32 m0, s27, 1024
  s_nop 0
  buffer_load_dwordx4 v59, s[8:11], s30 offen  lds
  s_add_u32 m0, s27, 2048
  s_nop 0
  buffer_load_dwordx4 v60, s[8:11], s30 offen  lds
  s_add_u32 m0, s27, 3072
  s_nop 0
  buffer_load_dwordx4 v61, s[8:11], s30 offen  lds
  s_add_u32 m0, s28, 0
  s_nop 0
  buffer_load_dwordx4 v62, s[12:15], s31 offen  lds
  s_add_u32 m0, s28, 1024
  s_nop 0
  buffer_load_dwordx4 v63, s[12:15], s31 offen  lds
  s_add_u32 m0, s28, 2048
  s_nop 0
  buffer_load_dwordx4 v64, s[12:15], s31 offen  lds
  s_add_u32 m0, s28, 3072
  s_nop 0
  buffer_load_dwordx4 v65, s[12:15], s31 offen  lds
  s_add_u32 m0, s28, 4096
  s_nop 0
  buffer_load_dwordx4 v66, s[12:15], s31 offen  lds
  s_waitcnt vmcnt(9)
  s_barrier
  s_mov_b32 s30, 1152
  s_mul_i32 s31, s26, 9
  s_add_u32 m0, s27, 16384
  s_nop 0
  buffer_load_dwordx4 v58, s[8:11], s30 offen  lds
  s_add_u32 m0, s27, 17408
  s_nop 0
  buffer_load_dwordx4 v59, s[8:11], s30 offen  lds
  s_add_u32 m0, s27, 18432
  s_nop 0
  buffer_load_dwordx4 v60, s[8:11], s30 offen  lds
  s_add_u32 m0, s27, 19456
  s_nop 0
  buffer_load_dwordx4 v61, s[8:11], s30 offen  lds
  s_add_u32 m0, s28, 20480
  s_nop 0
  buffer_load_dwordx4 v62, s[12:15], s31 offen  lds
  s_add_u32 m0, s28, 21504
  s_nop 0
  buffer_load_dwordx4 v63, s[12:15], s31 offen  lds
  s_add_u32 m0, s28, 22528
  s_nop 0
  buffer_load_dwordx4 v64, s[12:15], s31 offen  lds
  s_add_u32 m0, s28, 23552
  s_nop 0
  buffer_load_dwordx4 v65, s[12:15], s31 offen  lds
  s_add_u32 m0, s28, 24576
  s_nop 0
  buffer_load_dwordx4 v66, s[12:15], s31 offen  lds
  s_waitcnt vmcnt(9)
  s_barrier
  s_waitcnt vmcnt(0)
  s_barrier
  s_cmp_lg_u32 s29, 0
  s_cbranch_scc1 g1_kernel_ri3100
  s_mov_b32 m0, 32768
  s_nop 0
  buffer_load_dwordx4 v144, s[76:79], s69 offen nt lds
  s_mov_b32 m0, 33792
  s_nop 0
  buffer_load_dwordx4 v145, s[76:79], s69 offen nt lds
  s_mov_b32 m0, 34816
  s_nop 0
  buffer_load_dwordx4 v146, s[76:79], s69 offen nt lds
  s_add_u32 s69, s69, 786432
  s_mov_b32 m0, 35840
  s_nop 0
  buffer_load_dwordx4 v144, s[76:79], s69 offen nt lds
  s_mov_b32 m0, 36864
  s_nop 0
  buffer_load_dwordx4 v145, s[76:79], s69 offen nt lds
  s_mov_b32 m0, 37888
  s_nop 0
  buffer_load_dwordx4 v146, s[76:79], s69 offen nt lds
  s_add_u32 s69, s69, 786432
  s_cmp_ge_u32 s21, 8
  s_cbranch_scc1 g1_kernel_rix101
  s_mov_b32 m0, 38912
  s_nop 0
  buffer_load_dwordx4 v144, s[76:79], s69 offen nt lds
  s_mov_b32 m0, 39936
  s_nop 0
  buffer_load_dwordx4 v145, s[76:79], s69 offen nt lds
  s_mov_b32 m0, 40960
  s_nop 0
  buffer_load_dwordx4 v146, s[76:79], s69 offen nt lds
  s_add_u32 s69, s69, 786432
  s_branch g1_kernel_rix101
g1_kernel_ri3100:
  s_cmp_eq_u32 s65, 0
  s_cbranch_scc1 g1_kernel_rix101
  s_add_u32 m0, s70, 0
  s_nop 0
  buffer_load_dwordx4 v144, s[76:79], s69 offen nt lds
  s_add_u32 m0, s70, 1024
  s_nop 0
  buffer_load_dwordx4 v145, s[76:79], s69 offen nt lds
  s_add_u32 m0, s70, 2048
  s_nop 0
  buffer_load_dwordx4 v146, s[76:79], s69 offen nt lds
  s_add_u32 m0, s70, 3072
  s_nop 0
  buffer_load_dwordx4 v147, s[76:79], s69 offen nt lds
  s_add_u32 m0, s70, 4096
  s_nop 0
  buffer_load_dwordx4 v148, s[76:79], s69 offen nt lds
g1_kernel_rix101:
  s_barrier
  s_barrier
  s_waitcnt vmcnt(0)
  s_cmp_lg_u32 s29, 0
  s_cbranch_scc1 g1_kernel_rf16102
  v_lshrrev_b32 v28, 4, v1
  v_and_b32 v29, 15, v1
  v_lshrrev_b32 v30, 2, v29
  v_and_b32 v29, 3, v29
  v_lshrrev_b32 v31, 1, v28
  v_lshlrev_b32 v31, 3, v31
  v_add_u32 v30, v30, v31
  v_mul_u32_u24 v30, 192, v30
  v_and_b32 v28, 1, v28
  v_lshlrev_b32 v28, 5, v28
  v_lshlrev_b32 v29, 3, v29
  v_add3_u32 v28, v30, v28, v29
  v_lshlrev_b32 v29, 4, v1
  v_mov_b32 v140, 0
  v_mov_b32 v141, 0
  v_mov_b32 v142, 0
  ds_read_b64_tr_b16 v[120:121], v28 offset:32768
  ds_read_b64_tr_b16 v[122:123], v28 offset:33536
  ds_read_b64_tr_b16 v[124:125], v28 offset:32832
  ds_read_b64_tr_b16 v[126:127], v28 offset:33600
  ds_read_b64_tr_b16 v[128:129], v28 offset:32896
  ds_read_b64_tr_b16 v[130:131], v28 offset:33664
  s_add_u32 s34, s21, 0
  s_mul_i32 s35, s32, 40
  s_add_u32 s34, s34, s35
  s_mul_i32 s34, s34, 3072
  s_add_u32 s34, s34, 28442624
  s_waitcnt lgkmcnt(0)
  buffer_store_dwordx4 v[120:123], v29, s[16:19], s34 offen offset:0 sc1
  buffer_store_dwordx4 v[124:127], v29, s[16:19], s34 offen offset:1024 sc1
  buffer_store_dwordx4 v[128:131], v29, s[16:19], s34 offen offset:2048 sc1
  v_dot2_f32_bf16 v140, v120, v4, v140
  v_dot2_f32_bf16 v140, v121, v4, v140
  v_dot2_f32_bf16 v140, v122, v4, v140
  v_dot2_f32_bf16 v140, v123, v4, v140
  v_dot2_f32_bf16 v141, v124, v4, v141
  v_dot2_f32_bf16 v141, v125, v4, v141
  v_dot2_f32_bf16 v141, v126, v4, v141
  v_dot2_f32_bf16 v141, v127, v4, v141
  v_dot2_f32_bf16 v142, v128, v4, v142
  v_dot2_f32_bf16 v142, v129, v4, v142
  v_dot2_f32_bf16 v142, v130, v4, v142
  v_dot2_f32_bf16 v142, v131, v4, v142
  s_nop 1
g1_kernel_rf3s104:
  ds_read_b64_tr_b16 v[120:121], v28 offset:35840
  ds_read_b64_tr_b16 v[122:123], v28 offset:36608
  ds_read_b64_tr_b16 v[124:125], v28 offset:35904
  ds_read_b64_tr_b16 v[126:127], v28 offset:36672
  ds_read_b64_tr_b16 v[128:129], v28 offset:35968
  ds_read_b64_tr_b16 v[130:131], v28 offset:36736
  s_add_u32 s34, s21, 16
  s_mul_i32 s35, s32, 40
  s_add_u32 s34, s34, s35
  s_mul_i32 s34, s34, 3072
  s_add_u32 s34, s34, 28442624
  s_waitcnt lgkmcnt(0)
  buffer_store_dwordx4 v[120:123], v29, s[16:19], s34 offen offset:0 sc1
  buffer_store_dwordx4 v[124:127], v29, s[16:19], s34 offen offset:1024 sc1
  buffer_store_dwordx4 v[128:131], v29, s[16:19], s34 offen offset:2048 sc1
  v_dot2_f32_bf16 v140, v120, v4, v140
  v_dot2_f32_bf16 v140, v121, v4, v140
  v_dot2_f32_bf16 v140, v122, v4, v140
  v_dot2_f32_bf16 v140, v123, v4, v140
  v_dot2_f32_bf16 v141, v124, v4, v141
  v_dot2_f32_bf16 v141, v125, v4, v141
  v_dot2_f32_bf16 v141, v126, v4, v141
  v_dot2_f32_bf16 v141, v127, v4, v141
  v_dot2_f32_bf16 v142, v128, v4, v142
  v_dot2_f32_bf16 v142, v129, v4, v142
  v_dot2_f32_bf16 v142, v130, v4, v142
  v_dot2_f32_bf16 v142, v131, v4, v142
  s_nop 1
g1_kernel_rf3s105:
  s_cmp_ge_u32 s21, 8
  s_cbranch_scc1 g1_kernel_rf3s106
  ds_read_b64_tr_b16 v[120:121], v28 offset:38912
  ds_read_b64_tr_b16 v[122:123], v28 offset:39680
  ds_read_b64_tr_b16 v[124:125], v28 offset:38976
  ds_read_b64_tr_b16 v[126:127], v28 offset:39744
  ds_read_b64_tr_b16 v[128:129], v28 offset:39040
  ds_read_b64_tr_b16 v[130:131], v28 offset:39808
  s_add_u32 s34, s21, 32
  s_mul_i32 s35, s32, 40
  s_add_u32 s34, s34, s35
  s_mul_i32 s34, s34, 3072
  s_add_u32 s34, s34, 28442624
  s_waitcnt lgkmcnt(0)
  buffer_store_dwordx4 v[120:123], v29, s[16:19], s34 offen offset:0 sc1
  buffer_store_dwordx4 v[124:127], v29, s[16:19], s34 offen offset:1024 sc1
  buffer_store_dwordx4 v[128:131], v29, s[16:19], s34 offen offset:2048 sc1
  v_dot2_f32_bf16 v140, v120, v4, v140
  v_dot2_f32_bf16 v140, v121, v4, v140
  v_dot2_f32_bf16 v140, v122, v4, v140
  v_dot2_f32_bf16 v140, v123, v4, v140
  v_dot2_f32_bf16 v141, v124, v4, v141
  v_dot2_f32_bf16 v141, v125, v4, v141
  v_dot2_f32_bf16 v141, v126, v4, v141
  v_dot2_f32_bf16 v141, v127, v4, v141
  v_dot2_f32_bf16 v142, v128, v4, v142
  v_dot2_f32_bf16 v142, v129, v4, v142
  v_dot2_f32_bf16 v142, v130, v4, v142
  v_dot2_f32_bf16 v142, v131, v4, v142
  s_nop 1
g1_kernel_rf3s106:
  v_mov_b32 v32, v140
  s_nop 1
  v_permlane32_swap_b32 v140, v32
  v_add_f32 v140, v140, v32
  v_mov_b32 v33, v141
  s_nop 1
  v_permlane32_swap_b32 v141, v33
  v_add_f32 v141, v141, v33
  v_mov_b32 v34, v142
  s_nop 1
  v_permlane32_swap_b32 v142, v34
  v_add_f32 v142, v142, v34
  s_mul_i32 s34, s32, 6144
  s_mul_i32 s35, s21, 384
  s_add_u32 s34, s34, s35
  s_add_u32 s34, s34, 14188544
  v_lshlrev_b32 v28, 2, v2
  s_mov_b32 exec_hi, 0
  buffer_store_dword v140, v28, s[16:19], s34 offen offset:0
  buffer_store_dword v141, v28, s[16:19], s34 offen offset:128
  buffer_store_dword v142, v28, s[16:19], s34 offen offset:256
  s_branch g1_kernel_end1
g1_kernel_rf16102:
  s_cmp_eq_u32 s65, 0
  s_cbranch_scc1 g1_kernel_end1
  v_lshrrev_b32 v31, 4, v1
  v_and_b32 v30, 15, v1
  v_lshrrev_b32 v28, 1, v31
  v_lshlrev_b32 v28, 4, v28
  v_and_b32 v29, 1, v31
  v_lshl_add_u32 v28, v29, 2, v28
  v_lshrrev_b32 v29, 2, v30
  v_add_u32 v28, v28, v29
  v_mul_u32_u24 v28, 160, v28
  v_and_b32 v29, 3, v30
  v_lshl_add_u32 v28, v29, 3, v28
  s_sub_u32 s70, s29, 1
  s_mul_i32 s70, s70, 5120
  s_add_u32 s70, s70, 106496
  v_add_u32 v28, s70, v28
  ds_read_b64_tr_b16 v[120:121], v28 offset:0
  ds_read_b64_tr_b16 v[122:123], v28 offset:1280
  ds_read_b64_tr_b16 v[124:125], v28 offset:32
  ds_read_b64_tr_b16 v[126:127], v28 offset:1312
  ds_read_b64_tr_b16 v[128:129], v28 offset:64
  ds_read_b64_tr_b16 v[130:131], v28 offset:1344
  ds_read_b64_tr_b16 v[132:133], v28 offset:96
  ds_read_b64_tr_b16 v[134:135], v28 offset:1376
  ds_read_b64_tr_b16 v[136:137], v28 offset:128
  ds_read_b64_tr_b16 v[138:139], v28 offset:1408
  v_lshlrev_b32 v29, 4, v1
  s_add_u32 s70, s67, 4096
  s_waitcnt lgkmcnt(0)
  buffer_store_dwordx4 v[120:123], v29, s[16:19], s67 offen offset:0 sc1
  buffer_store_dwordx4 v[124:127], v29, s[16:19], s67 offen offset:1024 sc1
  buffer_store_dwordx4 v[128:131], v29, s[16:19], s67 offen offset:2048 sc1
  buffer_store_dwordx4 v[132:135], v29, s[16:19], s67 offen offset:3072 sc1
  buffer_store_dwordx4 v[136:139], v29, s[16:19], s70 offen offset:0 sc1
g1_kernel_end1:
  s_endpgm
.section .rodata,"a"
.p2align 6
.amdhsa_kernel g1_kernel
  .amdhsa_next_free_vgpr 252
  .amdhsa_next_free_sgpr 102
  .amdhsa_accum_offset 252
  .amdhsa_group_segment_fixed_size 0
  .amdhsa_kernarg_size 88
  .amdhsa_user_sgpr_count 2
  .amdhsa_user_sgpr_kernarg_segment_ptr 1
  .amdhsa_system_sgpr_workgroup_id_x 1
.end_amdhsa_kernel
.text
.globl l2_kernel
.p2align 8
.type l2_kernel,@function
l2_kernel:
  s_cmp_ge_u32 s2, 512
  s_cbranch_scc1 l2_kernel_end1
  s_cmp_ge_u32 s2, 256
  s_cbranch_scc1 l2_kernel_att2
  s_setprio 2
  s_load_dwordx2 s[4:5], s[0:1], 80
  s_load_dwordx2 s[40:41], s[0:1], 0
  s_and_b32 s36, s2, 7
  s_lshr_b32 s37, s2, 3
  s_and_b32 s38, s36, 3
  s_lshl_b32 s38, s38, 3
  s_and_b32 s39, s37, 7
  s_add_u32 s21, s38, s39
  s_lshr_b32 s38, s36, 2
  s_lshl_b32 s38, s38, 2
  s_lshr_b32 s46, s37, 3
  s_add_u32 s22, s38, s46
  v_and_b32 v1, 63, v0
  v_lshrrev_b32 v232, 6, v0
  v_and_b32 v2, 15, v1
  v_readfirstlane_b32 s20, v232
  v_lshrrev_b32 v3, 4, v1
  v_lshlrev_b32 v8, 4, v1
  s_add_u32 s47, s39, s46
  s_mul_i32 s48, s47, 52
  s_lshr_b32 s48, s48, 8
  s_mul_i32 s48, s48, 5
  s_sub_u32 s34, s47, s48
  s_add_u32 s47, s20, 0
  s_and_b32 s47, s47, 3
  s_mul_i32 s47, s47, 20480
  v_add_u32 v4, s47, v8
  s_add_u32 s47, s20, 1
  s_and_b32 s47, s47, 3
  s_mul_i32 s47, s47, 20480
  v_add_u32 v5, s47, v8
  s_add_u32 s47, s20, 2
  s_and_b32 s47, s47, 3
  s_mul_i32 s47, s47, 20480
  v_add_u32 v6, s47, v8
  s_add_u32 s47, s20, 3
  s_and_b32 s47, s47, 3
  s_mul_i32 s47, s47, 20480
  v_add_u32 v7, s47, v8
  s_add_u32 s47, s20, 0
  s_and_b32 s47, s47, 3
  s_lshl_b32 s47, s47, 4
  s_lshl_b32 s48, s21, 6
  s_add_u32 s47, s47, s48
  v_add_u32 v244, s47, v2
  s_add_u32 s47, s20, 1
  s_and_b32 s47, s47, 3
  s_lshl_b32 s47, s47, 4
  s_lshl_b32 s48, s21, 6
  s_add_u32 s47, s47, s48
  v_add_u32 v245, s47, v2
  s_add_u32 s47, s20, 2
  s_and_b32 s47, s47, 3
  s_lshl_b32 s47, s47, 4
  s_lshl_b32 s48, s21, 6
  s_add_u32 s47, s47, s48
  v_add_u32 v246, s47, v2
  s_add_u32 s47, s20, 3
  s_and_b32 s47, s47, 3
  s_lshl_b32 s47, s47, 4
  s_lshl_b32 s48, s21, 6
  s_add_u32 s47, s47, s48
  v_add_u32 v247, s47, v2
  v_lshlrev_b32 v248, 8, v3
  v_mov_b32 v249, 0x7ff00000
  s_mul_i32 s33, s20, 15360
  s_mul_i32 s56, s21, 80
  s_add_u32 s56, s56, 0
  s_lshl_b32 s56, s56, 10
  s_add_u32 s56, s56, 8912896
  s_mul_i32 s57, s22, 20
  s_add_u32 s57, s57, 0
  s_mul_i32 s57, s57, 5120
  s_add_u32 s57, s57, 24641536
  s_waitcnt lgkmcnt(0)
  s_mov_b32 s8, s4
  s_and_b32 s9, s5, 0xffff
  s_mov_b32 s10, 37748736
  s_mov_b32 s11, 0x20000
  s_mov_b32 s24, s40
  s_and_b32 s25, s41, 0xffff
  s_mov_b32 s26, 2621440
  s_mov_b32 s27, 0x20000
  s_add_u32 s47, s34, 0
  s_cmp_ge_u32 s47, 5
  s_cselect_b32 s48, 5, 0
  s_sub_u32 s47, s47, s48
  s_lshl_b32 s47, s47, 2
  s_add_u32 s47, s47, s20
  s_lshl_b32 s61, s47, 10
  s_add_u32 s61, s61, 8912896
  s_mul_i32 s62, s47, 52
  s_lshr_b32 s62, s62, 8
  s_and_b32 s63, s62, 1
  s_lshr_b32 s62, s62, 1
  s_add_u32 s62, s62, 1
  s_sub_u32 s48, 0, s62
  s_cmp_eq_u32 s63, 0
  s_cselect_b32 s62, s62, s48
  s_mul_i32 s32, s47, 5120
  s_add_u32 s32, s32, s57
  s_add_u32 s35, s32, 4096
  s_lshl_b32 s47, s47, 10
  s_add_u32 s23, s47, s56
  buffer_load_dwordx4 v[140:143], v8, s[8:11], s32 offen offset:0
  buffer_load_dwordx4 v[144:147], v8, s[8:11], s32 offen offset:1024
  buffer_load_dwordx4 v[148:151], v8, s[8:11], s32 offen offset:2048
  buffer_load_dwordx4 v[152:155], v8, s[8:11], s32 offen offset:3072
  buffer_load_dwordx4 v[156:159], v8, s[8:11], s35 offen offset:0
  v_subrev_u32 v242, s62, v244
  v_lshrrev_b32 v243, 4, v242
  v_mul_u32_u24 v243, 20480, v243
  v_and_b32 v92, 15, v242
  v_lshl_add_u32 v243, v92, 4, v243
  v_add_u32 v243, v243, v248
  v_cmp_gt_u32 vcc, 2048, v242
  s_nop 1
  v_cndmask_b32 v243, v249, v243, vcc
  buffer_load_dwordx4 v[92:95], v243, s[8:11], s61 offen
  v_subrev_u32 v242, s62, v245
  v_lshrrev_b32 v243, 4, v242
  v_mul_u32_u24 v243, 20480, v243
  v_and_b32 v96, 15, v242
  v_lshl_add_u32 v243, v96, 4, v243
  v_add_u32 v243, v243, v248
  v_cmp_gt_u32 vcc, 2048, v242
  s_nop 1
  v_cndmask_b32 v243, v249, v243, vcc
  buffer_load_dwordx4 v[96:99], v243, s[8:11], s61 offen
  v_subrev_u32 v242, s62, v246
  v_lshrrev_b32 v243, 4, v242
  v_mul_u32_u24 v243, 20480, v243
  v_and_b32 v100, 15, v242
  v_lshl_add_u32 v243, v100, 4, v243
  v_add_u32 v243, v243, v248
  v_cmp_gt_u32 vcc, 2048, v242
  s_nop 1
  v_cndmask_b32 v243, v249, v243, vcc
  buffer_load_dwordx4 v[100:103], v243, s[8:11], s61 offen
  v_subrev_u32 v242, s62, v247
  v_lshrrev_b32 v243, 4, v242
  v_mul_u32_u24 v243, 20480, v243
  v_and_b32 v104, 15, v242
  v_lshl_add_u32 v243, v104, 4, v243
  v_add_u32 v243, v243, v248
  v_cmp_gt_u32 vcc, 2048, v242
  s_nop 1
  v_cndmask_b32 v243, v249, v243, vcc
  buffer_load_dwordx4 v[104:107], v243, s[8:11], s61 offen
  s_add_u32 s47, s34, 1
  s_cmp_ge_u32 s47, 5
  s_cselect_b32 s48, 5, 0
  s_sub_u32 s47, s47, s48
  s_lshl_b32 s47, s47, 2
  s_add_u32 s47, s47, s20
  s_lshl_b32 s61, s47, 10
  s_add_u32 s61, s61, 8912896
  s_mul_i32 s62, s47, 52
  s_lshr_b32 s62, s62, 8
  s_and_b32 s63, s62, 1
  s_lshr_b32 s62, s62, 1
  s_add_u32 s62, s62, 1
  s_sub_u32 s48, 0, s62
  s_cmp_eq_u32 s63, 0
  s_cselect_b32 s62, s62, s48
  s_mul_i32 s32, s47, 5120
  s_add_u32 s32, s32, s57
  s_add_u32 s35, s32, 4096
  s_lshl_b32 s47, s47, 10
  s_add_u32 s23, s47, s56
  buffer_load_dwordx4 v[160:163], v8, s[8:11], s32 offen offset:0
  buffer_load_dwordx4 v[164:167], v8, s[8:11], s32 offen offset:1024
  buffer_load_dwordx4 v[168:171], v8, s[8:11], s32 offen offset:2048
  buffer_load_dwordx4 v[172:175], v8, s[8:11], s32 offen offset:3072
  buffer_load_dwordx4 v[176:179], v8, s[8:11], s35 offen offset:0
  v_subrev_u32 v242, s62, v244
  v_lshrrev_b32 v243, 4, v242
  v_mul_u32_u24 v243, 20480, v243
  v_and_b32 v108, 15, v242
  v_lshl_add_u32 v243, v108, 4, v243
  v_add_u32 v243, v243, v248
  v_cmp_gt_u32 vcc, 2048, v242
  s_nop 1
  v_cndmask_b32 v243, v249, v243, vcc
  buffer_load_dwordx4 v[108:111], v243, s[8:11], s61 offen
  v_subrev_u32 v242, s62, v245
  v_lshrrev_b32 v243, 4, v242
  v_mul_u32_u24 v243, 20480, v243
  v_and_b32 v112, 15, v242
  v_lshl_add_u32 v243, v112, 4, v243
  v_add_u32 v243, v243, v248
  v_cmp_gt_u32 vcc, 2048, v242
  s_nop 1
  v_cndmask_b32 v243, v249, v243, vcc
  buffer_load_dwordx4 v[112:115], v243, s[8:11], s61 offen
  v_subrev_u32 v242, s62, v246
  v_lshrrev_b32 v243, 4, v242
  v_mul_u32_u24 v243, 20480, v243
  v_and_b32 v116, 15, v242
  v_lshl_add_u32 v243, v116, 4, v243
  v_add_u32 v243, v243, v248
  v_cmp_gt_u32 vcc, 2048, v242
  s_nop 1
  v_cndmask_b32 v243, v249, v243, vcc
  buffer_load_dwordx4 v[116:119], v243, s[8:11], s61 offen
  v_subrev_u32 v242, s62, v247
  v_lshrrev_b32 v243, 4, v242
  v_mul_u32_u24 v243, 20480, v243
  v_and_b32 v120, 15, v242
  v_lshl_add_u32 v243, v120, 4, v243
  v_add_u32 v243, v243, v248
  v_cmp_gt_u32 vcc, 2048, v242
  s_nop 1
  v_cndmask_b32 v243, v249, v243, vcc
  buffer_load_dwordx4 v[120:123], v243, s[8:11], s61 offen
  s_lshl_b32 s47, s21, 6
  s_lshl_b32 s48, s20, 4
  s_add_u32 s47, s47, s48
  v_add_u32 v236, s47, v2
  v_mul_u32_u24 v238, 1280, v236
  v_lshl_add_u32 v238, v3, 3, v238
  s_mul_i32 s49, s22, 160
  s_lshl_b32 s54, s2, 2
  s_add_u32 s54, s54, s20
  s_mul_i32 s54, s54, 5120
  s_add_u32 s54, s54, 31981568
  s_add_u32 s55, s54, 4096
  v_lshrrev_b32 v232, 5, v236
  v_mul_u32_u24 v232, 40960, v232
  v_and_b32 v233, 31, v236
  v_lshrrev_b32 v234, 1, v3
  v_lshl_add_u32 v233, v234, 5, v233
  v_lshl_add_u32 v232, v233, 4, v232
  v_and_b32 v233, 1, v3
  v_lshl_add_u32 v237, v233, 3, v232
  s_mul_i32 s50, s22, 5120
  s_add_u32 s50, s50, 11534336
  s_add_u32 s51, s50, 4096
  s_waitcnt vmcnt(9)
  s_add_u32 s47, s34, 2
  s_cmp_ge_u32 s47, 5
  s_cselect_b32 s48, 5, 0
  s_sub_u32 s47, s47, s48
  s_lshl_b32 s47, s47, 2
  s_add_u32 s47, s47, s20
  s_lshl_b32 s61, s47, 10
  s_add_u32 s61, s61, 8912896
  s_mul_i32 s62, s47, 52
  s_lshr_b32 s62, s62, 8
  s_and_b32 s63, s62, 1
  s_lshr_b32 s62, s62, 1
  s_add_u32 s62, s62, 1
  s_sub_u32 s48, 0, s62
  s_cmp_eq_u32 s63, 0
  s_cselect_b32 s62, s62, s48
  s_mul_i32 s32, s47, 5120
  s_add_u32 s32, s32, s57
  s_add_u32 s35, s32, 4096
  s_lshl_b32 s47, s47, 10
  s_add_u32 s23, s47, s56
  v_mfma_f32_16x16x32_bf16 v[12:15], v[140:143], v[92:95], 0
  v_mfma_f32_16x16x32_bf16 v[16:19], v[144:147], v[92:95], 0
  buffer_load_dwordx4 v[180:183], v8, s[8:11], s32 offen offset:0
  v_mfma_f32_16x16x32_bf16 v[20:23], v[148:151], v[92:95], 0
  v_mfma_f32_16x16x32_bf16 v[24:27], v[152:155], v[92:95], 0
  buffer_load_dwordx4 v[184:187], v8, s[8:11], s32 offen offset:1024
  v_mfma_f32_16x16x32_bf16 v[28:31], v[156:159], v[92:95], 0
  v_mfma_f32_16x16x32_bf16 v[32:35], v[140:143], v[96:99], 0
  buffer_load_dwordx4 v[188:191], v8, s[8:11], s32 offen offset:2048
  v_mfma_f32_16x16x32_bf16 v[36:39], v[144:147], v[96:99], 0
  v_mfma_f32_16x16x32_bf16 v[40:43], v[148:151], v[96:99], 0
  buffer_load_dwordx4 v[192:195], v8, s[8:11], s32 offen offset:3072
  v_mfma_f32_16x16x32_bf16 v[44:47], v[152:155], v[96:99], 0
  v_mfma_f32_16x16x32_bf16 v[48:51], v[156:159], v[96:99], 0
  buffer_load_dwordx4 v[196:199], v8, s[8:11], s35 offen offset:0
  v_mfma_f32_16x16x32_bf16 v[52:55], v[140:143], v[100:103], 0
  v_mfma_f32_16x16x32_bf16 v[56:59], v[144:147], v[100:103], 0
  v_subrev_u32 v242, s62, v244
  v_lshrrev_b32 v243, 4, v242
  v_mul_u32_u24 v243, 20480, v243
  v_and_b32 v124, 15, v242
  v_lshl_add_u32 v243, v124, 4, v243
  v_add_u32 v243, v243, v248
  v_cmp_gt_u32 vcc, 2048, v242
  s_nop 1
  v_cndmask_b32 v243, v249, v243, vcc
  buffer_load_dwordx4 v[124:127], v243, s[8:11], s61 offen
  v_mfma_f32_16x16x32_bf16 v[60:63], v[148:151], v[100:103], 0
  v_mfma_f32_16x16x32_bf16 v[64:67], v[152:155], v[100:103], 0
  v_subrev_u32 v242, s62, v245
  v_lshrrev_b32 v243, 4, v242
  v_mul_u32_u24 v243, 20480, v243
  v_and_b32 v128, 15, v242
  v_lshl_add_u32 v243, v128, 4, v243
  v_add_u32 v243, v243, v248
  v_cmp_gt_u32 vcc, 2048, v242
  s_nop 1
  v_cndmask_b32 v243, v249, v243, vcc
  buffer_load_dwordx4 v[128:131], v243, s[8:11], s61 offen
  v_mfma_f32_16x16x32_bf16 v[68:71], v[156:159], v[100:103], 0
  v_mfma_f32_16x16x32_bf16 v[72:75], v[140:143], v[104:107], 0
  v_subrev_u32 v242, s62, v246
  v_lshrrev_b32 v243, 4, v242
  v_mul_u32_u24 v243, 20480, v243
  v_and_b32 v132, 15, v242
  v_lshl_add_u32 v243, v132, 4, v243
  v_add_u32 v243, v243, v248
  v_cmp_gt_u32 vcc, 2048, v242
  s_nop 1
  v_cndmask_b32 v243, v249, v243, vcc
  buffer_load_dwordx4 v[132:135], v243, s[8:11], s61 offen
  v_mfma_f32_16x16x32_bf16 v[76:79], v[144:147], v[104:107], 0
  v_mfma_f32_16x16x32_bf16 v[80:83], v[148:151], v[104:107], 0
  v_subrev_u32 v242, s62, v247
  v_lshrrev_b32 v243, 4, v242
  v_mul_u32_u24 v243, 20480, v243
  v_and_b32 v136, 15, v242
  v_lshl_add_u32 v243, v136, 4, v243
  v_add_u32 v243, v243, v248
  v_cmp_gt_u32 vcc, 2048, v242
  s_nop 1
  v_cndmask_b32 v243, v249, v243, vcc
  buffer_load_dwordx4 v[136:139], v243, s[8:11], s61 offen
  v_mfma_f32_16x16x32_bf16 v[84:87], v[152:155], v[104:107], 0
  v_mfma_f32_16x16x32_bf16 v[88:91], v[156:159], v[104:107], 0
  s_waitcnt vmcnt(9)
  s_add_u32 s47, s34, 3
  s_cmp_ge_u32 s47, 5
  s_cselect_b32 s48, 5, 0
  s_sub_u32 s47, s47, s48
  s_lshl_b32 s47, s47, 2
  s_add_u32 s47, s47, s20
  s_lshl_b32 s61, s47, 10
  s_add_u32 s61, s61, 8912896
  s_mul_i32 s62, s47, 52
  s_lshr_b32 s62, s62, 8
  s_and_b32 s63, s62, 1
  s_lshr_b32 s62, s62, 1
  s_add_u32 s62, s62, 1
  s_sub_u32 s48, 0, s62
  s_cmp_eq_u32 s63, 0
  s_cselect_b32 s62, s62, s48
  s_mul_i32 s32, s47, 5120
  s_add_u32 s32, s32, s57
  s_add_u32 s35, s32, 4096
  s_lshl_b32 s47, s47, 10
  s_add_u32 s23, s47, s56
  v_mfma_f32_16x16x32_bf16 v[12:15], v[160:163], v[108:111], v[12:15]
  v_mfma_f32_16x16x32_bf16 v[16:19], v[164:167], v[108:111], v[16:19]
  buffer_load_dwordx4 v[140:143], v8, s[8:11], s32 offen offset:0
  v_mfma_f32_16x16x32_bf16 v[20:23], v[168:171], v[108:111], v[20:23]
  v_mfma_f32_16x16x32_bf16 v[24:27], v[172:175], v[108:111], v[24:27]
  buffer_load_dwordx4 v[144:147], v8, s[8:11], s32 offen offset:1024
  v_mfma_f32_16x16x32_bf16 v[28:31], v[176:179], v[108:111], v[28:31]
  v_mfma_f32_16x16x32_bf16 v[32:35], v[160:163], v[112:115], v[32:35]
  buffer_load_dwordx4 v[148:151], v8, s[8:11], s32 offen offset:2048
  v_mfma_f32_16x16x32_bf16 v[36:39], v[164:167], v[112:115], v[36:39]
  v_mfma_f32_16x16x32_bf16 v[40:43], v[168:171], v[112:115], v[40:43]
  buffer_load_dwordx4 v[152:155], v8, s[8:11], s32 offen offset:3072
  v_mfma_f32_16x16x32_bf16 v[44:47], v[172:175], v[112:115], v[44:47]
  v_mfma_f32_16x16x32_bf16 v[48:51], v[176:179], v[112:115], v[48:51]
  buffer_load_dwordx4 v[156:159], v8, s[8:11], s35 offen offset:0
  v_mfma_f32_16x16x32_bf16 v[52:55], v[160:163], v[116:119], v[52:55]
  v_mfma_f32_16x16x32_bf16 v[56:59], v[164:167], v[116:119], v[56:59]
  v_subrev_u32 v242, s62, v244
  v_lshrrev_b32 v243, 4, v242
  v_mul_u32_u24 v243, 20480, v243
  v_and_b32 v92, 15, v242
  v_lshl_add_u32 v243, v92, 4, v243
  v_add_u32 v243, v243, v248
  v_cmp_gt_u32 vcc, 2048, v242
  s_nop 1
  v_cndmask_b32 v243, v249, v243, vcc
  buffer_load_dwordx4 v[92:95], v243, s[8:11], s61 offen
  v_mfma_f32_16x16x32_bf16 v[60:63], v[168:171], v[116:119], v[60:63]
  v_mfma_f32_16x16x32_bf16 v[64:67], v[172:175], v[116:119], v[64:67]
  v_subrev_u32 v242, s62, v245
  v_lshrrev_b32 v243, 4, v242
  v_mul_u32_u24 v243, 20480, v243
  v_and_b32 v96, 15, v242
  v_lshl_add_u32 v243, v96, 4, v243
  v_add_u32 v243, v243, v248
  v_cmp_gt_u32 vcc, 2048, v242
  s_nop 1
  v_cndmask_b32 v243, v249, v243, vcc
  buffer_load_dwordx4 v[96:99], v243, s[8:11], s61 offen
  v_mfma_f32_16x16x32_bf16 v[68:71], v[176:179], v[116:119], v[68:71]
  v_mfma_f32_16x16x32_bf16 v[72:75], v[160:163], v[120:123], v[72:75]
  v_subrev_u32 v242, s62, v246
  v_lshrrev_b32 v243, 4, v242
  v_mul_u32_u24 v243, 20480, v243
  v_and_b32 v100, 15, v242
  v_lshl_add_u32 v243, v100, 4, v243
  v_add_u32 v243, v243, v248
  v_cmp_gt_u32 vcc, 2048, v242
  s_nop 1
  v_cndmask_b32 v243, v249, v243, vcc
  buffer_load_dwordx4 v[100:103], v243, s[8:11], s61 offen
  v_mfma_f32_16x16x32_bf16 v[76:79], v[164:167], v[120:123], v[76:79]
  v_mfma_f32_16x16x32_bf16 v[80:83], v[168:171], v[120:123], v[80:83]
  v_subrev_u32 v242, s62, v247
  v_lshrrev_b32 v243, 4, v242
  v_mul_u32_u24 v243, 20480, v243
  v_and_b32 v104, 15, v242
  v_lshl_add_u32 v243, v104, 4, v243
  v_add_u32 v243, v243, v248
  v_cmp_gt_u32 vcc, 2048, v242
  s_nop 1
  v_cndmask_b32 v243, v249, v243, vcc
  buffer_load_dwordx4 v[104:107], v243, s[8:11], s61 offen
  v_mfma_f32_16x16x32_bf16 v[84:87], v[172:175], v[120:123], v[84:87]
  v_mfma_f32_16x16x32_bf16 v[88:91], v[176:179], v[120:123], v[88:91]
  s_waitcnt vmcnt(9)
  s_add_u32 s47, s34, 4
  s_cmp_ge_u32 s47, 5
  s_cselect_b32 s48, 5, 0
  s_sub_u32 s47, s47, s48
  s_lshl_b32 s47, s47, 2
  s_add_u32 s47, s47, s20
  s_lshl_b32 s61, s47, 10
  s_add_u32 s61, s61, 8912896
  s_mul_i32 s62, s47, 52
  s_lshr_b32 s62, s62, 8
  s_and_b32 s63, s62, 1
  s_lshr_b32 s62, s62, 1
  s_add_u32 s62, s62, 1
  s_sub_u32 s48, 0, s62
  s_cmp_eq_u32 s63, 0
  s_cselect_b32 s62, s62, s48
  s_mul_i32 s32, s47, 5120
  s_add_u32 s32, s32, s57
  s_add_u32 s35, s32, 4096
  s_lshl_b32 s47, s47, 10
  s_add_u32 s23, s47, s56
  v_mfma_f32_16x16x32_bf16 v[12:15], v[180:183], v[124:127], v[12:15]
  v_mfma_f32_16x16x32_bf16 v[16:19], v[184:187], v[124:127], v[16:19]
  buffer_load_dwordx4 v[160:163], v8, s[8:11], s32 offen offset:0
  v_mfma_f32_16x16x32_bf16 v[20:23], v[188:191], v[124:127], v[20:23]
  v_mfma_f32_16x16x32_bf16 v[24:27], v[192:195], v[124:127], v[24:27]
  buffer_load_dwordx4 v[164:167], v8, s[8:11], s32 offen offset:1024
  v_mfma_f32_16x16x32_bf16 v[28:31], v[196:199], v[124:127], v[28:31]
  v_mfma_f32_16x16x32_bf16 v[32:35], v[180:183], v[128:131], v[32:35]
  buffer_load_dwordx4 v[168:171], v8, s[8:11], s32 offen offset:2048
  v_mfma_f32_16x16x32_bf16 v[36:39], v[184:187], v[128:131], v[36:39]
  v_mfma_f32_16x16x32_bf16 v[40:43], v[188:191], v[128:131], v[40:43]
  buffer_load_dwordx4 v[172:175], v8, s[8:11], s32 offen offset:3072
  v_mfma_f32_16x16x32_bf16 v[44:47], v[192:195], v[128:131], v[44:47]
  v_mfma_f32_16x16x32_bf16 v[48:51], v[196:199], v[128:131], v[48:51]
  buffer_load_dwordx4 v[176:179], v8, s[8:11], s35 offen offset:0
  v_mfma_f32_16x16x32_bf16 v[52:55], v[180:183], v[132:135], v[52:55]
  v_mfma_f32_16x16x32_bf16 v[56:59], v[184:187], v[132:135], v[56:59]
  v_subrev_u32 v242, s62, v244
  v_lshrrev_b32 v243, 4, v242
  v_mul_u32_u24 v243, 20480, v243
  v_and_b32 v108, 15, v242
  v_lshl_add_u32 v243, v108, 4, v243
  v_add_u32 v243, v243, v248
  v_cmp_gt_u32 vcc, 2048, v242
  s_nop 1
  v_cndmask_b32 v243, v249, v243, vcc
  buffer_load_dwordx4 v[108:111], v243, s[8:11], s61 offen
  v_mfma_f32_16x16x32_bf16 v[60:63], v[188:191], v[132:135], v[60:63]
  v_mfma_f32_16x16x32_bf16 v[64:67], v[192:195], v[132:135], v[64:67]
  v_subrev_u32 v242, s62, v245
  v_lshrrev_b32 v243, 4, v242
  v_mul_u32_u24 v243, 20480, v243
  v_and_b32 v112, 15, v242
  v_lshl_add_u32 v243, v112, 4, v243
  v_add_u32 v243, v243, v248
  v_cmp_gt_u32 vcc, 2048, v242
  s_nop 1
  v_cndmask_b32 v243, v249, v243, vcc
  buffer_load_dwordx4 v[112:115], v243, s[8:11], s61 offen
  v_mfma_f32_16x16x32_bf16 v[68:71], v[196:199], v[132:135], v[68:71]
  v_mfma_f32_16x16x32_bf16 v[72:75], v[180:183], v[136:139], v[72:75]
  v_subrev_u32 v242, s62, v246
  v_lshrrev_b32 v243, 4, v242
  v_mul_u32_u24 v243, 20480, v243
  v_and_b32 v116, 15, v242
  v_lshl_add_u32 v243, v116, 4, v243
  v_add_u32 v243, v243, v248
  v_cmp_gt_u32 vcc, 2048, v242
  s_nop 1
  v_cndmask_b32 v243, v249, v243, vcc
  buffer_load_dwordx4 v[116:119], v243, s[8:11], s61 offen
  v_mfma_f32_16x16x32_bf16 v[76:79], v[184:187], v[136:139], v[76:79]
  v_mfma_f32_16x16x32_bf16 v[80:83], v[188:191], v[136:139], v[80:83]
  v_subrev_u32 v242, s62, v247
  v_lshrrev_b32 v243, 4, v242
  v_mul_u32_u24 v243, 20480, v243
  v_and_b32 v120, 15, v242
  v_lshl_add_u32 v243, v120, 4, v243
  v_add_u32 v243, v243, v248
  v_cmp_gt_u32 vcc, 2048, v242
  s_nop 1
  v_cndmask_b32 v243, v249, v243, vcc
  buffer_load_dwordx4 v[120:123], v243, s[8:11], s61 offen
  v_mfma_f32_16x16x32_bf16 v[84:87], v[192:195], v[136:139], v[84:87]
  v_mfma_f32_16x16x32_bf16 v[88:91], v[196:199], v[136:139], v[88:91]
  v_and_b32 v232, 1, v3
  v_lshlrev_b32 v232, 5, v232
  v_lshrrev_b32 v233, 1, v3
  v_lshl_add_u32 v232, v233, 4, v232
  v_mul_u32_u24 v233, 1280, v236
  v_add_u32 v232, v232, v233
  buffer_load_dwordx4 v[200:203], v232, s[24:27], s49 offen offset:0
  buffer_load_dwordx4 v[204:207], v232, s[24:27], s49 offen offset:64
  buffer_load_dwordx2 v[208:209], v238, s[24:27], s49 offen offset:128
  v_lshlrev_b32 v232, 3, v236
  s_mov_b32 s52, 14163968
  buffer_load_dwordx2 v[230:231], v232, s[8:11], s52 offen
  s_waitcnt vmcnt(13)
  v_mfma_f32_16x16x32_bf16 v[12:15], v[140:143], v[92:95], v[12:15]
  v_mfma_f32_16x16x32_bf16 v[16:19], v[144:147], v[92:95], v[16:19]
  v_mfma_f32_16x16x32_bf16 v[20:23], v[148:151], v[92:95], v[20:23]
  v_mfma_f32_16x16x32_bf16 v[24:27], v[152:155], v[92:95], v[24:27]
  v_mfma_f32_16x16x32_bf16 v[28:31], v[156:159], v[92:95], v[28:31]
  v_mfma_f32_16x16x32_bf16 v[32:35], v[140:143], v[96:99], v[32:35]
  v_mfma_f32_16x16x32_bf16 v[36:39], v[144:147], v[96:99], v[36:39]
  v_mfma_f32_16x16x32_bf16 v[40:43], v[148:151], v[96:99], v[40:43]
  v_mfma_f32_16x16x32_bf16 v[44:47], v[152:155], v[96:99], v[44:47]
  v_mfma_f32_16x16x32_bf16 v[48:51], v[156:159], v[96:99], v[48:51]
  v_mfma_f32_16x16x32_bf16 v[52:55], v[140:143], v[100:103], v[52:55]
  v_mfma_f32_16x16x32_bf16 v[56:59], v[144:147], v[100:103], v[56:59]
  v_mfma_f32_16x16x32_bf16 v[60:63], v[148:151], v[100:103], v[60:63]
  v_mfma_f32_16x16x32_bf16 v[64:67], v[152:155], v[100:103], v[64:67]
  v_mfma_f32_16x16x32_bf16 v[68:71], v[156:159], v[100:103], v[68:71]
  v_mfma_f32_16x16x32_bf16 v[72:75], v[140:143], v[104:107], v[72:75]
  v_mfma_f32_16x16x32_bf16 v[76:79], v[144:147], v[104:107], v[76:79]
  v_mfma_f32_16x16x32_bf16 v[80:83], v[148:151], v[104:107], v[80:83]
  v_mfma_f32_16x16x32_bf16 v[84:87], v[152:155], v[104:107], v[84:87]
  v_mfma_f32_16x16x32_bf16 v[88:91], v[156:159], v[104:107], v[88:91]
  s_waitcnt vmcnt(4)
  v_mfma_f32_16x16x32_bf16 v[12:15], v[160:163], v[108:111], v[12:15]
  v_mfma_f32_16x16x32_bf16 v[16:19], v[164:167], v[108:111], v[16:19]
  v_mfma_f32_16x16x32_bf16 v[20:23], v[168:171], v[108:111], v[20:23]
  v_mfma_f32_16x16x32_bf16 v[24:27], v[172:175], v[108:111], v[24:27]
  v_mfma_f32_16x16x32_bf16 v[28:31], v[176:179], v[108:111], v[28:31]
  v_mfma_f32_16x16x32_bf16 v[32:35], v[160:163], v[112:115], v[32:35]
  v_mfma_f32_16x16x32_bf16 v[36:39], v[164:167], v[112:115], v[36:39]
  v_mfma_f32_16x16x32_bf16 v[40:43], v[168:171], v[112:115], v[40:43]
  v_mfma_f32_16x16x32_bf16 v[44:47], v[172:175], v[112:115], v[44:47]
  v_mfma_f32_16x16x32_bf16 v[48:51], v[176:179], v[112:115], v[48:51]
  v_mfma_f32_16x16x32_bf16 v[52:55], v[160:163], v[116:119], v[52:55]
  v_mfma_f32_16x16x32_bf16 v[56:59], v[164:167], v[116:119], v[56:59]
  v_mfma_f32_16x16x32_bf16 v[60:63], v[168:171], v[116:119], v[60:63]
  v_mfma_f32_16x16x32_bf16 v[64:67], v[172:175], v[116:119], v[64:67]
  v_mfma_f32_16x16x32_bf16 v[68:71], v[176:179], v[116:119], v[68:71]
  v_mfma_f32_16x16x32_bf16 v[72:75], v[160:163], v[120:123], v[72:75]
  v_mfma_f32_16x16x32_bf16 v[76:79], v[164:167], v[120:123], v[76:79]
  v_mfma_f32_16x16x32_bf16 v[80:83], v[168:171], v[120:123], v[80:83]
  v_mfma_f32_16x16x32_bf16 v[84:87], v[172:175], v[120:123], v[84:87]
  v_mfma_f32_16x16x32_bf16 v[88:91], v[176:179], v[120:123], v[88:91]
  s_add_u32 s47, s20, 1
  s_and_b32 s47, s47, 3
  s_mul_i32 s47, s47, 15360
  s_add_u32 s47, s47, 0
  v_add_u32 v240, s47, v8
  ds_write_b128 v240, v[32:35] offset:0
  ds_write_b128 v240, v[36:39] offset:1024
  ds_write_b128 v240, v[40:43] offset:2048
  ds_write_b128 v240, v[44:47] offset:3072
  ds_write_b128 v240, v[48:51] offset:4096
  s_add_u32 s47, s20, 2
  s_and_b32 s47, s47, 3
  s_mul_i32 s47, s47, 15360
  s_add_u32 s47, s47, 5120
  v_add_u32 v240, s47, v8
  ds_write_b128 v240, v[52:55] offset:0
  ds_write_b128 v240, v[56:59] offset:1024
  ds_write_b128 v240, v[60:63] offset:2048
  ds_write_b128 v240, v[64:67] offset:3072
  ds_write_b128 v240, v[68:71] offset:4096
  s_add_u32 s47, s20, 3
  s_and_b32 s47, s47, 3
  s_mul_i32 s47, s47, 15360
  s_add_u32 s47, s47, 10240
  v_add_u32 v240, s47, v8
  ds_write_b128 v240, v[72:75] offset:0
  ds_write_b128 v240, v[76:79] offset:1024
  ds_write_b128 v240, v[80:83] offset:2048
  ds_write_b128 v240, v[84:87] offset:3072
  ds_write_b128 v240, v[88:91] offset:4096
  v_add_u32 v240, s33, v8
  s_waitcnt lgkmcnt(0)
  s_barrier
  ds_read_b128 v[32:35], v240 offset:0
  ds_read_b128 v[36:39], v240 offset:1024
  ds_read_b128 v[40:43], v240 offset:2048
  ds_read_b128 v[44:47], v240 offset:3072
  ds_read_b128 v[48:51], v240 offset:4096
  ds_read_b128 v[52:55], v240 offset:5120
  ds_read_b128 v[56:59], v240 offset:6144
  ds_read_b128 v[60:63], v240 offset:7168
  ds_read_b128 v[64:67], v240 offset:8192
  ds_read_b128 v[68:71], v240 offset:9216
  ds_read_b128 v[72:75], v240 offset:10240
  ds_read_b128 v[76:79], v240 offset:11264
  ds_read_b128 v[80:83], v240 offset:12288
  ds_read_b128 v[84:87], v240 offset:13312
  ds_read_b128 v[88:91], v240 offset:14336
  s_waitcnt vmcnt(0) lgkmcnt(0)
  s_barrier
  v_add_f32 v32, v32, v52
  v_add_f32 v12, v12, v72
  v_add_f32 v33, v33, v53
  v_add_f32 v13, v13, v73
  v_add_f32 v34, v34, v54
  v_add_f32 v14, v14, v74
  v_add_f32 v35, v35, v55
  v_add_f32 v15, v15, v75
  v_add_f32 v36, v36, v56
  v_add_f32 v16, v16, v76
  v_add_f32 v37, v37, v57
  v_add_f32 v17, v17, v77
  v_add_f32 v38, v38, v58
  v_add_f32 v18, v18, v78
  v_add_f32 v39, v39, v59
  v_add_f32 v19, v19, v79
  v_add_f32 v40, v40, v60
  v_add_f32 v20, v20, v80
  v_add_f32 v41, v41, v61
  v_add_f32 v21, v21, v81
  v_add_f32 v42, v42, v62
  v_add_f32 v22, v22, v82
  v_add_f32 v43, v43, v63
  v_add_f32 v23, v23, v83
  v_add_f32 v44, v44, v64
  v_add_f32 v24, v24, v84
  v_add_f32 v45, v45, v65
  v_add_f32 v25, v25, v85
  v_add_f32 v46, v46, v66
  v_add_f32 v26, v26, v86
  v_add_f32 v47, v47, v67
  v_add_f32 v27, v27, v87
  v_add_f32 v48, v48, v68
  v_add_f32 v28, v28, v88
  v_add_f32 v49, v49, v69
  v_add_f32 v29, v29, v89
  v_add_f32 v50, v50, v70
  v_add_f32 v30, v30, v90
  v_add_f32 v51, v51, v71
  v_add_f32 v31, v31, v91
  v_add_f32 v12, v12, v32
  v_add_f32 v13, v13, v33
  v_add_f32 v14, v14, v34
  v_add_f32 v15, v15, v35
  v_add_f32 v16, v16, v36
  v_add_f32 v17, v17, v37
  v_add_f32 v18, v18, v38
  v_add_f32 v19, v19, v39
  v_add_f32 v20, v20, v40
  v_add_f32 v21, v21, v41
  v_add_f32 v22, v22, v42
  v_add_f32 v23, v23, v43
  v_add_f32 v24, v24, v44
  v_add_f32 v25, v25, v45
  v_add_f32 v26, v26, v46
  v_add_f32 v27, v27, v47
  v_add_f32 v28, v28, v48
  v_add_f32 v29, v29, v49
  v_add_f32 v30, v30, v50
  v_add_f32 v31, v31, v51
  v_mul_f32 v110, v230, v231
  v_mov_b32 v108, 0
  v_mov_b32 v109, 0
  v_permlane16_swap_b32 v200, v202
  v_permlane16_swap_b32 v201, v203
  v_permlane16_swap_b32 v204, v206
  v_permlane16_swap_b32 v205, v207
  v_and_b32 v112, 1, v3
  v_lshlrev_b32 v113, 3, v112
  v_sub_u32 v113, v237, v113
  v_lshl_add_u32 v112, v112, 10, v113
  v_lshlrev_b32 v92, 16, v200
  v_and_b32 v93, 0xffff0000, v200
  v_lshlrev_b32 v94, 16, v201
  v_and_b32 v95, 0xffff0000, v201
  v_fma_f32 v92, v92, v231, -v110
  v_add_f32 v12, v12, v92
  v_fma_f32 v93, v93, v231, -v110
  v_add_f32 v13, v13, v93
  v_fma_f32 v94, v94, v231, -v110
  v_add_f32 v14, v14, v94
  v_fma_f32 v95, v95, v231, -v110
  v_add_f32 v15, v15, v95
  v_cvt_pk_bf16_f32 v124, v12, v13
  v_cvt_pk_bf16_f32 v125, v14, v15
  v_add_f32 v108, v108, v12
  v_fmac_f32 v109, v12, v12
  v_add_f32 v108, v108, v13
  v_fmac_f32 v109, v13, v13
  v_add_f32 v108, v108, v14
  v_fmac_f32 v109, v14, v14
  v_add_f32 v108, v108, v15
  v_fmac_f32 v109, v15, v15
  v_lshlrev_b32 v92, 16, v202
  v_and_b32 v93, 0xffff0000, v202
  v_lshlrev_b32 v94, 16, v203
  v_and_b32 v95, 0xffff0000, v203
  v_fma_f32 v92, v92, v231, -v110
  v_add_f32 v16, v16, v92
  v_fma_f32 v93, v93, v231, -v110
  v_add_f32 v17, v17, v93
  v_fma_f32 v94, v94, v231, -v110
  v_add_f32 v18, v18, v94
  v_fma_f32 v95, v95, v231, -v110
  v_add_f32 v19, v19, v95
  v_cvt_pk_bf16_f32 v126, v16, v17
  v_cvt_pk_bf16_f32 v127, v18, v19
  s_nop 0
  v_permlane16_swap_b32 v124, v126
  v_permlane16_swap_b32 v125, v127
  buffer_store_dwordx4 v[124:127], v112, s[8:11], s50 offen offset:0 sc1
  v_add_f32 v108, v108, v16
  v_fmac_f32 v109, v16, v16
  v_add_f32 v108, v108, v17
  v_fmac_f32 v109, v17, v17
  v_add_f32 v108, v108, v18
  v_fmac_f32 v109, v18, v18
  v_add_f32 v108, v108, v19
  v_fmac_f32 v109, v19, v19
  v_lshlrev_b32 v92, 16, v204
  v_and_b32 v93, 0xffff0000, v204
  v_lshlrev_b32 v94, 16, v205
  v_and_b32 v95, 0xffff0000, v205
  v_fma_f32 v92, v92, v231, -v110
  v_add_f32 v20, v20, v92
  v_fma_f32 v93, v93, v231, -v110
  v_add_f32 v21, v21, v93
  v_fma_f32 v94, v94, v231, -v110
  v_add_f32 v22, v22, v94
  v_fma_f32 v95, v95, v231, -v110
  v_add_f32 v23, v23, v95
  v_cvt_pk_bf16_f32 v128, v20, v21
  v_cvt_pk_bf16_f32 v129, v22, v23
  v_add_f32 v108, v108, v20
  v_fmac_f32 v109, v20, v20
  v_add_f32 v108, v108, v21
  v_fmac_f32 v109, v21, v21
  v_add_f32 v108, v108, v22
  v_fmac_f32 v109, v22, v22
  v_add_f32 v108, v108, v23
  v_fmac_f32 v109, v23, v23
  v_lshlrev_b32 v92, 16, v206
  v_and_b32 v93, 0xffff0000, v206
  v_lshlrev_b32 v94, 16, v207
  v_and_b32 v95, 0xffff0000, v207
  v_fma_f32 v92, v92, v231, -v110
  v_add_f32 v24, v24, v92
  v_fma_f32 v93, v93, v231, -v110
  v_add_f32 v25, v25, v93
  v_fma_f32 v94, v94, v231, -v110
  v_add_f32 v26, v26, v94
  v_fma_f32 v95, v95, v231, -v110
  v_add_f32 v27, v27, v95
  v_cvt_pk_bf16_f32 v130, v24, v25
  v_cvt_pk_bf16_f32 v131, v26, v27
  s_nop 0
  v_permlane16_swap_b32 v128, v130
  v_permlane16_swap_b32 v129, v131
  buffer_store_dwordx4 v[128:131], v112, s[8:11], s50 offen offset:2048 sc1
  v_add_f32 v108, v108, v24
  v_fmac_f32 v109, v24, v24
  v_add_f32 v108, v108, v25
  v_fmac_f32 v109, v25, v25
  v_add_f32 v108, v108, v26
  v_fmac_f32 v109, v26, v26
  v_add_f32 v108, v108, v27
  v_fmac_f32 v109, v27, v27
  v_lshlrev_b32 v92, 16, v208
  v_and_b32 v93, 0xffff0000, v208
  v_lshlrev_b32 v94, 16, v209
  v_and_b32 v95, 0xffff0000, v209
  v_fma_f32 v92, v92, v231, -v110
  v_add_f32 v28, v28, v92
  v_fma_f32 v93, v93, v231, -v110
  v_add_f32 v29, v29, v93
  v_fma_f32 v94, v94, v231, -v110
  v_add_f32 v30, v30, v94
  v_fma_f32 v95, v95, v231, -v110
  v_add_f32 v31, v31, v95
  v_cvt_pk_bf16_f32 v132, v28, v29
  v_cvt_pk_bf16_f32 v133, v30, v31
  buffer_store_dwordx2 v[132:133], v237, s[8:11], s51 offen sc1
  v_add_f32 v108, v108, v28
  v_fmac_f32 v109, v28, v28
  v_add_f32 v108, v108, v29
  v_fmac_f32 v109, v29, v29
  v_add_f32 v108, v108, v30
  v_fmac_f32 v109, v30, v30
  v_add_f32 v108, v108, v31
  v_fmac_f32 v109, v31, v31
  v_mov_b32 v92, v108
  s_nop 1
  v_permlane16_swap_b32 v108, v92
  v_add_f32 v108, v108, v92
  v_mov_b32 v92, v108
  s_nop 1
  v_permlane32_swap_b32 v108, v92
  v_add_f32 v108, v108, v92
  v_mov_b32 v92, v109
  s_nop 1
  v_permlane16_swap_b32 v109, v92
  v_add_f32 v109, v109, v92
  v_mov_b32 v92, v109
  s_nop 1
  v_permlane32_swap_b32 v109, v92
  v_add_f32 v109, v109, v92
  v_lshlrev_b32 v92, 3, v236
  s_lshl_b32 s47, s22, 14
  s_add_u32 s47, s47, 14417920
  s_mov_b64 exec, 0xffff
  buffer_store_dwordx2 v[108:109], v92, s[8:11], s47 offen sc1
  s_mov_b64 exec, -1
  s_lshl_b32 s53, s21, 2
  s_add_u32 s53, s53, s20
  s_lshl_b32 s53, s53, 10
  s_lshl_b32 s47, s22, 7
  s_add_u32 s53, s53, s47
  s_add_u32 s53, s53, 31457280
  v_and_b32 v92, 31, v0
  v_lshlrev_b32 v92, 2, v92
  v_mov_b32 v93, 1
  s_waitcnt vmcnt(0)
  s_mov_b32 exec_hi, 0
  buffer_store_dword v93, v92, s[8:11], s53 offen sc1
  s_mov_b64 exec, -1
  s_load_dwordx2 s[4:5], s[0:1], 80
  s_and_b32 s36, s2, 7
  s_lshr_b32 s37, s2, 3
  s_and_b32 s38, s36, 3
  s_lshl_b32 s38, s38, 2
  s_and_b32 s39, s37, 3
  s_add_u32 s21, s38, s39
  s_lshr_b32 s38, s36, 2
  s_lshl_b32 s38, s38, 3
  s_lshr_b32 s40, s37, 2
  s_add_u32 s22, s38, s40
  v_and_b32 v1, 63, v0
  v_lshrrev_b32 v184, 6, v0
  v_and_b32 v2, 31, v1
  v_readfirstlane_b32 s20, v184
  v_lshrrev_b32 v3, 5, v1
  s_mul_i32 s41, s39, 5
  s_lshr_b32 s41, s41, 1
  s_add_u32 s41, s41, s40
  s_cmp_ge_u32 s41, 10
  s_cselect_b32 s42, 10, 0
  s_sub_u32 s26, s41, s42
  s_mul_i32 s26, s26, 1
  s_waitcnt lgkmcnt(0)
  s_mov_b32 s8, s4
  s_and_b32 s9, s5, 0xffff
  s_mov_b32 s10, 37748736
  s_mov_b32 s11, 0x20000
  s_mul_i32 s23, s20, 3072
  s_mul_i32 s41, s22, 122880
  s_add_u32 s41, s41, s23
  s_add_u32 s57, s41, 28442624
  v_lshlrev_b32 v7, 4, v1
  s_lshl_b32 s43, s21, 2
  s_add_u32 s43, s43, s20
  s_mul_i32 s44, s43, 40960
  s_add_u32 s44, s44, 11534336
  s_add_u32 s45, s26, 0
  s_cmp_ge_u32 s45, 10
  s_cselect_b32 s46, 10, 0
  s_sub_u32 s45, s45, s46
  s_mul_i32 s24, s45, 12288
  s_add_u32 s24, s24, s57
  s_lshl_b32 s45, s45, 12
  s_add_u32 s25, s44, s45
  s_add_u32 m0, s23, 0
  s_nop 0
  buffer_load_dwordx4 v7, s[8:11], s24 offen offset:0 lds
  s_add_u32 m0, s23, 1024
  s_add_u32 s24, s24, 1024
  buffer_load_dwordx4 v7, s[8:11], s24 offen lds
  s_add_u32 m0, s23, 2048
  s_add_u32 s24, s24, 1024
  buffer_load_dwordx4 v7, s[8:11], s24 offen lds
  s_add_u32 s45, s26, 1
  s_cmp_ge_u32 s45, 10
  s_cselect_b32 s46, 10, 0
  s_sub_u32 s45, s45, s46
  s_mul_i32 s24, s45, 12288
  s_add_u32 s24, s24, s57
  s_lshl_b32 s45, s45, 12
  s_add_u32 s25, s44, s45
  s_add_u32 m0, s23, 12288
  s_nop 0
  buffer_load_dwordx4 v7, s[8:11], s24 offen offset:0 lds
  s_add_u32 m0, s23, 13312
  s_add_u32 s24, s24, 1024
  buffer_load_dwordx4 v7, s[8:11], s24 offen lds
  s_add_u32 m0, s23, 14336
  s_add_u32 s24, s24, 1024
  buffer_load_dwordx4 v7, s[8:11], s24 offen lds
  s_add_u32 s45, s26, 2
  s_cmp_ge_u32 s45, 10
  s_cselect_b32 s46, 10, 0
  s_sub_u32 s45, s45, s46
  s_mul_i32 s24, s45, 12288
  s_add_u32 s24, s24, s57
  s_lshl_b32 s45, s45, 12
  s_add_u32 s25, s44, s45
  s_add_u32 m0, s23, 24576
  s_nop 0
  buffer_load_dwordx4 v7, s[8:11], s24 offen offset:0 lds
  s_add_u32 m0, s23, 25600
  s_add_u32 s24, s24, 1024
  buffer_load_dwordx4 v7, s[8:11], s24 offen lds
  s_add_u32 m0, s23, 26624
  s_add_u32 s24, s24, 1024
  buffer_load_dwordx4 v7, s[8:11], s24 offen lds
  s_add_u32 s45, s26, 3
  s_cmp_ge_u32 s45, 10
  s_cselect_b32 s46, 10, 0
  s_sub_u32 s45, s45, s46
  s_mul_i32 s24, s45, 12288
  s_add_u32 s24, s24, s57
  s_lshl_b32 s45, s45, 12
  s_add_u32 s25, s44, s45
  s_add_u32 m0, s23, 36864
  s_nop 0
  buffer_load_dwordx4 v7, s[8:11], s24 offen offset:0 lds
  s_add_u32 m0, s23, 37888
  s_add_u32 s24, s24, 1024
  buffer_load_dwordx4 v7, s[8:11], s24 offen lds
  s_add_u32 m0, s23, 38912
  s_add_u32 s24, s24, 1024
  buffer_load_dwordx4 v7, s[8:11], s24 offen lds
  s_mul_i32 s45, s22, 6144
  s_mul_i32 s46, s20, 96
  s_add_u32 s45, s45, s46
  s_add_u32 s45, s45, 14188544
  v_lshlrev_b32 v184, 2, v1
  s_mov_b64 exec, 0xffffff
  buffer_load_dword v160, v184, s[8:11], s45 offen offset:0
  buffer_load_dword v161, v184, s[8:11], s45 offen offset:384
  buffer_load_dword v162, v184, s[8:11], s45 offen offset:768
  buffer_load_dword v163, v184, s[8:11], s45 offen offset:1152
  buffer_load_dword v164, v184, s[8:11], s45 offen offset:1536
  buffer_load_dword v165, v184, s[8:11], s45 offen offset:1920
  buffer_load_dword v166, v184, s[8:11], s45 offen offset:2304
  buffer_load_dword v167, v184, s[8:11], s45 offen offset:2688
  buffer_load_dword v168, v184, s[8:11], s45 offen offset:3072
  buffer_load_dword v169, v184, s[8:11], s45 offen offset:3456
  buffer_load_dword v170, v184, s[8:11], s45 offen offset:3840
  s_add_u32 s45, s45, 4096
  buffer_load_dword v171, v184, s[8:11], s45 offen offset:128
  buffer_load_dword v172, v184, s[8:11], s45 offen offset:512
  buffer_load_dword v173, v184, s[8:11], s45 offen offset:896
  buffer_load_dword v174, v184, s[8:11], s45 offen offset:1280
  buffer_load_dword v175, v184, s[8:11], s45 offen offset:1664
  s_mov_b64 exec, -1
  s_lshl_b32 s53, s43, 11
  s_add_u32 s53, s53, 31457280
  v_and_b32 v192, 15, v0
  v_lshlrev_b32 v192, 7, v192
l2_kernel_wap4:
  buffer_load_dword v193, v192, s[8:11], s53 offen sc1
  s_waitcnt vmcnt(0)
  v_cmp_ne_u32 vcc, 1, v193
  s_nop 0
  s_cbranch_vccz l2_kernel_wa3
  s_sleep 2
  s_branch l2_kernel_wap4
l2_kernel_wa3:
  s_add_u32 s45, s26, 0
  s_cmp_ge_u32 s45, 10
  s_cselect_b32 s46, 10, 0
  s_sub_u32 s45, s45, s46
  s_mul_i32 s24, s45, 12288
  s_add_u32 s24, s24, s57
  s_lshl_b32 s45, s45, 12
  s_add_u32 s25, s44, s45
  buffer_load_dwordx4 v[60:63], v7, s[8:11], s25 offen offset:0 sc1
  buffer_load_dwordx4 v[64:67], v7, s[8:11], s25 offen offset:1024 sc1
  buffer_load_dwordx4 v[68:71], v7, s[8:11], s25 offen offset:2048 sc1
  buffer_load_dwordx4 v[72:75], v7, s[8:11], s25 offen offset:3072 sc1
  s_add_u32 s45, s26, 1
  s_cmp_ge_u32 s45, 10
  s_cselect_b32 s46, 10, 0
  s_sub_u32 s45, s45, s46
  s_mul_i32 s24, s45, 12288
  s_add_u32 s24, s24, s57
  s_lshl_b32 s45, s45, 12
  s_add_u32 s25, s44, s45
  buffer_load_dwordx4 v[76:79], v7, s[8:11], s25 offen offset:0 sc1
  buffer_load_dwordx4 v[80:83], v7, s[8:11], s25 offen offset:1024 sc1
  buffer_load_dwordx4 v[84:87], v7, s[8:11], s25 offen offset:2048 sc1
  buffer_load_dwordx4 v[88:91], v7, s[8:11], s25 offen offset:3072 sc1
  s_waitcnt vmcnt(4)
  s_barrier
  s_add_u32 s45, s26, 2
  s_cmp_ge_u32 s45, 10
  s_cselect_b32 s46, 10, 0
  s_sub_u32 s45, s45, s46
  s_mul_i32 s24, s45, 12288
  s_add_u32 s24, s24, s57
  s_lshl_b32 s45, s45, 12
  s_add_u32 s25, s44, s45
  buffer_load_dwordx4 v[92:95], v7, s[8:11], s25 offen offset:0 sc1
  buffer_load_dwordx4 v[96:99], v7, s[8:11], s25 offen offset:1024 sc1
  buffer_load_dwordx4 v[100:103], v7, s[8:11], s25 offen offset:2048 sc1
  buffer_load_dwordx4 v[104:107], v7, s[8:11], s25 offen offset:3072 sc1
  s_add_u32 s45, s26, 3
  s_cmp_ge_u32 s45, 10
  s_cselect_b32 s46, 10, 0
  s_sub_u32 s45, s45, s46
  s_mul_i32 s24, s45, 12288
  s_add_u32 s24, s24, s57
  s_lshl_b32 s45, s45, 12
  s_add_u32 s25, s44, s45
  buffer_load_dwordx4 v[108:111], v7, s[8:11], s25 offen offset:0 sc1
  buffer_load_dwordx4 v[112:115], v7, s[8:11], s25 offen offset:1024 sc1
  buffer_load_dwordx4 v[116:119], v7, s[8:11], s25 offen offset:2048 sc1
  buffer_load_dwordx4 v[120:123], v7, s[8:11], s25 offen offset:3072 sc1
  s_lshl_b32 s45, s43, 8
  s_add_u32 s45, s45, 14417920
  v_lshlrev_b32 v184, 3, v2
  v_lshl_add_u32 v184, v3, 16, v184
  buffer_load_dwordx2 v[176:177], v184, s[8:11], s45 offen sc1
  s_add_u32 s45, s45, 16384
  buffer_load_dwordx2 v[178:179], v184, s[8:11], s45 offen sc1
  s_add_u32 s45, s45, 16384
  buffer_load_dwordx2 v[180:181], v184, s[8:11], s45 offen sc1
  s_add_u32 s45, s45, 16384
  buffer_load_dwordx2 v[182:183], v184, s[8:11], s45 offen sc1
  ds_read_b128 v[124:127], v7 offset:0
  ds_read_b128 v[128:131], v7 offset:1024
  ds_read_b128 v[132:135], v7 offset:2048
  ds_read_b128 v[136:139], v7 offset:3072
  ds_read_b128 v[140:143], v7 offset:4096
  ds_read_b128 v[144:147], v7 offset:5120
  s_setprio 0
  s_waitcnt lgkmcnt(3)
  v_mfma_f32_32x32x16_bf16 v[12:27], v[124:127], v[60:63], 0
  ds_read_b128 v[148:151], v7 offset:6144
  v_mfma_f32_32x32x16_bf16 v[28:43], v[128:131], v[60:63], 0
  ds_read_b128 v[152:155], v7 offset:7168
  v_mfma_f32_32x32x16_bf16 v[44:59], v[132:135], v[60:63], 0
  ds_read_b128 v[156:159], v7 offset:8192
  s_waitcnt lgkmcnt(3)
  v_mfma_f32_32x32x16_bf16 v[12:27], v[136:139], v[64:67], v[12:27]
  ds_read_b128 v[124:127], v7 offset:9216
  v_mfma_f32_32x32x16_bf16 v[28:43], v[140:143], v[64:67], v[28:43]
  ds_read_b128 v[128:131], v7 offset:10240
  v_mfma_f32_32x32x16_bf16 v[44:59], v[144:147], v[64:67], v[44:59]
  ds_read_b128 v[132:135], v7 offset:11264
  s_waitcnt vmcnt(12)
  s_barrier
  s_waitcnt lgkmcnt(3)
  v_mfma_f32_32x32x16_bf16 v[12:27], v[148:151], v[68:71], v[12:27]
  ds_read_b128 v[136:139], v7 offset:12288
  v_mfma_f32_32x32x16_bf16 v[28:43], v[152:155], v[68:71], v[28:43]
  ds_read_b128 v[140:143], v7 offset:13312
  v_mfma_f32_32x32x16_bf16 v[44:59], v[156:159], v[68:71], v[44:59]
  ds_read_b128 v[144:147], v7 offset:14336
  s_waitcnt lgkmcnt(3)
  v_mfma_f32_32x32x16_bf16 v[12:27], v[124:127], v[72:75], v[12:27]
  ds_read_b128 v[148:151], v7 offset:15360
  v_mfma_f32_32x32x16_bf16 v[28:43], v[128:131], v[72:75], v[28:43]
  ds_read_b128 v[152:155], v7 offset:16384
  v_mfma_f32_32x32x16_bf16 v[44:59], v[132:135], v[72:75], v[44:59]
  ds_read_b128 v[156:159], v7 offset:17408
  s_waitcnt lgkmcnt(3)
  v_mfma_f32_32x32x16_bf16 v[12:27], v[136:139], v[76:79], v[12:27]
  ds_read_b128 v[124:127], v7 offset:18432
  v_mfma_f32_32x32x16_bf16 v[28:43], v[140:143], v[76:79], v[28:43]
  ds_read_b128 v[128:131], v7 offset:19456
  v_mfma_f32_32x32x16_bf16 v[44:59], v[144:147], v[76:79], v[44:59]
  ds_read_b128 v[132:135], v7 offset:20480
  s_waitcnt lgkmcnt(3)
  v_mfma_f32_32x32x16_bf16 v[12:27], v[148:151], v[80:83], v[12:27]
  ds_read_b128 v[136:139], v7 offset:21504
  v_mfma_f32_32x32x16_bf16 v[28:43], v[152:155], v[80:83], v[28:43]
  ds_read_b128 v[140:143], v7 offset:22528
  v_mfma_f32_32x32x16_bf16 v[44:59], v[156:159], v[80:83], v[44:59]
  ds_read_b128 v[144:147], v7 offset:23552
  s_waitcnt vmcnt(8)
  s_barrier
  s_add_u32 s45, s26, 4
  s_cmp_ge_u32 s45, 10
  s_cselect_b32 s46, 10, 0
  s_sub_u32 s45, s45, s46
  s_mul_i32 s24, s45, 12288
  s_add_u32 s24, s24, s57
  s_lshl_b32 s45, s45, 12
  s_add_u32 s25, s44, s45
  s_add_u32 m0, s23, 0
  s_nop 0
  buffer_load_dwordx4 v7, s[8:11], s24 offen offset:0 lds
  s_add_u32 m0, s23, 1024
  s_add_u32 s24, s24, 1024
  buffer_load_dwordx4 v7, s[8:11], s24 offen lds
  s_add_u32 m0, s23, 2048
  s_add_u32 s24, s24, 1024
  buffer_load_dwordx4 v7, s[8:11], s24 offen lds
  buffer_load_dwordx4 v[60:63], v7, s[8:11], s25 offen offset:0 sc1
  buffer_load_dwordx4 v[64:67], v7, s[8:11], s25 offen offset:1024 sc1
  buffer_load_dwordx4 v[68:71], v7, s[8:11], s25 offen offset:2048 sc1
  buffer_load_dwordx4 v[72:75], v7, s[8:11], s25 offen offset:3072 sc1
  s_waitcnt lgkmcnt(3)
  v_mfma_f32_32x32x16_bf16 v[12:27], v[124:127], v[84:87], v[12:27]
  ds_read_b128 v[148:151], v7 offset:24576
  v_mfma_f32_32x32x16_bf16 v[28:43], v[128:131], v[84:87], v[28:43]
  ds_read_b128 v[152:155], v7 offset:25600
  v_mfma_f32_32x32x16_bf16 v[44:59], v[132:135], v[84:87], v[44:59]
  ds_read_b128 v[156:159], v7 offset:26624
  s_waitcnt lgkmcnt(3)
  v_mfma_f32_32x32x16_bf16 v[12:27], v[136:139], v[88:91], v[12:27]
  ds_read_b128 v[124:127], v7 offset:27648
  v_mfma_f32_32x32x16_bf16 v[28:43], v[140:143], v[88:91], v[28:43]
  ds_read_b128 v[128:131], v7 offset:28672
  v_mfma_f32_32x32x16_bf16 v[44:59], v[144:147], v[88:91], v[44:59]
  ds_read_b128 v[132:135], v7 offset:29696
  s_waitcnt lgkmcnt(3)
  v_mfma_f32_32x32x16_bf16 v[12:27], v[148:151], v[92:95], v[12:27]
  ds_read_b128 v[136:139], v7 offset:30720
  v_mfma_f32_32x32x16_bf16 v[28:43], v[152:155], v[92:95], v[28:43]
  ds_read_b128 v[140:143], v7 offset:31744
  v_mfma_f32_32x32x16_bf16 v[44:59], v[156:159], v[92:95], v[44:59]
  ds_read_b128 v[144:147], v7 offset:32768
  s_waitcnt lgkmcnt(3)
  v_mfma_f32_32x32x16_bf16 v[12:27], v[124:127], v[96:99], v[12:27]
  ds_read_b128 v[148:151], v7 offset:33792
  v_mfma_f32_32x32x16_bf16 v[28:43], v[128:131], v[96:99], v[28:43]
  ds_read_b128 v[152:155], v7 offset:34816
  v_mfma_f32_32x32x16_bf16 v[44:59], v[132:135], v[96:99], v[44:59]
  ds_read_b128 v[156:159], v7 offset:35840
  s_waitcnt vmcnt(11)
  s_barrier
  s_add_u32 s45, s26, 5
  s_cmp_ge_u32 s45, 10
  s_cselect_b32 s46, 10, 0
  s_sub_u32 s45, s45, s46
  s_mul_i32 s24, s45, 12288
  s_add_u32 s24, s24, s57
  s_lshl_b32 s45, s45, 12
  s_add_u32 s25, s44, s45
  s_add_u32 m0, s23, 12288
  s_nop 0
  buffer_load_dwordx4 v7, s[8:11], s24 offen offset:0 lds
  s_add_u32 m0, s23, 13312
  s_add_u32 s24, s24, 1024
  buffer_load_dwordx4 v7, s[8:11], s24 offen lds
  s_add_u32 m0, s23, 14336
  s_add_u32 s24, s24, 1024
  buffer_load_dwordx4 v7, s[8:11], s24 offen lds
  buffer_load_dwordx4 v[76:79], v7, s[8:11], s25 offen offset:0 sc1
  buffer_load_dwordx4 v[80:83], v7, s[8:11], s25 offen offset:1024 sc1
  buffer_load_dwordx4 v[84:87], v7, s[8:11], s25 offen offset:2048 sc1
  buffer_load_dwordx4 v[88:91], v7, s[8:11], s25 offen offset:3072 sc1
  s_waitcnt lgkmcnt(3)
  v_mfma_f32_32x32x16_bf16 v[12:27], v[136:139], v[100:103], v[12:27]
  ds_read_b128 v[124:127], v7 offset:36864
  v_mfma_f32_32x32x16_bf16 v[28:43], v[140:143], v[100:103], v[28:43]
  ds_read_b128 v[128:131], v7 offset:37888
  v_mfma_f32_32x32x16_bf16 v[44:59], v[144:147], v[100:103], v[44:59]
  ds_read_b128 v[132:135], v7 offset:38912
  s_waitcnt lgkmcnt(3)
  v_mfma_f32_32x32x16_bf16 v[12:27], v[148:151], v[104:107], v[12:27]
  ds_read_b128 v[136:139], v7 offset:39936
  v_mfma_f32_32x32x16_bf16 v[28:43], v[152:155], v[104:107], v[28:43]
  ds_read_b128 v[140:143], v7 offset:40960
  v_mfma_f32_32x32x16_bf16 v[44:59], v[156:159], v[104:107], v[44:59]
  ds_read_b128 v[144:147], v7 offset:41984
  s_waitcnt lgkmcnt(3)
  v_mfma_f32_32x32x16_bf16 v[12:27], v[124:127], v[108:111], v[12:27]
  ds_read_b128 v[148:151], v7 offset:43008
  v_mfma_f32_32x32x16_bf16 v[28:43], v[128:131], v[108:111], v[28:43]
  ds_read_b128 v[152:155], v7 offset:44032
  v_mfma_f32_32x32x16_bf16 v[44:59], v[132:135], v[108:111], v[44:59]
  ds_read_b128 v[156:159], v7 offset:45056
  s_waitcnt lgkmcnt(3)
  v_mfma_f32_32x32x16_bf16 v[12:27], v[136:139], v[112:115], v[12:27]
  ds_read_b128 v[124:127], v7 offset:46080
  v_mfma_f32_32x32x16_bf16 v[28:43], v[140:143], v[112:115], v[28:43]
  ds_read_b128 v[128:131], v7 offset:47104
  v_mfma_f32_32x32x16_bf16 v[44:59], v[144:147], v[112:115], v[44:59]
  ds_read_b128 v[132:135], v7 offset:48128
  s_waitcnt vmcnt(7)
  s_barrier
  s_add_u32 s45, s26, 6
  s_cmp_ge_u32 s45, 10
  s_cselect_b32 s46, 10, 0
  s_sub_u32 s45, s45, s46
  s_mul_i32 s24, s45, 12288
  s_add_u32 s24, s24, s57
  s_lshl_b32 s45, s45, 12
  s_add_u32 s25, s44, s45
  s_add_u32 m0, s23, 24576
  s_nop 0
  buffer_load_dwordx4 v7, s[8:11], s24 offen offset:0 lds
  s_add_u32 m0, s23, 25600
  s_add_u32 s24, s24, 1024
  buffer_load_dwordx4 v7, s[8:11], s24 offen lds
  s_add_u32 m0, s23, 26624
  s_add_u32 s24, s24, 1024
  buffer_load_dwordx4 v7, s[8:11], s24 offen lds
  buffer_load_dwordx4 v[92:95], v7, s[8:11], s25 offen offset:0 sc1
  buffer_load_dwordx4 v[96:99], v7, s[8:11], s25 offen offset:1024 sc1
  buffer_load_dwordx4 v[100:103], v7, s[8:11], s25 offen offset:2048 sc1
  buffer_load_dwordx4 v[104:107], v7, s[8:11], s25 offen offset:3072 sc1
  s_waitcnt lgkmcnt(3)
  v_mfma_f32_32x32x16_bf16 v[12:27], v[148:151], v[116:119], v[12:27]
  ds_read_b128 v[136:139], v7 offset:0
  v_mfma_f32_32x32x16_bf16 v[28:43], v[152:155], v[116:119], v[28:43]
  ds_read_b128 v[140:143], v7 offset:1024
  v_mfma_f32_32x32x16_bf16 v[44:59], v[156:159], v[116:119], v[44:59]
  ds_read_b128 v[144:147], v7 offset:2048
  s_waitcnt lgkmcnt(3)
  v_mfma_f32_32x32x16_bf16 v[12:27], v[124:127], v[120:123], v[12:27]
  ds_read_b128 v[148:151], v7 offset:3072
  v_mfma_f32_32x32x16_bf16 v[28:43], v[128:131], v[120:123], v[28:43]
  ds_read_b128 v[152:155], v7 offset:4096
  v_mfma_f32_32x32x16_bf16 v[44:59], v[132:135], v[120:123], v[44:59]
  ds_read_b128 v[156:159], v7 offset:5120
  s_waitcnt lgkmcnt(3)
  v_mfma_f32_32x32x16_bf16 v[12:27], v[136:139], v[60:63], v[12:27]
  ds_read_b128 v[124:127], v7 offset:6144
  v_mfma_f32_32x32x16_bf16 v[28:43], v[140:143], v[60:63], v[28:43]
  ds_read_b128 v[128:131], v7 offset:7168
  v_mfma_f32_32x32x16_bf16 v[44:59], v[144:147], v[60:63], v[44:59]
  ds_read_b128 v[132:135], v7 offset:8192
  s_waitcnt lgkmcnt(3)
  v_mfma_f32_32x32x16_bf16 v[12:27], v[148:151], v[64:67], v[12:27]
  ds_read_b128 v[136:139], v7 offset:9216
  v_mfma_f32_32x32x16_bf16 v[28:43], v[152:155], v[64:67], v[28:43]
  ds_read_b128 v[140:143], v7 offset:10240
  v_mfma_f32_32x32x16_bf16 v[44:59], v[156:159], v[64:67], v[44:59]
  ds_read_b128 v[144:147], v7 offset:11264
  s_waitcnt vmcnt(7)
  s_barrier
  s_add_u32 s45, s26, 7
  s_cmp_ge_u32 s45, 10
  s_cselect_b32 s46, 10, 0
  s_sub_u32 s45, s45, s46
  s_mul_i32 s24, s45, 12288
  s_add_u32 s24, s24, s57
  s_lshl_b32 s45, s45, 12
  s_add_u32 s25, s44, s45
  s_add_u32 m0, s23, 36864
  s_nop 0
  buffer_load_dwordx4 v7, s[8:11], s24 offen offset:0 lds
  s_add_u32 m0, s23, 37888
  s_add_u32 s24, s24, 1024
  buffer_load_dwordx4 v7, s[8:11], s24 offen lds
  s_add_u32 m0, s23, 38912
  s_add_u32 s24, s24, 1024
  buffer_load_dwordx4 v7, s[8:11], s24 offen lds
  buffer_load_dwordx4 v[108:111], v7, s[8:11], s25 offen offset:0 sc1
  buffer_load_dwordx4 v[112:115], v7, s[8:11], s25 offen offset:1024 sc1
  buffer_load_dwordx4 v[116:119], v7, s[8:11], s25 offen offset:2048 sc1
  buffer_load_dwordx4 v[120:123], v7, s[8:11], s25 offen offset:3072 sc1
  s_waitcnt lgkmcnt(3)
  v_mfma_f32_32x32x16_bf16 v[12:27], v[124:127], v[68:71], v[12:27]
  ds_read_b128 v[148:151], v7 offset:12288
  v_mfma_f32_32x32x16_bf16 v[28:43], v[128:131], v[68:71], v[28:43]
  ds_read_b128 v[152:155], v7 offset:13312
  v_mfma_f32_32x32x16_bf16 v[44:59], v[132:135], v[68:71], v[44:59]
  ds_read_b128 v[156:159], v7 offset:14336
  s_waitcnt lgkmcnt(3)
  v_mfma_f32_32x32x16_bf16 v[12:27], v[136:139], v[72:75], v[12:27]
  ds_read_b128 v[124:127], v7 offset:15360
  v_mfma_f32_32x32x16_bf16 v[28:43], v[140:143], v[72:75], v[28:43]
  ds_read_b128 v[128:131], v7 offset:16384
  v_mfma_f32_32x32x16_bf16 v[44:59], v[144:147], v[72:75], v[44:59]
  ds_read_b128 v[132:135], v7 offset:17408
  s_waitcnt lgkmcnt(3)
  v_mfma_f32_32x32x16_bf16 v[12:27], v[148:151], v[76:79], v[12:27]
  ds_read_b128 v[136:139], v7 offset:18432
  v_mfma_f32_32x32x16_bf16 v[28:43], v[152:155], v[76:79], v[28:43]
  ds_read_b128 v[140:143], v7 offset:19456
  v_mfma_f32_32x32x16_bf16 v[44:59], v[156:159], v[76:79], v[44:59]
  ds_read_b128 v[144:147], v7 offset:20480
  s_waitcnt lgkmcnt(3)
  v_mfma_f32_32x32x16_bf16 v[12:27], v[124:127], v[80:83], v[12:27]
  ds_read_b128 v[148:151], v7 offset:21504
  v_mfma_f32_32x32x16_bf16 v[28:43], v[128:131], v[80:83], v[28:43]
  ds_read_b128 v[152:155], v7 offset:22528
  v_mfma_f32_32x32x16_bf16 v[44:59], v[132:135], v[80:83], v[44:59]
  ds_read_b128 v[156:159], v7 offset:23552
  s_waitcnt vmcnt(7)
  s_barrier
  s_add_u32 s45, s26, 8
  s_cmp_ge_u32 s45, 10
  s_cselect_b32 s46, 10, 0
  s_sub_u32 s45, s45, s46
  s_mul_i32 s24, s45, 12288
  s_add_u32 s24, s24, s57
  s_lshl_b32 s45, s45, 12
  s_add_u32 s25, s44, s45
  s_add_u32 m0, s23, 0
  s_nop 0
  buffer_load_dwordx4 v7, s[8:11], s24 offen offset:0 lds
  s_add_u32 m0, s23, 1024
  s_add_u32 s24, s24, 1024
  buffer_load_dwordx4 v7, s[8:11], s24 offen lds
  s_add_u32 m0, s23, 2048
  s_add_u32 s24, s24, 1024
  buffer_load_dwordx4 v7, s[8:11], s24 offen lds
  buffer_load_dwordx4 v[60:63], v7, s[8:11], s25 offen offset:0 sc1
  buffer_load_dwordx4 v[64:67], v7, s[8:11], s25 offen offset:1024 sc1
  buffer_load_dwordx4 v[68:71], v7, s[8:11], s25 offen offset:2048 sc1
  buffer_load_dwordx4 v[72:75], v7, s[8:11], s25 offen offset:3072 sc1
  s_waitcnt lgkmcnt(3)
  v_mfma_f32_32x32x16_bf16 v[12:27], v[136:139], v[84:87], v[12:27]
  ds_read_b128 v[124:127], v7 offset:24576
  v_mfma_f32_32x32x16_bf16 v[28:43], v[140:143], v[84:87], v[28:43]
  ds_read_b128 v[128:131], v7 offset:25600
  v_mfma_f32_32x32x16_bf16 v[44:59], v[144:147], v[84:87], v[44:59]
  ds_read_b128 v[132:135], v7 offset:26624
  s_waitcnt lgkmcnt(3)
  v_mfma_f32_32x32x16_bf16 v[12:27], v[148:151], v[88:91], v[12:27]
  ds_read_b128 v[136:139], v7 offset:27648
  v_mfma_f32_32x32x16_bf16 v[28:43], v[152:155], v[88:91], v[28:43]
  ds_read_b128 v[140:143], v7 offset:28672
  v_mfma_f32_32x32x16_bf16 v[44:59], v[156:159], v[88:91], v[44:59]
  ds_read_b128 v[144:147], v7 offset:29696
  s_waitcnt lgkmcnt(3)
  v_mfma_f32_32x32x16_bf16 v[12:27], v[124:127], v[92:95], v[12:27]
  ds_read_b128 v[148:151], v7 offset:30720
  v_mfma_f32_32x32x16_bf16 v[28:43], v[128:131], v[92:95], v[28:43]
  ds_read_b128 v[152:155], v7 offset:31744
  v_mfma_f32_32x32x16_bf16 v[44:59], v[132:135], v[92:95], v[44:59]
  ds_read_b128 v[156:159], v7 offset:32768
  s_waitcnt lgkmcnt(3)
  v_mfma_f32_32x32x16_bf16 v[12:27], v[136:139], v[96:99], v[12:27]
  ds_read_b128 v[124:127], v7 offset:33792
  v_mfma_f32_32x32x16_bf16 v[28:43], v[140:143], v[96:99], v[28:43]
  ds_read_b128 v[128:131], v7 offset:34816
  v_mfma_f32_32x32x16_bf16 v[44:59], v[144:147], v[96:99], v[44:59]
  ds_read_b128 v[132:135], v7 offset:35840
  s_waitcnt vmcnt(7)
  s_barrier
  s_add_u32 s45, s26, 9
  s_cmp_ge_u32 s45, 10
  s_cselect_b32 s46, 10, 0
  s_sub_u32 s45, s45, s46
  s_mul_i32 s24, s45, 12288
  s_add_u32 s24, s24, s57
  s_lshl_b32 s45, s45, 12
  s_add_u32 s25, s44, s45
  s_add_u32 m0, s23, 12288
  s_nop 0
  buffer_load_dwordx4 v7, s[8:11], s24 offen offset:0 lds
  s_add_u32 m0, s23, 13312
  s_add_u32 s24, s24, 1024
  buffer_load_dwordx4 v7, s[8:11], s24 offen lds
  s_add_u32 m0, s23, 14336
  s_add_u32 s24, s24, 1024
  buffer_load_dwordx4 v7, s[8:11], s24 offen lds
  buffer_load_dwordx4 v[76:79], v7, s[8:11], s25 offen offset:0 sc1
  buffer_load_dwordx4 v[80:83], v7, s[8:11], s25 offen offset:1024 sc1
  buffer_load_dwordx4 v[84:87], v7, s[8:11], s25 offen offset:2048 sc1
  buffer_load_dwordx4 v[88:91], v7, s[8:11], s25 offen offset:3072 sc1
  s_waitcnt lgkmcnt(3)
  v_mfma_f32_32x32x16_bf16 v[12:27], v[148:151], v[100:103], v[12:27]
  ds_read_b128 v[136:139], v7 offset:36864
  v_mfma_f32_32x32x16_bf16 v[28:43], v[152:155], v[100:103], v[28:43]
  ds_read_b128 v[140:143], v7 offset:37888
  v_mfma_f32_32x32x16_bf16 v[44:59], v[156:159], v[100:103], v[44:59]
  ds_read_b128 v[144:147], v7 offset:38912
  s_waitcnt lgkmcnt(3)
  v_mfma_f32_32x32x16_bf16 v[12:27], v[124:127], v[104:107], v[12:27]
  ds_read_b128 v[148:151], v7 offset:39936
  v_mfma_f32_32x32x16_bf16 v[28:43], v[128:131], v[104:107], v[28:43]
  ds_read_b128 v[152:155], v7 offset:40960
  v_mfma_f32_32x32x16_bf16 v[44:59], v[132:135], v[104:107], v[44:59]
  ds_read_b128 v[156:159], v7 offset:41984
  s_waitcnt lgkmcnt(3)
  v_mfma_f32_32x32x16_bf16 v[12:27], v[136:139], v[108:111], v[12:27]
  ds_read_b128 v[124:127], v7 offset:43008
  v_mfma_f32_32x32x16_bf16 v[28:43], v[140:143], v[108:111], v[28:43]
  ds_read_b128 v[128:131], v7 offset:44032
  v_mfma_f32_32x32x16_bf16 v[44:59], v[144:147], v[108:111], v[44:59]
  ds_read_b128 v[132:135], v7 offset:45056
  s_waitcnt lgkmcnt(3)
  v_mfma_f32_32x32x16_bf16 v[12:27], v[148:151], v[112:115], v[12:27]
  ds_read_b128 v[136:139], v7 offset:46080
  v_mfma_f32_32x32x16_bf16 v[28:43], v[152:155], v[112:115], v[28:43]
  ds_read_b128 v[140:143], v7 offset:47104
  v_mfma_f32_32x32x16_bf16 v[44:59], v[156:159], v[112:115], v[44:59]
  ds_read_b128 v[144:147], v7 offset:48128
  s_waitcnt vmcnt(7)
  s_barrier
  s_waitcnt lgkmcnt(3)
  v_mfma_f32_32x32x16_bf16 v[12:27], v[124:127], v[116:119], v[12:27]
  ds_read_b128 v[148:151], v7 offset:0
  v_mfma_f32_32x32x16_bf16 v[28:43], v[128:131], v[116:119], v[28:43]
  ds_read_b128 v[152:155], v7 offset:1024
  v_mfma_f32_32x32x16_bf16 v[44:59], v[132:135], v[116:119], v[44:59]
  ds_read_b128 v[156:159], v7 offset:2048
  s_waitcnt lgkmcnt(3)
  v_mfma_f32_32x32x16_bf16 v[12:27], v[136:139], v[120:123], v[12:27]
  ds_read_b128 v[124:127], v7 offset:3072
  v_mfma_f32_32x32x16_bf16 v[28:43], v[140:143], v[120:123], v[28:43]
  ds_read_b128 v[128:131], v7 offset:4096
  v_mfma_f32_32x32x16_bf16 v[44:59], v[144:147], v[120:123], v[44:59]
  ds_read_b128 v[132:135], v7 offset:5120
  s_waitcnt lgkmcnt(3)
  v_mfma_f32_32x32x16_bf16 v[12:27], v[148:151], v[60:63], v[12:27]
  ds_read_b128 v[136:139], v7 offset:6144
  v_mfma_f32_32x32x16_bf16 v[28:43], v[152:155], v[60:63], v[28:43]
  ds_read_b128 v[140:143], v7 offset:7168
  v_mfma_f32_32x32x16_bf16 v[44:59], v[156:159], v[60:63], v[44:59]
  ds_read_b128 v[144:147], v7 offset:8192
  s_waitcnt lgkmcnt(3)
  v_mfma_f32_32x32x16_bf16 v[12:27], v[124:127], v[64:67], v[12:27]
  ds_read_b128 v[148:151], v7 offset:9216
  v_mfma_f32_32x32x16_bf16 v[28:43], v[128:131], v[64:67], v[28:43]
  ds_read_b128 v[152:155], v7 offset:10240
  v_mfma_f32_32x32x16_bf16 v[44:59], v[132:135], v[64:67], v[44:59]
  ds_read_b128 v[156:159], v7 offset:11264
  s_waitcnt vmcnt(0)
  s_barrier
  s_waitcnt lgkmcnt(3)
  v_mfma_f32_32x32x16_bf16 v[12:27], v[136:139], v[68:71], v[12:27]
  ds_read_b128 v[124:127], v7 offset:12288
  v_mfma_f32_32x32x16_bf16 v[28:43], v[140:143], v[68:71], v[28:43]
  ds_read_b128 v[128:131], v7 offset:13312
  v_mfma_f32_32x32x16_bf16 v[44:59], v[144:147], v[68:71], v[44:59]
  ds_read_b128 v[132:135], v7 offset:14336
  s_waitcnt lgkmcnt(3)
  v_mfma_f32_32x32x16_bf16 v[12:27], v[148:151], v[72:75], v[12:27]
  ds_read_b128 v[136:139], v7 offset:15360
  v_mfma_f32_32x32x16_bf16 v[28:43], v[152:155], v[72:75], v[28:43]
  ds_read_b128 v[140:143], v7 offset:16384
  v_mfma_f32_32x32x16_bf16 v[44:59], v[156:159], v[72:75], v[44:59]
  ds_read_b128 v[144:147], v7 offset:17408
  s_waitcnt lgkmcnt(3)
  v_mfma_f32_32x32x16_bf16 v[12:27], v[124:127], v[76:79], v[12:27]
  ds_read_b128 v[148:151], v7 offset:18432
  v_mfma_f32_32x32x16_bf16 v[28:43], v[128:131], v[76:79], v[28:43]
  ds_read_b128 v[152:155], v7 offset:19456
  v_mfma_f32_32x32x16_bf16 v[44:59], v[132:135], v[76:79], v[44:59]
  ds_read_b128 v[156:159], v7 offset:20480
  s_waitcnt lgkmcnt(3)
  v_mfma_f32_32x32x16_bf16 v[12:27], v[136:139], v[80:83], v[12:27]
  ds_read_b128 v[124:127], v7 offset:21504
  v_mfma_f32_32x32x16_bf16 v[28:43], v[140:143], v[80:83], v[28:43]
  ds_read_b128 v[128:131], v7 offset:22528
  v_mfma_f32_32x32x16_bf16 v[44:59], v[144:147], v[80:83], v[44:59]
  ds_read_b128 v[132:135], v7 offset:23552
  s_waitcnt lgkmcnt(3)
  v_mfma_f32_32x32x16_bf16 v[12:27], v[148:151], v[84:87], v[12:27]
  v_mfma_f32_32x32x16_bf16 v[28:43], v[152:155], v[84:87], v[28:43]
  v_mfma_f32_32x32x16_bf16 v[44:59], v[156:159], v[84:87], v[44:59]
  s_waitcnt lgkmcnt(0)
  v_mfma_f32_32x32x16_bf16 v[12:27], v[124:127], v[88:91], v[12:27]
  v_mfma_f32_32x32x16_bf16 v[28:43], v[128:131], v[88:91], v[28:43]
  v_mfma_f32_32x32x16_bf16 v[44:59], v[132:135], v[88:91], v[44:59]
  s_setprio 2
  s_waitcnt vmcnt(0)
  v_add_f32 v160, v160, v168
  v_add_f32 v161, v161, v169
  v_add_f32 v162, v162, v170
  v_add_f32 v163, v163, v171
  v_add_f32 v164, v164, v172
  v_add_f32 v165, v165, v173
  v_add_f32 v166, v166, v174
  v_add_f32 v167, v167, v175
  v_add_f32 v160, v160, v164
  v_add_f32 v161, v161, v165
  v_add_f32 v162, v162, v166
  v_add_f32 v163, v163, v167
  v_add_f32 v160, v160, v162
  v_add_f32 v161, v161, v163
  v_add_f32 v160, v160, v161
  s_mul_i32 s45, s20, 96
  s_add_u32 s45, s45, 49152
  v_lshlrev_b32 v184, 2, v1
  v_add_u32 v184, s45, v184
  s_mov_b64 exec, 0xffffff
  ds_write_b32 v184, v160
  s_mov_b64 exec, -1
  v_add_f32 v176, v176, v178
  v_add_f32 v177, v177, v179
  v_add_f32 v180, v180, v182
  v_add_f32 v181, v181, v183
  v_add_f32 v176, v176, v180
  v_add_f32 v177, v177, v181
  v_mov_b32 v189, v176
  s_nop 1
  v_permlane32_swap_b32 v176, v189
  v_add_f32 v176, v176, v189
  v_mov_b32 v190, v177
  s_nop 1
  v_permlane32_swap_b32 v177, v190
  v_add_f32 v177, v177, v190
  v_mul_f32 v184, 0x3acccccd, v176
  v_mul_f32 v186, 0x3acccccd, v177
  v_fma_f32 v186, -v184, v184, v186
  v_max_f32 v186, 0, v186
  v_add_f32 v185, 0x3727c5ac, v186
  v_rsq_f32 v185, v185
  v_sub_f32 v212, 0, v184
  v_sub_f32 v213, 0, v184
  v_mov_b32 v214, v185
  v_mov_b32 v215, v185
  v_mov_b32 v216, 0xc0135761
  v_mov_b32 v217, 0xc0135761
  v_mov_b32 v218, 0xbdd2d3e8
  v_mov_b32 v219, 0xbdd2d3e8
  v_mov_b32 v220, 1.0
  v_mov_b32 v221, 1.0
  s_lshl_b32 s45, s43, 5
  v_add_u32 v187, s45, v2
  v_lshrrev_b32 v188, 4, v187
  s_mov_b32 s46, 73728
  v_mul_lo_u32 v188, v188, s46
  v_and_b32 v187, 15, v187
  v_lshlrev_b32 v187, 4, v187
  v_lshlrev_b32 v189, 8, v3
  v_add3_u32 v187, v187, v188, v189
  s_mul_i32 s45, s22, 3072
  s_add_u32 s45, s45, 15228928
  v_lshlrev_b32 v191, 4, v3
  v_add_u32 v191, 49152, v191
  s_waitcnt lgkmcnt(0)
  s_barrier
  ds_read_b128 v[60:63], v191 offset:0
  ds_read_b128 v[64:67], v191 offset:32
  ds_read_b128 v[68:71], v191 offset:64
  ds_read_b128 v[72:75], v191 offset:96
  ds_read_b128 v[76:79], v191 offset:128
  ds_read_b128 v[80:83], v191 offset:160
  ds_read_b128 v[84:87], v191 offset:192
  ds_read_b128 v[88:91], v191 offset:224
  ds_read_b128 v[92:95], v191 offset:256
  ds_read_b128 v[96:99], v191 offset:288
  ds_read_b128 v[100:103], v191 offset:320
  ds_read_b128 v[104:107], v191 offset:352
  s_waitcnt lgkmcnt(0)
  s_barrier
  s_mov_b32 s46, 0xbdd2d3e8
  v_fma_f32 v12, v60, v212, v12
  v_fma_f32 v13, v61, v212, v13
  v_fma_f32 v14, v62, v212, v14
  v_fma_f32 v15, v63, v212, v15
  v_mul_f32 v12, v12, v214
  v_mul_f32 v13, v13, v214
  v_mul_f32 v14, v14, v214
  v_mul_f32 v15, v15, v214
  v_mul_f32 v192, v12, v12
  v_mul_f32 v193, v13, v13
  v_mul_f32 v194, v14, v14
  v_mul_f32 v195, v15, v15
  v_fma_f32 v192, v192, s46, v216
  v_fma_f32 v193, v193, s46, v216
  v_fma_f32 v194, v194, s46, v216
  v_fma_f32 v195, v195, s46, v216
  v_mul_f32 v192, v192, v12
  v_mul_f32 v193, v193, v13
  v_mul_f32 v194, v194, v14
  v_mul_f32 v195, v195, v15
  v_exp_f32 v192, v192
  v_exp_f32 v193, v193
  v_exp_f32 v194, v194
  v_exp_f32 v195, v195
  v_add_f32 v192, 1.0, v192
  v_add_f32 v193, 1.0, v193
  v_add_f32 v194, 1.0, v194
  v_add_f32 v195, 1.0, v195
  v_rcp_f32 v192, v192
  v_rcp_f32 v193, v193
  v_rcp_f32 v194, v194
  v_rcp_f32 v195, v195
  v_mul_f32 v12, v12, v192
  v_mul_f32 v13, v13, v193
  v_mul_f32 v14, v14, v194
  v_mul_f32 v15, v15, v195
  v_cvt_pk_bf16_f32 v200, v12, v13
  v_cvt_pk_bf16_f32 v201, v14, v15
  v_fma_f32 v16, v64, v212, v16
  v_fma_f32 v17, v65, v212, v17
  v_fma_f32 v18, v66, v212, v18
  v_fma_f32 v19, v67, v212, v19
  v_mul_f32 v16, v16, v214
  v_mul_f32 v17, v17, v214
  v_mul_f32 v18, v18, v214
  v_mul_f32 v19, v19, v214
  v_mul_f32 v196, v16, v16
  v_mul_f32 v197, v17, v17
  v_mul_f32 v198, v18, v18
  v_mul_f32 v199, v19, v19
  v_fma_f32 v196, v196, s46, v216
  v_fma_f32 v197, v197, s46, v216
  v_fma_f32 v198, v198, s46, v216
  v_fma_f32 v199, v199, s46, v216
  v_mul_f32 v196, v196, v16
  v_mul_f32 v197, v197, v17
  v_mul_f32 v198, v198, v18
  v_mul_f32 v199, v199, v19
  v_exp_f32 v196, v196
  v_exp_f32 v197, v197
  v_exp_f32 v198, v198
  v_exp_f32 v199, v199
  v_add_f32 v196, 1.0, v196
  v_add_f32 v197, 1.0, v197
  v_add_f32 v198, 1.0, v198
  v_add_f32 v199, 1.0, v199
  v_rcp_f32 v196, v196
  v_rcp_f32 v197, v197
  v_rcp_f32 v198, v198
  v_rcp_f32 v199, v199
  v_mul_f32 v16, v16, v196
  v_mul_f32 v17, v17, v197
  v_mul_f32 v18, v18, v198
  v_mul_f32 v19, v19, v199
  v_cvt_pk_bf16_f32 v202, v16, v17
  v_cvt_pk_bf16_f32 v203, v18, v19
  buffer_store_dwordx4 v[200:203], v187, s[8:11], s45 offen offset:0 sc1
  v_fma_f32 v20, v68, v212, v20
  v_fma_f32 v21, v69, v212, v21
  v_fma_f32 v22, v70, v212, v22
  v_fma_f32 v23, v71, v212, v23
  v_mul_f32 v20, v20, v214
  v_mul_f32 v21, v21, v214
  v_mul_f32 v22, v22, v214
  v_mul_f32 v23, v23, v214
  v_mul_f32 v192, v20, v20
  v_mul_f32 v193, v21, v21
  v_mul_f32 v194, v22, v22
  v_mul_f32 v195, v23, v23
  v_fma_f32 v192, v192, s46, v216
  v_fma_f32 v193, v193, s46, v216
  v_fma_f32 v194, v194, s46, v216
  v_fma_f32 v195, v195, s46, v216
  v_mul_f32 v192, v192, v20
  v_mul_f32 v193, v193, v21
  v_mul_f32 v194, v194, v22
  v_mul_f32 v195, v195, v23
  v_exp_f32 v192, v192
  v_exp_f32 v193, v193
  v_exp_f32 v194, v194
  v_exp_f32 v195, v195
  v_add_f32 v192, 1.0, v192
  v_add_f32 v193, 1.0, v193
  v_add_f32 v194, 1.0, v194
  v_add_f32 v195, 1.0, v195
  v_rcp_f32 v192, v192
  v_rcp_f32 v193, v193
  v_rcp_f32 v194, v194
  v_rcp_f32 v195, v195
  v_mul_f32 v20, v20, v192
  v_mul_f32 v21, v21, v193
  v_mul_f32 v22, v22, v194
  v_mul_f32 v23, v23, v195
  v_cvt_pk_bf16_f32 v204, v20, v21
  v_cvt_pk_bf16_f32 v205, v22, v23
  v_fma_f32 v24, v72, v212, v24
  v_fma_f32 v25, v73, v212, v25
  v_fma_f32 v26, v74, v212, v26
  v_fma_f32 v27, v75, v212, v27
  v_mul_f32 v24, v24, v214
  v_mul_f32 v25, v25, v214
  v_mul_f32 v26, v26, v214
  v_mul_f32 v27, v27, v214
  v_mul_f32 v196, v24, v24
  v_mul_f32 v197, v25, v25
  v_mul_f32 v198, v26, v26
  v_mul_f32 v199, v27, v27
  v_fma_f32 v196, v196, s46, v216
  v_fma_f32 v197, v197, s46, v216
  v_fma_f32 v198, v198, s46, v216
  v_fma_f32 v199, v199, s46, v216
  v_mul_f32 v196, v196, v24
  v_mul_f32 v197, v197, v25
  v_mul_f32 v198, v198, v26
  v_mul_f32 v199, v199, v27
  v_exp_f32 v196, v196
  v_exp_f32 v197, v197
  v_exp_f32 v198, v198
  v_exp_f32 v199, v199
  v_add_f32 v196, 1.0, v196
  v_add_f32 v197, 1.0, v197
  v_add_f32 v198, 1.0, v198
  v_add_f32 v199, 1.0, v199
  v_rcp_f32 v196, v196
  v_rcp_f32 v197, v197
  v_rcp_f32 v198, v198
  v_rcp_f32 v199, v199
  v_mul_f32 v24, v24, v196
  v_mul_f32 v25, v25, v197
  v_mul_f32 v26, v26, v198
  v_mul_f32 v27, v27, v199
  v_cvt_pk_bf16_f32 v206, v24, v25
  v_cvt_pk_bf16_f32 v207, v26, v27
  buffer_store_dwordx4 v[204:207], v187, s[8:11], s45 offen offset:512 sc1
  v_fma_f32 v28, v76, v212, v28
  v_fma_f32 v29, v77, v212, v29
  v_fma_f32 v30, v78, v212, v30
  v_fma_f32 v31, v79, v212, v31
  v_mul_f32 v28, v28, v214
  v_mul_f32 v29, v29, v214
  v_mul_f32 v30, v30, v214
  v_mul_f32 v31, v31, v214
  v_mul_f32 v192, v28, v28
  v_mul_f32 v193, v29, v29
  v_mul_f32 v194, v30, v30
  v_mul_f32 v195, v31, v31
  v_fma_f32 v192, v192, s46, v216
  v_fma_f32 v193, v193, s46, v216
  v_fma_f32 v194, v194, s46, v216
  v_fma_f32 v195, v195, s46, v216
  v_mul_f32 v192, v192, v28
  v_mul_f32 v193, v193, v29
  v_mul_f32 v194, v194, v30
  v_mul_f32 v195, v195, v31
  v_exp_f32 v192, v192
  v_exp_f32 v193, v193
  v_exp_f32 v194, v194
  v_exp_f32 v195, v195
  v_add_f32 v192, 1.0, v192
  v_add_f32 v193, 1.0, v193
  v_add_f32 v194, 1.0, v194
  v_add_f32 v195, 1.0, v195
  v_rcp_f32 v192, v192
  v_rcp_f32 v193, v193
  v_rcp_f32 v194, v194
  v_rcp_f32 v195, v195
  v_mul_f32 v28, v28, v192
  v_mul_f32 v29, v29, v193
  v_mul_f32 v30, v30, v194
  v_mul_f32 v31, v31, v195
  v_cvt_pk_bf16_f32 v200, v28, v29
  v_cvt_pk_bf16_f32 v201, v30, v31
  v_fma_f32 v32, v80, v212, v32
  v_fma_f32 v33, v81, v212, v33
  v_fma_f32 v34, v82, v212, v34
  v_fma_f32 v35, v83, v212, v35
  v_mul_f32 v32, v32, v214
  v_mul_f32 v33, v33, v214
  v_mul_f32 v34, v34, v214
  v_mul_f32 v35, v35, v214
  v_mul_f32 v196, v32, v32
  v_mul_f32 v197, v33, v33
  v_mul_f32 v198, v34, v34
  v_mul_f32 v199, v35, v35
  v_fma_f32 v196, v196, s46, v216
  v_fma_f32 v197, v197, s46, v216
  v_fma_f32 v198, v198, s46, v216
  v_fma_f32 v199, v199, s46, v216
  v_mul_f32 v196, v196, v32
  v_mul_f32 v197, v197, v33
  v_mul_f32 v198, v198, v34
  v_mul_f32 v199, v199, v35
  v_exp_f32 v196, v196
  v_exp_f32 v197, v197
  v_exp_f32 v198, v198
  v_exp_f32 v199, v199
  v_add_f32 v196, 1.0, v196
  v_add_f32 v197, 1.0, v197
  v_add_f32 v198, 1.0, v198
  v_add_f32 v199, 1.0, v199
  v_rcp_f32 v196, v196
  v_rcp_f32 v197, v197
  v_rcp_f32 v198, v198
  v_rcp_f32 v199, v199
  v_mul_f32 v32, v32, v196
  v_mul_f32 v33, v33, v197
  v_mul_f32 v34, v34, v198
  v_mul_f32 v35, v35, v199
  v_cvt_pk_bf16_f32 v202, v32, v33
  v_cvt_pk_bf16_f32 v203, v34, v35
  buffer_store_dwordx4 v[200:203], v187, s[8:11], s45 offen offset:1024 sc1
  v_fma_f32 v36, v84, v212, v36
  v_fma_f32 v37, v85, v212, v37
  v_fma_f32 v38, v86, v212, v38
  v_fma_f32 v39, v87, v212, v39
  v_mul_f32 v36, v36, v214
  v_mul_f32 v37, v37, v214
  v_mul_f32 v38, v38, v214
  v_mul_f32 v39, v39, v214
  v_mul_f32 v192, v36, v36
  v_mul_f32 v193, v37, v37
  v_mul_f32 v194, v38, v38
  v_mul_f32 v195, v39, v39
  v_fma_f32 v192, v192, s46, v216
  v_fma_f32 v193, v193, s46, v216
  v_fma_f32 v194, v194, s46, v216
  v_fma_f32 v195, v195, s46, v216
  v_mul_f32 v192, v192, v36
  v_mul_f32 v193, v193, v37
  v_mul_f32 v194, v194, v38
  v_mul_f32 v195, v195, v39
  v_exp_f32 v192, v192
  v_exp_f32 v193, v193
  v_exp_f32 v194, v194
  v_exp_f32 v195, v195
  v_add_f32 v192, 1.0, v192
  v_add_f32 v193, 1.0, v193
  v_add_f32 v194, 1.0, v194
  v_add_f32 v195, 1.0, v195
  v_rcp_f32 v192, v192
  v_rcp_f32 v193, v193
  v_rcp_f32 v194, v194
  v_rcp_f32 v195, v195
  v_mul_f32 v36, v36, v192
  v_mul_f32 v37, v37, v193
  v_mul_f32 v38, v38, v194
  v_mul_f32 v39, v39, v195
  v_cvt_pk_bf16_f32 v204, v36, v37
  v_cvt_pk_bf16_f32 v205, v38, v39
  v_fma_f32 v40, v88, v212, v40
  v_fma_f32 v41, v89, v212, v41
  v_fma_f32 v42, v90, v212, v42
  v_fma_f32 v43, v91, v212, v43
  v_mul_f32 v40, v40, v214
  v_mul_f32 v41, v41, v214
  v_mul_f32 v42, v42, v214
  v_mul_f32 v43, v43, v214
  v_mul_f32 v196, v40, v40
  v_mul_f32 v197, v41, v41
  v_mul_f32 v198, v42, v42
  v_mul_f32 v199, v43, v43
  v_fma_f32 v196, v196, s46, v216
  v_fma_f32 v197, v197, s46, v216
  v_fma_f32 v198, v198, s46, v216
  v_fma_f32 v199, v199, s46, v216
  v_mul_f32 v196, v196, v40
  v_mul_f32 v197, v197, v41
  v_mul_f32 v198, v198, v42
  v_mul_f32 v199, v199, v43
  v_exp_f32 v196, v196
  v_exp_f32 v197, v197
  v_exp_f32 v198, v198
  v_exp_f32 v199, v199
  v_add_f32 v196, 1.0, v196
  v_add_f32 v197, 1.0, v197
  v_add_f32 v198, 1.0, v198
  v_add_f32 v199, 1.0, v199
  v_rcp_f32 v196, v196
  v_rcp_f32 v197, v197
  v_rcp_f32 v198, v198
  v_rcp_f32 v199, v199
  v_mul_f32 v40, v40, v196
  v_mul_f32 v41, v41, v197
  v_mul_f32 v42, v42, v198
  v_mul_f32 v43, v43, v199
  v_cvt_pk_bf16_f32 v206, v40, v41
  v_cvt_pk_bf16_f32 v207, v42, v43
  buffer_store_dwordx4 v[204:207], v187, s[8:11], s45 offen offset:1536 sc1
  v_fma_f32 v44, v92, v212, v44
  v_fma_f32 v45, v93, v212, v45
  v_fma_f32 v46, v94, v212, v46
  v_fma_f32 v47, v95, v212, v47
  v_mul_f32 v44, v44, v214
  v_mul_f32 v45, v45, v214
  v_mul_f32 v46, v46, v214
  v_mul_f32 v47, v47, v214
  v_mul_f32 v192, v44, v44
  v_mul_f32 v193, v45, v45
  v_mul_f32 v194, v46, v46
  v_mul_f32 v195, v47, v47
  v_fma_f32 v192, v192, s46, v216
  v_fma_f32 v193, v193, s46, v216
  v_fma_f32 v194, v194, s46, v216
  v_fma_f32 v195, v195, s46, v216
  v_mul_f32 v192, v192, v44
  v_mul_f32 v193, v193, v45
  v_mul_f32 v194, v194, v46
  v_mul_f32 v195, v195, v47
  v_exp_f32 v192, v192
  v_exp_f32 v193, v193
  v_exp_f32 v194, v194
  v_exp_f32 v195, v195
  v_add_f32 v192, 1.0, v192
  v_add_f32 v193, 1.0, v193
  v_add_f32 v194, 1.0, v194
  v_add_f32 v195, 1.0, v195
  v_rcp_f32 v192, v192
  v_rcp_f32 v193, v193
  v_rcp_f32 v194, v194
  v_rcp_f32 v195, v195
  v_mul_f32 v44, v44, v192
  v_mul_f32 v45, v45, v193
  v_mul_f32 v46, v46, v194
  v_mul_f32 v47, v47, v195
  v_cvt_pk_bf16_f32 v200, v44, v45
  v_cvt_pk_bf16_f32 v201, v46, v47
  v_fma_f32 v48, v96, v212, v48
  v_fma_f32 v49, v97, v212, v49
  v_fma_f32 v50, v98, v212, v50
  v_fma_f32 v51, v99, v212, v51
  v_mul_f32 v48, v48, v214
  v_mul_f32 v49, v49, v214
  v_mul_f32 v50, v50, v214
  v_mul_f32 v51, v51, v214
  v_mul_f32 v196, v48, v48
  v_mul_f32 v197, v49, v49
  v_mul_f32 v198, v50, v50
  v_mul_f32 v199, v51, v51
  v_fma_f32 v196, v196, s46, v216
  v_fma_f32 v197, v197, s46, v216
  v_fma_f32 v198, v198, s46, v216
  v_fma_f32 v199, v199, s46, v216
  v_mul_f32 v196, v196, v48
  v_mul_f32 v197, v197, v49
  v_mul_f32 v198, v198, v50
  v_mul_f32 v199, v199, v51
  v_exp_f32 v196, v196
  v_exp_f32 v197, v197
  v_exp_f32 v198, v198
  v_exp_f32 v199, v199
  v_add_f32 v196, 1.0, v196
  v_add_f32 v197, 1.0, v197
  v_add_f32 v198, 1.0, v198
  v_add_f32 v199, 1.0, v199
  v_rcp_f32 v196, v196
  v_rcp_f32 v197, v197
  v_rcp_f32 v198, v198
  v_rcp_f32 v199, v199
  v_mul_f32 v48, v48, v196
  v_mul_f32 v49, v49, v197
  v_mul_f32 v50, v50, v198
  v_mul_f32 v51, v51, v199
  v_cvt_pk_bf16_f32 v202, v48, v49
  v_cvt_pk_bf16_f32 v203, v50, v51
  buffer_store_dwordx4 v[200:203], v187, s[8:11], s45 offen offset:2048 sc1
  v_fma_f32 v52, v100, v212, v52
  v_fma_f32 v53, v101, v212, v53
  v_fma_f32 v54, v102, v212, v54
  v_fma_f32 v55, v103, v212, v55
  v_mul_f32 v52, v52, v214
  v_mul_f32 v53, v53, v214
  v_mul_f32 v54, v54, v214
  v_mul_f32 v55, v55, v214
  v_mul_f32 v192, v52, v52
  v_mul_f32 v193, v53, v53
  v_mul_f32 v194, v54, v54
  v_mul_f32 v195, v55, v55
  v_fma_f32 v192, v192, s46, v216
  v_fma_f32 v193, v193, s46, v216
  v_fma_f32 v194, v194, s46, v216
  v_fma_f32 v195, v195, s46, v216
  v_mul_f32 v192, v192, v52
  v_mul_f32 v193, v193, v53
  v_mul_f32 v194, v194, v54
  v_mul_f32 v195, v195, v55
  v_exp_f32 v192, v192
  v_exp_f32 v193, v193
  v_exp_f32 v194, v194
  v_exp_f32 v195, v195
  v_add_f32 v192, 1.0, v192
  v_add_f32 v193, 1.0, v193
  v_add_f32 v194, 1.0, v194
  v_add_f32 v195, 1.0, v195
  v_rcp_f32 v192, v192
  v_rcp_f32 v193, v193
  v_rcp_f32 v194, v194
  v_rcp_f32 v195, v195
  v_mul_f32 v52, v52, v192
  v_mul_f32 v53, v53, v193
  v_mul_f32 v54, v54, v194
  v_mul_f32 v55, v55, v195
  v_cvt_pk_bf16_f32 v204, v52, v53
  v_cvt_pk_bf16_f32 v205, v54, v55
  v_fma_f32 v56, v104, v212, v56
  v_fma_f32 v57, v105, v212, v57
  v_fma_f32 v58, v106, v212, v58
  v_fma_f32 v59, v107, v212, v59
  v_mul_f32 v56, v56, v214
  v_mul_f32 v57, v57, v214
  v_mul_f32 v58, v58, v214
  v_mul_f32 v59, v59, v214
  v_mul_f32 v196, v56, v56
  v_mul_f32 v197, v57, v57
  v_mul_f32 v198, v58, v58
  v_mul_f32 v199, v59, v59
  v_fma_f32 v196, v196, s46, v216
  v_fma_f32 v197, v197, s46, v216
  v_fma_f32 v198, v198, s46, v216
  v_fma_f32 v199, v199, s46, v216
  v_mul_f32 v196, v196, v56
  v_mul_f32 v197, v197, v57
  v_mul_f32 v198, v198, v58
  v_mul_f32 v199, v199, v59
  v_exp_f32 v196, v196
  v_exp_f32 v197, v197
  v_exp_f32 v198, v198
  v_exp_f32 v199, v199
  v_add_f32 v196, 1.0, v196
  v_add_f32 v197, 1.0, v197
  v_add_f32 v198, 1.0, v198
  v_add_f32 v199, 1.0, v199
  v_rcp_f32 v196, v196
  v_rcp_f32 v197, v197
  v_rcp_f32 v198, v198
  v_rcp_f32 v199, v199
  v_mul_f32 v56, v56, v196
  v_mul_f32 v57, v57, v197
  v_mul_f32 v58, v58, v198
  v_mul_f32 v59, v59, v199
  v_cvt_pk_bf16_f32 v206, v56, v57
  v_cvt_pk_bf16_f32 v207, v58, v59
  buffer_store_dwordx4 v[204:207], v187, s[8:11], s45 offen offset:2560 sc1
  s_lshl_b32 s53, s43, 11
  s_lshl_b32 s47, s22, 7
  s_add_u32 s53, s53, s47
  s_add_u32 s53, s53, 31588352
  v_and_b32 v184, 31, v0
  v_lshlrev_b32 v184, 2, v184
  v_mov_b32 v185, 1
  s_waitcnt vmcnt(0)
  s_mov_b32 exec_hi, 0
  buffer_store_dword v185, v184, s[8:11], s53 offen sc1
  s_mov_b64 exec, -1
  s_setprio 0
  s_load_dwordx2 s[4:5], s[0:1], 80
  s_load_dwordx2 s[40:41], s[0:1], 0
  s_load_dwordx2 s[44:45], s[0:1], 64
  s_and_b32 s36, s2, 7
  s_lshr_b32 s37, s2, 3
  s_and_b32 s38, s36, 3
  s_lshl_b32 s38, s38, 3
  s_and_b32 s39, s37, 7
  s_add_u32 s21, s38, s39
  s_lshr_b32 s38, s36, 2
  s_lshl_b32 s38, s38, 2
  s_lshr_b32 s46, s37, 3
  s_add_u32 s22, s38, s46
  v_and_b32 v1, 63, v0
  v_lshrrev_b32 v232, 6, v0
  v_and_b32 v2, 15, v1
  v_readfirstlane_b32 s20, v232
  v_lshrrev_b32 v3, 4, v1
  v_lshlrev_b32 v8, 4, v1
  s_mul_i32 s47, s46, 3
  s_add_u32 s47, s47, s39
  s_cmp_ge_u32 s47, 12
  s_cselect_b32 s48, 12, 0
  s_sub_u32 s34, s47, s48
  s_add_u32 s47, s20, 0
  s_and_b32 s47, s47, 3
  s_mul_i32 s47, s47, 73728
  v_add_u32 v4, s47, v8
  s_add_u32 s47, s20, 1
  s_and_b32 s47, s47, 3
  s_mul_i32 s47, s47, 73728
  v_add_u32 v5, s47, v8
  s_add_u32 s47, s20, 2
  s_and_b32 s47, s47, 3
  s_mul_i32 s47, s47, 73728
  v_add_u32 v6, s47, v8
  s_add_u32 s47, s20, 3
  s_and_b32 s47, s47, 3
  s_mul_i32 s47, s47, 73728
  v_add_u32 v7, s47, v8
  s_mul_i32 s33, s20, 15360
  s_mul_i32 s56, s21, 288
  s_add_u32 s56, s56, 24
  s_lshl_b32 s56, s56, 10
  s_add_u32 s56, s56, 15204352
  s_mul_i32 s57, s22, 48
  s_add_u32 s57, s57, 352
  s_mul_i32 s57, s57, 5120
  s_add_u32 s57, s57, 24641536
  s_waitcnt lgkmcnt(0)
  s_mov_b32 s8, s4
  s_and_b32 s9, s5, 0xffff
  s_mov_b32 s10, 37748736
  s_mov_b32 s11, 0x20000
  s_mov_b32 s24, s40
  s_and_b32 s25, s41, 0xffff
  s_mov_b32 s26, 2621440
  s_mov_b32 s27, 0x20000
  s_mov_b32 s28, s44
  s_and_b32 s29, s45, 0xffff
  s_mov_b32 s30, 2621440
  s_mov_b32 s31, 0x20000
  s_mul_i32 s58, s21, 288
  s_lshl_b32 s58, s58, 10
  s_add_u32 s58, s58, 15204352
  s_mul_i32 s59, s22, 24
  s_add_u32 s59, s59, 160
  s_mul_i32 s59, s59, 5120
  s_add_u32 s59, s59, 24641536
  s_add_u32 s47, s39, s46
  s_cmp_ge_u32 s47, 6
  s_cselect_b32 s48, 6, 0
  s_sub_u32 s60, s47, s48
  s_add_u32 s47, s34, 0
  s_cmp_ge_u32 s47, 12
  s_cselect_b32 s48, 12, 0
  s_sub_u32 s47, s47, s48
  s_lshl_b32 s47, s47, 2
  s_add_u32 s47, s47, s20
  s_mul_i32 s32, s47, 5120
  s_add_u32 s32, s32, s57
  s_add_u32 s35, s32, 4096
  s_lshl_b32 s47, s47, 10
  s_add_u32 s23, s47, s56
  buffer_load_dwordx4 v[140:143], v8, s[8:11], s32 offen offset:0
  buffer_load_dwordx4 v[144:147], v8, s[8:11], s32 offen offset:1024
  buffer_load_dwordx4 v[148:151], v8, s[8:11], s32 offen offset:2048
  buffer_load_dwordx4 v[152:155], v8, s[8:11], s32 offen offset:3072
  buffer_load_dwordx4 v[156:159], v8, s[8:11], s35 offen offset:0
  s_add_u32 s47, s34, 1
  s_cmp_ge_u32 s47, 12
  s_cselect_b32 s48, 12, 0
  s_sub_u32 s47, s47, s48
  s_lshl_b32 s47, s47, 2
  s_add_u32 s47, s47, s20
  s_mul_i32 s32, s47, 5120
  s_add_u32 s32, s32, s57
  s_add_u32 s35, s32, 4096
  s_lshl_b32 s47, s47, 10
  s_add_u32 s23, s47, s56
  buffer_load_dwordx4 v[160:163], v8, s[8:11], s32 offen offset:0
  buffer_load_dwordx4 v[164:167], v8, s[8:11], s32 offen offset:1024
  buffer_load_dwordx4 v[168:171], v8, s[8:11], s32 offen offset:2048
  buffer_load_dwordx4 v[172:175], v8, s[8:11], s32 offen offset:3072
  buffer_load_dwordx4 v[176:179], v8, s[8:11], s35 offen offset:0
  s_lshl_b32 s53, s21, 12
  s_add_u32 s53, s53, 31588352
  v_and_b32 v240, 31, v0
  v_lshlrev_b32 v240, 7, v240
l2_kernel_wbp6:
  buffer_load_dword v241, v240, s[8:11], s53 offen sc1
  s_waitcnt vmcnt(0)
  v_cmp_ne_u32 vcc, 1, v241
  s_nop 0
  s_cbranch_vccz l2_kernel_wb5
  s_sleep 2
  s_branch l2_kernel_wbp6
l2_kernel_wb5:
  s_add_u32 s47, s34, 0
  s_cmp_ge_u32 s47, 12
  s_cselect_b32 s48, 12, 0
  s_sub_u32 s47, s47, s48
  s_lshl_b32 s47, s47, 2
  s_add_u32 s47, s47, s20
  s_mul_i32 s32, s47, 5120
  s_add_u32 s32, s32, s57
  s_add_u32 s35, s32, 4096
  s_lshl_b32 s47, s47, 10
  s_add_u32 s23, s47, s56
  buffer_load_dwordx4 v[92:95], v4, s[8:11], s23 offen sc1
  buffer_load_dwordx4 v[96:99], v5, s[8:11], s23 offen sc1
  buffer_load_dwordx4 v[100:103], v6, s[8:11], s23 offen sc1
  buffer_load_dwordx4 v[104:107], v7, s[8:11], s23 offen sc1
  s_add_u32 s47, s34, 1
  s_cmp_ge_u32 s47, 12
  s_cselect_b32 s48, 12, 0
  s_sub_u32 s47, s47, s48
  s_lshl_b32 s47, s47, 2
  s_add_u32 s47, s47, s20
  s_mul_i32 s32, s47, 5120
  s_add_u32 s32, s32, s57
  s_add_u32 s35, s32, 4096
  s_lshl_b32 s47, s47, 10
  s_add_u32 s23, s47, s56
  buffer_load_dwordx4 v[108:111], v4, s[8:11], s23 offen sc1
  buffer_load_dwordx4 v[112:115], v5, s[8:11], s23 offen sc1
  buffer_load_dwordx4 v[116:119], v6, s[8:11], s23 offen sc1
  buffer_load_dwordx4 v[120:123], v7, s[8:11], s23 offen sc1
  s_lshl_b32 s47, s21, 6
  s_lshl_b32 s48, s20, 4
  s_add_u32 s47, s47, s48
  v_add_u32 v236, s47, v2
  v_mul_u32_u24 v238, 1280, v236
  v_lshl_add_u32 v238, v3, 3, v238
  s_mul_i32 s49, s22, 160
  s_lshl_b32 s54, s2, 2
  s_add_u32 s54, s54, s20
  s_mul_i32 s54, s54, 5120
  s_add_u32 s54, s54, 31981568
  s_add_u32 s55, s54, 4096
  v_lshrrev_b32 v232, 5, v236
  v_mul_u32_u24 v232, 40960, v232
  v_and_b32 v233, 31, v236
  v_lshrrev_b32 v234, 1, v3
  v_lshl_add_u32 v233, v234, 5, v233
  v_lshl_add_u32 v232, v233, 4, v232
  v_and_b32 v233, 1, v3
  v_lshl_add_u32 v237, v233, 3, v232
  s_mul_i32 s50, s22, 5120
  s_add_u32 s50, s50, 11534336
  s_add_u32 s51, s50, 4096
  s_waitcnt vmcnt(4)
  s_add_u32 s47, s34, 2
  s_cmp_ge_u32 s47, 12
  s_cselect_b32 s48, 12, 0
  s_sub_u32 s47, s47, s48
  s_lshl_b32 s47, s47, 2
  s_add_u32 s47, s47, s20
  s_mul_i32 s32, s47, 5120
  s_add_u32 s32, s32, s57
  s_add_u32 s35, s32, 4096
  s_lshl_b32 s47, s47, 10
  s_add_u32 s23, s47, s56
  v_mfma_f32_16x16x32_bf16 v[12:15], v[140:143], v[92:95], 0
  v_mfma_f32_16x16x32_bf16 v[16:19], v[144:147], v[92:95], 0
  buffer_load_dwordx4 v[180:183], v8, s[8:11], s32 offen offset:0
  v_mfma_f32_16x16x32_bf16 v[20:23], v[148:151], v[92:95], 0
  v_mfma_f32_16x16x32_bf16 v[24:27], v[152:155], v[92:95], 0
  buffer_load_dwordx4 v[184:187], v8, s[8:11], s32 offen offset:1024
  v_mfma_f32_16x16x32_bf16 v[28:31], v[156:159], v[92:95], 0
  v_mfma_f32_16x16x32_bf16 v[32:35], v[140:143], v[96:99], 0
  buffer_load_dwordx4 v[188:191], v8, s[8:11], s32 offen offset:2048
  v_mfma_f32_16x16x32_bf16 v[36:39], v[144:147], v[96:99], 0
  v_mfma_f32_16x16x32_bf16 v[40:43], v[148:151], v[96:99], 0
  buffer_load_dwordx4 v[192:195], v8, s[8:11], s32 offen offset:3072
  v_mfma_f32_16x16x32_bf16 v[44:47], v[152:155], v[96:99], 0
  v_mfma_f32_16x16x32_bf16 v[48:51], v[156:159], v[96:99], 0
  buffer_load_dwordx4 v[196:199], v8, s[8:11], s35 offen offset:0
  v_mfma_f32_16x16x32_bf16 v[52:55], v[140:143], v[100:103], 0
  v_mfma_f32_16x16x32_bf16 v[56:59], v[144:147], v[100:103], 0
  buffer_load_dwordx4 v[124:127], v4, s[8:11], s23 offen sc1
  v_mfma_f32_16x16x32_bf16 v[60:63], v[148:151], v[100:103], 0
  v_mfma_f32_16x16x32_bf16 v[64:67], v[152:155], v[100:103], 0
  buffer_load_dwordx4 v[128:131], v5, s[8:11], s23 offen sc1
  v_mfma_f32_16x16x32_bf16 v[68:71], v[156:159], v[100:103], 0
  v_mfma_f32_16x16x32_bf16 v[72:75], v[140:143], v[104:107], 0
  buffer_load_dwordx4 v[132:135], v6, s[8:11], s23 offen sc1
  v_mfma_f32_16x16x32_bf16 v[76:79], v[144:147], v[104:107], 0
  v_mfma_f32_16x16x32_bf16 v[80:83], v[148:151], v[104:107], 0
  buffer_load_dwordx4 v[136:139], v7, s[8:11], s23 offen sc1
  v_mfma_f32_16x16x32_bf16 v[84:87], v[152:155], v[104:107], 0
  v_mfma_f32_16x16x32_bf16 v[88:91], v[156:159], v[104:107], 0
  s_waitcnt vmcnt(9)
  s_add_u32 s47, s34, 3
  s_cmp_ge_u32 s47, 12
  s_cselect_b32 s48, 12, 0
  s_sub_u32 s47, s47, s48
  s_lshl_b32 s47, s47, 2
  s_add_u32 s47, s47, s20
  s_mul_i32 s32, s47, 5120
  s_add_u32 s32, s32, s57
  s_add_u32 s35, s32, 4096
  s_lshl_b32 s47, s47, 10
  s_add_u32 s23, s47, s56
  v_mfma_f32_16x16x32_bf16 v[12:15], v[160:163], v[108:111], v[12:15]
  v_mfma_f32_16x16x32_bf16 v[16:19], v[164:167], v[108:111], v[16:19]
  buffer_load_dwordx4 v[140:143], v8, s[8:11], s32 offen offset:0
  v_mfma_f32_16x16x32_bf16 v[20:23], v[168:171], v[108:111], v[20:23]
  v_mfma_f32_16x16x32_bf16 v[24:27], v[172:175], v[108:111], v[24:27]
  buffer_load_dwordx4 v[144:147], v8, s[8:11], s32 offen offset:1024
  v_mfma_f32_16x16x32_bf16 v[28:31], v[176:179], v[108:111], v[28:31]
  v_mfma_f32_16x16x32_bf16 v[32:35], v[160:163], v[112:115], v[32:35]
  buffer_load_dwordx4 v[148:151], v8, s[8:11], s32 offen offset:2048
  v_mfma_f32_16x16x32_bf16 v[36:39], v[164:167], v[112:115], v[36:39]
  v_mfma_f32_16x16x32_bf16 v[40:43], v[168:171], v[112:115], v[40:43]
  buffer_load_dwordx4 v[152:155], v8, s[8:11], s32 offen offset:3072
  v_mfma_f32_16x16x32_bf16 v[44:47], v[172:175], v[112:115], v[44:47]
  v_mfma_f32_16x16x32_bf16 v[48:51], v[176:179], v[112:115], v[48:51]
  buffer_load_dwordx4 v[156:159], v8, s[8:11], s35 offen offset:0
  v_mfma_f32_16x16x32_bf16 v[52:55], v[160:163], v[116:119], v[52:55]
  v_mfma_f32_16x16x32_bf16 v[56:59], v[164:167], v[116:119], v[56:59]
  buffer_load_dwordx4 v[92:95], v4, s[8:11], s23 offen sc1
  v_mfma_f32_16x16x32_bf16 v[60:63], v[168:171], v[116:119], v[60:63]
  v_mfma_f32_16x16x32_bf16 v[64:67], v[172:175], v[116:119], v[64:67]
  buffer_load_dwordx4 v[96:99], v5, s[8:11], s23 offen sc1
  v_mfma_f32_16x16x32_bf16 v[68:71], v[176:179], v[116:119], v[68:71]
  v_mfma_f32_16x16x32_bf16 v[72:75], v[160:163], v[120:123], v[72:75]
  buffer_load_dwordx4 v[100:103], v6, s[8:11], s23 offen sc1
  v_mfma_f32_16x16x32_bf16 v[76:79], v[164:167], v[120:123], v[76:79]
  v_mfma_f32_16x16x32_bf16 v[80:83], v[168:171], v[120:123], v[80:83]
  buffer_load_dwordx4 v[104:107], v7, s[8:11], s23 offen sc1
  v_mfma_f32_16x16x32_bf16 v[84:87], v[172:175], v[120:123], v[84:87]
  v_mfma_f32_16x16x32_bf16 v[88:91], v[176:179], v[120:123], v[88:91]
  s_waitcnt vmcnt(9)
  s_add_u32 s47, s34, 4
  s_cmp_ge_u32 s47, 12
  s_cselect_b32 s48, 12, 0
  s_sub_u32 s47, s47, s48
  s_lshl_b32 s47, s47, 2
  s_add_u32 s47, s47, s20
  s_mul_i32 s32, s47, 5120
  s_add_u32 s32, s32, s57
  s_add_u32 s35, s32, 4096
  s_lshl_b32 s47, s47, 10
  s_add_u32 s23, s47, s56
  v_mfma_f32_16x16x32_bf16 v[12:15], v[180:183], v[124:127], v[12:15]
  v_mfma_f32_16x16x32_bf16 v[16:19], v[184:187], v[124:127], v[16:19]
  buffer_load_dwordx4 v[160:163], v8, s[8:11], s32 offen offset:0
  v_mfma_f32_16x16x32_bf16 v[20:23], v[188:191], v[124:127], v[20:23]
  v_mfma_f32_16x16x32_bf16 v[24:27], v[192:195], v[124:127], v[24:27]
  buffer_load_dwordx4 v[164:167], v8, s[8:11], s32 offen offset:1024
  v_mfma_f32_16x16x32_bf16 v[28:31], v[196:199], v[124:127], v[28:31]
  v_mfma_f32_16x16x32_bf16 v[32:35], v[180:183], v[128:131], v[32:35]
  buffer_load_dwordx4 v[168:171], v8, s[8:11], s32 offen offset:2048
  v_mfma_f32_16x16x32_bf16 v[36:39], v[184:187], v[128:131], v[36:39]
  v_mfma_f32_16x16x32_bf16 v[40:43], v[188:191], v[128:131], v[40:43]
  buffer_load_dwordx4 v[172:175], v8, s[8:11], s32 offen offset:3072
  v_mfma_f32_16x16x32_bf16 v[44:47], v[192:195], v[128:131], v[44:47]
  v_mfma_f32_16x16x32_bf16 v[48:51], v[196:199], v[128:131], v[48:51]
  buffer_load_dwordx4 v[176:179], v8, s[8:11], s35 offen offset:0
  v_mfma_f32_16x16x32_bf16 v[52:55], v[180:183], v[132:135], v[52:55]
  v_mfma_f32_16x16x32_bf16 v[56:59], v[184:187], v[132:135], v[56:59]
  buffer_load_dwordx4 v[108:111], v4, s[8:11], s23 offen sc1
  v_mfma_f32_16x16x32_bf16 v[60:63], v[188:191], v[132:135], v[60:63]
  v_mfma_f32_16x16x32_bf16 v[64:67], v[192:195], v[132:135], v[64:67]
  buffer_load_dwordx4 v[112:115], v5, s[8:11], s23 offen sc1
  v_mfma_f32_16x16x32_bf16 v[68:71], v[196:199], v[132:135], v[68:71]
  v_mfma_f32_16x16x32_bf16 v[72:75], v[180:183], v[136:139], v[72:75]
  buffer_load_dwordx4 v[116:119], v6, s[8:11], s23 offen sc1
  v_mfma_f32_16x16x32_bf16 v[76:79], v[184:187], v[136:139], v[76:79]
  v_mfma_f32_16x16x32_bf16 v[80:83], v[188:191], v[136:139], v[80:83]
  buffer_load_dwordx4 v[120:123], v7, s[8:11], s23 offen sc1
  v_mfma_f32_16x16x32_bf16 v[84:87], v[192:195], v[136:139], v[84:87]
  v_mfma_f32_16x16x32_bf16 v[88:91], v[196:199], v[136:139], v[88:91]
  s_waitcnt vmcnt(9)
  s_add_u32 s47, s34, 5
  s_cmp_ge_u32 s47, 12
  s_cselect_b32 s48, 12, 0
  s_sub_u32 s47, s47, s48
  s_lshl_b32 s47, s47, 2
  s_add_u32 s47, s47, s20
  s_mul_i32 s32, s47, 5120
  s_add_u32 s32, s32, s57
  s_add_u32 s35, s32, 4096
  s_lshl_b32 s47, s47, 10
  s_add_u32 s23, s47, s56
  v_mfma_f32_16x16x32_bf16 v[12:15], v[140:143], v[92:95], v[12:15]
  v_mfma_f32_16x16x32_bf16 v[16:19], v[144:147], v[92:95], v[16:19]
  buffer_load_dwordx4 v[180:183], v8, s[8:11], s32 offen offset:0
  v_mfma_f32_16x16x32_bf16 v[20:23], v[148:151], v[92:95], v[20:23]
  v_mfma_f32_16x16x32_bf16 v[24:27], v[152:155], v[92:95], v[24:27]
  buffer_load_dwordx4 v[184:187], v8, s[8:11], s32 offen offset:1024
  v_mfma_f32_16x16x32_bf16 v[28:31], v[156:159], v[92:95], v[28:31]
  v_mfma_f32_16x16x32_bf16 v[32:35], v[140:143], v[96:99], v[32:35]
  buffer_load_dwordx4 v[188:191], v8, s[8:11], s32 offen offset:2048
  v_mfma_f32_16x16x32_bf16 v[36:39], v[144:147], v[96:99], v[36:39]
  v_mfma_f32_16x16x32_bf16 v[40:43], v[148:151], v[96:99], v[40:43]
  buffer_load_dwordx4 v[192:195], v8, s[8:11], s32 offen offset:3072
  v_mfma_f32_16x16x32_bf16 v[44:47], v[152:155], v[96:99], v[44:47]
  v_mfma_f32_16x16x32_bf16 v[48:51], v[156:159], v[96:99], v[48:51]
  buffer_load_dwordx4 v[196:199], v8, s[8:11], s35 offen offset:0
  v_mfma_f32_16x16x32_bf16 v[52:55], v[140:143], v[100:103], v[52:55]
  v_mfma_f32_16x16x32_bf16 v[56:59], v[144:147], v[100:103], v[56:59]
  buffer_load_dwordx4 v[124:127], v4, s[8:11], s23 offen sc1
  v_mfma_f32_16x16x32_bf16 v[60:63], v[148:151], v[100:103], v[60:63]
  v_mfma_f32_16x16x32_bf16 v[64:67], v[152:155], v[100:103], v[64:67]
  buffer_load_dwordx4 v[128:131], v5, s[8:11], s23 offen sc1
  v_mfma_f32_16x16x32_bf16 v[68:71], v[156:159], v[100:103], v[68:71]
  v_mfma_f32_16x16x32_bf16 v[72:75], v[140:143], v[104:107], v[72:75]
  buffer_load_dwordx4 v[132:135], v6, s[8:11], s23 offen sc1
  v_mfma_f32_16x16x32_bf16 v[76:79], v[144:147], v[104:107], v[76:79]
  v_mfma_f32_16x16x32_bf16 v[80:83], v[148:151], v[104:107], v[80:83]
  buffer_load_dwordx4 v[136:139], v7, s[8:11], s23 offen sc1
  v_mfma_f32_16x16x32_bf16 v[84:87], v[152:155], v[104:107], v[84:87]
  v_mfma_f32_16x16x32_bf16 v[88:91], v[156:159], v[104:107], v[88:91]
  s_waitcnt vmcnt(9)
  s_add_u32 s47, s34, 6
  s_cmp_ge_u32 s47, 12
  s_cselect_b32 s48, 12, 0
  s_sub_u32 s47, s47, s48
  s_lshl_b32 s47, s47, 2
  s_add_u32 s47, s47, s20
  s_mul_i32 s32, s47, 5120
  s_add_u32 s32, s32, s57
  s_add_u32 s35, s32, 4096
  s_lshl_b32 s47, s47, 10
  s_add_u32 s23, s47, s56
  v_mfma_f32_16x16x32_bf16 v[12:15], v[160:163], v[108:111], v[12:15]
  v_mfma_f32_16x16x32_bf16 v[16:19], v[164:167], v[108:111], v[16:19]
  buffer_load_dwordx4 v[140:143], v8, s[8:11], s32 offen offset:0
  v_mfma_f32_16x16x32_bf16 v[20:23], v[168:171], v[108:111], v[20:23]
  v_mfma_f32_16x16x32_bf16 v[24:27], v[172:175], v[108:111], v[24:27]
  buffer_load_dwordx4 v[144:147], v8, s[8:11], s32 offen offset:1024
  v_mfma_f32_16x16x32_bf16 v[28:31], v[176:179], v[108:111], v[28:31]
  v_mfma_f32_16x16x32_bf16 v[32:35], v[160:163], v[112:115], v[32:35]
  buffer_load_dwordx4 v[148:151], v8, s[8:11], s32 offen offset:2048
  v_mfma_f32_16x16x32_bf16 v[36:39], v[164:167], v[112:115], v[36:39]
  v_mfma_f32_16x16x32_bf16 v[40:43], v[168:171], v[112:115], v[40:43]
  buffer_load_dwordx4 v[152:155], v8, s[8:11], s32 offen offset:3072
  v_mfma_f32_16x16x32_bf16 v[44:47], v[172:175], v[112:115], v[44:47]
  v_mfma_f32_16x16x32_bf16 v[48:51], v[176:179], v[112:115], v[48:51]
  buffer_load_dwordx4 v[156:159], v8, s[8:11], s35 offen offset:0
  v_mfma_f32_16x16x32_bf16 v[52:55], v[160:163], v[116:119], v[52:55]
  v_mfma_f32_16x16x32_bf16 v[56:59], v[164:167], v[116:119], v[56:59]
  buffer_load_dwordx4 v[92:95], v4, s[8:11], s23 offen sc1
  v_mfma_f32_16x16x32_bf16 v[60:63], v[168:171], v[116:119], v[60:63]
  v_mfma_f32_16x16x32_bf16 v[64:67], v[172:175], v[116:119], v[64:67]
  buffer_load_dwordx4 v[96:99], v5, s[8:11], s23 offen sc1
  v_mfma_f32_16x16x32_bf16 v[68:71], v[176:179], v[116:119], v[68:71]
  v_mfma_f32_16x16x32_bf16 v[72:75], v[160:163], v[120:123], v[72:75]
  buffer_load_dwordx4 v[100:103], v6, s[8:11], s23 offen sc1
  v_mfma_f32_16x16x32_bf16 v[76:79], v[164:167], v[120:123], v[76:79]
  v_mfma_f32_16x16x32_bf16 v[80:83], v[168:171], v[120:123], v[80:83]
  buffer_load_dwordx4 v[104:107], v7, s[8:11], s23 offen sc1
  v_mfma_f32_16x16x32_bf16 v[84:87], v[172:175], v[120:123], v[84:87]
  v_mfma_f32_16x16x32_bf16 v[88:91], v[176:179], v[120:123], v[88:91]
  s_waitcnt vmcnt(9)
  s_add_u32 s47, s34, 7
  s_cmp_ge_u32 s47, 12
  s_cselect_b32 s48, 12, 0
  s_sub_u32 s47, s47, s48
  s_lshl_b32 s47, s47, 2
  s_add_u32 s47, s47, s20
  s_mul_i32 s32, s47, 5120
  s_add_u32 s32, s32, s57
  s_add_u32 s35, s32, 4096
  s_lshl_b32 s47, s47, 10
  s_add_u32 s23, s47, s56
  v_mfma_f32_16x16x32_bf16 v[12:15], v[180:183], v[124:127], v[12:15]
  v_mfma_f32_16x16x32_bf16 v[16:19], v[184:187], v[124:127], v[16:19]
  buffer_load_dwordx4 v[160:163], v8, s[8:11], s32 offen offset:0
  v_mfma_f32_16x16x32_bf16 v[20:23], v[188:191], v[124:127], v[20:23]
  v_mfma_f32_16x16x32_bf16 v[24:27], v[192:195], v[124:127], v[24:27]
  buffer_load_dwordx4 v[164:167], v8, s[8:11], s32 offen offset:1024
  v_mfma_f32_16x16x32_bf16 v[28:31], v[196:199], v[124:127], v[28:31]
  v_mfma_f32_16x16x32_bf16 v[32:35], v[180:183], v[128:131], v[32:35]
  buffer_load_dwordx4 v[168:171], v8, s[8:11], s32 offen offset:2048
  v_mfma_f32_16x16x32_bf16 v[36:39], v[184:187], v[128:131], v[36:39]
  v_mfma_f32_16x16x32_bf16 v[40:43], v[188:191], v[128:131], v[40:43]
  buffer_load_dwordx4 v[172:175], v8, s[8:11], s32 offen offset:3072
  v_mfma_f32_16x16x32_bf16 v[44:47], v[192:195], v[128:131], v[44:47]
  v_mfma_f32_16x16x32_bf16 v[48:51], v[196:199], v[128:131], v[48:51]
  buffer_load_dwordx4 v[176:179], v8, s[8:11], s35 offen offset:0
  v_mfma_f32_16x16x32_bf16 v[52:55], v[180:183], v[132:135], v[52:55]
  v_mfma_f32_16x16x32_bf16 v[56:59], v[184:187], v[132:135], v[56:59]
  buffer_load_dwordx4 v[108:111], v4, s[8:11], s23 offen sc1
  v_mfma_f32_16x16x32_bf16 v[60:63], v[188:191], v[132:135], v[60:63]
  v_mfma_f32_16x16x32_bf16 v[64:67], v[192:195], v[132:135], v[64:67]
  buffer_load_dwordx4 v[112:115], v5, s[8:11], s23 offen sc1
  v_mfma_f32_16x16x32_bf16 v[68:71], v[196:199], v[132:135], v[68:71]
  v_mfma_f32_16x16x32_bf16 v[72:75], v[180:183], v[136:139], v[72:75]
  buffer_load_dwordx4 v[116:119], v6, s[8:11], s23 offen sc1
  v_mfma_f32_16x16x32_bf16 v[76:79], v[184:187], v[136:139], v[76:79]
  v_mfma_f32_16x16x32_bf16 v[80:83], v[188:191], v[136:139], v[80:83]
  buffer_load_dwordx4 v[120:123], v7, s[8:11], s23 offen sc1
  v_mfma_f32_16x16x32_bf16 v[84:87], v[192:195], v[136:139], v[84:87]
  v_mfma_f32_16x16x32_bf16 v[88:91], v[196:199], v[136:139], v[88:91]
  s_waitcnt vmcnt(9)
  s_add_u32 s47, s34, 8
  s_cmp_ge_u32 s47, 12
  s_cselect_b32 s48, 12, 0
  s_sub_u32 s47, s47, s48
  s_lshl_b32 s47, s47, 2
  s_add_u32 s47, s47, s20
  s_mul_i32 s32, s47, 5120
  s_add_u32 s32, s32, s57
  s_add_u32 s35, s32, 4096
  s_lshl_b32 s47, s47, 10
  s_add_u32 s23, s47, s56
  v_mfma_f32_16x16x32_bf16 v[12:15], v[140:143], v[92:95], v[12:15]
  v_mfma_f32_16x16x32_bf16 v[16:19], v[144:147], v[92:95], v[16:19]
  buffer_load_dwordx4 v[180:183], v8, s[8:11], s32 offen offset:0
  v_mfma_f32_16x16x32_bf16 v[20:23], v[148:151], v[92:95], v[20:23]
  v_mfma_f32_16x16x32_bf16 v[24:27], v[152:155], v[92:95], v[24:27]
  buffer_load_dwordx4 v[184:187], v8, s[8:11], s32 offen offset:1024
  v_mfma_f32_16x16x32_bf16 v[28:31], v[156:159], v[92:95], v[28:31]
  v_mfma_f32_16x16x32_bf16 v[32:35], v[140:143], v[96:99], v[32:35]
  buffer_load_dwordx4 v[188:191], v8, s[8:11], s32 offen offset:2048
  v_mfma_f32_16x16x32_bf16 v[36:39], v[144:147], v[96:99], v[36:39]
  v_mfma_f32_16x16x32_bf16 v[40:43], v[148:151], v[96:99], v[40:43]
  buffer_load_dwordx4 v[192:195], v8, s[8:11], s32 offen offset:3072
  v_mfma_f32_16x16x32_bf16 v[44:47], v[152:155], v[96:99], v[44:47]
  v_mfma_f32_16x16x32_bf16 v[48:51], v[156:159], v[96:99], v[48:51]
  buffer_load_dwordx4 v[196:199], v8, s[8:11], s35 offen offset:0
  v_mfma_f32_16x16x32_bf16 v[52:55], v[140:143], v[100:103], v[52:55]
  v_mfma_f32_16x16x32_bf16 v[56:59], v[144:147], v[100:103], v[56:59]
  buffer_load_dwordx4 v[124:127], v4, s[8:11], s23 offen sc1
  v_mfma_f32_16x16x32_bf16 v[60:63], v[148:151], v[100:103], v[60:63]
  v_mfma_f32_16x16x32_bf16 v[64:67], v[152:155], v[100:103], v[64:67]
  buffer_load_dwordx4 v[128:131], v5, s[8:11], s23 offen sc1
  v_mfma_f32_16x16x32_bf16 v[68:71], v[156:159], v[100:103], v[68:71]
  v_mfma_f32_16x16x32_bf16 v[72:75], v[140:143], v[104:107], v[72:75]
  buffer_load_dwordx4 v[132:135], v6, s[8:11], s23 offen sc1
  v_mfma_f32_16x16x32_bf16 v[76:79], v[144:147], v[104:107], v[76:79]
  v_mfma_f32_16x16x32_bf16 v[80:83], v[148:151], v[104:107], v[80:83]
  buffer_load_dwordx4 v[136:139], v7, s[8:11], s23 offen sc1
  v_mfma_f32_16x16x32_bf16 v[84:87], v[152:155], v[104:107], v[84:87]
  v_mfma_f32_16x16x32_bf16 v[88:91], v[156:159], v[104:107], v[88:91]
  s_waitcnt vmcnt(9)
  s_add_u32 s47, s34, 9
  s_cmp_ge_u32 s47, 12
  s_cselect_b32 s48, 12, 0
  s_sub_u32 s47, s47, s48
  s_lshl_b32 s47, s47, 2
  s_add_u32 s47, s47, s20
  s_mul_i32 s32, s47, 5120
  s_add_u32 s32, s32, s57
  s_add_u32 s35, s32, 4096
  s_lshl_b32 s47, s47, 10
  s_add_u32 s23, s47, s56
  v_mfma_f32_16x16x32_bf16 v[12:15], v[160:163], v[108:111], v[12:15]
  v_mfma_f32_16x16x32_bf16 v[16:19], v[164:167], v[108:111], v[16:19]
  buffer_load_dwordx4 v[140:143], v8, s[8:11], s32 offen offset:0
  v_mfma_f32_16x16x32_bf16 v[20:23], v[168:171], v[108:111], v[20:23]
  v_mfma_f32_16x16x32_bf16 v[24:27], v[172:175], v[108:111], v[24:27]
  buffer_load_dwordx4 v[144:147], v8, s[8:11], s32 offen offset:1024
  v_mfma_f32_16x16x32_bf16 v[28:31], v[176:179], v[108:111], v[28:31]
  v_mfma_f32_16x16x32_bf16 v[32:35], v[160:163], v[112:115], v[32:35]
  buffer_load_dwordx4 v[148:151], v8, s[8:11], s32 offen offset:2048
  v_mfma_f32_16x16x32_bf16 v[36:39], v[164:167], v[112:115], v[36:39]
  v_mfma_f32_16x16x32_bf16 v[40:43], v[168:171], v[112:115], v[40:43]
  buffer_load_dwordx4 v[152:155], v8, s[8:11], s32 offen offset:3072
  v_mfma_f32_16x16x32_bf16 v[44:47], v[172:175], v[112:115], v[44:47]
  v_mfma_f32_16x16x32_bf16 v[48:51], v[176:179], v[112:115], v[48:51]
  buffer_load_dwordx4 v[156:159], v8, s[8:11], s35 offen offset:0
  v_mfma_f32_16x16x32_bf16 v[52:55], v[160:163], v[116:119], v[52:55]
  v_mfma_f32_16x16x32_bf16 v[56:59], v[164:167], v[116:119], v[56:59]
  buffer_load_dwordx4 v[92:95], v4, s[8:11], s23 offen sc1
  v_mfma_f32_16x16x32_bf16 v[60:63], v[168:171], v[116:119], v[60:63]
  v_mfma_f32_16x16x32_bf16 v[64:67], v[172:175], v[116:119], v[64:67]
  buffer_load_dwordx4 v[96:99], v5, s[8:11], s23 offen sc1
  v_mfma_f32_16x16x32_bf16 v[68:71], v[176:179], v[116:119], v[68:71]
  v_mfma_f32_16x16x32_bf16 v[72:75], v[160:163], v[120:123], v[72:75]
  buffer_load_dwordx4 v[100:103], v6, s[8:11], s23 offen sc1
  v_mfma_f32_16x16x32_bf16 v[76:79], v[164:167], v[120:123], v[76:79]
  v_mfma_f32_16x16x32_bf16 v[80:83], v[168:171], v[120:123], v[80:83]
  buffer_load_dwordx4 v[104:107], v7, s[8:11], s23 offen sc1
  v_mfma_f32_16x16x32_bf16 v[84:87], v[172:175], v[120:123], v[84:87]
  v_mfma_f32_16x16x32_bf16 v[88:91], v[176:179], v[120:123], v[88:91]
  s_setprio 2
  s_waitcnt vmcnt(9)
  s_add_u32 s47, s34, 10
  s_cmp_ge_u32 s47, 12
  s_cselect_b32 s48, 12, 0
  s_sub_u32 s47, s47, s48
  s_lshl_b32 s47, s47, 2
  s_add_u32 s47, s47, s20
  s_mul_i32 s32, s47, 5120
  s_add_u32 s32, s32, s57
  s_add_u32 s35, s32, 4096
  s_lshl_b32 s47, s47, 10
  s_add_u32 s23, s47, s56
  v_mfma_f32_16x16x32_bf16 v[12:15], v[180:183], v[124:127], v[12:15]
  v_mfma_f32_16x16x32_bf16 v[16:19], v[184:187], v[124:127], v[16:19]
  buffer_load_dwordx4 v[160:163], v8, s[8:11], s32 offen offset:0
  v_mfma_f32_16x16x32_bf16 v[20:23], v[188:191], v[124:127], v[20:23]
  v_mfma_f32_16x16x32_bf16 v[24:27], v[192:195], v[124:127], v[24:27]
  buffer_load_dwordx4 v[164:167], v8, s[8:11], s32 offen offset:1024
  v_mfma_f32_16x16x32_bf16 v[28:31], v[196:199], v[124:127], v[28:31]
  v_mfma_f32_16x16x32_bf16 v[32:35], v[180:183], v[128:131], v[32:35]
  buffer_load_dwordx4 v[168:171], v8, s[8:11], s32 offen offset:2048
  v_mfma_f32_16x16x32_bf16 v[36:39], v[184:187], v[128:131], v[36:39]
  v_mfma_f32_16x16x32_bf16 v[40:43], v[188:191], v[128:131], v[40:43]
  buffer_load_dwordx4 v[172:175], v8, s[8:11], s32 offen offset:3072
  v_mfma_f32_16x16x32_bf16 v[44:47], v[192:195], v[128:131], v[44:47]
  v_mfma_f32_16x16x32_bf16 v[48:51], v[196:199], v[128:131], v[48:51]
  buffer_load_dwordx4 v[176:179], v8, s[8:11], s35 offen offset:0
  v_mfma_f32_16x16x32_bf16 v[52:55], v[180:183], v[132:135], v[52:55]
  v_mfma_f32_16x16x32_bf16 v[56:59], v[184:187], v[132:135], v[56:59]
  buffer_load_dwordx4 v[108:111], v4, s[8:11], s23 offen sc1
  v_mfma_f32_16x16x32_bf16 v[60:63], v[188:191], v[132:135], v[60:63]
  v_mfma_f32_16x16x32_bf16 v[64:67], v[192:195], v[132:135], v[64:67]
  buffer_load_dwordx4 v[112:115], v5, s[8:11], s23 offen sc1
  v_mfma_f32_16x16x32_bf16 v[68:71], v[196:199], v[132:135], v[68:71]
  v_mfma_f32_16x16x32_bf16 v[72:75], v[180:183], v[136:139], v[72:75]
  buffer_load_dwordx4 v[116:119], v6, s[8:11], s23 offen sc1
  v_mfma_f32_16x16x32_bf16 v[76:79], v[184:187], v[136:139], v[76:79]
  v_mfma_f32_16x16x32_bf16 v[80:83], v[188:191], v[136:139], v[80:83]
  buffer_load_dwordx4 v[120:123], v7, s[8:11], s23 offen sc1
  v_mfma_f32_16x16x32_bf16 v[84:87], v[192:195], v[136:139], v[84:87]
  v_mfma_f32_16x16x32_bf16 v[88:91], v[196:199], v[136:139], v[88:91]
  s_waitcnt vmcnt(9)
  s_add_u32 s47, s34, 11
  s_cmp_ge_u32 s47, 12
  s_cselect_b32 s48, 12, 0
  s_sub_u32 s47, s47, s48
  s_lshl_b32 s47, s47, 2
  s_add_u32 s47, s47, s20
  s_mul_i32 s32, s47, 5120
  s_add_u32 s32, s32, s57
  s_add_u32 s35, s32, 4096
  s_lshl_b32 s47, s47, 10
  s_add_u32 s23, s47, s56
  v_mfma_f32_16x16x32_bf16 v[12:15], v[140:143], v[92:95], v[12:15]
  v_mfma_f32_16x16x32_bf16 v[16:19], v[144:147], v[92:95], v[16:19]
  buffer_load_dwordx4 v[180:183], v8, s[8:11], s32 offen offset:0
  v_mfma_f32_16x16x32_bf16 v[20:23], v[148:151], v[92:95], v[20:23]
  v_mfma_f32_16x16x32_bf16 v[24:27], v[152:155], v[92:95], v[24:27]
  buffer_load_dwordx4 v[184:187], v8, s[8:11], s32 offen offset:1024
  v_mfma_f32_16x16x32_bf16 v[28:31], v[156:159], v[92:95], v[28:31]
  v_mfma_f32_16x16x32_bf16 v[32:35], v[140:143], v[96:99], v[32:35]
  buffer_load_dwordx4 v[188:191], v8, s[8:11], s32 offen offset:2048
  v_mfma_f32_16x16x32_bf16 v[36:39], v[144:147], v[96:99], v[36:39]
  v_mfma_f32_16x16x32_bf16 v[40:43], v[148:151], v[96:99], v[40:43]
  buffer_load_dwordx4 v[192:195], v8, s[8:11], s32 offen offset:3072
  v_mfma_f32_16x16x32_bf16 v[44:47], v[152:155], v[96:99], v[44:47]
  v_mfma_f32_16x16x32_bf16 v[48:51], v[156:159], v[96:99], v[48:51]
  buffer_load_dwordx4 v[196:199], v8, s[8:11], s35 offen offset:0
  v_mfma_f32_16x16x32_bf16 v[52:55], v[140:143], v[100:103], v[52:55]
  v_mfma_f32_16x16x32_bf16 v[56:59], v[144:147], v[100:103], v[56:59]
  buffer_load_dwordx4 v[124:127], v4, s[8:11], s23 offen sc1
  v_mfma_f32_16x16x32_bf16 v[60:63], v[148:151], v[100:103], v[60:63]
  v_mfma_f32_16x16x32_bf16 v[64:67], v[152:155], v[100:103], v[64:67]
  buffer_load_dwordx4 v[128:131], v5, s[8:11], s23 offen sc1
  v_mfma_f32_16x16x32_bf16 v[68:71], v[156:159], v[100:103], v[68:71]
  v_mfma_f32_16x16x32_bf16 v[72:75], v[140:143], v[104:107], v[72:75]
  buffer_load_dwordx4 v[132:135], v6, s[8:11], s23 offen sc1
  v_mfma_f32_16x16x32_bf16 v[76:79], v[144:147], v[104:107], v[76:79]
  v_mfma_f32_16x16x32_bf16 v[80:83], v[148:151], v[104:107], v[80:83]
  buffer_load_dwordx4 v[136:139], v7, s[8:11], s23 offen sc1
  v_mfma_f32_16x16x32_bf16 v[84:87], v[152:155], v[104:107], v[84:87]
  v_mfma_f32_16x16x32_bf16 v[88:91], v[156:159], v[104:107], v[88:91]
  v_and_b32 v232, 1, v3
  v_lshlrev_b32 v232, 5, v232
  v_lshrrev_b32 v233, 1, v3
  v_lshl_add_u32 v232, v233, 4, v232
  v_mul_u32_u24 v233, 1280, v236
  v_add_u32 v232, v232, v233
  buffer_load_dwordx4 v[200:203], v232, s[24:27], s49 offen offset:0
  buffer_load_dwordx4 v[204:207], v232, s[24:27], s49 offen offset:64
  buffer_load_dwordx2 v[208:209], v238, s[24:27], s49 offen offset:128
  buffer_load_dwordx2 v[220:221], v237, s[8:11], s50 offen offset:0 sc1
  buffer_load_dwordx2 v[222:223], v237, s[8:11], s50 offen offset:1024 sc1
  buffer_load_dwordx2 v[224:225], v237, s[8:11], s50 offen offset:2048 sc1
  buffer_load_dwordx2 v[226:227], v237, s[8:11], s50 offen offset:3072 sc1
  buffer_load_dwordx2 v[228:229], v237, s[8:11], s51 offen offset:0 sc1
  s_waitcnt vmcnt(17)
  v_mfma_f32_16x16x32_bf16 v[12:15], v[160:163], v[108:111], v[12:15]
  v_mfma_f32_16x16x32_bf16 v[16:19], v[164:167], v[108:111], v[16:19]
  v_mfma_f32_16x16x32_bf16 v[20:23], v[168:171], v[108:111], v[20:23]
  v_mfma_f32_16x16x32_bf16 v[24:27], v[172:175], v[108:111], v[24:27]
  v_mfma_f32_16x16x32_bf16 v[28:31], v[176:179], v[108:111], v[28:31]
  v_mfma_f32_16x16x32_bf16 v[32:35], v[160:163], v[112:115], v[32:35]
  v_mfma_f32_16x16x32_bf16 v[36:39], v[164:167], v[112:115], v[36:39]
  v_mfma_f32_16x16x32_bf16 v[40:43], v[168:171], v[112:115], v[40:43]
  v_mfma_f32_16x16x32_bf16 v[44:47], v[172:175], v[112:115], v[44:47]
  v_mfma_f32_16x16x32_bf16 v[48:51], v[176:179], v[112:115], v[48:51]
  v_mfma_f32_16x16x32_bf16 v[52:55], v[160:163], v[116:119], v[52:55]
  v_mfma_f32_16x16x32_bf16 v[56:59], v[164:167], v[116:119], v[56:59]
  v_mfma_f32_16x16x32_bf16 v[60:63], v[168:171], v[116:119], v[60:63]
  v_mfma_f32_16x16x32_bf16 v[64:67], v[172:175], v[116:119], v[64:67]
  v_mfma_f32_16x16x32_bf16 v[68:71], v[176:179], v[116:119], v[68:71]
  v_mfma_f32_16x16x32_bf16 v[72:75], v[160:163], v[120:123], v[72:75]
  v_mfma_f32_16x16x32_bf16 v[76:79], v[164:167], v[120:123], v[76:79]
  v_mfma_f32_16x16x32_bf16 v[80:83], v[168:171], v[120:123], v[80:83]
  v_mfma_f32_16x16x32_bf16 v[84:87], v[172:175], v[120:123], v[84:87]
  v_mfma_f32_16x16x32_bf16 v[88:91], v[176:179], v[120:123], v[88:91]
  s_waitcnt vmcnt(8)
  v_mfma_f32_16x16x32_bf16 v[12:15], v[180:183], v[124:127], v[12:15]
  v_mfma_f32_16x16x32_bf16 v[16:19], v[184:187], v[124:127], v[16:19]
  v_mfma_f32_16x16x32_bf16 v[20:23], v[188:191], v[124:127], v[20:23]
  v_mfma_f32_16x16x32_bf16 v[24:27], v[192:195], v[124:127], v[24:27]
  v_mfma_f32_16x16x32_bf16 v[28:31], v[196:199], v[124:127], v[28:31]
  v_mfma_f32_16x16x32_bf16 v[32:35], v[180:183], v[128:131], v[32:35]
  v_mfma_f32_16x16x32_bf16 v[36:39], v[184:187], v[128:131], v[36:39]
  v_mfma_f32_16x16x32_bf16 v[40:43], v[188:191], v[128:131], v[40:43]
  v_mfma_f32_16x16x32_bf16 v[44:47], v[192:195], v[128:131], v[44:47]
  v_mfma_f32_16x16x32_bf16 v[48:51], v[196:199], v[128:131], v[48:51]
  v_mfma_f32_16x16x32_bf16 v[52:55], v[180:183], v[132:135], v[52:55]
  v_mfma_f32_16x16x32_bf16 v[56:59], v[184:187], v[132:135], v[56:59]
  v_mfma_f32_16x16x32_bf16 v[60:63], v[188:191], v[132:135], v[60:63]
  v_mfma_f32_16x16x32_bf16 v[64:67], v[192:195], v[132:135], v[64:67]
  v_mfma_f32_16x16x32_bf16 v[68:71], v[196:199], v[132:135], v[68:71]
  v_mfma_f32_16x16x32_bf16 v[72:75], v[180:183], v[136:139], v[72:75]
  v_mfma_f32_16x16x32_bf16 v[76:79], v[184:187], v[136:139], v[76:79]
  v_mfma_f32_16x16x32_bf16 v[80:83], v[188:191], v[136:139], v[80:83]
  v_mfma_f32_16x16x32_bf16 v[84:87], v[192:195], v[136:139], v[84:87]
  v_mfma_f32_16x16x32_bf16 v[88:91], v[196:199], v[136:139], v[88:91]
  s_setprio 2
  s_mul_i32 s33, s20, 15360
  s_add_u32 s47, s60, 0
  s_cmp_ge_u32 s47, 6
  s_cselect_b32 s48, 6, 0
  s_sub_u32 s47, s47, s48
  s_lshl_b32 s47, s47, 2
  s_add_u32 s47, s47, s20
  s_mul_i32 s32, s47, 5120
  s_add_u32 s32, s32, s59
  s_add_u32 s35, s32, 4096
  s_lshl_b32 s47, s47, 10
  s_add_u32 s23, s47, s58
  buffer_load_dwordx4 v[140:143], v8, s[8:11], s32 offen offset:0
  buffer_load_dwordx4 v[144:147], v8, s[8:11], s32 offen offset:1024
  buffer_load_dwordx4 v[148:151], v8, s[8:11], s32 offen offset:2048
  buffer_load_dwordx4 v[152:155], v8, s[8:11], s32 offen offset:3072
  buffer_load_dwordx4 v[156:159], v8, s[8:11], s35 offen offset:0
  s_add_u32 s47, s60, 1
  s_cmp_ge_u32 s47, 6
  s_cselect_b32 s48, 6, 0
  s_sub_u32 s47, s47, s48
  s_lshl_b32 s47, s47, 2
  s_add_u32 s47, s47, s20
  s_mul_i32 s32, s47, 5120
  s_add_u32 s32, s32, s59
  s_add_u32 s35, s32, 4096
  s_lshl_b32 s47, s47, 10
  s_add_u32 s23, s47, s58
  buffer_load_dwordx4 v[160:163], v8, s[8:11], s32 offen offset:0
  buffer_load_dwordx4 v[164:167], v8, s[8:11], s32 offen offset:1024
  buffer_load_dwordx4 v[168:171], v8, s[8:11], s32 offen offset:2048
  buffer_load_dwordx4 v[172:175], v8, s[8:11], s32 offen offset:3072
  buffer_load_dwordx4 v[176:179], v8, s[8:11], s35 offen offset:0
  s_add_u32 s47, s60, 2
  s_cmp_ge_u32 s47, 6
  s_cselect_b32 s48, 6, 0
  s_sub_u32 s47, s47, s48
  s_lshl_b32 s47, s47, 2
  s_add_u32 s47, s47, s20
  s_mul_i32 s32, s47, 5120
  s_add_u32 s32, s32, s59
  s_add_u32 s35, s32, 4096
  s_lshl_b32 s47, s47, 10
  s_add_u32 s23, s47, s58
  buffer_load_dwordx4 v[180:183], v8, s[8:11], s32 offen offset:0
  buffer_load_dwordx4 v[184:187], v8, s[8:11], s32 offen offset:1024
  buffer_load_dwordx4 v[188:191], v8, s[8:11], s32 offen offset:2048
  buffer_load_dwordx4 v[192:195], v8, s[8:11], s32 offen offset:3072
  buffer_load_dwordx4 v[196:199], v8, s[8:11], s35 offen offset:0
  s_add_u32 s47, s60, 3
  s_cmp_ge_u32 s47, 6
  s_cselect_b32 s48, 6, 0
  s_sub_u32 s47, s47, s48
  s_lshl_b32 s47, s47, 2
  s_add_u32 s47, s47, s20
  s_mul_i32 s32, s47, 5120
  s_add_u32 s32, s32, s59
  s_add_u32 s35, s32, 4096
  s_lshl_b32 s47, s47, 10
  s_add_u32 s23, s47, s58
  s_add_u32 m0, s33, 0
  s_nop 0
  buffer_load_dwordx4 v8, s[8:11], s32 offen offset:0 lds
  buffer_load_dwordx4 v8, s[8:11], s32 offen offset:1024 lds
  buffer_load_dwordx4 v8, s[8:11], s32 offen offset:2048 lds
  buffer_load_dwordx4 v8, s[8:11], s32 offen offset:3072 lds
  s_add_u32 m0, s33, 4096
  s_nop 0
  buffer_load_dwordx4 v8, s[8:11], s35 offen lds
  s_add_u32 s47, s60, 4
  s_cmp_ge_u32 s47, 6
  s_cselect_b32 s48, 6, 0
  s_sub_u32 s47, s47, s48
  s_lshl_b32 s47, s47, 2
  s_add_u32 s47, s47, s20
  s_mul_i32 s32, s47, 5120
  s_add_u32 s32, s32, s59
  s_add_u32 s35, s32, 4096
  s_lshl_b32 s47, s47, 10
  s_add_u32 s23, s47, s58
  s_add_u32 m0, s33, 5120
  s_nop 0
  buffer_load_dwordx4 v8, s[8:11], s32 offen offset:0 lds
  buffer_load_dwordx4 v8, s[8:11], s32 offen offset:1024 lds
  buffer_load_dwordx4 v8, s[8:11], s32 offen offset:2048 lds
  buffer_load_dwordx4 v8, s[8:11], s32 offen offset:3072 lds
  s_add_u32 m0, s33, 9216
  s_nop 0
  buffer_load_dwordx4 v8, s[8:11], s35 offen lds
  s_add_u32 s47, s60, 5
  s_cmp_ge_u32 s47, 6
  s_cselect_b32 s48, 6, 0
  s_sub_u32 s47, s47, s48
  s_lshl_b32 s47, s47, 2
  s_add_u32 s47, s47, s20
  s_mul_i32 s32, s47, 5120
  s_add_u32 s32, s32, s59
  s_add_u32 s35, s32, 4096
  s_lshl_b32 s47, s47, 10
  s_add_u32 s23, s47, s58
  s_add_u32 m0, s33, 10240
  s_nop 0
  buffer_load_dwordx4 v8, s[8:11], s32 offen offset:0 lds
  buffer_load_dwordx4 v8, s[8:11], s32 offen offset:1024 lds
  buffer_load_dwordx4 v8, s[8:11], s32 offen offset:2048 lds
  buffer_load_dwordx4 v8, s[8:11], s32 offen offset:3072 lds
  s_add_u32 m0, s33, 14336
  s_nop 0
  buffer_load_dwordx4 v8, s[8:11], s35 offen lds
  s_waitcnt vmcnt(30)
  v_permlane16_swap_b32 v200, v202
  v_permlane16_swap_b32 v201, v203
  v_permlane16_swap_b32 v204, v206
  v_permlane16_swap_b32 v205, v207
  v_lshlrev_b32 v92, 16, v200
  v_and_b32 v93, 0xffff0000, v200
  v_lshlrev_b32 v94, 16, v201
  v_and_b32 v95, 0xffff0000, v201
  v_lshlrev_b32 v96, 16, v220
  v_and_b32 v97, 0xffff0000, v220
  v_lshlrev_b32 v98, 16, v221
  v_and_b32 v99, 0xffff0000, v221
  v_add_f32 v92, v92, v96
  v_add_f32 v12, v12, v92
  v_add_f32 v93, v93, v97
  v_add_f32 v13, v13, v93
  v_add_f32 v94, v94, v98
  v_add_f32 v14, v14, v94
  v_add_f32 v95, v95, v99
  v_add_f32 v15, v15, v95
  v_lshlrev_b32 v92, 16, v202
  v_and_b32 v93, 0xffff0000, v202
  v_lshlrev_b32 v94, 16, v203
  v_and_b32 v95, 0xffff0000, v203
  v_lshlrev_b32 v96, 16, v222
  v_and_b32 v97, 0xffff0000, v222
  v_lshlrev_b32 v98, 16, v223
  v_and_b32 v99, 0xffff0000, v223
  v_add_f32 v92, v92, v96
  v_add_f32 v16, v16, v92
  v_add_f32 v93, v93, v97
  v_add_f32 v17, v17, v93
  v_add_f32 v94, v94, v98
  v_add_f32 v18, v18, v94
  v_add_f32 v95, v95, v99
  v_add_f32 v19, v19, v95
  v_lshlrev_b32 v92, 16, v204
  v_and_b32 v93, 0xffff0000, v204
  v_lshlrev_b32 v94, 16, v205
  v_and_b32 v95, 0xffff0000, v205
  v_lshlrev_b32 v96, 16, v224
  v_and_b32 v97, 0xffff0000, v224
  v_lshlrev_b32 v98, 16, v225
  v_and_b32 v99, 0xffff0000, v225
  v_add_f32 v92, v92, v96
  v_add_f32 v20, v20, v92
  v_add_f32 v93, v93, v97
  v_add_f32 v21, v21, v93
  v_add_f32 v94, v94, v98
  v_add_f32 v22, v22, v94
  v_add_f32 v95, v95, v99
  v_add_f32 v23, v23, v95
  v_lshlrev_b32 v92, 16, v206
  v_and_b32 v93, 0xffff0000, v206
  v_lshlrev_b32 v94, 16, v207
  v_and_b32 v95, 0xffff0000, v207
  v_lshlrev_b32 v96, 16, v226
  v_and_b32 v97, 0xffff0000, v226
  v_lshlrev_b32 v98, 16, v227
  v_and_b32 v99, 0xffff0000, v227
  v_add_f32 v92, v92, v96
  v_add_f32 v24, v24, v92
  v_add_f32 v93, v93, v97
  v_add_f32 v25, v25, v93
  v_add_f32 v94, v94, v98
  v_add_f32 v26, v26, v94
  v_add_f32 v95, v95, v99
  v_add_f32 v27, v27, v95
  v_lshlrev_b32 v92, 16, v208
  v_and_b32 v93, 0xffff0000, v208
  v_lshlrev_b32 v94, 16, v209
  v_and_b32 v95, 0xffff0000, v209
  v_lshlrev_b32 v96, 16, v228
  v_and_b32 v97, 0xffff0000, v228
  v_lshlrev_b32 v98, 16, v229
  v_and_b32 v99, 0xffff0000, v229
  v_add_f32 v92, v92, v96
  v_add_f32 v28, v28, v92
  v_add_f32 v93, v93, v97
  v_add_f32 v29, v29, v93
  v_add_f32 v94, v94, v98
  v_add_f32 v30, v30, v94
  v_add_f32 v95, v95, v99
  v_add_f32 v31, v31, v95
  s_lshl_b32 s53, s21, 12
  s_add_u32 s53, s53, 31719424
  v_and_b32 v240, 31, v0
  v_lshlrev_b32 v240, 7, v240
l2_kernel_wcp8:
  buffer_load_dword v241, v240, s[8:11], s53 offen sc1
  s_waitcnt vmcnt(0)
  v_cmp_ne_u32 vcc, 1, v241
  s_nop 0
  s_cbranch_vccz l2_kernel_wc7
  s_sleep 2
  s_branch l2_kernel_wcp8
l2_kernel_wc7:
  s_add_u32 s47, s60, 0
  s_cmp_ge_u32 s47, 6
  s_cselect_b32 s48, 6, 0
  s_sub_u32 s47, s47, s48
  s_lshl_b32 s47, s47, 2
  s_add_u32 s47, s47, s20
  s_mul_i32 s32, s47, 5120
  s_add_u32 s32, s32, s59
  s_add_u32 s35, s32, 4096
  s_lshl_b32 s47, s47, 10
  s_add_u32 s23, s47, s58
  buffer_load_dwordx4 v[92:95], v4, s[8:11], s23 offen sc1
  buffer_load_dwordx4 v[96:99], v5, s[8:11], s23 offen sc1
  buffer_load_dwordx4 v[100:103], v6, s[8:11], s23 offen sc1
  buffer_load_dwordx4 v[104:107], v7, s[8:11], s23 offen sc1
  s_add_u32 s47, s60, 1
  s_cmp_ge_u32 s47, 6
  s_cselect_b32 s48, 6, 0
  s_sub_u32 s47, s47, s48
  s_lshl_b32 s47, s47, 2
  s_add_u32 s47, s47, s20
  s_mul_i32 s32, s47, 5120
  s_add_u32 s32, s32, s59
  s_add_u32 s35, s32, 4096
  s_lshl_b32 s47, s47, 10
  s_add_u32 s23, s47, s58
  buffer_load_dwordx4 v[108:111], v4, s[8:11], s23 offen sc1
  buffer_load_dwordx4 v[112:115], v5, s[8:11], s23 offen sc1
  buffer_load_dwordx4 v[116:119], v6, s[8:11], s23 offen sc1
  buffer_load_dwordx4 v[120:123], v7, s[8:11], s23 offen sc1
  s_add_u32 s47, s60, 2
  s_cmp_ge_u32 s47, 6
  s_cselect_b32 s48, 6, 0
  s_sub_u32 s47, s47, s48
  s_lshl_b32 s47, s47, 2
  s_add_u32 s47, s47, s20
  s_mul_i32 s32, s47, 5120
  s_add_u32 s32, s32, s59
  s_add_u32 s35, s32, 4096
  s_lshl_b32 s47, s47, 10
  s_add_u32 s23, s47, s58
  buffer_load_dwordx4 v[124:127], v4, s[8:11], s23 offen sc1
  buffer_load_dwordx4 v[128:131], v5, s[8:11], s23 offen sc1
  buffer_load_dwordx4 v[132:135], v6, s[8:11], s23 offen sc1
  buffer_load_dwordx4 v[136:139], v7, s[8:11], s23 offen sc1
  s_add_u32 s47, s60, 3
  s_cmp_ge_u32 s47, 6
  s_cselect_b32 s48, 6, 0
  s_sub_u32 s47, s47, s48
  s_lshl_b32 s47, s47, 2
  s_add_u32 s47, s47, s20
  s_mul_i32 s32, s47, 5120
  s_add_u32 s32, s32, s59
  s_add_u32 s35, s32, 4096
  s_lshl_b32 s47, s47, 10
  s_add_u32 s23, s47, s58
  buffer_load_dwordx4 v[200:203], v4, s[8:11], s23 offen sc1
  buffer_load_dwordx4 v[204:207], v5, s[8:11], s23 offen sc1
  buffer_load_dwordx4 v[208:211], v6, s[8:11], s23 offen sc1
  buffer_load_dwordx4 v[212:215], v7, s[8:11], s23 offen sc1
  s_add_u32 s47, s60, 4
  s_cmp_ge_u32 s47, 6
  s_cselect_b32 s48, 6, 0
  s_sub_u32 s47, s47, s48
  s_lshl_b32 s47, s47, 2
  s_add_u32 s47, s47, s20
  s_mul_i32 s32, s47, 5120
  s_add_u32 s32, s32, s59
  s_add_u32 s35, s32, 4096
  s_lshl_b32 s47, s47, 10
  s_add_u32 s23, s47, s58
  buffer_load_dwordx4 v[216:219], v4, s[8:11], s23 offen sc1
  buffer_load_dwordx4 v[220:223], v5, s[8:11], s23 offen sc1
  buffer_load_dwordx4 v[224:227], v6, s[8:11], s23 offen sc1
  buffer_load_dwordx4 v[228:231], v7, s[8:11], s23 offen sc1
  v_add_u32 v241, s33, v8
  s_waitcnt vmcnt(16)
  v_mfma_f32_16x16x32_bf16 v[12:15], v[140:143], v[92:95], v[12:15]
  v_mfma_f32_16x16x32_bf16 v[16:19], v[144:147], v[92:95], v[16:19]
  v_mfma_f32_16x16x32_bf16 v[20:23], v[148:151], v[92:95], v[20:23]
  v_mfma_f32_16x16x32_bf16 v[24:27], v[152:155], v[92:95], v[24:27]
  v_mfma_f32_16x16x32_bf16 v[28:31], v[156:159], v[92:95], v[28:31]
  v_mfma_f32_16x16x32_bf16 v[32:35], v[140:143], v[96:99], v[32:35]
  v_mfma_f32_16x16x32_bf16 v[36:39], v[144:147], v[96:99], v[36:39]
  v_mfma_f32_16x16x32_bf16 v[40:43], v[148:151], v[96:99], v[40:43]
  v_mfma_f32_16x16x32_bf16 v[44:47], v[152:155], v[96:99], v[44:47]
  v_mfma_f32_16x16x32_bf16 v[48:51], v[156:159], v[96:99], v[48:51]
  v_mfma_f32_16x16x32_bf16 v[52:55], v[140:143], v[100:103], v[52:55]
  v_mfma_f32_16x16x32_bf16 v[56:59], v[144:147], v[100:103], v[56:59]
  v_mfma_f32_16x16x32_bf16 v[60:63], v[148:151], v[100:103], v[60:63]
  v_mfma_f32_16x16x32_bf16 v[64:67], v[152:155], v[100:103], v[64:67]
  v_mfma_f32_16x16x32_bf16 v[68:71], v[156:159], v[100:103], v[68:71]
  v_mfma_f32_16x16x32_bf16 v[72:75], v[140:143], v[104:107], v[72:75]
  v_mfma_f32_16x16x32_bf16 v[76:79], v[144:147], v[104:107], v[76:79]
  v_mfma_f32_16x16x32_bf16 v[80:83], v[148:151], v[104:107], v[80:83]
  v_mfma_f32_16x16x32_bf16 v[84:87], v[152:155], v[104:107], v[84:87]
  v_mfma_f32_16x16x32_bf16 v[88:91], v[156:159], v[104:107], v[88:91]
  s_add_u32 s47, s60, 5
  s_cmp_ge_u32 s47, 6
  s_cselect_b32 s48, 6, 0
  s_sub_u32 s47, s47, s48
  s_lshl_b32 s47, s47, 2
  s_add_u32 s47, s47, s20
  s_mul_i32 s32, s47, 5120
  s_add_u32 s32, s32, s59
  s_add_u32 s35, s32, 4096
  s_lshl_b32 s47, s47, 10
  s_add_u32 s23, s47, s58
  buffer_load_dwordx4 v[92:95], v4, s[8:11], s23 offen sc1
  buffer_load_dwordx4 v[96:99], v5, s[8:11], s23 offen sc1
  buffer_load_dwordx4 v[100:103], v6, s[8:11], s23 offen sc1
  buffer_load_dwordx4 v[104:107], v7, s[8:11], s23 offen sc1
  ds_read_b128 v[140:143], v241 offset:0
  ds_read_b128 v[144:147], v241 offset:1024
  ds_read_b128 v[148:151], v241 offset:2048
  ds_read_b128 v[152:155], v241 offset:3072
  ds_read_b128 v[156:159], v241 offset:4096
  s_waitcnt vmcnt(16)
  v_mfma_f32_16x16x32_bf16 v[12:15], v[160:163], v[108:111], v[12:15]
  v_mfma_f32_16x16x32_bf16 v[16:19], v[164:167], v[108:111], v[16:19]
  v_mfma_f32_16x16x32_bf16 v[20:23], v[168:171], v[108:111], v[20:23]
  v_mfma_f32_16x16x32_bf16 v[24:27], v[172:175], v[108:111], v[24:27]
  v_mfma_f32_16x16x32_bf16 v[28:31], v[176:179], v[108:111], v[28:31]
  v_mfma_f32_16x16x32_bf16 v[32:35], v[160:163], v[112:115], v[32:35]
  v_mfma_f32_16x16x32_bf16 v[36:39], v[164:167], v[112:115], v[36:39]
  v_mfma_f32_16x16x32_bf16 v[40:43], v[168:171], v[112:115], v[40:43]
  v_mfma_f32_16x16x32_bf16 v[44:47], v[172:175], v[112:115], v[44:47]
  v_mfma_f32_16x16x32_bf16 v[48:51], v[176:179], v[112:115], v[48:51]
  v_mfma_f32_16x16x32_bf16 v[52:55], v[160:163], v[116:119], v[52:55]
  v_mfma_f32_16x16x32_bf16 v[56:59], v[164:167], v[116:119], v[56:59]
  v_mfma_f32_16x16x32_bf16 v[60:63], v[168:171], v[116:119], v[60:63]
  v_mfma_f32_16x16x32_bf16 v[64:67], v[172:175], v[116:119], v[64:67]
  v_mfma_f32_16x16x32_bf16 v[68:71], v[176:179], v[116:119], v[68:71]
  v_mfma_f32_16x16x32_bf16 v[72:75], v[160:163], v[120:123], v[72:75]
  v_mfma_f32_16x16x32_bf16 v[76:79], v[164:167], v[120:123], v[76:79]
  v_mfma_f32_16x16x32_bf16 v[80:83], v[168:171], v[120:123], v[80:83]
  v_mfma_f32_16x16x32_bf16 v[84:87], v[172:175], v[120:123], v[84:87]
  v_mfma_f32_16x16x32_bf16 v[88:91], v[176:179], v[120:123], v[88:91]
  ds_read_b128 v[160:163], v241 offset:5120
  ds_read_b128 v[164:167], v241 offset:6144
  ds_read_b128 v[168:171], v241 offset:7168
  ds_read_b128 v[172:175], v241 offset:8192
  ds_read_b128 v[176:179], v241 offset:9216
  s_waitcnt vmcnt(12)
  v_mfma_f32_16x16x32_bf16 v[12:15], v[180:183], v[124:127], v[12:15]
  v_mfma_f32_16x16x32_bf16 v[16:19], v[184:187], v[124:127], v[16:19]
  v_mfma_f32_16x16x32_bf16 v[20:23], v[188:191], v[124:127], v[20:23]
  v_mfma_f32_16x16x32_bf16 v[24:27], v[192:195], v[124:127], v[24:27]
  v_mfma_f32_16x16x32_bf16 v[28:31], v[196:199], v[124:127], v[28:31]
  v_mfma_f32_16x16x32_bf16 v[32:35], v[180:183], v[128:131], v[32:35]
  v_mfma_f32_16x16x32_bf16 v[36:39], v[184:187], v[128:131], v[36:39]
  v_mfma_f32_16x16x32_bf16 v[40:43], v[188:191], v[128:131], v[40:43]
  v_mfma_f32_16x16x32_bf16 v[44:47], v[192:195], v[128:131], v[44:47]
  v_mfma_f32_16x16x32_bf16 v[48:51], v[196:199], v[128:131], v[48:51]
  v_mfma_f32_16x16x32_bf16 v[52:55], v[180:183], v[132:135], v[52:55]
  v_mfma_f32_16x16x32_bf16 v[56:59], v[184:187], v[132:135], v[56:59]
  v_mfma_f32_16x16x32_bf16 v[60:63], v[188:191], v[132:135], v[60:63]
  v_mfma_f32_16x16x32_bf16 v[64:67], v[192:195], v[132:135], v[64:67]
  v_mfma_f32_16x16x32_bf16 v[68:71], v[196:199], v[132:135], v[68:71]
  v_mfma_f32_16x16x32_bf16 v[72:75], v[180:183], v[136:139], v[72:75]
  v_mfma_f32_16x16x32_bf16 v[76:79], v[184:187], v[136:139], v[76:79]
  v_mfma_f32_16x16x32_bf16 v[80:83], v[188:191], v[136:139], v[80:83]
  v_mfma_f32_16x16x32_bf16 v[84:87], v[192:195], v[136:139], v[84:87]
  v_mfma_f32_16x16x32_bf16 v[88:91], v[196:199], v[136:139], v[88:91]
  ds_read_b128 v[180:183], v241 offset:10240
  ds_read_b128 v[184:187], v241 offset:11264
  ds_read_b128 v[188:191], v241 offset:12288
  ds_read_b128 v[192:195], v241 offset:13312
  ds_read_b128 v[196:199], v241 offset:14336
  s_waitcnt vmcnt(8) lgkmcnt(0)
  v_mfma_f32_16x16x32_bf16 v[12:15], v[140:143], v[200:203], v[12:15]
  v_mfma_f32_16x16x32_bf16 v[16:19], v[144:147], v[200:203], v[16:19]
  v_mfma_f32_16x16x32_bf16 v[20:23], v[148:151], v[200:203], v[20:23]
  v_mfma_f32_16x16x32_bf16 v[24:27], v[152:155], v[200:203], v[24:27]
  v_mfma_f32_16x16x32_bf16 v[28:31], v[156:159], v[200:203], v[28:31]
  v_mfma_f32_16x16x32_bf16 v[32:35], v[140:143], v[204:207], v[32:35]
  v_mfma_f32_16x16x32_bf16 v[36:39], v[144:147], v[204:207], v[36:39]
  v_mfma_f32_16x16x32_bf16 v[40:43], v[148:151], v[204:207], v[40:43]
  v_mfma_f32_16x16x32_bf16 v[44:47], v[152:155], v[204:207], v[44:47]
  v_mfma_f32_16x16x32_bf16 v[48:51], v[156:159], v[204:207], v[48:51]
  v_mfma_f32_16x16x32_bf16 v[52:55], v[140:143], v[208:211], v[52:55]
  v_mfma_f32_16x16x32_bf16 v[56:59], v[144:147], v[208:211], v[56:59]
  v_mfma_f32_16x16x32_bf16 v[60:63], v[148:151], v[208:211], v[60:63]
  v_mfma_f32_16x16x32_bf16 v[64:67], v[152:155], v[208:211], v[64:67]
  v_mfma_f32_16x16x32_bf16 v[68:71], v[156:159], v[208:211], v[68:71]
  v_mfma_f32_16x16x32_bf16 v[72:75], v[140:143], v[212:215], v[72:75]
  v_mfma_f32_16x16x32_bf16 v[76:79], v[144:147], v[212:215], v[76:79]
  v_mfma_f32_16x16x32_bf16 v[80:83], v[148:151], v[212:215], v[80:83]
  v_mfma_f32_16x16x32_bf16 v[84:87], v[152:155], v[212:215], v[84:87]
  v_mfma_f32_16x16x32_bf16 v[88:91], v[156:159], v[212:215], v[88:91]
  s_waitcnt vmcnt(4) lgkmcnt(0)
  v_mfma_f32_16x16x32_bf16 v[12:15], v[160:163], v[216:219], v[12:15]
  v_mfma_f32_16x16x32_bf16 v[16:19], v[164:167], v[216:219], v[16:19]
  v_mfma_f32_16x16x32_bf16 v[20:23], v[168:171], v[216:219], v[20:23]
  v_mfma_f32_16x16x32_bf16 v[24:27], v[172:175], v[216:219], v[24:27]
  v_mfma_f32_16x16x32_bf16 v[28:31], v[176:179], v[216:219], v[28:31]
  v_mfma_f32_16x16x32_bf16 v[32:35], v[160:163], v[220:223], v[32:35]
  v_mfma_f32_16x16x32_bf16 v[36:39], v[164:167], v[220:223], v[36:39]
  v_mfma_f32_16x16x32_bf16 v[40:43], v[168:171], v[220:223], v[40:43]
  v_mfma_f32_16x16x32_bf16 v[44:47], v[172:175], v[220:223], v[44:47]
  v_mfma_f32_16x16x32_bf16 v[48:51], v[176:179], v[220:223], v[48:51]
  v_mfma_f32_16x16x32_bf16 v[52:55], v[160:163], v[224:227], v[52:55]
  v_mfma_f32_16x16x32_bf16 v[56:59], v[164:167], v[224:227], v[56:59]
  v_mfma_f32_16x16x32_bf16 v[60:63], v[168:171], v[224:227], v[60:63]
  v_mfma_f32_16x16x32_bf16 v[64:67], v[172:175], v[224:227], v[64:67]
  v_mfma_f32_16x16x32_bf16 v[68:71], v[176:179], v[224:227], v[68:71]
  v_mfma_f32_16x16x32_bf16 v[72:75], v[160:163], v[228:231], v[72:75]
  v_mfma_f32_16x16x32_bf16 v[76:79], v[164:167], v[228:231], v[76:79]
  v_mfma_f32_16x16x32_bf16 v[80:83], v[168:171], v[228:231], v[80:83]
  v_mfma_f32_16x16x32_bf16 v[84:87], v[172:175], v[228:231], v[84:87]
  v_mfma_f32_16x16x32_bf16 v[88:91], v[176:179], v[228:231], v[88:91]
  s_waitcnt vmcnt(0) lgkmcnt(0)
  v_mfma_f32_16x16x32_bf16 v[12:15], v[180:183], v[92:95], v[12:15]
  v_mfma_f32_16x16x32_bf16 v[16:19], v[184:187], v[92:95], v[16:19]
  v_mfma_f32_16x16x32_bf16 v[20:23], v[188:191], v[92:95], v[20:23]
  v_mfma_f32_16x16x32_bf16 v[24:27], v[192:195], v[92:95], v[24:27]
  v_mfma_f32_16x16x32_bf16 v[28:31], v[196:199], v[92:95], v[28:31]
  v_mfma_f32_16x16x32_bf16 v[32:35], v[180:183], v[96:99], v[32:35]
  v_mfma_f32_16x16x32_bf16 v[36:39], v[184:187], v[96:99], v[36:39]
  v_mfma_f32_16x16x32_bf16 v[40:43], v[188:191], v[96:99], v[40:43]
  v_mfma_f32_16x16x32_bf16 v[44:47], v[192:195], v[96:99], v[44:47]
  v_mfma_f32_16x16x32_bf16 v[48:51], v[196:199], v[96:99], v[48:51]
  v_mfma_f32_16x16x32_bf16 v[52:55], v[180:183], v[100:103], v[52:55]
  v_mfma_f32_16x16x32_bf16 v[56:59], v[184:187], v[100:103], v[56:59]
  v_mfma_f32_16x16x32_bf16 v[60:63], v[188:191], v[100:103], v[60:63]
  v_mfma_f32_16x16x32_bf16 v[64:67], v[192:195], v[100:103], v[64:67]
  v_mfma_f32_16x16x32_bf16 v[68:71], v[196:199], v[100:103], v[68:71]
  v_mfma_f32_16x16x32_bf16 v[72:75], v[180:183], v[104:107], v[72:75]
  v_mfma_f32_16x16x32_bf16 v[76:79], v[184:187], v[104:107], v[76:79]
  v_mfma_f32_16x16x32_bf16 v[80:83], v[188:191], v[104:107], v[80:83]
  v_mfma_f32_16x16x32_bf16 v[84:87], v[192:195], v[104:107], v[84:87]
  v_mfma_f32_16x16x32_bf16 v[88:91], v[196:199], v[104:107], v[88:91]
  s_barrier
  s_add_u32 s47, s20, 1
  s_and_b32 s47, s47, 3
  s_mul_i32 s47, s47, 15360
  s_add_u32 s47, s47, 0
  v_add_u32 v240, s47, v8
  ds_write_b128 v240, v[32:35] offset:0
  ds_write_b128 v240, v[36:39] offset:1024
  ds_write_b128 v240, v[40:43] offset:2048
  ds_write_b128 v240, v[44:47] offset:3072
  ds_write_b128 v240, v[48:51] offset:4096
  s_add_u32 s47, s20, 2
  s_and_b32 s47, s47, 3
  s_mul_i32 s47, s47, 15360
  s_add_u32 s47, s47, 5120
  v_add_u32 v240, s47, v8
  ds_write_b128 v240, v[52:55] offset:0
  ds_write_b128 v240, v[56:59] offset:1024
  ds_write_b128 v240, v[60:63] offset:2048
  ds_write_b128 v240, v[64:67] offset:3072
  ds_write_b128 v240, v[68:71] offset:4096
  s_add_u32 s47, s20, 3
  s_and_b32 s47, s47, 3
  s_mul_i32 s47, s47, 15360
  s_add_u32 s47, s47, 10240
  v_add_u32 v240, s47, v8
  ds_write_b128 v240, v[72:75] offset:0
  ds_write_b128 v240, v[76:79] offset:1024
  ds_write_b128 v240, v[80:83] offset:2048
  ds_write_b128 v240, v[84:87] offset:3072
  ds_write_b128 v240, v[88:91] offset:4096
  v_add_u32 v240, s33, v8
  s_waitcnt lgkmcnt(0)
  s_barrier
  ds_read_b128 v[32:35], v240 offset:0
  ds_read_b128 v[36:39], v240 offset:1024
  ds_read_b128 v[40:43], v240 offset:2048
  ds_read_b128 v[44:47], v240 offset:3072
  ds_read_b128 v[48:51], v240 offset:4096
  ds_read_b128 v[52:55], v240 offset:5120
  ds_read_b128 v[56:59], v240 offset:6144
  ds_read_b128 v[60:63], v240 offset:7168
  ds_read_b128 v[64:67], v240 offset:8192
  ds_read_b128 v[68:71], v240 offset:9216
  ds_read_b128 v[72:75], v240 offset:10240
  ds_read_b128 v[76:79], v240 offset:11264
  ds_read_b128 v[80:83], v240 offset:12288
  ds_read_b128 v[84:87], v240 offset:13312
  ds_read_b128 v[88:91], v240 offset:14336
  s_waitcnt vmcnt(0) lgkmcnt(0)
  v_add_f32 v32, v32, v52
  v_add_f32 v12, v12, v72
  v_add_f32 v33, v33, v53
  v_add_f32 v13, v13, v73
  v_add_f32 v34, v34, v54
  v_add_f32 v14, v14, v74
  v_add_f32 v35, v35, v55
  v_add_f32 v15, v15, v75
  v_add_f32 v36, v36, v56
  v_add_f32 v16, v16, v76
  v_add_f32 v37, v37, v57
  v_add_f32 v17, v17, v77
  v_add_f32 v38, v38, v58
  v_add_f32 v18, v18, v78
  v_add_f32 v39, v39, v59
  v_add_f32 v19, v19, v79
  v_add_f32 v40, v40, v60
  v_add_f32 v20, v20, v80
  v_add_f32 v41, v41, v61
  v_add_f32 v21, v21, v81
  v_add_f32 v42, v42, v62
  v_add_f32 v22, v22, v82
  v_add_f32 v43, v43, v63
  v_add_f32 v23, v23, v83
  v_add_f32 v44, v44, v64
  v_add_f32 v24, v24, v84
  v_add_f32 v45, v45, v65
  v_add_f32 v25, v25, v85
  v_add_f32 v46, v46, v66
  v_add_f32 v26, v26, v86
  v_add_f32 v47, v47, v67
  v_add_f32 v27, v27, v87
  v_add_f32 v48, v48, v68
  v_add_f32 v28, v28, v88
  v_add_f32 v49, v49, v69
  v_add_f32 v29, v29, v89
  v_add_f32 v50, v50, v70
  v_add_f32 v30, v30, v90
  v_add_f32 v51, v51, v71
  v_add_f32 v31, v31, v91
  v_add_f32 v12, v12, v32
  v_add_f32 v13, v13, v33
  v_add_f32 v14, v14, v34
  v_add_f32 v15, v15, v35
  v_add_f32 v16, v16, v36
  v_add_f32 v17, v17, v37
  v_add_f32 v18, v18, v38
  v_add_f32 v19, v19, v39
  v_add_f32 v20, v20, v40
  v_add_f32 v21, v21, v41
  v_add_f32 v22, v22, v42
  v_add_f32 v23, v23, v43
  v_add_f32 v24, v24, v44
  v_add_f32 v25, v25, v45
  v_add_f32 v26, v26, v46
  v_add_f32 v27, v27, v47
  v_add_f32 v28, v28, v48
  v_add_f32 v29, v29, v49
  v_add_f32 v30, v30, v50
  v_add_f32 v31, v31, v51
  v_and_b32 v108, 1, v3
  v_lshlrev_b32 v108, 5, v108
  v_lshrrev_b32 v109, 1, v3
  v_lshl_add_u32 v108, v109, 4, v108
  v_mul_u32_u24 v109, 1280, v236
  v_add_u32 v108, v108, v109
  v_cvt_pk_bf16_f32 v124, v12, v13
  v_cvt_pk_bf16_f32 v125, v14, v15
  v_cvt_pk_bf16_f32 v126, v16, v17
  v_cvt_pk_bf16_f32 v127, v18, v19
  s_nop 0
  v_permlane16_swap_b32 v124, v126
  v_permlane16_swap_b32 v125, v127
  buffer_store_dwordx4 v[124:127], v108, s[28:31], s49 offen offset:0
  v_cvt_pk_bf16_f32 v128, v20, v21
  v_cvt_pk_bf16_f32 v129, v22, v23
  v_cvt_pk_bf16_f32 v130, v24, v25
  v_cvt_pk_bf16_f32 v131, v26, v27
  s_nop 0
  v_permlane16_swap_b32 v128, v130
  v_permlane16_swap_b32 v129, v131
  buffer_store_dwordx4 v[128:131], v108, s[28:31], s49 offen offset:64
  v_cvt_pk_bf16_f32 v132, v28, v29
  v_cvt_pk_bf16_f32 v133, v30, v31
  buffer_store_dwordx2 v[132:133], v238, s[28:31], s49 offen offset:128
  s_endpgm
l2_kernel_att2:
  s_sub_u32 s2, s2, 256
  s_setprio 3
  s_load_dwordx2 s[4:5], s[0:1], 80
  v_lshrrev_b32 v8, 6, v0
  s_and_b32 s36, s2, 7
  s_lshr_b32 s37, s2, 3
  v_readfirstlane_b32 s20, v8
  s_lshl_b32 s21, s36, 2
  s_lshr_b32 s38, s37, 3
  s_add_u32 s21, s21, s38
  s_and_b32 s22, s37, 7
  v_and_b32 v1, 63, v0
  v_and_b32 v2, 31, v1
  v_lshrrev_b32 v3, 5, v1
  s_mov_b32 s26, -1
  s_mov_b32 s27, 0
  s_mov_b32 s30, 0
  s_mov_b32 s31, -1
  s_mov_b32 s28, 0xfffff
  s_mov_b32 s29, 0xfffff
  v_lshlrev_b32 v4, 4, v1
  v_lshlrev_b32 v5, 4, v2
  v_lshl_add_u32 v5, v3, 3, v5
  v_mul_u32_u24 v6, 320, v3
  v_lshl_add_u32 v6, v2, 4, v6
  s_mul_i32 s40, s21, 98304
  s_mul_i32 s41, s22, 12288
  s_add_u32 s25, s40, s41
  s_add_u32 s25, s25, 0
  s_mul_i32 s41, s20, 24576
  s_add_u32 s23, s40, s41
  s_add_u32 s23, s23, 3145728
  s_mul_i32 s40, s21, 81920
  s_mul_i32 s41, s20, 20480
  s_add_u32 s24, s40, s41
  s_add_u32 s24, s24, 6291456
  v_cmp_eq_u32 vcc, 20, v2
  v_mov_b32 v8, 0x3f803f80
  s_nop 0
  v_cndmask_b32 v9, 0, v8, vcc
  v_mov_b32 v220, v9
  v_mov_b32 v221, v9
  v_mov_b32 v222, v9
  v_mov_b32 v223, v9
  v_mov_b32 v224, v9
  v_mov_b32 v225, v9
  v_mov_b32 v226, v9
  v_mov_b32 v227, v9
  v_mov_b32 v228, v9
  v_mov_b32 v229, v9
  v_mov_b32 v230, v9
  v_mov_b32 v231, v9
  v_mov_b32 v232, v9
  v_mov_b32 v233, v9
  v_mov_b32 v234, v9
  v_mov_b32 v235, v9
  v_mov_b32 v236, v9
  v_mov_b32 v237, v9
  v_mov_b32 v238, v9
  v_mov_b32 v239, v9
  v_mov_b32 v240, v9
  v_mov_b32 v241, v9
  v_mov_b32 v242, v9
  v_mov_b32 v243, v9
  v_mov_b32 v44, 0
  v_mov_b32 v45, 0
  v_mov_b32 v46, 0
  v_mov_b32 v47, 0
  v_mov_b32 v48, 0
  v_mov_b32 v49, 0
  v_mov_b32 v50, 0
  v_mov_b32 v51, 0
  v_mov_b32 v52, 0
  v_mov_b32 v53, 0
  v_mov_b32 v54, 0
  v_mov_b32 v55, 0
  v_mov_b32 v56, 0
  v_mov_b32 v57, 0
  v_mov_b32 v58, 0
  v_mov_b32 v59, 0
  s_waitcnt lgkmcnt(0)
  s_mov_b32 s8, s4
  s_and_b32 s9, s5, 0xffff
  s_mov_b32 s10, 37748736
  s_mov_b32 s11, 0x20000
  s_lshl_b32 s43, s20, 1
  s_mul_i32 s44, s43, 1536
  s_add_u32 s44, s44, s25
  s_lshl_b32 m0, s43, 10
  s_nop 0
  buffer_load_dwordx4 v4, s[8:11], s44 offen lds
  s_add_u32 s44, s44, 1536
  s_add_u32 s43, s43, 1
  s_lshl_b32 m0, s43, 10
  s_nop 0
  buffer_load_dwordx4 v4, s[8:11], s44 offen lds
  s_lshl_b32 s42, s21, 14
  s_lshl_b32 s43, s22, 11
  s_add_u32 s42, s42, s43
  s_add_u32 s42, s42, 30408704
  s_lshl_b32 s43, s20, 10
  s_add_u32 s42, s42, s43
  s_lshl_b32 s44, s21, 13
  s_lshl_b32 s45, s22, 10
  s_add_u32 s44, s44, s45
  s_add_u32 s44, s44, 30932992
  s_lshl_b32 s45, s21, 8
  s_add_u32 s45, s45, 14155776
  s_cmp_eq_u32 s20, 2
  s_cselect_b32 s42, s44, s42
  s_cmp_eq_u32 s20, 3
  s_cselect_b32 s42, s45, s42
  s_cselect_b32 s46, 0xffff, -1
  s_cselect_b32 s47, 0, -1
  s_add_u32 m0, s43, 8192
  s_mov_b32 exec_lo, s46
  s_mov_b32 exec_hi, s47
  buffer_load_dwordx4 v4, s[8:11], s42 offen lds
  s_mov_b64 exec, -1
  buffer_load_dwordx4 v[208:211], v4, s[8:11], s23 offen
  buffer_load_dwordx2 v[244:245], v5, s[8:11], s23 offen offset:1024
  s_mov_b64 exec, s[28:29]
  buffer_load_dwordx4 v[220:223], v6, s[8:11], s24 offen
  buffer_load_dwordx4 v[224:227], v6, s[8:11], s24 offen offset:640
  s_mov_b64 exec, -1
  s_add_u32 s23, s23, 1536
  s_add_u32 s24, s24, 1280
  buffer_load_dwordx4 v[212:215], v4, s[8:11], s23 offen
  buffer_load_dwordx2 v[246:247], v5, s[8:11], s23 offen offset:1024
  s_mov_b64 exec, s[28:29]
  buffer_load_dwordx4 v[228:231], v6, s[8:11], s24 offen
  buffer_load_dwordx4 v[232:235], v6, s[8:11], s24 offen offset:640
  s_mov_b64 exec, -1
  s_add_u32 s23, s23, 1536
  s_add_u32 s24, s24, 1280
  s_waitcnt vmcnt(8)
  s_barrier
  v_lshlrev_b32 v8, 2, v1
  ds_read_b32 v160, v8 offset:11264
  v_lshlrev_b32 v9, 2, v2
  v_lshlrev_b32 v10, 3, v2
  s_lshl_b32 s43, s20, 1
  s_add_u32 s43, s43, 0
  s_and_b32 s43, s43, 7
  s_lshl_b32 s44, s43, 7
  v_add_u32 v164, s44, v9
  ds_read_b32 v176, v164 offset:10240
  s_lshl_b32 s43, s20, 1
  s_add_u32 s43, s43, 1
  s_and_b32 s43, s43, 7
  s_lshl_b32 s44, s43, 7
  v_add_u32 v165, s44, v9
  ds_read_b32 v177, v165 offset:10240
  s_lshl_b32 s43, s20, 1
  s_add_u32 s43, s43, 2
  s_and_b32 s43, s43, 7
  s_lshl_b32 s44, s43, 7
  v_add_u32 v166, s44, v9
  ds_read_b32 v178, v166 offset:10240
  s_lshl_b32 s43, s20, 1
  s_add_u32 s43, s43, 3
  s_and_b32 s43, s43, 7
  s_lshl_b32 s44, s43, 7
  v_add_u32 v167, s44, v9
  ds_read_b32 v179, v167 offset:10240
  s_lshl_b32 s43, s20, 1
  s_add_u32 s43, s43, 4
  s_and_b32 s43, s43, 7
  s_lshl_b32 s44, s43, 7
  v_add_u32 v164, s44, v9
  ds_read_b32 v180, v164 offset:10240
  s_lshl_b32 s43, s20, 1
  s_add_u32 s43, s43, 5
  s_and_b32 s43, s43, 7
  s_lshl_b32 s44, s43, 7
  v_add_u32 v165, s44, v9
  ds_read_b32 v181, v165 offset:10240
  s_lshl_b32 s43, s20, 1
  s_add_u32 s43, s43, 6
  s_and_b32 s43, s43, 7
  s_lshl_b32 s44, s43, 7
  v_add_u32 v166, s44, v9
  ds_read_b32 v182, v166 offset:10240
  s_lshl_b32 s43, s20, 1
  s_add_u32 s43, s43, 7
  s_and_b32 s43, s43, 7
  s_lshl_b32 s44, s43, 7
  v_add_u32 v167, s44, v9
  ds_read_b32 v183, v167 offset:10240
  s_lshl_b32 s43, s20, 1
  s_add_u32 s43, s43, 0
  s_and_b32 s43, s43, 7
  s_lshl_b32 s44, s43, 10
  v_add_u32 v168, s44, v4
  ds_read_b128 v[12:15], v168
  s_lshl_b32 s43, s20, 1
  s_add_u32 s43, s43, 1
  s_and_b32 s43, s43, 7
  s_lshl_b32 s44, s43, 10
  v_add_u32 v169, s44, v4
  ds_read_b128 v[16:19], v169
  s_lshl_b32 s43, s20, 1
  s_add_u32 s43, s43, 2
  s_and_b32 s43, s43, 7
  s_lshl_b32 s44, s43, 10
  v_add_u32 v170, s44, v4
  ds_read_b128 v[20:23], v170
  s_lshl_b32 s43, s20, 1
  s_add_u32 s43, s43, 3
  s_and_b32 s43, s43, 7
  s_lshl_b32 s44, s43, 10
  v_add_u32 v171, s44, v4
  ds_read_b128 v[24:27], v171
  s_lshl_b32 s43, s20, 1
  s_add_u32 s43, s43, 4
  s_and_b32 s43, s43, 7
  s_lshl_b32 s44, s43, 10
  v_add_u32 v168, s44, v4
  ds_read_b128 v[28:31], v168
  s_lshl_b32 s43, s20, 1
  s_add_u32 s43, s43, 5
  s_and_b32 s43, s43, 7
  s_lshl_b32 s44, s43, 10
  v_add_u32 v169, s44, v4
  ds_read_b128 v[32:35], v169
  s_lshl_b32 s43, s20, 1
  s_add_u32 s43, s43, 6
  s_and_b32 s43, s43, 7
  s_lshl_b32 s44, s43, 10
  v_add_u32 v170, s44, v4
  ds_read_b128 v[36:39], v170
  s_lshl_b32 s43, s20, 1
  s_add_u32 s43, s43, 7
  s_and_b32 s43, s43, 7
  s_lshl_b32 s44, s43, 10
  v_add_u32 v171, s44, v4
  ds_read_b128 v[40:43], v171
  s_mov_b64 exec, s[26:27]
  s_lshl_b32 s43, s20, 1
  s_add_u32 s43, s43, 0
  s_and_b32 s43, s43, 7
  s_lshl_b32 s44, s43, 8
  v_add_u32 v172, s44, v10
  ds_read_b64 v[44:45], v172 offset:8192
  s_lshl_b32 s43, s20, 1
  s_add_u32 s43, s43, 1
  s_and_b32 s43, s43, 7
  s_lshl_b32 s44, s43, 8
  v_add_u32 v173, s44, v10
  ds_read_b64 v[46:47], v173 offset:8192
  s_lshl_b32 s43, s20, 1
  s_add_u32 s43, s43, 2
  s_and_b32 s43, s43, 7
  s_lshl_b32 s44, s43, 8
  v_add_u32 v174, s44, v10
  ds_read_b64 v[48:49], v174 offset:8192
  s_lshl_b32 s43, s20, 1
  s_add_u32 s43, s43, 3
  s_and_b32 s43, s43, 7
  s_lshl_b32 s44, s43, 8
  v_add_u32 v175, s44, v10
  ds_read_b64 v[50:51], v175 offset:8192
  s_lshl_b32 s43, s20, 1
  s_add_u32 s43, s43, 4
  s_and_b32 s43, s43, 7
  s_lshl_b32 s44, s43, 8
  v_add_u32 v172, s44, v10
  ds_read_b64 v[52:53], v172 offset:8192
  s_lshl_b32 s43, s20, 1
  s_add_u32 s43, s43, 5
  s_and_b32 s43, s43, 7
  s_lshl_b32 s44, s43, 8
  v_add_u32 v173, s44, v10
  ds_read_b64 v[54:55], v173 offset:8192
  s_lshl_b32 s43, s20, 1
  s_add_u32 s43, s43, 6
  s_and_b32 s43, s43, 7
  s_lshl_b32 s44, s43, 8
  v_add_u32 v174, s44, v10
  ds_read_b64 v[56:57], v174 offset:8192
  s_lshl_b32 s43, s20, 1
  s_add_u32 s43, s43, 7
  s_and_b32 s43, s43, 7
  s_lshl_b32 s44, s43, 8
  v_add_u32 v175, s44, v10
  ds_read_b64 v[58:59], v175 offset:8192
  s_mov_b64 exec, -1
  s_waitcnt lgkmcnt(15)
  v_max_f32_dpp v160, v160, v160 quad_perm:[1,0,3,2] row_mask:0xf bank_mask:0xf
  s_nop 1
  v_max_f32_dpp v160, v160, v160 quad_perm:[2,3,0,1] row_mask:0xf bank_mask:0xf
  s_nop 1
  v_max_f32_dpp v160, v160, v160 row_half_mirror row_mask:0xf bank_mask:0xf
  s_nop 1
  v_max_f32_dpp v160, v160, v160 row_mirror row_mask:0xf bank_mask:0xf
  v_mov_b32 v161, v160
  s_nop 1
  v_permlane16_swap_b32 v160, v161
  v_max_f32 v160, v160, v161
  v_mov_b32 v161, v160
  s_nop 1
  v_permlane32_swap_b32 v160, v161
  v_max_f32 v160, v160, v161
  v_mul_f32 v160, 0x3f840000, v160
  v_mul_f32 v176, v176, v160
  v_mul_f32 v177, v177, v160
  v_mul_f32 v178, v178, v160
  v_mul_f32 v179, v179, v160
  v_mul_f32 v180, v180, v160
  v_mul_f32 v181, v181, v160
  v_mul_f32 v182, v182, v160
  v_mul_f32 v183, v183, v160
  v_sqrt_f32 v176, v176
  v_sqrt_f32 v177, v177
  v_sqrt_f32 v178, v178
  v_sqrt_f32 v179, v179
  v_sqrt_f32 v180, v180
  v_sqrt_f32 v181, v181
  v_sqrt_f32 v182, v182
  v_sqrt_f32 v183, v183
  v_max3_f32 v162, v176, v177, v178
  v_max3_f32 v162, v162, v179, v180
  v_max3_f32 v162, v162, v181, v182
  v_max_f32 v162, v162, v183
  v_mov_b32 v163, 0x42400000
  v_cmp_nle_f32 vcc, v162, v163
  s_nop 0
  s_cbranch_vccz l2_kernel_fast9
  s_waitcnt vmcnt(0) lgkmcnt(0)
  s_barrier
  v_mov_b32 v176, 0xff800000
  v_mov_b32 v177, 0xff800000
  v_mov_b32 v178, 0xff800000
  v_mov_b32 v179, 0xff800000
  v_mov_b32 v180, 0xff800000
  v_mov_b32 v181, 0xff800000
  v_mov_b32 v182, 0xff800000
  v_mov_b32 v183, 0xff800000
  s_sub_u32 s33, s23, 3072
  s_mov_b32 s32, 16
  v_mov_b32 v200, 0
  v_mov_b32 v201, 0
l2_kernel_slow10:
  buffer_load_dwordx4 v[192:195], v4, s[8:11], s33 offen
  s_mov_b64 exec, s[26:27]
  buffer_load_dwordx2 v[200:201], v5, s[8:11], s33 offen offset:1024
  s_mov_b64 exec, -1
  s_add_u32 s33, s33, 1536
  s_waitcnt vmcnt(0)
  v_mfma_f32_32x32x16_bf16 v[160:175], v[192:195], v[12:15], 0
  v_mfma_f32_32x32x8_bf16 v[160:175], v[200:201], v[44:45], v[160:175]
  s_nop 11
  v_max3_f32 v176, v176, v160, v161
  v_max3_f32 v176, v176, v162, v163
  v_max3_f32 v176, v176, v164, v165
  v_max3_f32 v176, v176, v166, v167
  v_max3_f32 v176, v176, v168, v169
  v_max3_f32 v176, v176, v170, v171
  v_max3_f32 v176, v176, v172, v173
  v_max3_f32 v176, v176, v174, v175
  v_mfma_f32_32x32x16_bf16 v[160:175], v[192:195], v[16:19], 0
  v_mfma_f32_32x32x8_bf16 v[160:175], v[200:201], v[46:47], v[160:175]
  s_nop 11
  v_max3_f32 v177, v177, v160, v161
  v_max3_f32 v177, v177, v162, v163
  v_max3_f32 v177, v177, v164, v165
  v_max3_f32 v177, v177, v166, v167
  v_max3_f32 v177, v177, v168, v169
  v_max3_f32 v177, v177, v170, v171
  v_max3_f32 v177, v177, v172, v173
  v_max3_f32 v177, v177, v174, v175
  v_mfma_f32_32x32x16_bf16 v[160:175], v[192:195], v[20:23], 0
  v_mfma_f32_32x32x8_bf16 v[160:175], v[200:201], v[48:49], v[160:175]
  s_nop 11
  v_max3_f32 v178, v178, v160, v161
  v_max3_f32 v178, v178, v162, v163
  v_max3_f32 v178, v178, v164, v165
  v_max3_f32 v178, v178, v166, v167
  v_max3_f32 v178, v178, v168, v169
  v_max3_f32 v178, v178, v170, v171
  v_max3_f32 v178, v178, v172, v173
  v_max3_f32 v178, v178, v174, v175
  v_mfma_f32_32x32x16_bf16 v[160:175], v[192:195], v[24:27], 0
  v_mfma_f32_32x32x8_bf16 v[160:175], v[200:201], v[50:51], v[160:175]
  s_nop 11
  v_max3_f32 v179, v179, v160, v161
  v_max3_f32 v179, v179, v162, v163
  v_max3_f32 v179, v179, v164, v165
  v_max3_f32 v179, v179, v166, v167
  v_max3_f32 v179, v179, v168, v169
  v_max3_f32 v179, v179, v170, v171
  v_max3_f32 v179, v179, v172, v173
  v_max3_f32 v179, v179, v174, v175
  v_mfma_f32_32x32x16_bf16 v[160:175], v[192:195], v[28:31], 0
  v_mfma_f32_32x32x8_bf16 v[160:175], v[200:201], v[52:53], v[160:175]
  s_nop 11
  v_max3_f32 v180, v180, v160, v161
  v_max3_f32 v180, v180, v162, v163
  v_max3_f32 v180, v180, v164, v165
  v_max3_f32 v180, v180, v166, v167
  v_max3_f32 v180, v180, v168, v169
  v_max3_f32 v180, v180, v170, v171
  v_max3_f32 v180, v180, v172, v173
  v_max3_f32 v180, v180, v174, v175
  v_mfma_f32_32x32x16_bf16 v[160:175], v[192:195], v[32:35], 0
  v_mfma_f32_32x32x8_bf16 v[160:175], v[200:201], v[54:55], v[160:175]
  s_nop 11
  v_max3_f32 v181, v181, v160, v161
  v_max3_f32 v181, v181, v162, v163
  v_max3_f32 v181, v181, v164, v165
  v_max3_f32 v181, v181, v166, v167
  v_max3_f32 v181, v181, v168, v169
  v_max3_f32 v181, v181, v170, v171
  v_max3_f32 v181, v181, v172, v173
  v_max3_f32 v181, v181, v174, v175
  v_mfma_f32_32x32x16_bf16 v[160:175], v[192:195], v[36:39], 0
  v_mfma_f32_32x32x8_bf16 v[160:175], v[200:201], v[56:57], v[160:175]
  s_nop 11
  v_max3_f32 v182, v182, v160, v161
  v_max3_f32 v182, v182, v162, v163
  v_max3_f32 v182, v182, v164, v165
  v_max3_f32 v182, v182, v166, v167
  v_max3_f32 v182, v182, v168, v169
  v_max3_f32 v182, v182, v170, v171
  v_max3_f32 v182, v182, v172, v173
  v_max3_f32 v182, v182, v174, v175
  v_mfma_f32_32x32x16_bf16 v[160:175], v[192:195], v[40:43], 0
  v_mfma_f32_32x32x8_bf16 v[160:175], v[200:201], v[58:59], v[160:175]
  s_nop 11
  v_max3_f32 v183, v183, v160, v161
  v_max3_f32 v183, v183, v162, v163
  v_max3_f32 v183, v183, v164, v165
  v_max3_f32 v183, v183, v166, v167
  v_max3_f32 v183, v183, v168, v169
  v_max3_f32 v183, v183, v170, v171
  v_max3_f32 v183, v183, v172, v173
  v_max3_f32 v183, v183, v174, v175
  s_sub_u32 s32, s32, 1
  s_cmp_lg_u32 s32, 0
  s_cbranch_scc1 l2_kernel_slow10
  v_mov_b32 v160, v176
  s_nop 1
  v_permlane32_swap_b32 v176, v160
  v_max_f32 v176, v176, v160
  v_mov_b32 v161, v177
  s_nop 1
  v_permlane32_swap_b32 v177, v161
  v_max_f32 v177, v177, v161
  v_mov_b32 v162, v178
  s_nop 1
  v_permlane32_swap_b32 v178, v162
  v_max_f32 v178, v178, v162
  v_mov_b32 v163, v179
  s_nop 1
  v_permlane32_swap_b32 v179, v163
  v_max_f32 v179, v179, v163
  v_mov_b32 v164, v180
  s_nop 1
  v_permlane32_swap_b32 v180, v164
  v_max_f32 v180, v180, v164
  v_mov_b32 v165, v181
  s_nop 1
  v_permlane32_swap_b32 v181, v165
  v_max_f32 v181, v181, v165
  v_mov_b32 v166, v182
  s_nop 1
  v_permlane32_swap_b32 v182, v166
  v_max_f32 v182, v182, v166
  v_mov_b32 v167, v183
  s_nop 1
  v_permlane32_swap_b32 v183, v167
  v_max_f32 v183, v183, v167
  v_lshlrev_b32 v8, 2, v2
  s_lshl_b32 s40, s20, 10
  v_add_u32 v9, s40, v8
  s_lshl_b32 s43, s20, 1
  s_add_u32 s43, s43, 0
  s_and_b32 s43, s43, 7
  s_lshl_b32 s43, s43, 7
  v_add_u32 v10, s43, v9
  ds_write_b32 v10, v176
  s_lshl_b32 s43, s20, 1
  s_add_u32 s43, s43, 1
  s_and_b32 s43, s43, 7
  s_lshl_b32 s43, s43, 7
  v_add_u32 v10, s43, v9
  ds_write_b32 v10, v177
  s_lshl_b32 s43, s20, 1
  s_add_u32 s43, s43, 2
  s_and_b32 s43, s43, 7
  s_lshl_b32 s43, s43, 7
  v_add_u32 v10, s43, v9
  ds_write_b32 v10, v178
  s_lshl_b32 s43, s20, 1
  s_add_u32 s43, s43, 3
  s_and_b32 s43, s43, 7
  s_lshl_b32 s43, s43, 7
  v_add_u32 v10, s43, v9
  ds_write_b32 v10, v179
  s_lshl_b32 s43, s20, 1
  s_add_u32 s43, s43, 4
  s_and_b32 s43, s43, 7
  s_lshl_b32 s43, s43, 7
  v_add_u32 v10, s43, v9
  ds_write_b32 v10, v180
  s_lshl_b32 s43, s20, 1
  s_add_u32 s43, s43, 5
  s_and_b32 s43, s43, 7
  s_lshl_b32 s43, s43, 7
  v_add_u32 v10, s43, v9
  ds_write_b32 v10, v181
  s_lshl_b32 s43, s20, 1
  s_add_u32 s43, s43, 6
  s_and_b32 s43, s43, 7
  s_lshl_b32 s43, s43, 7
  v_add_u32 v10, s43, v9
  ds_write_b32 v10, v182
  s_lshl_b32 s43, s20, 1
  s_add_u32 s43, s43, 7
  s_and_b32 s43, s43, 7
  s_lshl_b32 s43, s43, 7
  v_add_u32 v10, s43, v9
  ds_write_b32 v10, v183
  s_waitcnt lgkmcnt(0)
  s_barrier
  s_lshl_b32 s43, s20, 1
  s_add_u32 s43, s43, 0
  s_and_b32 s43, s43, 7
  s_lshl_b32 s43, s43, 7
  v_add_u32 v10, s43, v8
  ds_read_b32 v160, v10 offset:0
  s_lshl_b32 s43, s20, 1
  s_add_u32 s43, s43, 1
  s_and_b32 s43, s43, 7
  s_lshl_b32 s43, s43, 7
  v_add_u32 v10, s43, v8
  ds_read_b32 v161, v10 offset:0
  s_lshl_b32 s43, s20, 1
  s_add_u32 s43, s43, 2
  s_and_b32 s43, s43, 7
  s_lshl_b32 s43, s43, 7
  v_add_u32 v10, s43, v8
  ds_read_b32 v162, v10 offset:0
  s_lshl_b32 s43, s20, 1
  s_add_u32 s43, s43, 3
  s_and_b32 s43, s43, 7
  s_lshl_b32 s43, s43, 7
  v_add_u32 v10, s43, v8
  ds_read_b32 v163, v10 offset:0
  s_lshl_b32 s43, s20, 1
  s_add_u32 s43, s43, 4
  s_and_b32 s43, s43, 7
  s_lshl_b32 s43, s43, 7
  v_add_u32 v10, s43, v8
  ds_read_b32 v164, v10 offset:0
  s_lshl_b32 s43, s20, 1
  s_add_u32 s43, s43, 5
  s_and_b32 s43, s43, 7
  s_lshl_b32 s43, s43, 7
  v_add_u32 v10, s43, v8
  ds_read_b32 v165, v10 offset:0
  s_lshl_b32 s43, s20, 1
  s_add_u32 s43, s43, 6
  s_and_b32 s43, s43, 7
  s_lshl_b32 s43, s43, 7
  v_add_u32 v10, s43, v8
  ds_read_b32 v166, v10 offset:0
  s_lshl_b32 s43, s20, 1
  s_add_u32 s43, s43, 7
  s_and_b32 s43, s43, 7
  s_lshl_b32 s43, s43, 7
  v_add_u32 v10, s43, v8
  ds_read_b32 v167, v10 offset:0
  s_waitcnt lgkmcnt(0)
  v_max_f32 v176, v176, v160
  v_max_f32 v177, v177, v161
  v_max_f32 v178, v178, v162
  v_max_f32 v179, v179, v163
  v_max_f32 v180, v180, v164
  v_max_f32 v181, v181, v165
  v_max_f32 v182, v182, v166
  v_max_f32 v183, v183, v167
  s_lshl_b32 s43, s20, 1
  s_add_u32 s43, s43, 0
  s_and_b32 s43, s43, 7
  s_lshl_b32 s43, s43, 7
  v_add_u32 v10, s43, v8
  ds_read_b32 v160, v10 offset:1024
  s_lshl_b32 s43, s20, 1
  s_add_u32 s43, s43, 1
  s_and_b32 s43, s43, 7
  s_lshl_b32 s43, s43, 7
  v_add_u32 v10, s43, v8
  ds_read_b32 v161, v10 offset:1024
  s_lshl_b32 s43, s20, 1
  s_add_u32 s43, s43, 2
  s_and_b32 s43, s43, 7
  s_lshl_b32 s43, s43, 7
  v_add_u32 v10, s43, v8
  ds_read_b32 v162, v10 offset:1024
  s_lshl_b32 s43, s20, 1
  s_add_u32 s43, s43, 3
  s_and_b32 s43, s43, 7
  s_lshl_b32 s43, s43, 7
  v_add_u32 v10, s43, v8
  ds_read_b32 v163, v10 offset:1024
  s_lshl_b32 s43, s20, 1
  s_add_u32 s43, s43, 4
  s_and_b32 s43, s43, 7
  s_lshl_b32 s43, s43, 7
  v_add_u32 v10, s43, v8
  ds_read_b32 v164, v10 offset:1024
  s_lshl_b32 s43, s20, 1
  s_add_u32 s43, s43, 5
  s_and_b32 s43, s43, 7
  s_lshl_b32 s43, s43, 7
  v_add_u32 v10, s43, v8
  ds_read_b32 v165, v10 offset:1024
  s_lshl_b32 s43, s20, 1
  s_add_u32 s43, s43, 6
  s_and_b32 s43, s43, 7
  s_lshl_b32 s43, s43, 7
  v_add_u32 v10, s43, v8
  ds_read_b32 v166, v10 offset:1024
  s_lshl_b32 s43, s20, 1
  s_add_u32 s43, s43, 7
  s_and_b32 s43, s43, 7
  s_lshl_b32 s43, s43, 7
  v_add_u32 v10, s43, v8
  ds_read_b32 v167, v10 offset:1024
  s_waitcnt lgkmcnt(0)
  v_max_f32 v176, v176, v160
  v_max_f32 v177, v177, v161
  v_max_f32 v178, v178, v162
  v_max_f32 v179, v179, v163
  v_max_f32 v180, v180, v164
  v_max_f32 v181, v181, v165
  v_max_f32 v182, v182, v166
  v_max_f32 v183, v183, v167
  s_lshl_b32 s43, s20, 1
  s_add_u32 s43, s43, 0
  s_and_b32 s43, s43, 7
  s_lshl_b32 s43, s43, 7
  v_add_u32 v10, s43, v8
  ds_read_b32 v160, v10 offset:2048
  s_lshl_b32 s43, s20, 1
  s_add_u32 s43, s43, 1
  s_and_b32 s43, s43, 7
  s_lshl_b32 s43, s43, 7
  v_add_u32 v10, s43, v8
  ds_read_b32 v161, v10 offset:2048
  s_lshl_b32 s43, s20, 1
  s_add_u32 s43, s43, 2
  s_and_b32 s43, s43, 7
  s_lshl_b32 s43, s43, 7
  v_add_u32 v10, s43, v8
  ds_read_b32 v162, v10 offset:2048
  s_lshl_b32 s43, s20, 1
  s_add_u32 s43, s43, 3
  s_and_b32 s43, s43, 7
  s_lshl_b32 s43, s43, 7
  v_add_u32 v10, s43, v8
  ds_read_b32 v163, v10 offset:2048
  s_lshl_b32 s43, s20, 1
  s_add_u32 s43, s43, 4
  s_and_b32 s43, s43, 7
  s_lshl_b32 s43, s43, 7
  v_add_u32 v10, s43, v8
  ds_read_b32 v164, v10 offset:2048
  s_lshl_b32 s43, s20, 1
  s_add_u32 s43, s43, 5
  s_and_b32 s43, s43, 7
  s_lshl_b32 s43, s43, 7
  v_add_u32 v10, s43, v8
  ds_read_b32 v165, v10 offset:2048
  s_lshl_b32 s43, s20, 1
  s_add_u32 s43, s43, 6
  s_and_b32 s43, s43, 7
  s_lshl_b32 s43, s43, 7
  v_add_u32 v10, s43, v8
  ds_read_b32 v166, v10 offset:2048
  s_lshl_b32 s43, s20, 1
  s_add_u32 s43, s43, 7
  s_and_b32 s43, s43, 7
  s_lshl_b32 s43, s43, 7
  v_add_u32 v10, s43, v8
  ds_read_b32 v167, v10 offset:2048
  s_waitcnt lgkmcnt(0)
  v_max_f32 v176, v176, v160
  v_max_f32 v177, v177, v161
  v_max_f32 v178, v178, v162
  v_max_f32 v179, v179, v163
  v_max_f32 v180, v180, v164
  v_max_f32 v181, v181, v165
  v_max_f32 v182, v182, v166
  v_max_f32 v183, v183, v167
  s_lshl_b32 s43, s20, 1
  s_add_u32 s43, s43, 0
  s_and_b32 s43, s43, 7
  s_lshl_b32 s43, s43, 7
  v_add_u32 v10, s43, v8
  ds_read_b32 v160, v10 offset:3072
  s_lshl_b32 s43, s20, 1
  s_add_u32 s43, s43, 1
  s_and_b32 s43, s43, 7
  s_lshl_b32 s43, s43, 7
  v_add_u32 v10, s43, v8
  ds_read_b32 v161, v10 offset:3072
  s_lshl_b32 s43, s20, 1
  s_add_u32 s43, s43, 2
  s_and_b32 s43, s43, 7
  s_lshl_b32 s43, s43, 7
  v_add_u32 v10, s43, v8
  ds_read_b32 v162, v10 offset:3072
  s_lshl_b32 s43, s20, 1
  s_add_u32 s43, s43, 3
  s_and_b32 s43, s43, 7
  s_lshl_b32 s43, s43, 7
  v_add_u32 v10, s43, v8
  ds_read_b32 v163, v10 offset:3072
  s_lshl_b32 s43, s20, 1
  s_add_u32 s43, s43, 4
  s_and_b32 s43, s43, 7
  s_lshl_b32 s43, s43, 7
  v_add_u32 v10, s43, v8
  ds_read_b32 v164, v10 offset:3072
  s_lshl_b32 s43, s20, 1
  s_add_u32 s43, s43, 5
  s_and_b32 s43, s43, 7
  s_lshl_b32 s43, s43, 7
  v_add_u32 v10, s43, v8
  ds_read_b32 v165, v10 offset:3072
  s_lshl_b32 s43, s20, 1
  s_add_u32 s43, s43, 6
  s_and_b32 s43, s43, 7
  s_lshl_b32 s43, s43, 7
  v_add_u32 v10, s43, v8
  ds_read_b32 v166, v10 offset:3072
  s_lshl_b32 s43, s20, 1
  s_add_u32 s43, s43, 7
  s_and_b32 s43, s43, 7
  s_lshl_b32 s43, s43, 7
  v_add_u32 v10, s43, v8
  ds_read_b32 v167, v10 offset:3072
  s_waitcnt lgkmcnt(0)
  v_max_f32 v176, v176, v160
  v_max_f32 v177, v177, v161
  v_max_f32 v178, v178, v162
  v_max_f32 v179, v179, v163
  v_max_f32 v180, v180, v164
  v_max_f32 v181, v181, v165
  v_max_f32 v182, v182, v166
  v_max_f32 v183, v183, v167
  s_barrier
l2_kernel_fast9:
  s_waitcnt vmcnt(4) lgkmcnt(0)
  s_mov_b64 exec, s[30:31]
  v_sub_f32 v160, 0, v176
  v_and_b32 v161, 0xffff0000, v160
  v_sub_f32 v160, v160, v161
  v_cvt_pk_bf16_f32 v44, v161, v160
  v_sub_f32 v162, 0, v177
  v_and_b32 v163, 0xffff0000, v162
  v_sub_f32 v162, v162, v163
  v_cvt_pk_bf16_f32 v46, v163, v162
  v_sub_f32 v160, 0, v178
  v_and_b32 v161, 0xffff0000, v160
  v_sub_f32 v160, v160, v161
  v_cvt_pk_bf16_f32 v48, v161, v160
  v_sub_f32 v162, 0, v179
  v_and_b32 v163, 0xffff0000, v162
  v_sub_f32 v162, v162, v163
  v_cvt_pk_bf16_f32 v50, v163, v162
  v_sub_f32 v160, 0, v180
  v_and_b32 v161, 0xffff0000, v160
  v_sub_f32 v160, v160, v161
  v_cvt_pk_bf16_f32 v52, v161, v160
  v_sub_f32 v162, 0, v181
  v_and_b32 v163, 0xffff0000, v162
  v_sub_f32 v162, v162, v163
  v_cvt_pk_bf16_f32 v54, v163, v162
  v_sub_f32 v160, 0, v182
  v_and_b32 v161, 0xffff0000, v160
  v_sub_f32 v160, v160, v161
  v_cvt_pk_bf16_f32 v56, v161, v160
  v_sub_f32 v162, 0, v183
  v_and_b32 v163, 0xffff0000, v162
  v_sub_f32 v162, v162, v163
  v_cvt_pk_bf16_f32 v58, v163, v162
  s_mov_b64 exec, -1
  s_setprio 1
  v_mfma_f32_32x32x16_bf16 v[160:175], v[208:211], v[12:15], 0
  v_mfma_f32_32x32x8_bf16 v[160:175], v[244:245], v[44:45], v[160:175]
  s_nop 7
  s_nop 3
  v_exp_f32 v160, v160
  v_exp_f32 v161, v161
  v_exp_f32 v162, v162
  v_exp_f32 v163, v163
  v_exp_f32 v164, v164
  v_exp_f32 v165, v165
  v_mfma_f32_32x32x16_bf16 v[176:191], v[208:211], v[16:19], 0
  v_exp_f32 v166, v166
  v_exp_f32 v167, v167
  v_cvt_pk_bf16_f32 v192, v160, v161
  v_cvt_pk_bf16_f32 v193, v162, v163
  v_mfma_f32_32x32x8_bf16 v[176:191], v[244:245], v[46:47], v[176:191]
  v_cvt_pk_bf16_f32 v194, v164, v165
  v_cvt_pk_bf16_f32 v195, v166, v167
  v_exp_f32 v168, v168
  v_exp_f32 v169, v169
  v_exp_f32 v170, v170
  v_exp_f32 v171, v171
  v_mfma_f32_32x32x16_bf16 v[60:75], v[220:223], v[192:195], 0
  v_exp_f32 v172, v172
  v_exp_f32 v173, v173
  v_exp_f32 v174, v174
  v_exp_f32 v175, v175
  v_cvt_pk_bf16_f32 v196, v168, v169
  v_cvt_pk_bf16_f32 v197, v170, v171
  v_cvt_pk_bf16_f32 v198, v172, v173
  v_cvt_pk_bf16_f32 v199, v174, v175
  v_exp_f32 v176, v176
  v_exp_f32 v177, v177
  v_mfma_f32_32x32x16_bf16 v[60:75], v[224:227], v[196:199], v[60:75]
  s_setprio 3
  buffer_load_dwordx4 v[216:219], v4, s[8:11], s23 offen
  buffer_load_dwordx2 v[248:249], v5, s[8:11], s23 offen offset:1024
  s_mov_b64 exec, s[28:29]
  buffer_load_dwordx4 v[236:239], v6, s[8:11], s24 offen
  buffer_load_dwordx4 v[240:243], v6, s[8:11], s24 offen offset:640
  s_mov_b64 exec, -1
  s_setprio 1
  s_add_u32 s23, s23, 1536
  s_add_u32 s24, s24, 1280
  v_exp_f32 v178, v178
  v_exp_f32 v179, v179
  v_exp_f32 v180, v180
  v_exp_f32 v181, v181
  v_mfma_f32_32x32x16_bf16 v[160:175], v[208:211], v[20:23], 0
  v_exp_f32 v182, v182
  v_exp_f32 v183, v183
  v_cvt_pk_bf16_f32 v200, v176, v177
  v_cvt_pk_bf16_f32 v201, v178, v179
  v_mfma_f32_32x32x8_bf16 v[160:175], v[244:245], v[48:49], v[160:175]
  v_cvt_pk_bf16_f32 v202, v180, v181
  v_cvt_pk_bf16_f32 v203, v182, v183
  v_exp_f32 v184, v184
  v_exp_f32 v185, v185
  v_exp_f32 v186, v186
  v_exp_f32 v187, v187
  v_mfma_f32_32x32x16_bf16 v[72:87], v[220:223], v[200:203], 0
  v_exp_f32 v188, v188
  v_exp_f32 v189, v189
  v_exp_f32 v190, v190
  v_exp_f32 v191, v191
  v_cvt_pk_bf16_f32 v204, v184, v185
  v_cvt_pk_bf16_f32 v205, v186, v187
  v_cvt_pk_bf16_f32 v206, v188, v189
  v_cvt_pk_bf16_f32 v207, v190, v191
  v_exp_f32 v160, v160
  v_exp_f32 v161, v161
  v_mfma_f32_32x32x16_bf16 v[72:87], v[224:227], v[204:207], v[72:87]
  v_exp_f32 v162, v162
  v_exp_f32 v163, v163
  v_exp_f32 v164, v164
  v_exp_f32 v165, v165
  v_mfma_f32_32x32x16_bf16 v[176:191], v[208:211], v[24:27], 0
  v_exp_f32 v166, v166
  v_exp_f32 v167, v167
  v_cvt_pk_bf16_f32 v192, v160, v161
  v_cvt_pk_bf16_f32 v193, v162, v163
  v_mfma_f32_32x32x8_bf16 v[176:191], v[244:245], v[50:51], v[176:191]
  v_cvt_pk_bf16_f32 v194, v164, v165
  v_cvt_pk_bf16_f32 v195, v166, v167
  v_exp_f32 v168, v168
  v_exp_f32 v169, v169
  v_exp_f32 v170, v170
  v_exp_f32 v171, v171
  v_mfma_f32_32x32x16_bf16 v[84:99], v[220:223], v[192:195], 0
  v_exp_f32 v172, v172
  v_exp_f32 v173, v173
  v_exp_f32 v174, v174
  v_exp_f32 v175, v175
  v_cvt_pk_bf16_f32 v196, v168, v169
  v_cvt_pk_bf16_f32 v197, v170, v171
  v_cvt_pk_bf16_f32 v198, v172, v173
  v_cvt_pk_bf16_f32 v199, v174, v175
  v_exp_f32 v176, v176
  v_exp_f32 v177, v177
  v_mfma_f32_32x32x16_bf16 v[84:99], v[224:227], v[196:199], v[84:99]
  v_exp_f32 v178, v178
  v_exp_f32 v179, v179
  v_exp_f32 v180, v180
  v_exp_f32 v181, v181
  v_mfma_f32_32x32x16_bf16 v[160:175], v[208:211], v[28:31], 0
  v_exp_f32 v182, v182
  v_exp_f32 v183, v183
  v_cvt_pk_bf16_f32 v200, v176, v177
  v_cvt_pk_bf16_f32 v201, v178, v179
  v_mfma_f32_32x32x8_bf16 v[160:175], v[244:245], v[52:53], v[160:175]
  v_cvt_pk_bf16_f32 v202, v180, v181
  v_cvt_pk_bf16_f32 v203, v182, v183
  v_exp_f32 v184, v184
  v_exp_f32 v185, v185
  v_exp_f32 v186, v186
  v_exp_f32 v187, v187
  v_mfma_f32_32x32x16_bf16 v[96:111], v[220:223], v[200:203], 0
  v_exp_f32 v188, v188
  v_exp_f32 v189, v189
  v_exp_f32 v190, v190
  v_exp_f32 v191, v191
  v_cvt_pk_bf16_f32 v204, v184, v185
  v_cvt_pk_bf16_f32 v205, v186, v187
  v_cvt_pk_bf16_f32 v206, v188, v189
  v_cvt_pk_bf16_f32 v207, v190, v191
  v_exp_f32 v160, v160
  v_exp_f32 v161, v161
  v_mfma_f32_32x32x16_bf16 v[96:111], v[224:227], v[204:207], v[96:111]
  v_exp_f32 v162, v162
  v_exp_f32 v163, v163
  v_exp_f32 v164, v164
  v_exp_f32 v165, v165
  v_mfma_f32_32x32x16_bf16 v[176:191], v[208:211], v[32:35], 0
  v_exp_f32 v166, v166
  v_exp_f32 v167, v167
  v_cvt_pk_bf16_f32 v192, v160, v161
  v_cvt_pk_bf16_f32 v193, v162, v163
  v_mfma_f32_32x32x8_bf16 v[176:191], v[244:245], v[54:55], v[176:191]
  v_cvt_pk_bf16_f32 v194, v164, v165
  v_cvt_pk_bf16_f32 v195, v166, v167
  v_exp_f32 v168, v168
  v_exp_f32 v169, v169
  v_exp_f32 v170, v170
  v_exp_f32 v171, v171
  v_mfma_f32_32x32x16_bf16 v[108:123], v[220:223], v[192:195], 0
  v_exp_f32 v172, v172
  v_exp_f32 v173, v173
  v_exp_f32 v174, v174
  v_exp_f32 v175, v175
  v_cvt_pk_bf16_f32 v196, v168, v169
  v_cvt_pk_bf16_f32 v197, v170, v171
  v_cvt_pk_bf16_f32 v198, v172, v173
  v_cvt_pk_bf16_f32 v199, v174, v175
  v_exp_f32 v176, v176
  v_exp_f32 v177, v177
  v_mfma_f32_32x32x16_bf16 v[108:123], v[224:227], v[196:199], v[108:123]
  v_exp_f32 v178, v178
  v_exp_f32 v179, v179
  v_exp_f32 v180, v180
  v_exp_f32 v181, v181
  v_mfma_f32_32x32x16_bf16 v[160:175], v[208:211], v[36:39], 0
  v_exp_f32 v182, v182
  v_exp_f32 v183, v183
  v_cvt_pk_bf16_f32 v200, v176, v177
  v_cvt_pk_bf16_f32 v201, v178, v179
  v_mfma_f32_32x32x8_bf16 v[160:175], v[244:245], v[56:57], v[160:175]
  v_cvt_pk_bf16_f32 v202, v180, v181
  v_cvt_pk_bf16_f32 v203, v182, v183
  v_exp_f32 v184, v184
  v_exp_f32 v185, v185
  v_exp_f32 v186, v186
  v_exp_f32 v187, v187
  v_mfma_f32_32x32x16_bf16 v[120:135], v[220:223], v[200:203], 0
  v_exp_f32 v188, v188
  v_exp_f32 v189, v189
  v_exp_f32 v190, v190
  v_exp_f32 v191, v191
  v_cvt_pk_bf16_f32 v204, v184, v185
  v_cvt_pk_bf16_f32 v205, v186, v187
  v_cvt_pk_bf16_f32 v206, v188, v189
  v_cvt_pk_bf16_f32 v207, v190, v191
  v_exp_f32 v160, v160
  v_exp_f32 v161, v161
  v_mfma_f32_32x32x16_bf16 v[120:135], v[224:227], v[204:207], v[120:135]
  v_exp_f32 v162, v162
  v_exp_f32 v163, v163
  v_exp_f32 v164, v164
  v_exp_f32 v165, v165
  v_mfma_f32_32x32x16_bf16 v[176:191], v[208:211], v[40:43], 0
  v_exp_f32 v166, v166
  v_exp_f32 v167, v167
  v_cvt_pk_bf16_f32 v192, v160, v161
  v_cvt_pk_bf16_f32 v193, v162, v163
  v_mfma_f32_32x32x8_bf16 v[176:191], v[244:245], v[58:59], v[176:191]
  v_cvt_pk_bf16_f32 v194, v164, v165
  v_cvt_pk_bf16_f32 v195, v166, v167
  v_exp_f32 v168, v168
  v_exp_f32 v169, v169
  v_exp_f32 v170, v170
  v_exp_f32 v171, v171
  v_mfma_f32_32x32x16_bf16 v[132:147], v[220:223], v[192:195], 0
  v_exp_f32 v172, v172
  v_exp_f32 v173, v173
  v_exp_f32 v174, v174
  v_exp_f32 v175, v175
  v_cvt_pk_bf16_f32 v196, v168, v169
  v_cvt_pk_bf16_f32 v197, v170, v171
  v_cvt_pk_bf16_f32 v198, v172, v173
  v_cvt_pk_bf16_f32 v199, v174, v175
  s_waitcnt vmcnt(6)
  v_exp_f32 v176, v176
  v_exp_f32 v177, v177
  v_mfma_f32_32x32x16_bf16 v[132:147], v[224:227], v[196:199], v[132:147]
  v_exp_f32 v178, v178
  v_exp_f32 v179, v179
  v_exp_f32 v180, v180
  v_exp_f32 v181, v181
  v_mfma_f32_32x32x16_bf16 v[160:175], v[212:215], v[12:15], 0
  v_exp_f32 v182, v182
  v_exp_f32 v183, v183
  v_cvt_pk_bf16_f32 v200, v176, v177
  v_cvt_pk_bf16_f32 v201, v178, v179
  v_mfma_f32_32x32x8_bf16 v[160:175], v[246:247], v[44:45], v[160:175]
  v_cvt_pk_bf16_f32 v202, v180, v181
  v_cvt_pk_bf16_f32 v203, v182, v183
  v_exp_f32 v184, v184
  v_exp_f32 v185, v185
  v_exp_f32 v186, v186
  v_exp_f32 v187, v187
  v_mfma_f32_32x32x16_bf16 v[144:159], v[220:223], v[200:203], 0
  v_exp_f32 v188, v188
  v_exp_f32 v189, v189
  v_exp_f32 v190, v190
  v_exp_f32 v191, v191
  v_cvt_pk_bf16_f32 v204, v184, v185
  v_cvt_pk_bf16_f32 v205, v186, v187
  v_cvt_pk_bf16_f32 v206, v188, v189
  v_cvt_pk_bf16_f32 v207, v190, v191
  s_mov_b32 s32, 5
l2_kernel_loop11:
  s_waitcnt vmcnt(4)
  v_exp_f32 v160, v160
  v_exp_f32 v161, v161
  v_mfma_f32_32x32x16_bf16 v[144:159], v[224:227], v[204:207], v[144:159]
  v_exp_f32 v162, v162
  v_exp_f32 v163, v163
  v_exp_f32 v164, v164
  v_exp_f32 v165, v165
  v_mfma_f32_32x32x16_bf16 v[176:191], v[212:215], v[16:19], 0
  v_exp_f32 v166, v166
  v_exp_f32 v167, v167
  v_cvt_pk_bf16_f32 v192, v160, v161
  v_cvt_pk_bf16_f32 v193, v162, v163
  v_mfma_f32_32x32x8_bf16 v[176:191], v[246:247], v[46:47], v[176:191]
  v_cvt_pk_bf16_f32 v194, v164, v165
  v_cvt_pk_bf16_f32 v195, v166, v167
  v_exp_f32 v168, v168
  v_exp_f32 v169, v169
  v_exp_f32 v170, v170
  v_exp_f32 v171, v171
  v_mfma_f32_32x32x16_bf16 v[60:75], v[228:231], v[192:195], v[60:75]
  v_exp_f32 v172, v172
  v_exp_f32 v173, v173
  v_exp_f32 v174, v174
  v_exp_f32 v175, v175
  v_cvt_pk_bf16_f32 v196, v168, v169
  v_cvt_pk_bf16_f32 v197, v170, v171
  v_cvt_pk_bf16_f32 v198, v172, v173
  v_cvt_pk_bf16_f32 v199, v174, v175
  v_exp_f32 v176, v176
  v_exp_f32 v177, v177
  v_mfma_f32_32x32x16_bf16 v[60:75], v[232:235], v[196:199], v[60:75]
  s_setprio 3
  buffer_load_dwordx4 v[208:211], v4, s[8:11], s23 offen
  buffer_load_dwordx2 v[244:245], v5, s[8:11], s23 offen offset:1024
  s_mov_b64 exec, s[28:29]
  buffer_load_dwordx4 v[220:223], v6, s[8:11], s24 offen
  buffer_load_dwordx4 v[224:227], v6, s[8:11], s24 offen offset:640
  s_mov_b64 exec, -1
  s_setprio 1
  s_add_u32 s23, s23, 1536
  s_add_u32 s24, s24, 1280
  v_exp_f32 v178, v178
  v_exp_f32 v179, v179
  v_exp_f32 v180, v180
  v_exp_f32 v181, v181
  v_mfma_f32_32x32x16_bf16 v[160:175], v[212:215], v[20:23], 0
  v_exp_f32 v182, v182
  v_exp_f32 v183, v183
  v_cvt_pk_bf16_f32 v200, v176, v177
  v_cvt_pk_bf16_f32 v201, v178, v179
  v_mfma_f32_32x32x8_bf16 v[160:175], v[246:247], v[48:49], v[160:175]
  v_cvt_pk_bf16_f32 v202, v180, v181
  v_cvt_pk_bf16_f32 v203, v182, v183
  v_exp_f32 v184, v184
  v_exp_f32 v185, v185
  v_exp_f32 v186, v186
  v_exp_f32 v187, v187
  v_mfma_f32_32x32x16_bf16 v[72:87], v[228:231], v[200:203], v[72:87]
  v_exp_f32 v188, v188
  v_exp_f32 v189, v189
  v_exp_f32 v190, v190
  v_exp_f32 v191, v191
  v_cvt_pk_bf16_f32 v204, v184, v185
  v_cvt_pk_bf16_f32 v205, v186, v187
  v_cvt_pk_bf16_f32 v206, v188, v189
  v_cvt_pk_bf16_f32 v207, v190, v191
  v_exp_f32 v160, v160
  v_exp_f32 v161, v161
  v_mfma_f32_32x32x16_bf16 v[72:87], v[232:235], v[204:207], v[72:87]
  v_exp_f32 v162, v162
  v_exp_f32 v163, v163
  v_exp_f32 v164, v164
  v_exp_f32 v165, v165
  v_mfma_f32_32x32x16_bf16 v[176:191], v[212:215], v[24:27], 0
  v_exp_f32 v166, v166
  v_exp_f32 v167, v167
  v_cvt_pk_bf16_f32 v192, v160, v161
  v_cvt_pk_bf16_f32 v193, v162, v163
  v_mfma_f32_32x32x8_bf16 v[176:191], v[246:247], v[50:51], v[176:191]
  v_cvt_pk_bf16_f32 v194, v164, v165
  v_cvt_pk_bf16_f32 v195, v166, v167
  v_exp_f32 v168, v168
  v_exp_f32 v169, v169
  v_exp_f32 v170, v170
  v_exp_f32 v171, v171
  v_mfma_f32_32x32x16_bf16 v[84:99], v[228:231], v[192:195], v[84:99]
  v_exp_f32 v172, v172
  v_exp_f32 v173, v173
  v_exp_f32 v174, v174
  v_exp_f32 v175, v175
  v_cvt_pk_bf16_f32 v196, v168, v169
  v_cvt_pk_bf16_f32 v197, v170, v171
  v_cvt_pk_bf16_f32 v198, v172, v173
  v_cvt_pk_bf16_f32 v199, v174, v175
  v_exp_f32 v176, v176
  v_exp_f32 v177, v177
  v_mfma_f32_32x32x16_bf16 v[84:99], v[232:235], v[196:199], v[84:99]
  v_exp_f32 v178, v178
  v_exp_f32 v179, v179
  v_exp_f32 v180, v180
  v_exp_f32 v181, v181
  v_mfma_f32_32x32x16_bf16 v[160:175], v[212:215], v[28:31], 0
  v_exp_f32 v182, v182
  v_exp_f32 v183, v183
  v_cvt_pk_bf16_f32 v200, v176, v177
  v_cvt_pk_bf16_f32 v201, v178, v179
  v_mfma_f32_32x32x8_bf16 v[160:175], v[246:247], v[52:53], v[160:175]
  v_cvt_pk_bf16_f32 v202, v180, v181
  v_cvt_pk_bf16_f32 v203, v182, v183
  v_exp_f32 v184, v184
  v_exp_f32 v185, v185
  v_exp_f32 v186, v186
  v_exp_f32 v187, v187
  v_mfma_f32_32x32x16_bf16 v[96:111], v[228:231], v[200:203], v[96:111]
  v_exp_f32 v188, v188
  v_exp_f32 v189, v189
  v_exp_f32 v190, v190
  v_exp_f32 v191, v191
  v_cvt_pk_bf16_f32 v204, v184, v185
  v_cvt_pk_bf16_f32 v205, v186, v187
  v_cvt_pk_bf16_f32 v206, v188, v189
  v_cvt_pk_bf16_f32 v207, v190, v191
  v_exp_f32 v160, v160
  v_exp_f32 v161, v161
  v_mfma_f32_32x32x16_bf16 v[96:111], v[232:235], v[204:207], v[96:111]
  v_exp_f32 v162, v162
  v_exp_f32 v163, v163
  v_exp_f32 v164, v164
  v_exp_f32 v165, v165
  v_mfma_f32_32x32x16_bf16 v[176:191], v[212:215], v[32:35], 0
  v_exp_f32 v166, v166
  v_exp_f32 v167, v167
  v_cvt_pk_bf16_f32 v192, v160, v161
  v_cvt_pk_bf16_f32 v193, v162, v163
  v_mfma_f32_32x32x8_bf16 v[176:191], v[246:247], v[54:55], v[176:191]
  v_cvt_pk_bf16_f32 v194, v164, v165
  v_cvt_pk_bf16_f32 v195, v166, v167
  v_exp_f32 v168, v168
  v_exp_f32 v169, v169
  v_exp_f32 v170, v170
  v_exp_f32 v171, v171
  v_mfma_f32_32x32x16_bf16 v[108:123], v[228:231], v[192:195], v[108:123]
  v_exp_f32 v172, v172
  v_exp_f32 v173, v173
  v_exp_f32 v174, v174
  v_exp_f32 v175, v175
  v_cvt_pk_bf16_f32 v196, v168, v169
  v_cvt_pk_bf16_f32 v197, v170, v171
  v_cvt_pk_bf16_f32 v198, v172, v173
  v_cvt_pk_bf16_f32 v199, v174, v175
  v_exp_f32 v176, v176
  v_exp_f32 v177, v177
  v_mfma_f32_32x32x16_bf16 v[108:123], v[232:235], v[196:199], v[108:123]
  v_exp_f32 v178, v178
  v_exp_f32 v179, v179
  v_exp_f32 v180, v180
  v_exp_f32 v181, v181
  v_mfma_f32_32x32x16_bf16 v[160:175], v[212:215], v[36:39], 0
  v_exp_f32 v182, v182
  v_exp_f32 v183, v183
  v_cvt_pk_bf16_f32 v200, v176, v177
  v_cvt_pk_bf16_f32 v201, v178, v179
  v_mfma_f32_32x32x8_bf16 v[160:175], v[246:247], v[56:57], v[160:175]
  v_cvt_pk_bf16_f32 v202, v180, v181
  v_cvt_pk_bf16_f32 v203, v182, v183
  v_exp_f32 v184, v184
  v_exp_f32 v185, v185
  v_exp_f32 v186, v186
  v_exp_f32 v187, v187
  v_mfma_f32_32x32x16_bf16 v[120:135], v[228:231], v[200:203], v[120:135]
  v_exp_f32 v188, v188
  v_exp_f32 v189, v189
  v_exp_f32 v190, v190
  v_exp_f32 v191, v191
  v_cvt_pk_bf16_f32 v204, v184, v185
  v_cvt_pk_bf16_f32 v205, v186, v187
  v_cvt_pk_bf16_f32 v206, v188, v189
  v_cvt_pk_bf16_f32 v207, v190, v191
  v_exp_f32 v160, v160
  v_exp_f32 v161, v161
  v_mfma_f32_32x32x16_bf16 v[120:135], v[232:235], v[204:207], v[120:135]
  v_exp_f32 v162, v162
  v_exp_f32 v163, v163
  v_exp_f32 v164, v164
  v_exp_f32 v165, v165
  v_mfma_f32_32x32x16_bf16 v[176:191], v[212:215], v[40:43], 0
  v_exp_f32 v166, v166
  v_exp_f32 v167, v167
  v_cvt_pk_bf16_f32 v192, v160, v161
  v_cvt_pk_bf16_f32 v193, v162, v163
  v_mfma_f32_32x32x8_bf16 v[176:191], v[246:247], v[58:59], v[176:191]
  v_cvt_pk_bf16_f32 v194, v164, v165
  v_cvt_pk_bf16_f32 v195, v166, v167
  v_exp_f32 v168, v168
  v_exp_f32 v169, v169
  v_exp_f32 v170, v170
  v_exp_f32 v171, v171
  v_mfma_f32_32x32x16_bf16 v[132:147], v[228:231], v[192:195], v[132:147]
  v_exp_f32 v172, v172
  v_exp_f32 v173, v173
  v_exp_f32 v174, v174
  v_exp_f32 v175, v175
  v_cvt_pk_bf16_f32 v196, v168, v169
  v_cvt_pk_bf16_f32 v197, v170, v171
  v_cvt_pk_bf16_f32 v198, v172, v173
  v_cvt_pk_bf16_f32 v199, v174, v175
  s_waitcnt vmcnt(6)
  v_exp_f32 v176, v176
  v_exp_f32 v177, v177
  v_mfma_f32_32x32x16_bf16 v[132:147], v[232:235], v[196:199], v[132:147]
  v_exp_f32 v178, v178
  v_exp_f32 v179, v179
  v_exp_f32 v180, v180
  v_exp_f32 v181, v181
  v_mfma_f32_32x32x16_bf16 v[160:175], v[216:219], v[12:15], 0
  v_exp_f32 v182, v182
  v_exp_f32 v183, v183
  v_cvt_pk_bf16_f32 v200, v176, v177
  v_cvt_pk_bf16_f32 v201, v178, v179
  v_mfma_f32_32x32x8_bf16 v[160:175], v[248:249], v[44:45], v[160:175]
  v_cvt_pk_bf16_f32 v202, v180, v181
  v_cvt_pk_bf16_f32 v203, v182, v183
  v_exp_f32 v184, v184
  v_exp_f32 v185, v185
  v_exp_f32 v186, v186
  v_exp_f32 v187, v187
  v_mfma_f32_32x32x16_bf16 v[144:159], v[228:231], v[200:203], v[144:159]
  v_exp_f32 v188, v188
  v_exp_f32 v189, v189
  v_exp_f32 v190, v190
  v_exp_f32 v191, v191
  v_cvt_pk_bf16_f32 v204, v184, v185
  v_cvt_pk_bf16_f32 v205, v186, v187
  v_cvt_pk_bf16_f32 v206, v188, v189
  v_cvt_pk_bf16_f32 v207, v190, v191
  s_waitcnt vmcnt(4)
  v_exp_f32 v160, v160
  v_exp_f32 v161, v161
  v_mfma_f32_32x32x16_bf16 v[144:159], v[232:235], v[204:207], v[144:159]
  v_exp_f32 v162, v162
  v_exp_f32 v163, v163
  v_exp_f32 v164, v164
  v_exp_f32 v165, v165
  v_mfma_f32_32x32x16_bf16 v[176:191], v[216:219], v[16:19], 0
  v_exp_f32 v166, v166
  v_exp_f32 v167, v167
  v_cvt_pk_bf16_f32 v192, v160, v161
  v_cvt_pk_bf16_f32 v193, v162, v163
  v_mfma_f32_32x32x8_bf16 v[176:191], v[248:249], v[46:47], v[176:191]
  v_cvt_pk_bf16_f32 v194, v164, v165
  v_cvt_pk_bf16_f32 v195, v166, v167
  v_exp_f32 v168, v168
  v_exp_f32 v169, v169
  v_exp_f32 v170, v170
  v_exp_f32 v171, v171
  v_mfma_f32_32x32x16_bf16 v[60:75], v[236:239], v[192:195], v[60:75]
  v_exp_f32 v172, v172
  v_exp_f32 v173, v173
  v_exp_f32 v174, v174
  v_exp_f32 v175, v175
  v_cvt_pk_bf16_f32 v196, v168, v169
  v_cvt_pk_bf16_f32 v197, v170, v171
  v_cvt_pk_bf16_f32 v198, v172, v173
  v_cvt_pk_bf16_f32 v199, v174, v175
  v_exp_f32 v176, v176
  v_exp_f32 v177, v177
  v_mfma_f32_32x32x16_bf16 v[60:75], v[240:243], v[196:199], v[60:75]
  s_setprio 3
  buffer_load_dwordx4 v[212:215], v4, s[8:11], s23 offen
  buffer_load_dwordx2 v[246:247], v5, s[8:11], s23 offen offset:1024
  s_mov_b64 exec, s[28:29]
  buffer_load_dwordx4 v[228:231], v6, s[8:11], s24 offen
  buffer_load_dwordx4 v[232:235], v6, s[8:11], s24 offen offset:640
  s_mov_b64 exec, -1
  s_setprio 1
  s_add_u32 s23, s23, 1536
  s_add_u32 s24, s24, 1280
  v_exp_f32 v178, v178
  v_exp_f32 v179, v179
  v_exp_f32 v180, v180
  v_exp_f32 v181, v181
  v_mfma_f32_32x32x16_bf16 v[160:175], v[216:219], v[20:23], 0
  v_exp_f32 v182, v182
  v_exp_f32 v183, v183
  v_cvt_pk_bf16_f32 v200, v176, v177
  v_cvt_pk_bf16_f32 v201, v178, v179
  v_mfma_f32_32x32x8_bf16 v[160:175], v[248:249], v[48:49], v[160:175]
  v_cvt_pk_bf16_f32 v202, v180, v181
  v_cvt_pk_bf16_f32 v203, v182, v183
  v_exp_f32 v184, v184
  v_exp_f32 v185, v185
  v_exp_f32 v186, v186
  v_exp_f32 v187, v187
  v_mfma_f32_32x32x16_bf16 v[72:87], v[236:239], v[200:203], v[72:87]
  v_exp_f32 v188, v188
  v_exp_f32 v189, v189
  v_exp_f32 v190, v190
  v_exp_f32 v191, v191
  v_cvt_pk_bf16_f32 v204, v184, v185
  v_cvt_pk_bf16_f32 v205, v186, v187
  v_cvt_pk_bf16_f32 v206, v188, v189
  v_cvt_pk_bf16_f32 v207, v190, v191
  v_exp_f32 v160, v160
  v_exp_f32 v161, v161
  v_mfma_f32_32x32x16_bf16 v[72:87], v[240:243], v[204:207], v[72:87]
  v_exp_f32 v162, v162
  v_exp_f32 v163, v163
  v_exp_f32 v164, v164
  v_exp_f32 v165, v165
  v_mfma_f32_32x32x16_bf16 v[176:191], v[216:219], v[24:27], 0
  v_exp_f32 v166, v166
  v_exp_f32 v167, v167
  v_cvt_pk_bf16_f32 v192, v160, v161
  v_cvt_pk_bf16_f32 v193, v162, v163
  v_mfma_f32_32x32x8_bf16 v[176:191], v[248:249], v[50:51], v[176:191]
  v_cvt_pk_bf16_f32 v194, v164, v165
  v_cvt_pk_bf16_f32 v195, v166, v167
  v_exp_f32 v168, v168
  v_exp_f32 v169, v169
  v_exp_f32 v170, v170
  v_exp_f32 v171, v171
  v_mfma_f32_32x32x16_bf16 v[84:99], v[236:239], v[192:195], v[84:99]
  v_exp_f32 v172, v172
  v_exp_f32 v173, v173
  v_exp_f32 v174, v174
  v_exp_f32 v175, v175
  v_cvt_pk_bf16_f32 v196, v168, v169
  v_cvt_pk_bf16_f32 v197, v170, v171
  v_cvt_pk_bf16_f32 v198, v172, v173
  v_cvt_pk_bf16_f32 v199, v174, v175
  v_exp_f32 v176, v176
  v_exp_f32 v177, v177
  v_mfma_f32_32x32x16_bf16 v[84:99], v[240:243], v[196:199], v[84:99]
  v_exp_f32 v178, v178
  v_exp_f32 v179, v179
  v_exp_f32 v180, v180
  v_exp_f32 v181, v181
  v_mfma_f32_32x32x16_bf16 v[160:175], v[216:219], v[28:31], 0
  v_exp_f32 v182, v182
  v_exp_f32 v183, v183
  v_cvt_pk_bf16_f32 v200, v176, v177
  v_cvt_pk_bf16_f32 v201, v178, v179
  v_mfma_f32_32x32x8_bf16 v[160:175], v[248:249], v[52:53], v[160:175]
  v_cvt_pk_bf16_f32 v202, v180, v181
  v_cvt_pk_bf16_f32 v203, v182, v183
  v_exp_f32 v184, v184
  v_exp_f32 v185, v185
  v_exp_f32 v186, v186
  v_exp_f32 v187, v187
  v_mfma_f32_32x32x16_bf16 v[96:111], v[236:239], v[200:203], v[96:111]
  v_exp_f32 v188, v188
  v_exp_f32 v189, v189
  v_exp_f32 v190, v190
  v_exp_f32 v191, v191
  v_cvt_pk_bf16_f32 v204, v184, v185
  v_cvt_pk_bf16_f32 v205, v186, v187
  v_cvt_pk_bf16_f32 v206, v188, v189
  v_cvt_pk_bf16_f32 v207, v190, v191
  v_exp_f32 v160, v160
  v_exp_f32 v161, v161
  v_mfma_f32_32x32x16_bf16 v[96:111], v[240:243], v[204:207], v[96:111]
  v_exp_f32 v162, v162
  v_exp_f32 v163, v163
  v_exp_f32 v164, v164
  v_exp_f32 v165, v165
  v_mfma_f32_32x32x16_bf16 v[176:191], v[216:219], v[32:35], 0
  v_exp_f32 v166, v166
  v_exp_f32 v167, v167
  v_cvt_pk_bf16_f32 v192, v160, v161
  v_cvt_pk_bf16_f32 v193, v162, v163
  v_mfma_f32_32x32x8_bf16 v[176:191], v[248:249], v[54:55], v[176:191]
  v_cvt_pk_bf16_f32 v194, v164, v165
  v_cvt_pk_bf16_f32 v195, v166, v167
  v_exp_f32 v168, v168
  v_exp_f32 v169, v169
  v_exp_f32 v170, v170
  v_exp_f32 v171, v171
  v_mfma_f32_32x32x16_bf16 v[108:123], v[236:239], v[192:195], v[108:123]
  v_exp_f32 v172, v172
  v_exp_f32 v173, v173
  v_exp_f32 v174, v174
  v_exp_f32 v175, v175
  v_cvt_pk_bf16_f32 v196, v168, v169
  v_cvt_pk_bf16_f32 v197, v170, v171
  v_cvt_pk_bf16_f32 v198, v172, v173
  v_cvt_pk_bf16_f32 v199, v174, v175
  v_exp_f32 v176, v176
  v_exp_f32 v177, v177
  v_mfma_f32_32x32x16_bf16 v[108:123], v[240:243], v[196:199], v[108:123]
  v_exp_f32 v178, v178
  v_exp_f32 v179, v179
  v_exp_f32 v180, v180
  v_exp_f32 v181, v181
  v_mfma_f32_32x32x16_bf16 v[160:175], v[216:219], v[36:39], 0
  v_exp_f32 v182, v182
  v_exp_f32 v183, v183
  v_cvt_pk_bf16_f32 v200, v176, v177
  v_cvt_pk_bf16_f32 v201, v178, v179
  v_mfma_f32_32x32x8_bf16 v[160:175], v[248:249], v[56:57], v[160:175]
  v_cvt_pk_bf16_f32 v202, v180, v181
  v_cvt_pk_bf16_f32 v203, v182, v183
  v_exp_f32 v184, v184
  v_exp_f32 v185, v185
  v_exp_f32 v186, v186
  v_exp_f32 v187, v187
  v_mfma_f32_32x32x16_bf16 v[120:135], v[236:239], v[200:203], v[120:135]
  v_exp_f32 v188, v188
  v_exp_f32 v189, v189
  v_exp_f32 v190, v190
  v_exp_f32 v191, v191
  v_cvt_pk_bf16_f32 v204, v184, v185
  v_cvt_pk_bf16_f32 v205, v186, v187
  v_cvt_pk_bf16_f32 v206, v188, v189
  v_cvt_pk_bf16_f32 v207, v190, v191
  v_exp_f32 v160, v160
  v_exp_f32 v161, v161
  v_mfma_f32_32x32x16_bf16 v[120:135], v[240:243], v[204:207], v[120:135]
  v_exp_f32 v162, v162
  v_exp_f32 v163, v163
  v_exp_f32 v164, v164
  v_exp_f32 v165, v165
  v_mfma_f32_32x32x16_bf16 v[176:191], v[216:219], v[40:43], 0
  v_exp_f32 v166, v166
  v_exp_f32 v167, v167
  v_cvt_pk_bf16_f32 v192, v160, v161
  v_cvt_pk_bf16_f32 v193, v162, v163
  v_mfma_f32_32x32x8_bf16 v[176:191], v[248:249], v[58:59], v[176:191]
  v_cvt_pk_bf16_f32 v194, v164, v165
  v_cvt_pk_bf16_f32 v195, v166, v167
  v_exp_f32 v168, v168
  v_exp_f32 v169, v169
  v_exp_f32 v170, v170
  v_exp_f32 v171, v171
  v_mfma_f32_32x32x16_bf16 v[132:147], v[236:239], v[192:195], v[132:147]
  v_exp_f32 v172, v172
  v_exp_f32 v173, v173
  v_exp_f32 v174, v174
  v_exp_f32 v175, v175
  v_cvt_pk_bf16_f32 v196, v168, v169
  v_cvt_pk_bf16_f32 v197, v170, v171
  v_cvt_pk_bf16_f32 v198, v172, v173
  v_cvt_pk_bf16_f32 v199, v174, v175
  s_waitcnt vmcnt(6)
  v_exp_f32 v176, v176
  v_exp_f32 v177, v177
  v_mfma_f32_32x32x16_bf16 v[132:147], v[240:243], v[196:199], v[132:147]
  v_exp_f32 v178, v178
  v_exp_f32 v179, v179
  v_exp_f32 v180, v180
  v_exp_f32 v181, v181
  v_mfma_f32_32x32x16_bf16 v[160:175], v[208:211], v[12:15], 0
  v_exp_f32 v182, v182
  v_exp_f32 v183, v183
  v_cvt_pk_bf16_f32 v200, v176, v177
  v_cvt_pk_bf16_f32 v201, v178, v179
  v_mfma_f32_32x32x8_bf16 v[160:175], v[244:245], v[44:45], v[160:175]
  v_cvt_pk_bf16_f32 v202, v180, v181
  v_cvt_pk_bf16_f32 v203, v182, v183
  v_exp_f32 v184, v184
  v_exp_f32 v185, v185
  v_exp_f32 v186, v186
  v_exp_f32 v187, v187
  v_mfma_f32_32x32x16_bf16 v[144:159], v[236:239], v[200:203], v[144:159]
  v_exp_f32 v188, v188
  v_exp_f32 v189, v189
  v_exp_f32 v190, v190
  v_exp_f32 v191, v191
  v_cvt_pk_bf16_f32 v204, v184, v185
  v_cvt_pk_bf16_f32 v205, v186, v187
  v_cvt_pk_bf16_f32 v206, v188, v189
  v_cvt_pk_bf16_f32 v207, v190, v191
  s_waitcnt vmcnt(4)
  v_exp_f32 v160, v160
  v_exp_f32 v161, v161
  v_mfma_f32_32x32x16_bf16 v[144:159], v[240:243], v[204:207], v[144:159]
  v_exp_f32 v162, v162
  v_exp_f32 v163, v163
  v_exp_f32 v164, v164
  v_exp_f32 v165, v165
  v_mfma_f32_32x32x16_bf16 v[176:191], v[208:211], v[16:19], 0
  v_exp_f32 v166, v166
  v_exp_f32 v167, v167
  v_cvt_pk_bf16_f32 v192, v160, v161
  v_cvt_pk_bf16_f32 v193, v162, v163
  v_mfma_f32_32x32x8_bf16 v[176:191], v[244:245], v[46:47], v[176:191]
  v_cvt_pk_bf16_f32 v194, v164, v165
  v_cvt_pk_bf16_f32 v195, v166, v167
  v_exp_f32 v168, v168
  v_exp_f32 v169, v169
  v_exp_f32 v170, v170
  v_exp_f32 v171, v171
  v_mfma_f32_32x32x16_bf16 v[60:75], v[220:223], v[192:195], v[60:75]
  v_exp_f32 v172, v172
  v_exp_f32 v173, v173
  v_exp_f32 v174, v174
  v_exp_f32 v175, v175
  v_cvt_pk_bf16_f32 v196, v168, v169
  v_cvt_pk_bf16_f32 v197, v170, v171
  v_cvt_pk_bf16_f32 v198, v172, v173
  v_cvt_pk_bf16_f32 v199, v174, v175
  v_exp_f32 v176, v176
  v_exp_f32 v177, v177
  v_mfma_f32_32x32x16_bf16 v[60:75], v[224:227], v[196:199], v[60:75]
  s_setprio 3
  buffer_load_dwordx4 v[216:219], v4, s[8:11], s23 offen
  buffer_load_dwordx2 v[248:249], v5, s[8:11], s23 offen offset:1024
  s_mov_b64 exec, s[28:29]
  buffer_load_dwordx4 v[236:239], v6, s[8:11], s24 offen
  buffer_load_dwordx4 v[240:243], v6, s[8:11], s24 offen offset:640
  s_mov_b64 exec, -1
  s_setprio 1
  s_add_u32 s23, s23, 1536
  s_add_u32 s24, s24, 1280
  v_exp_f32 v178, v178
  v_exp_f32 v179, v179
  v_exp_f32 v180, v180
  v_exp_f32 v181, v181
  v_mfma_f32_32x32x16_bf16 v[160:175], v[208:211], v[20:23], 0
  v_exp_f32 v182, v182
  v_exp_f32 v183, v183
  v_cvt_pk_bf16_f32 v200, v176, v177
  v_cvt_pk_bf16_f32 v201, v178, v179
  v_mfma_f32_32x32x8_bf16 v[160:175], v[244:245], v[48:49], v[160:175]
  v_cvt_pk_bf16_f32 v202, v180, v181
  v_cvt_pk_bf16_f32 v203, v182, v183
  v_exp_f32 v184, v184
  v_exp_f32 v185, v185
  v_exp_f32 v186, v186
  v_exp_f32 v187, v187
  v_mfma_f32_32x32x16_bf16 v[72:87], v[220:223], v[200:203], v[72:87]
  v_exp_f32 v188, v188
  v_exp_f32 v189, v189
  v_exp_f32 v190, v190
  v_exp_f32 v191, v191
  v_cvt_pk_bf16_f32 v204, v184, v185
  v_cvt_pk_bf16_f32 v205, v186, v187
  v_cvt_pk_bf16_f32 v206, v188, v189
  v_cvt_pk_bf16_f32 v207, v190, v191
  v_exp_f32 v160, v160
  v_exp_f32 v161, v161
  v_mfma_f32_32x32x16_bf16 v[72:87], v[224:227], v[204:207], v[72:87]
  v_exp_f32 v162, v162
  v_exp_f32 v163, v163
  v_exp_f32 v164, v164
  v_exp_f32 v165, v165
  v_mfma_f32_32x32x16_bf16 v[176:191], v[208:211], v[24:27], 0
  v_exp_f32 v166, v166
  v_exp_f32 v167, v167
  v_cvt_pk_bf16_f32 v192, v160, v161
  v_cvt_pk_bf16_f32 v193, v162, v163
  v_mfma_f32_32x32x8_bf16 v[176:191], v[244:245], v[50:51], v[176:191]
  v_cvt_pk_bf16_f32 v194, v164, v165
  v_cvt_pk_bf16_f32 v195, v166, v167
  v_exp_f32 v168, v168
  v_exp_f32 v169, v169
  v_exp_f32 v170, v170
  v_exp_f32 v171, v171
  v_mfma_f32_32x32x16_bf16 v[84:99], v[220:223], v[192:195], v[84:99]
  v_exp_f32 v172, v172
  v_exp_f32 v173, v173
  v_exp_f32 v174, v174
  v_exp_f32 v175, v175
  v_cvt_pk_bf16_f32 v196, v168, v169
  v_cvt_pk_bf16_f32 v197, v170, v171
  v_cvt_pk_bf16_f32 v198, v172, v173
  v_cvt_pk_bf16_f32 v199, v174, v175
  v_exp_f32 v176, v176
  v_exp_f32 v177, v177
  v_mfma_f32_32x32x16_bf16 v[84:99], v[224:227], v[196:199], v[84:99]
  v_exp_f32 v178, v178
  v_exp_f32 v179, v179
  v_exp_f32 v180, v180
  v_exp_f32 v181, v181
  v_mfma_f32_32x32x16_bf16 v[160:175], v[208:211], v[28:31], 0
  v_exp_f32 v182, v182
  v_exp_f32 v183, v183
  v_cvt_pk_bf16_f32 v200, v176, v177
  v_cvt_pk_bf16_f32 v201, v178, v179
  v_mfma_f32_32x32x8_bf16 v[160:175], v[244:245], v[52:53], v[160:175]
  v_cvt_pk_bf16_f32 v202, v180, v181
  v_cvt_pk_bf16_f32 v203, v182, v183
  v_exp_f32 v184, v184
  v_exp_f32 v185, v185
  v_exp_f32 v186, v186
  v_exp_f32 v187, v187
  v_mfma_f32_32x32x16_bf16 v[96:111], v[220:223], v[200:203], v[96:111]
  v_exp_f32 v188, v188
  v_exp_f32 v189, v189
  v_exp_f32 v190, v190
  v_exp_f32 v191, v191
  v_cvt_pk_bf16_f32 v204, v184, v185
  v_cvt_pk_bf16_f32 v205, v186, v187
  v_cvt_pk_bf16_f32 v206, v188, v189
  v_cvt_pk_bf16_f32 v207, v190, v191
  v_exp_f32 v160, v160
  v_exp_f32 v161, v161
  v_mfma_f32_32x32x16_bf16 v[96:111], v[224:227], v[204:207], v[96:111]
  v_exp_f32 v162, v162
  v_exp_f32 v163, v163
  v_exp_f32 v164, v164
  v_exp_f32 v165, v165
  v_mfma_f32_32x32x16_bf16 v[176:191], v[208:211], v[32:35], 0
  v_exp_f32 v166, v166
  v_exp_f32 v167, v167
  v_cvt_pk_bf16_f32 v192, v160, v161
  v_cvt_pk_bf16_f32 v193, v162, v163
  v_mfma_f32_32x32x8_bf16 v[176:191], v[244:245], v[54:55], v[176:191]
  v_cvt_pk_bf16_f32 v194, v164, v165
  v_cvt_pk_bf16_f32 v195, v166, v167
  v_exp_f32 v168, v168
  v_exp_f32 v169, v169
  v_exp_f32 v170, v170
  v_exp_f32 v171, v171
  v_mfma_f32_32x32x16_bf16 v[108:123], v[220:223], v[192:195], v[108:123]
  v_exp_f32 v172, v172
  v_exp_f32 v173, v173
  v_exp_f32 v174, v174
  v_exp_f32 v175, v175
  v_cvt_pk_bf16_f32 v196, v168, v169
  v_cvt_pk_bf16_f32 v197, v170, v171
  v_cvt_pk_bf16_f32 v198, v172, v173
  v_cvt_pk_bf16_f32 v199, v174, v175
  v_exp_f32 v176, v176
  v_exp_f32 v177, v177
  v_mfma_f32_32x32x16_bf16 v[108:123], v[224:227], v[196:199], v[108:123]
  v_exp_f32 v178, v178
  v_exp_f32 v179, v179
  v_exp_f32 v180, v180
  v_exp_f32 v181, v181
  v_mfma_f32_32x32x16_bf16 v[160:175], v[208:211], v[36:39], 0
  v_exp_f32 v182, v182
  v_exp_f32 v183, v183
  v_cvt_pk_bf16_f32 v200, v176, v177
  v_cvt_pk_bf16_f32 v201, v178, v179
  v_mfma_f32_32x32x8_bf16 v[160:175], v[244:245], v[56:57], v[160:175]
  v_cvt_pk_bf16_f32 v202, v180, v181
  v_cvt_pk_bf16_f32 v203, v182, v183
  v_exp_f32 v184, v184
  v_exp_f32 v185, v185
  v_exp_f32 v186, v186
  v_exp_f32 v187, v187
  v_mfma_f32_32x32x16_bf16 v[120:135], v[220:223], v[200:203], v[120:135]
  v_exp_f32 v188, v188
  v_exp_f32 v189, v189
  v_exp_f32 v190, v190
  v_exp_f32 v191, v191
  v_cvt_pk_bf16_f32 v204, v184, v185
  v_cvt_pk_bf16_f32 v205, v186, v187
  v_cvt_pk_bf16_f32 v206, v188, v189
  v_cvt_pk_bf16_f32 v207, v190, v191
  v_exp_f32 v160, v160
  v_exp_f32 v161, v161
  v_mfma_f32_32x32x16_bf16 v[120:135], v[224:227], v[204:207], v[120:135]
  v_exp_f32 v162, v162
  v_exp_f32 v163, v163
  v_exp_f32 v164, v164
  v_exp_f32 v165, v165
  v_mfma_f32_32x32x16_bf16 v[176:191], v[208:211], v[40:43], 0
  v_exp_f32 v166, v166
  v_exp_f32 v167, v167
  v_cvt_pk_bf16_f32 v192, v160, v161
  v_cvt_pk_bf16_f32 v193, v162, v163
  v_mfma_f32_32x32x8_bf16 v[176:191], v[244:245], v[58:59], v[176:191]
  v_cvt_pk_bf16_f32 v194, v164, v165
  v_cvt_pk_bf16_f32 v195, v166, v167
  v_exp_f32 v168, v168
  v_exp_f32 v169, v169
  v_exp_f32 v170, v170
  v_exp_f32 v171, v171
  v_mfma_f32_32x32x16_bf16 v[132:147], v[220:223], v[192:195], v[132:147]
  v_exp_f32 v172, v172
  v_exp_f32 v173, v173
  v_exp_f32 v174, v174
  v_exp_f32 v175, v175
  v_cvt_pk_bf16_f32 v196, v168, v169
  v_cvt_pk_bf16_f32 v197, v170, v171
  v_cvt_pk_bf16_f32 v198, v172, v173
  v_cvt_pk_bf16_f32 v199, v174, v175
  s_waitcnt vmcnt(6)
  v_exp_f32 v176, v176
  v_exp_f32 v177, v177
  v_mfma_f32_32x32x16_bf16 v[132:147], v[224:227], v[196:199], v[132:147]
  v_exp_f32 v178, v178
  v_exp_f32 v179, v179
  v_exp_f32 v180, v180
  v_exp_f32 v181, v181
  v_mfma_f32_32x32x16_bf16 v[160:175], v[212:215], v[12:15], 0
  v_exp_f32 v182, v182
  v_exp_f32 v183, v183
  v_cvt_pk_bf16_f32 v200, v176, v177
  v_cvt_pk_bf16_f32 v201, v178, v179
  v_mfma_f32_32x32x8_bf16 v[160:175], v[246:247], v[44:45], v[160:175]
  v_cvt_pk_bf16_f32 v202, v180, v181
  v_cvt_pk_bf16_f32 v203, v182, v183
  v_exp_f32 v184, v184
  v_exp_f32 v185, v185
  v_exp_f32 v186, v186
  v_exp_f32 v187, v187
  v_mfma_f32_32x32x16_bf16 v[144:159], v[220:223], v[200:203], v[144:159]
  v_exp_f32 v188, v188
  v_exp_f32 v189, v189
  v_exp_f32 v190, v190
  v_exp_f32 v191, v191
  v_cvt_pk_bf16_f32 v204, v184, v185
  v_cvt_pk_bf16_f32 v205, v186, v187
  v_cvt_pk_bf16_f32 v206, v188, v189
  v_cvt_pk_bf16_f32 v207, v190, v191
  s_sub_u32 s32, s32, 1
  s_cmp_lg_u32 s32, 0
  s_cbranch_scc1 l2_kernel_loop11
  v_mfma_f32_32x32x16_bf16 v[144:159], v[224:227], v[204:207], v[144:159]
  s_setprio 3
  s_mul_i32 s46, s21, 3
  s_lshr_b32 s47, s46, 2
  s_lshl_b32 s47, s47, 10
  s_and_b32 s48, s46, 3
  s_lshl_b32 s48, s48, 8
  s_add_u32 s50, s47, s48
  s_add_u32 s50, s50, 15204352
  s_add_u32 s46, s46, 2
  s_lshr_b32 s47, s46, 2
  s_lshl_b32 s47, s47, 10
  s_and_b32 s48, s46, 3
  s_lshl_b32 s48, s48, 8
  s_add_u32 s52, s47, s48
  s_add_u32 s52, s52, 15204352
  s_add_u32 s40, s20, 1
  s_and_b32 s40, s40, 3
  s_mul_i32 s40, s40, 18432
  s_add_u32 s40, s40, 0
  v_add_u32 v8, s40, v4
  ds_write_b128 v8, v[84:87] offset:0
  ds_write_b128 v8, v[88:91] offset:1024
  ds_write_b128 v8, v[92:95] offset:2048
  s_add_u32 s40, s20, 1
  s_and_b32 s40, s40, 3
  s_mul_i32 s40, s40, 18432
  s_add_u32 s40, s40, 3072
  v_add_u32 v9, s40, v4
  ds_write_b128 v9, v[96:99] offset:0
  ds_write_b128 v9, v[100:103] offset:1024
  ds_write_b128 v9, v[104:107] offset:2048
  s_add_u32 s40, s20, 2
  s_and_b32 s40, s40, 3
  s_mul_i32 s40, s40, 18432
  s_add_u32 s40, s40, 6144
  v_add_u32 v8, s40, v4
  ds_write_b128 v8, v[108:111] offset:0
  ds_write_b128 v8, v[112:115] offset:1024
  ds_write_b128 v8, v[116:119] offset:2048
  s_add_u32 s40, s20, 2
  s_and_b32 s40, s40, 3
  s_mul_i32 s40, s40, 18432
  s_add_u32 s40, s40, 9216
  v_add_u32 v9, s40, v4
  ds_write_b128 v9, v[120:123] offset:0
  ds_write_b128 v9, v[124:127] offset:1024
  ds_write_b128 v9, v[128:131] offset:2048
  s_add_u32 s40, s20, 3
  s_and_b32 s40, s40, 3
  s_mul_i32 s40, s40, 18432
  s_add_u32 s40, s40, 12288
  v_add_u32 v8, s40, v4
  ds_write_b128 v8, v[132:135] offset:0
  ds_write_b128 v8, v[136:139] offset:1024
  ds_write_b128 v8, v[140:143] offset:2048
  s_add_u32 s40, s20, 3
  s_and_b32 s40, s40, 3
  s_mul_i32 s40, s40, 18432
  s_add_u32 s40, s40, 15360
  v_add_u32 v9, s40, v4
  ds_write_b128 v9, v[144:147] offset:0
  ds_write_b128 v9, v[148:151] offset:1024
  ds_write_b128 v9, v[152:155] offset:2048
  s_mul_i32 s40, s20, 18432
  v_add_u32 v8, s40, v4
  s_waitcnt lgkmcnt(0)
  s_barrier
  ds_read_b128 v[84:87], v8 offset:0
  ds_read_b128 v[88:91], v8 offset:1024
  ds_read_b128 v[92:95], v8 offset:2048
  ds_read_b128 v[96:99], v8 offset:3072
  ds_read_b128 v[100:103], v8 offset:4096
  ds_read_b128 v[104:107], v8 offset:5120
  ds_read_b128 v[108:111], v8 offset:6144
  ds_read_b128 v[112:115], v8 offset:7168
  ds_read_b128 v[116:119], v8 offset:8192
  ds_read_b128 v[120:123], v8 offset:9216
  ds_read_b128 v[124:127], v8 offset:10240
  ds_read_b128 v[128:131], v8 offset:11264
  ds_read_b128 v[132:135], v8 offset:12288
  ds_read_b128 v[136:139], v8 offset:13312
  ds_read_b128 v[140:143], v8 offset:14336
  ds_read_b128 v[144:147], v8 offset:15360
  ds_read_b128 v[148:151], v8 offset:16384
  ds_read_b128 v[152:155], v8 offset:17408
  s_lshl_b32 s40, s22, 8
  s_lshl_b32 s41, s20, 6
  s_add_u32 s40, s40, s41
  v_add_u32 v208, s40, v2
  v_lshrrev_b32 v209, 4, v208
  s_mov_b32 s41, 73728
  v_mul_lo_u32 v209, v209, s41
  v_and_b32 v208, 15, v208
  v_lshl_add_u32 v208, v208, 4, v209
  v_add_u32 v209, 147456, v208
  s_waitcnt lgkmcnt(0)
  v_add_f32 v84, v84, v108
  v_add_f32 v60, v60, v132
  v_add_f32 v85, v85, v109
  v_add_f32 v61, v61, v133
  v_add_f32 v86, v86, v110
  v_add_f32 v62, v62, v134
  v_add_f32 v87, v87, v111
  v_add_f32 v63, v63, v135
  v_add_f32 v88, v88, v112
  v_add_f32 v64, v64, v136
  v_add_f32 v89, v89, v113
  v_add_f32 v65, v65, v137
  v_add_f32 v90, v90, v114
  v_add_f32 v66, v66, v138
  v_add_f32 v91, v91, v115
  v_add_f32 v67, v67, v139
  v_add_f32 v92, v92, v116
  v_add_f32 v68, v68, v140
  v_add_f32 v93, v93, v117
  v_add_f32 v69, v69, v141
  v_add_f32 v94, v94, v118
  v_add_f32 v70, v70, v142
  v_add_f32 v95, v95, v119
  v_add_f32 v71, v71, v143
  v_add_f32 v96, v96, v120
  v_add_f32 v72, v72, v144
  v_add_f32 v97, v97, v121
  v_add_f32 v73, v73, v145
  v_add_f32 v98, v98, v122
  v_add_f32 v74, v74, v146
  v_add_f32 v99, v99, v123
  v_add_f32 v75, v75, v147
  v_add_f32 v100, v100, v124
  v_add_f32 v76, v76, v148
  v_add_f32 v101, v101, v125
  v_add_f32 v77, v77, v149
  v_add_f32 v102, v102, v126
  v_add_f32 v78, v78, v150
  v_add_f32 v103, v103, v127
  v_add_f32 v79, v79, v151
  v_add_f32 v104, v104, v128
  v_add_f32 v80, v80, v152
  v_add_f32 v105, v105, v129
  v_add_f32 v81, v81, v153
  v_add_f32 v106, v106, v130
  v_add_f32 v82, v82, v154
  v_add_f32 v107, v107, v131
  v_add_f32 v83, v83, v155
  v_add_f32 v60, v60, v84
  v_add_f32 v61, v61, v85
  v_add_f32 v62, v62, v86
  v_add_f32 v63, v63, v87
  v_add_f32 v64, v64, v88
  v_add_f32 v65, v65, v89
  v_add_f32 v66, v66, v90
  v_add_f32 v67, v67, v91
  v_add_f32 v68, v68, v92
  v_add_f32 v69, v69, v93
  v_add_f32 v70, v70, v94
  v_add_f32 v71, v71, v95
  v_add_f32 v72, v72, v96
  v_add_f32 v73, v73, v97
  v_add_f32 v74, v74, v98
  v_add_f32 v75, v75, v99
  v_add_f32 v76, v76, v100
  v_add_f32 v77, v77, v101
  v_add_f32 v78, v78, v102
  v_add_f32 v79, v79, v103
  v_add_f32 v80, v80, v104
  v_add_f32 v81, v81, v105
  v_add_f32 v82, v82, v106
  v_add_f32 v83, v83, v107
  v_rcp_f32 v176, v68
  s_nop 0
  v_mov_b32 v177, v176
  s_nop 1
  v_permlane32_swap_b32 v176, v177
  v_mul_f32 v60, v60, v177
  v_mul_f32 v61, v61, v177
  v_mul_f32 v62, v62, v177
  v_mul_f32 v63, v63, v177
  v_mul_f32 v64, v64, v177
  v_mul_f32 v65, v65, v177
  v_mul_f32 v66, v66, v177
  v_mul_f32 v67, v67, v177
  v_mul_f32 v68, v68, v177
  v_mul_f32 v69, v69, v177
  v_mul_f32 v70, v70, v177
  v_mul_f32 v71, v71, v177
  v_cvt_pk_bf16_f32 v160, v60, v61
  v_cvt_pk_bf16_f32 v161, v62, v63
  v_cvt_pk_bf16_f32 v162, v64, v65
  v_cvt_pk_bf16_f32 v163, v66, v67
  v_cvt_pk_bf16_f32 v164, v68, v69
  v_cvt_pk_bf16_f32 v165, v70, v71
  v_permlane32_swap_b32 v160, v162
  v_permlane32_swap_b32 v161, v163
  v_rcp_f32 v178, v80
  s_nop 0
  v_mov_b32 v179, v178
  s_nop 1
  v_permlane32_swap_b32 v178, v179
  v_mul_f32 v72, v72, v179
  v_mul_f32 v73, v73, v179
  v_mul_f32 v74, v74, v179
  v_mul_f32 v75, v75, v179
  v_mul_f32 v76, v76, v179
  v_mul_f32 v77, v77, v179
  v_mul_f32 v78, v78, v179
  v_mul_f32 v79, v79, v179
  v_mul_f32 v80, v80, v179
  v_mul_f32 v81, v81, v179
  v_mul_f32 v82, v82, v179
  v_mul_f32 v83, v83, v179
  v_cvt_pk_bf16_f32 v168, v72, v73
  v_cvt_pk_bf16_f32 v169, v74, v75
  v_cvt_pk_bf16_f32 v170, v76, v77
  v_cvt_pk_bf16_f32 v171, v78, v79
  v_cvt_pk_bf16_f32 v172, v80, v81
  v_cvt_pk_bf16_f32 v173, v82, v83
  v_permlane32_swap_b32 v168, v170
  v_permlane32_swap_b32 v169, v171
  v_permlane32_swap_b32 v164, v172
  v_permlane32_swap_b32 v165, v173
  v_mov_b32 v166, 0
  v_mov_b32 v167, 0
  v_lshlrev_b32 v210, 8, v3
  v_add_u32 v211, v210, v208
  buffer_store_dwordx4 v[160:163], v211, s[8:11], s50 offen sc1
  v_add_u32 v211, v210, v209
  buffer_store_dwordx4 v[168:171], v211, s[8:11], s50 offen sc1
  v_cmp_eq_u32 vcc, 1, v3
  s_nop 1
  v_cndmask_b32 v211, v208, v209, vcc
  buffer_store_dwordx4 v[164:167], v211, s[8:11], s52 offen sc1
  s_lshl_b32 s43, s22, 2
  s_add_u32 s43, s43, s20
  s_lshl_b32 s43, s43, 12
  s_lshl_b32 s44, s21, 7
  s_add_u32 s43, s43, s44
  s_add_u32 s43, s43, 31719424
  v_and_b32 v8, 31, v0
  v_lshlrev_b32 v8, 2, v8
  v_mov_b32 v9, 1
  s_waitcnt vmcnt(0)
  s_mov_b32 exec_hi, 0
  buffer_store_dword v9, v8, s[8:11], s43 offen sc1
  s_mov_b64 exec, -1
l2_kernel_end1:
  s_endpgm
.section .rodata,"a"
.p2align 6
.amdhsa_kernel l2_kernel
  .amdhsa_next_free_vgpr 250
  .amdhsa_next_free_sgpr 102
  .amdhsa_accum_offset 252
  .amdhsa_group_segment_fixed_size 0
  .amdhsa_kernarg_size 88
  .amdhsa_user_sgpr_count 2
  .amdhsa_user_sgpr_kernarg_segment_ptr 1
  .amdhsa_system_sgpr_workgroup_id_x 1
.end_amdhsa_kernel
.text
TEXT_END:
  s_endpgm
```
